```python
import torch

def _softmax(x, axis=-1):
    return torch.softmax(x, dim=axis)

def _gelu(x):
    return torch.nn.functional.gelu(x, approximate='tanh')

def _silu(x):
    return torch.nn.functional.silu(x)

def _sigmoid(x):
    return torch.sigmoid(x)

def _layernorm(x, axis=-1, eps=1e-05):
    m = x.mean(dim=axis, keepdim=True)
    v = x.var(dim=axis, keepdim=True, unbiased=False)
    return (x - m) / torch.sqrt(v + eps)

def _scatter_add(tgt, idx, src, axis=0):
    return tgt.clone().index_add_(axis, idx, src)

def _segment_sum(src, seg, n):
    out = torch.zeros((n,) + src.shape[1:], dtype=src.dtype)
    return out.index_add_(0, seg, src)

def _pad(x, pw):
    flat = tuple((v for pair in reversed(pw) for v in pair))
    return torch.nn.functional.pad(x, flat)
kernel_name = 'interleave_layers__memory_aug_recurrent_mem_tr__glu_gated_swiglu__prompt'

def setup_inputs():

    _w = lambda a: (lambda t: t.to(torch.bfloat16) if t.is_floating_point() else t)(torch.as_tensor(a))

    def _A_setup():
        B, S, Dm = (1, 2048, 512)
        H, Dh = (32, 128)
        M, seg = (8, 32)
        seg = min(seg, S)
        S = S // seg * seg
        return {'x': _w((lambda *s: torch.randn(*s, dtype=torch.bfloat16) * 0.05)(B, S, Dm)), 'mem0': _w((lambda *s: torch.randn(*s, dtype=torch.bfloat16) * 0.2)(B, M, Dm)), 'Wq': _w((lambda *s: torch.randn(*s, dtype=torch.bfloat16) * 1.6)(Dm, H, Dh) * Dm ** (-0.5)), 'Wk': _w((lambda *s: torch.randn(*s, dtype=torch.bfloat16) * 1.6)(Dm, H, Dh) * Dm ** (-0.5)), 'Wv': _w((lambda *s: torch.randn(*s, dtype=torch.bfloat16) * 0.2)(Dm, H, Dh) * Dm ** (-0.5)), 'Wo': _w((lambda *s: torch.randn(*s, dtype=torch.bfloat16) * 0.2)(H, Dh, Dm) * (H * Dh) ** (-0.5)), 'seg_len': seg}
    _A_in = _A_setup()

    def _B_setup():
        B, S, D, F = (1, 2048, 512, 1792)
        return {'x': _w((lambda *s: torch.randn(*s, dtype=torch.bfloat16) * 0.05)(B, S, D)), 'w1': _w((lambda *s: torch.randn(*s, dtype=torch.bfloat16) * 0.2)(D, F) * (2.0 / D) ** 0.5), 'w3': _w((lambda *s: torch.randn(*s, dtype=torch.bfloat16) * 0.2)(D, F) * (2.0 / D) ** 0.5), 'w2': _w((lambda *s: torch.randn(*s, dtype=torch.bfloat16) * 0.2)(F, D) * (2.0 / F) ** 0.5)}
    _B_in = _B_setup()
    return {'A_x': _A_in['x'], 'A_mem0': _A_in['mem0'], 'A_Wq': _A_in['Wq'], 'A_Wk': _A_in['Wk'], 'A_Wv': _A_in['Wv'], 'A_Wo': _A_in['Wo'], 'A_seg_len': _A_in['seg_len'], 'B_x': _B_in['x'], 'B_w1': _B_in['w1'], 'B_w3': _B_in['w3'], 'B_w2': _B_in['w2']}

def reference(A_x, A_mem0, A_Wq, A_Wk, A_Wv, A_Wo, A_seg_len, B_x, B_w1, B_w3, B_w2):

    def _A_ref(x, mem0, Wq, Wk, Wv, Wo, seg_len):
        B, S, Dm = x.shape
        H, Dh = (Wq.shape[1], Wq.shape[2])
        M = mem0.shape[1]
        scale = Dh ** (-0.5)
        n_seg = S // seg_len
        L = M + seg_len
        idx = torch.arange(L)
        mask = (idx[:, None] < M) | (idx[:, None] >= idx[None, :])
        mem = mem0
        outs = []
        for s in range(n_seg):
            xs = x[:, s * seg_len:(s + 1) * seg_len, :].clone()
            h = torch.concatenate([mem, xs], axis=1)
            q = torch.einsum('btd,dhe->bhte', h, Wq)
            k = torch.einsum('btd,dhe->bhte', h, Wk)
            v = torch.einsum('btd,dhe->bhte', h, Wv)
            scores = torch.einsum('bhqe,bhke->bhqk', q, k) * scale
            scores = torch.where(mask[None, None], scores, -1000000000.0)
            p = _softmax(scores, axis=-1)
            o = torch.einsum('bhqk,bhke->bhqe', p, v)
            o = torch.einsum('bhte,hed->btd', o, Wo)
            mem = o[:, :M, :].clone()
            outs.append(o[:, M:, :])
        return torch.concatenate(outs, axis=1)

    def _B_ref(x, w1, w3, w2):
        gate = torch.einsum('bsd,df->bsf', x, w1)
        up = torch.einsum('bsd,df->bsf', x, w3)
        h = _silu(gate) * up
        out = torch.einsum('bsf,fd->bsd', h, w2)
        return out
    x = A_x
    x = x + _A_ref(_layernorm(x, axis=-1), A_mem0, A_Wq, A_Wk, A_Wv, A_Wo, A_seg_len)
    x = x + _B_ref(_layernorm(x, axis=-1), B_w1, B_w3, B_w2)
    x = x + _A_ref(_layernorm(x, axis=-1), A_mem0, A_Wq, A_Wk, A_Wv, A_Wo, A_seg_len)
    x = x + _B_ref(_layernorm(x, axis=-1), B_w1, B_w3, B_w2)
    return x
```

```asm
; @launch grid=(256,1,1) block=(256,1,1) lds=163840
.amdgcn_target "amdgcn-amd-amdhsa--gfx950"
.text
.globl interleave_layers__memory_aug_recurrent_mem_tr__glu_gated_swiglu__prompt_kernel
.p2align 8
.type interleave_layers__memory_aug_recurrent_mem_tr__glu_gated_swiglu__prompt_kernel,@function
interleave_layers__memory_aug_recurrent_mem_tr__glu_gated_swiglu__prompt_kernel:
s_cmp_ge_u32 s2, 256
s_cbranch_scc1 L_end0
s_load_dwordx16 s[48:63], s[0:1], 0
s_load_dwordx8 s[64:71], s[0:1], 64
s_load_dwordx4 s[72:75], s[0:1], 96
s_getreg_b32 s33, hwreg(HW_REG_XCC_ID, 0, 4)
v_lshrrev_b32 v3, 6, v0
v_and_b32 v1, 63, v0
v_readfirstlane_b32 s32, v3
v_lshlrev_b32 v2, 4, v1
s_and_b32 s33, s33, 7
s_mov_b32 s36, 0x100000
s_mov_b32 s46, 0x05040100
s_mov_b32 s47, 0x07060302
s_waitcnt lgkmcnt(0)
s_mov_b32 s4, s74
s_mov_b32 s5, s75
s_mov_b32 s6, 268435456
s_mov_b32 s7, 0x20000
s_mov_b32 s8, s72
s_mov_b32 s9, s73
s_mov_b32 s10, 256
s_mov_b32 s11, 0x20000
s_cmp_lg_u32 s32, 0
s_cbranch_scc1 L_noatom
v_mov_b32 v4, 1
s_lshl_b32 s43, s33, 5
v_mov_b32 v5, s43
s_mov_b64 exec, 1
buffer_atomic_add v4, v5, s[8:11], 0 offen sc0
s_mov_b64 exec, -1
L_noatom:
s_mov_b32 s12, s48
s_mov_b32 s13, s49
s_mov_b32 s14, 2097152
s_mov_b32 s15, 0x20000
s_lshl_b32 s40, s2, 2
s_add_u32 s40, s40, s32
s_lshl_b32 s41, s40, 10
s_add_u32 s42, s41, 0
buffer_load_dwordx4 v[32:35], v2, s[12:15], s42 offen
s_add_u32 s42, s41, 1048576
buffer_load_dwordx4 v[36:39], v2, s[12:15], s42 offen
v_mov_b32 v48, 0
v_mov_b32 v49, 0
v_lshlrev_b32 v56, 3, v1
s_lshl_b32 s42, s40, 9
buffer_store_dwordx2 v[48:49], v56, s[4:7], s42 offen sc1
s_add_u32 s41, s41, 10485760
s_bfe_u32 s40, s40, 0x40001
v_xor_b32 v59, s40, v1
v_lshlrev_b32 v59, 4, v59
s_waitcnt vmcnt(2)
v_lshlrev_b32 v48, 16, v32
v_and_b32 v49, 0xffff0000, v32
v_lshlrev_b32 v50, 16, v33
v_and_b32 v51, 0xffff0000, v33
v_lshlrev_b32 v52, 16, v34
v_and_b32 v53, 0xffff0000, v34
v_lshlrev_b32 v54, 16, v35
v_and_b32 v55, 0xffff0000, v35
v_add_f32 v56, v48, v49
v_add_f32 v56, v56, v50
v_add_f32 v56, v56, v51
v_add_f32 v56, v56, v52
v_add_f32 v56, v56, v53
v_add_f32 v56, v56, v54
v_add_f32 v56, v56, v55
s_nop 1
v_add_f32_dpp v56, v56, v56 row_ror:8 row_mask:0xf bank_mask:0xf
s_nop 1
v_add_f32_dpp v56, v56, v56 row_ror:4 row_mask:0xf bank_mask:0xf
s_nop 1
v_add_f32_dpp v56, v56, v56 row_ror:2 row_mask:0xf bank_mask:0xf
s_nop 1
v_add_f32_dpp v56, v56, v56 row_ror:1 row_mask:0xf bank_mask:0xf
v_mov_b32 v57, v56
s_nop 1
v_permlane16_swap_b32 v56, v57
v_add_f32 v56, v56, v57
v_mov_b32 v57, v56
s_nop 1
v_permlane32_swap_b32 v56, v57
v_add_f32 v56, v56, v57
v_mul_f32 v56, 0x3b000000, v56
v_sub_f32 v48, v48, v56
v_sub_f32 v49, v49, v56
v_sub_f32 v50, v50, v56
v_sub_f32 v51, v51, v56
v_sub_f32 v52, v52, v56
v_sub_f32 v53, v53, v56
v_sub_f32 v54, v54, v56
v_sub_f32 v55, v55, v56
v_mul_f32 v58, v48, v48
v_fmac_f32 v58, v49, v49
v_fmac_f32 v58, v50, v50
v_fmac_f32 v58, v51, v51
v_fmac_f32 v58, v52, v52
v_fmac_f32 v58, v53, v53
v_fmac_f32 v58, v54, v54
v_fmac_f32 v58, v55, v55
s_nop 1
v_add_f32_dpp v58, v58, v58 row_ror:8 row_mask:0xf bank_mask:0xf
s_nop 1
v_add_f32_dpp v58, v58, v58 row_ror:4 row_mask:0xf bank_mask:0xf
s_nop 1
v_add_f32_dpp v58, v58, v58 row_ror:2 row_mask:0xf bank_mask:0xf
s_nop 1
v_add_f32_dpp v58, v58, v58 row_ror:1 row_mask:0xf bank_mask:0xf
v_mov_b32 v57, v58
s_nop 1
v_permlane16_swap_b32 v58, v57
v_add_f32 v58, v58, v57
v_mov_b32 v57, v58
s_nop 1
v_permlane32_swap_b32 v58, v57
v_add_f32 v58, v58, v57
v_mov_b32 v57, 0x3727c5ac
v_fmac_f32 v57, 0x3b000000, v58
v_rsq_f32 v57, v57
s_nop 0
v_mul_f32 v48, v48, v57
v_mul_f32 v49, v49, v57
v_mul_f32 v50, v50, v57
v_mul_f32 v51, v51, v57
v_mul_f32 v52, v52, v57
v_mul_f32 v53, v53, v57
v_mul_f32 v54, v54, v57
v_mul_f32 v55, v55, v57
v_cvt_pk_bf16_f32 v32, v48, v49
v_cvt_pk_bf16_f32 v33, v50, v51
v_cvt_pk_bf16_f32 v34, v52, v53
v_cvt_pk_bf16_f32 v35, v54, v55
buffer_store_dwordx4 v[32:35], v59, s[4:7], s41 offen sc1
s_add_u32 s41, s41, 1048576
s_waitcnt vmcnt(2)
v_lshlrev_b32 v48, 16, v36
v_and_b32 v49, 0xffff0000, v36
v_lshlrev_b32 v50, 16, v37
v_and_b32 v51, 0xffff0000, v37
v_lshlrev_b32 v52, 16, v38
v_and_b32 v53, 0xffff0000, v38
v_lshlrev_b32 v54, 16, v39
v_and_b32 v55, 0xffff0000, v39
v_add_f32 v56, v48, v49
v_add_f32 v56, v56, v50
v_add_f32 v56, v56, v51
v_add_f32 v56, v56, v52
v_add_f32 v56, v56, v53
v_add_f32 v56, v56, v54
v_add_f32 v56, v56, v55
s_nop 1
v_add_f32_dpp v56, v56, v56 row_ror:8 row_mask:0xf bank_mask:0xf
s_nop 1
v_add_f32_dpp v56, v56, v56 row_ror:4 row_mask:0xf bank_mask:0xf
s_nop 1
v_add_f32_dpp v56, v56, v56 row_ror:2 row_mask:0xf bank_mask:0xf
s_nop 1
v_add_f32_dpp v56, v56, v56 row_ror:1 row_mask:0xf bank_mask:0xf
v_mov_b32 v57, v56
s_nop 1
v_permlane16_swap_b32 v56, v57
v_add_f32 v56, v56, v57
v_mov_b32 v57, v56
s_nop 1
v_permlane32_swap_b32 v56, v57
v_add_f32 v56, v56, v57
v_mul_f32 v56, 0x3b000000, v56
v_sub_f32 v48, v48, v56
v_sub_f32 v49, v49, v56
v_sub_f32 v50, v50, v56
v_sub_f32 v51, v51, v56
v_sub_f32 v52, v52, v56
v_sub_f32 v53, v53, v56
v_sub_f32 v54, v54, v56
v_sub_f32 v55, v55, v56
v_mul_f32 v58, v48, v48
v_fmac_f32 v58, v49, v49
v_fmac_f32 v58, v50, v50
v_fmac_f32 v58, v51, v51
v_fmac_f32 v58, v52, v52
v_fmac_f32 v58, v53, v53
v_fmac_f32 v58, v54, v54
v_fmac_f32 v58, v55, v55
s_nop 1
v_add_f32_dpp v58, v58, v58 row_ror:8 row_mask:0xf bank_mask:0xf
s_nop 1
v_add_f32_dpp v58, v58, v58 row_ror:4 row_mask:0xf bank_mask:0xf
s_nop 1
v_add_f32_dpp v58, v58, v58 row_ror:2 row_mask:0xf bank_mask:0xf
s_nop 1
v_add_f32_dpp v58, v58, v58 row_ror:1 row_mask:0xf bank_mask:0xf
v_mov_b32 v57, v58
s_nop 1
v_permlane16_swap_b32 v58, v57
v_add_f32 v58, v58, v57
v_mov_b32 v57, v58
s_nop 1
v_permlane32_swap_b32 v58, v57
v_add_f32 v58, v58, v57
v_mov_b32 v57, 0x3727c5ac
v_fmac_f32 v57, 0x3b000000, v58
v_rsq_f32 v57, v57
s_nop 0
v_mul_f32 v48, v48, v57
v_mul_f32 v49, v49, v57
v_mul_f32 v50, v50, v57
v_mul_f32 v51, v51, v57
v_mul_f32 v52, v52, v57
v_mul_f32 v53, v53, v57
v_mul_f32 v54, v54, v57
v_mul_f32 v55, v55, v57
v_cvt_pk_bf16_f32 v36, v48, v49
v_cvt_pk_bf16_f32 v37, v50, v51
v_cvt_pk_bf16_f32 v38, v52, v53
v_cvt_pk_bf16_f32 v39, v54, v55
buffer_store_dwordx4 v[36:39], v59, s[4:7], s41 offen sc1
s_add_u32 s41, s41, 1048576
s_cmp_lg_u32 s32, 0
s_cbranch_scc1 L_norank
v_mov_b32 v5, 0
s_mov_b64 exec, 1
ds_write_b32 v5, v4
s_mov_b64 exec, -1
s_waitcnt lgkmcnt(0)
L_norank:
s_barrier
v_mov_b32 v5, 0
ds_read_b32 v4, v5
s_waitcnt lgkmcnt(0)
v_readfirstlane_b32 s34, v4
s_mov_b32 s35, s33
s_barrier
s_cmp_ge_u32 s34, 32
s_cbranch_scc1 L_wait_fallback
s_lshl_b32 s40, s35, 1
s_lshr_b32 s41, s34, 4
s_add_u32 s40, s40, s41
s_lshl_b32 s40, s40, 2
s_mov_b32 s42, 3850646032
s_mov_b32 s43, 3687511958
s_lshr_b64 s[42:43], s[42:43], s40
s_bfe_u32 s35, s42, 0x30001
s_and_b32 s42, s42, 1
s_lshl_b32 s42, s42, 4
s_and_b32 s34, s34, 15
s_or_b32 s34, s34, s42
s_cmp_le_u32 s35, 1
s_cbranch_scc1 L_go_chain_L
s_cmp_le_u32 s35, 3
s_cbranch_scc1 L_go_qkv_L
s_bitcmp1_b32 s35, 0
s_cbranch_scc1 L_go_ffn_L
s_getpc_b64 s[40:41]
L_pc_att_L:
s_add_u32 s40, s40, R_att_L-L_pc_att_L
s_addc_u32 s41, s41, 0
s_setpc_b64 s[40:41]
L_go_chain_L:
s_getpc_b64 s[40:41]
L_pc_chain_L:
s_add_u32 s40, s40, R_chain_L-L_pc_chain_L
s_addc_u32 s41, s41, 0
s_setpc_b64 s[40:41]
L_go_qkv_L:
s_getpc_b64 s[40:41]
L_pc_qkv_L:
s_add_u32 s40, s40, R_qkv_L-L_pc_qkv_L
s_addc_u32 s41, s41, 0
s_setpc_b64 s[40:41]
L_go_ffn_L:
s_getpc_b64 s[40:41]
L_pc_ffn_L:
s_add_u32 s40, s40, R_ffn_L-L_pc_ffn_L
s_addc_u32 s41, s41, 0
s_setpc_b64 s[40:41]
L_wait_fallback:
s_waitcnt vmcnt(0)
s_barrier
s_cmp_lg_u32 s32, 0
s_cbranch_scc1 L_da_1
v_mov_b32 v4, 1
s_lshl_b32 s40, s33, 5
v_mov_b32 v5, s40
s_mov_b64 exec, 1
buffer_atomic_add v4, v5, s[8:11], 0 offen offset:4
s_mov_b64 exec, -1
L_da_1:
v_lshlrev_b32 v6, 5, v1
buffer_load_dwordx2 v[4:5], v6, s[8:11], 0 offen sc1
s_waitcnt vmcnt(0)
L_cen_2:
s_mov_b32 s40, 0
v_readlane_b32 s41, v5, 0
s_nop 0
s_add_u32 s40, s40, s41
v_readlane_b32 s41, v5, 1
s_nop 0
s_add_u32 s40, s40, s41
v_readlane_b32 s41, v5, 2
s_nop 0
s_add_u32 s40, s40, s41
v_readlane_b32 s41, v5, 3
s_nop 0
s_add_u32 s40, s40, s41
v_readlane_b32 s41, v5, 4
s_nop 0
s_add_u32 s40, s40, s41
v_readlane_b32 s41, v5, 5
s_nop 0
s_add_u32 s40, s40, s41
v_readlane_b32 s41, v5, 6
s_nop 0
s_add_u32 s40, s40, s41
v_readlane_b32 s41, v5, 7
s_nop 0
s_add_u32 s40, s40, s41
s_cmp_eq_u32 s40, 256
s_cbranch_scc1 L_cenok_3
s_sub_u32 s36, s36, 1
s_cbranch_scc1 L_end0
s_sleep 4
buffer_load_dwordx2 v[4:5], v6, s[8:11], 0 offen sc1
s_waitcnt vmcnt(0)
s_branch L_cen_2
L_cenok_3:
L_fallback:
s_waitcnt vmcnt(0) lgkmcnt(0)
s_barrier
s_lshr_b32 s35, s2, 5
s_and_b32 s34, s2, 31
s_lshl_b32 s40, s35, 1
s_lshr_b32 s41, s34, 4
s_add_u32 s40, s40, s41
s_lshl_b32 s40, s40, 2
s_mov_b32 s42, 3850646032
s_mov_b32 s43, 3687511958
s_lshr_b64 s[42:43], s[42:43], s40
s_bfe_u32 s35, s42, 0x30001
s_and_b32 s42, s42, 1
s_lshl_b32 s42, s42, 4
s_and_b32 s34, s34, 15
s_or_b32 s34, s34, s42
s_cmp_le_u32 s35, 1
s_cbranch_scc1 L_go_chain_G
s_cmp_le_u32 s35, 3
s_cbranch_scc1 L_go_qkv_G
s_bitcmp1_b32 s35, 0
s_cbranch_scc1 L_go_ffn_G
s_getpc_b64 s[40:41]
L_pc_att_G:
s_add_u32 s40, s40, R_att_G-L_pc_att_G
s_addc_u32 s41, s41, 0
s_setpc_b64 s[40:41]
L_go_chain_G:
s_getpc_b64 s[40:41]
L_pc_chain_G:
s_add_u32 s40, s40, R_chain_G-L_pc_chain_G
s_addc_u32 s41, s41, 0
s_setpc_b64 s[40:41]
L_go_qkv_G:
s_getpc_b64 s[40:41]
L_pc_qkv_G:
s_add_u32 s40, s40, R_qkv_G-L_pc_qkv_G
s_addc_u32 s41, s41, 0
s_setpc_b64 s[40:41]
L_go_ffn_G:
s_getpc_b64 s[40:41]
L_pc_ffn_G:
s_add_u32 s40, s40, R_ffn_G-L_pc_ffn_G
s_addc_u32 s41, s41, 0
s_setpc_b64 s[40:41]
L_end0:
s_endpgm
.p2align 6
R_chain_L:
s_mov_b32 s12, s52
s_mov_b32 s13, s53
s_mov_b32 s14, 4194304
s_mov_b32 s15, 0x20000
s_mov_b32 s16, s54
s_mov_b32 s17, s55
s_mov_b32 s18, 4194304
s_mov_b32 s19, 0x20000
s_mov_b32 s20, s56
s_mov_b32 s21, s57
s_mov_b32 s22, 4194304
s_mov_b32 s23, 0x20000
s_mov_b32 s24, s58
s_mov_b32 s25, s59
s_mov_b32 s26, 4194304
s_mov_b32 s27, 0x20000
v_and_b32 v90, 15, v1
v_lshrrev_b32 v91, 4, v1
v_lshrrev_b32 v94, 1, v91
v_and_b32 v95, 1, v91
v_lshlrev_b32 v95, 2, v95
v_lshl_add_u32 v95, v94, 4, v95
s_lshl_b32 s40, s34, 8
s_lshl_b32 s41, s32, 6
s_add_u32 s88, s40, s41
s_lshl_b32 s40, s34, 17
s_lshl_b32 s41, s32, 8
s_add_u32 s40, s40, s41
v_lshlrev_b32 v92, 4, v90
v_lshl_add_u32 v93, v95, 10, v92
v_add_u32 v88, s40, v93
v_add_u32 v89, 8192, v88
s_lshl_b32 s86, s32, 15
s_lshl_b32 s87, s32, 13
s_add_u32 s87, s87, 131072
v_add_u32 v3, s86, v2
v_lshlrev_b32 v95, 3, v91
v_lshrrev_b32 v84, 2, v1
v_mul_u32_u24 v84, 8192, v84
v_and_b32 v80, 3, v1
v_lshl_add_u32 v80, v80, 4, v84
v_add_u32 v81, 130048, v80
v_and_b32 v84, 15, v1
v_lshlrev_b32 v84, 2, v84
v_lshl_add_u32 v82, v95, 6, v84
v_add_u32 v83, s87, v82
v_add_u32 v82, s86, v82
s_lshl_b32 s42, s35, 19
s_add_u32 s76, s42, 1048576
s_and_b32 s43, s32, 1
s_lshl_b32 s40, s43, 17
s_lshl_b32 s41, s34, 12
s_add_u32 s40, s40, s41
s_add_u32 s77, s40, s76
s_lshl_b32 s42, s35, 14
s_add_u32 s42, s42, 532480
s_lshl_b32 s40, s32, 11
s_add_u32 s78, s40, s42
s_and_b32 s40, s34, 0
s_mul_i32 s40, s40, 32768
s_add_u32 s78, s78, s40
s_lshr_b32 s40, s34, 3
s_lshl_b32 s40, s40, 11
s_lshl_b32 s41, s43, 9
s_add_u32 s40, s40, s41
s_and_b32 s41, s34, 1
s_lshl_b32 s41, s41, 10
s_add_u32 s40, s40, s41
s_bfe_u32 s41, s34, 0x20001
s_lshl_b32 s41, s41, 7
s_add_u32 s40, s40, s41
s_add_u32 s79, s40, s42
v_bfe_u32 v93, v90, 1, 2
v_lshlrev_b32 v93, 5, v93
v_and_b32 v95, 1, v91
v_lshl_add_u32 v93, v95, 4, v93
v_and_b32 v95, 1, v90
v_lshl_add_u32 v93, v95, 3, v93
v_lshl_add_u32 v11, v94, 2, v93
v_and_b32 v93, 7, v90
v_lshlrev_b32 v93, 4, v93
s_waitcnt vmcnt(0)
s_barrier
s_cmp_lg_u32 s32, 0
s_cbranch_scc1 L_da_5
v_mov_b32 v96, 1
s_lshl_b32 s40, s33, 5
v_mov_b32 v97, s40
s_mov_b64 exec, 1
buffer_atomic_add v96, v97, s[8:11], 0 offen offset:4
s_mov_b64 exec, -1
L_da_5:
s_cmp_eq_u32 s35, 0
s_cbranch_scc1 L_go_4
s_add_u32 s40, s34, 128
s_lshl_b32 s40, s40, 2
s_add_u32 s40, s40, s32
s_mul_i32 s40, s40, 7168
s_mov_b32 s12, s54
s_mov_b32 s13, s55
s_mov_b32 s14, 4194304
s_mov_b32 s15, 0x20000
s_add_u32 s41, s40, 0
buffer_load_dwordx4 v[104:107], v2, s[12:15], s41 offen offset:0
buffer_load_dwordx4 v[104:107], v2, s[12:15], s41 offen offset:1024
buffer_load_dwordx4 v[104:107], v2, s[12:15], s41 offen offset:2048
buffer_load_dwordx4 v[104:107], v2, s[12:15], s41 offen offset:3072
s_add_u32 s41, s40, 4096
buffer_load_dwordx4 v[104:107], v2, s[12:15], s41 offen offset:0
buffer_load_dwordx4 v[104:107], v2, s[12:15], s41 offen offset:1024
buffer_load_dwordx4 v[104:107], v2, s[12:15], s41 offen offset:2048
s_mov_b32 s12, s56
s_mov_b32 s13, s57
s_mov_b32 s14, 4194304
s_mov_b32 s15, 0x20000
s_add_u32 s41, s40, 0
buffer_load_dwordx4 v[104:107], v2, s[12:15], s41 offen offset:0
buffer_load_dwordx4 v[104:107], v2, s[12:15], s41 offen offset:1024
buffer_load_dwordx4 v[104:107], v2, s[12:15], s41 offen offset:2048
buffer_load_dwordx4 v[104:107], v2, s[12:15], s41 offen offset:3072
s_add_u32 s41, s40, 4096
buffer_load_dwordx4 v[104:107], v2, s[12:15], s41 offen offset:0
buffer_load_dwordx4 v[104:107], v2, s[12:15], s41 offen offset:1024
buffer_load_dwordx4 v[104:107], v2, s[12:15], s41 offen offset:2048
s_mov_b32 s12, s52
s_mov_b32 s13, s53
s_mov_b32 s14, 4194304
s_mov_b32 s15, 0x20000
s_add_u32 s41, s40, 0
buffer_load_dwordx4 v[104:107], v2, s[12:15], s41 offen offset:0
buffer_load_dwordx4 v[104:107], v2, s[12:15], s41 offen offset:1024
buffer_load_dwordx4 v[104:107], v2, s[12:15], s41 offen offset:2048
buffer_load_dwordx4 v[104:107], v2, s[12:15], s41 offen offset:3072
s_add_u32 s41, s40, 4096
buffer_load_dwordx4 v[104:107], v2, s[12:15], s41 offen offset:0
buffer_load_dwordx4 v[104:107], v2, s[12:15], s41 offen offset:1024
buffer_load_dwordx4 v[104:107], v2, s[12:15], s41 offen offset:2048
s_mov_b32 s12, s58
s_mov_b32 s13, s59
s_mov_b32 s14, 4194304
s_mov_b32 s15, 0x20000
s_add_u32 s41, s40, 0
buffer_load_dwordx4 v[104:107], v2, s[12:15], s41 offen offset:0
buffer_load_dwordx4 v[104:107], v2, s[12:15], s41 offen offset:1024
buffer_load_dwordx4 v[104:107], v2, s[12:15], s41 offen offset:2048
buffer_load_dwordx4 v[104:107], v2, s[12:15], s41 offen offset:3072
s_add_u32 s41, s40, 4096
buffer_load_dwordx4 v[104:107], v2, s[12:15], s41 offen offset:0
buffer_load_dwordx4 v[104:107], v2, s[12:15], s41 offen offset:1024
buffer_load_dwordx4 v[104:107], v2, s[12:15], s41 offen offset:2048
s_mov_b32 s12, s52
s_mov_b32 s13, s53
s_mov_b32 s14, 4194304
s_mov_b32 s15, 0x20000
v_lshlrev_b32 v98, 5, v1
buffer_load_dwordx2 v[96:97], v98, s[8:11], 0 offen sc1
s_waitcnt vmcnt(0)
L_cen_6:
s_mov_b32 s40, 0
v_readlane_b32 s41, v97, 0
s_nop 0
s_add_u32 s40, s40, s41
v_readlane_b32 s41, v97, 1
s_nop 0
s_add_u32 s40, s40, s41
v_readlane_b32 s41, v97, 2
s_nop 0
s_add_u32 s40, s40, s41
v_readlane_b32 s41, v97, 3
s_nop 0
s_add_u32 s40, s40, s41
v_readlane_b32 s41, v97, 4
s_nop 0
s_add_u32 s40, s40, s41
v_readlane_b32 s41, v97, 5
s_nop 0
s_add_u32 s40, s40, s41
v_readlane_b32 s41, v97, 6
s_nop 0
s_add_u32 s40, s40, s41
v_readlane_b32 s41, v97, 7
s_nop 0
s_add_u32 s40, s40, s41
s_cmp_eq_u32 s40, 256
s_cbranch_scc1 L_cenok_7
s_sub_u32 s36, s36, 1
s_cbranch_scc1 L_end_chain_L
s_sleep 4
buffer_load_dwordx2 v[96:97], v98, s[8:11], 0 offen sc1
s_waitcnt vmcnt(0)
s_branch L_cen_6
L_cenok_7:
v_cmp_ne_u32 vcc, 32, v96
s_nop 0
s_and_b32 s40, vcc_lo, 0xff
s_cbranch_scc1 L_fb_chain
s_mul_i32 s40, s35, 0
s_add_u32 s40, s40, 0
v_mov_b32 v97, s40
L_rw_8:
buffer_load_dword v96, v97, s[8:11], 0 offen offset:8 sc1
s_waitcnt vmcnt(0)
v_cmp_ne_u32 vcc, 32, v96
s_cbranch_vccz L_rwo_9
s_sub_u32 s36, s36, 1
s_cbranch_scc1 L_end_chain_L
s_sleep 2
s_branch L_rw_8
L_rwo_9:
L_go_4:
s_add_u32 s45, s88, 0
s_add_u32 m0, s86, 16384
s_nop 0
buffer_load_dwordx4 v80, s[16:19], s45 offen offset:0 lds
buffer_load_dwordx4 v81, s[16:19], s45 offen offset:1024 lds
s_add_u32 s45, s88, 262144
s_add_u32 m0, s86, 18432
s_nop 0
buffer_load_dwordx4 v80, s[16:19], s45 offen offset:0 lds
buffer_load_dwordx4 v81, s[16:19], s45 offen offset:1024 lds
s_add_u32 s45, s88, 524288
s_add_u32 m0, s86, 20480
s_nop 0
buffer_load_dwordx4 v80, s[16:19], s45 offen offset:0 lds
buffer_load_dwordx4 v81, s[16:19], s45 offen offset:1024 lds
s_add_u32 s45, s88, 786432
s_add_u32 m0, s86, 22528
s_nop 0
buffer_load_dwordx4 v80, s[16:19], s45 offen offset:0 lds
buffer_load_dwordx4 v81, s[16:19], s45 offen offset:1024 lds
s_add_u32 s45, s88, 1048576
s_add_u32 m0, s86, 24576
s_nop 0
buffer_load_dwordx4 v80, s[16:19], s45 offen offset:0 lds
buffer_load_dwordx4 v81, s[16:19], s45 offen offset:1024 lds
s_add_u32 s45, s88, 1310720
s_add_u32 m0, s86, 26624
s_nop 0
buffer_load_dwordx4 v80, s[16:19], s45 offen offset:0 lds
buffer_load_dwordx4 v81, s[16:19], s45 offen offset:1024 lds
s_add_u32 s45, s88, 1572864
s_add_u32 m0, s86, 28672
s_nop 0
buffer_load_dwordx4 v80, s[16:19], s45 offen offset:0 lds
buffer_load_dwordx4 v81, s[16:19], s45 offen offset:1024 lds
s_add_u32 s45, s88, 1835008
s_add_u32 m0, s86, 30720
s_nop 0
buffer_load_dwordx4 v80, s[16:19], s45 offen offset:0 lds
buffer_load_dwordx4 v81, s[16:19], s45 offen offset:1024 lds
s_add_u32 s45, s88, 2097152
s_add_u32 m0, s87, 0
s_nop 0
buffer_load_dwordx4 v80, s[16:19], s45 offen offset:0 lds
buffer_load_dwordx4 v81, s[16:19], s45 offen offset:1024 lds
s_add_u32 s45, s88, 2359296
s_add_u32 m0, s87, 2048
s_nop 0
buffer_load_dwordx4 v80, s[16:19], s45 offen offset:0 lds
buffer_load_dwordx4 v81, s[16:19], s45 offen offset:1024 lds
s_add_u32 s45, s88, 2621440
s_add_u32 m0, s87, 4096
s_nop 0
buffer_load_dwordx4 v80, s[16:19], s45 offen offset:0 lds
buffer_load_dwordx4 v81, s[16:19], s45 offen offset:1024 lds
s_add_u32 s45, s88, 2883584
s_add_u32 m0, s87, 6144
s_nop 0
buffer_load_dwordx4 v80, s[16:19], s45 offen offset:0 lds
buffer_load_dwordx4 v81, s[16:19], s45 offen offset:1024 lds
s_waitcnt vmcnt(22)
ds_read_b32 v112, v82 offset:16384
ds_read_b32 v113, v82 offset:16448
ds_read_b32 v114, v82 offset:16640
ds_read_b32 v115, v82 offset:16704
ds_read_b32 v116, v82 offset:16512
ds_read_b32 v117, v82 offset:16576
ds_read_b32 v118, v82 offset:16768
ds_read_b32 v119, v82 offset:16832
s_waitcnt lgkmcnt(6)
v_perm_b32 v104, v113, v112, s46
v_perm_b32 v108, v113, v112, s47
s_waitcnt lgkmcnt(4)
v_perm_b32 v105, v115, v114, s46
v_perm_b32 v109, v115, v114, s47
s_waitcnt lgkmcnt(2)
v_perm_b32 v106, v117, v116, s46
v_perm_b32 v110, v117, v116, s47
s_waitcnt lgkmcnt(0)
v_perm_b32 v107, v119, v118, s46
v_perm_b32 v111, v119, v118, s47
s_add_u32 s45, s88, 3145728
s_add_u32 m0, s86, 16384
s_nop 0
buffer_load_dwordx4 v80, s[16:19], s45 offen offset:0 lds
buffer_load_dwordx4 v81, s[16:19], s45 offen offset:1024 lds
v_accvgpr_write_b32 a0, v104
v_accvgpr_write_b32 a1, v105
v_accvgpr_write_b32 a2, v106
v_accvgpr_write_b32 a3, v107
v_accvgpr_write_b32 a8, v108
v_accvgpr_write_b32 a9, v109
v_accvgpr_write_b32 a10, v110
v_accvgpr_write_b32 a11, v111
s_waitcnt vmcnt(22)
ds_read_b32 v112, v82 offset:18432
ds_read_b32 v113, v82 offset:18496
ds_read_b32 v114, v82 offset:18688
ds_read_b32 v115, v82 offset:18752
ds_read_b32 v116, v82 offset:18560
ds_read_b32 v117, v82 offset:18624
ds_read_b32 v118, v82 offset:18816
ds_read_b32 v119, v82 offset:18880
s_waitcnt lgkmcnt(6)
v_perm_b32 v104, v113, v112, s46
v_perm_b32 v108, v113, v112, s47
s_waitcnt lgkmcnt(4)
v_perm_b32 v105, v115, v114, s46
v_perm_b32 v109, v115, v114, s47
s_waitcnt lgkmcnt(2)
v_perm_b32 v106, v117, v116, s46
v_perm_b32 v110, v117, v116, s47
s_waitcnt lgkmcnt(0)
v_perm_b32 v107, v119, v118, s46
v_perm_b32 v111, v119, v118, s47
s_add_u32 s45, s88, 3407872
s_add_u32 m0, s86, 18432
s_nop 0
buffer_load_dwordx4 v80, s[16:19], s45 offen offset:0 lds
buffer_load_dwordx4 v81, s[16:19], s45 offen offset:1024 lds
v_accvgpr_write_b32 a4, v104
v_accvgpr_write_b32 a5, v105
v_accvgpr_write_b32 a6, v106
v_accvgpr_write_b32 a7, v107
v_accvgpr_write_b32 a12, v108
v_accvgpr_write_b32 a13, v109
v_accvgpr_write_b32 a14, v110
v_accvgpr_write_b32 a15, v111
s_waitcnt vmcnt(22)
ds_read_b32 v112, v82 offset:20480
ds_read_b32 v113, v82 offset:20544
ds_read_b32 v114, v82 offset:20736
ds_read_b32 v115, v82 offset:20800
ds_read_b32 v116, v82 offset:20608
ds_read_b32 v117, v82 offset:20672
ds_read_b32 v118, v82 offset:20864
ds_read_b32 v119, v82 offset:20928
s_waitcnt lgkmcnt(6)
v_perm_b32 v104, v113, v112, s46
v_perm_b32 v108, v113, v112, s47
s_waitcnt lgkmcnt(4)
v_perm_b32 v105, v115, v114, s46
v_perm_b32 v109, v115, v114, s47
s_waitcnt lgkmcnt(2)
v_perm_b32 v106, v117, v116, s46
v_perm_b32 v110, v117, v116, s47
s_waitcnt lgkmcnt(0)
v_perm_b32 v107, v119, v118, s46
v_perm_b32 v111, v119, v118, s47
s_add_u32 s45, s88, 3670016
s_add_u32 m0, s86, 20480
s_nop 0
buffer_load_dwordx4 v80, s[16:19], s45 offen offset:0 lds
buffer_load_dwordx4 v81, s[16:19], s45 offen offset:1024 lds
v_accvgpr_write_b32 a16, v104
v_accvgpr_write_b32 a17, v105
v_accvgpr_write_b32 a18, v106
v_accvgpr_write_b32 a19, v107
v_accvgpr_write_b32 a24, v108
v_accvgpr_write_b32 a25, v109
v_accvgpr_write_b32 a26, v110
v_accvgpr_write_b32 a27, v111
s_waitcnt vmcnt(22)
ds_read_b32 v112, v82 offset:22528
ds_read_b32 v113, v82 offset:22592
ds_read_b32 v114, v82 offset:22784
ds_read_b32 v115, v82 offset:22848
ds_read_b32 v116, v82 offset:22656
ds_read_b32 v117, v82 offset:22720
ds_read_b32 v118, v82 offset:22912
ds_read_b32 v119, v82 offset:22976
s_waitcnt lgkmcnt(6)
v_perm_b32 v104, v113, v112, s46
v_perm_b32 v108, v113, v112, s47
s_waitcnt lgkmcnt(4)
v_perm_b32 v105, v115, v114, s46
v_perm_b32 v109, v115, v114, s47
s_waitcnt lgkmcnt(2)
v_perm_b32 v106, v117, v116, s46
v_perm_b32 v110, v117, v116, s47
s_waitcnt lgkmcnt(0)
v_perm_b32 v107, v119, v118, s46
v_perm_b32 v111, v119, v118, s47
s_add_u32 s45, s88, 3932160
s_add_u32 m0, s86, 22528
s_nop 0
buffer_load_dwordx4 v80, s[16:19], s45 offen offset:0 lds
buffer_load_dwordx4 v81, s[16:19], s45 offen offset:1024 lds
v_accvgpr_write_b32 a20, v104
v_accvgpr_write_b32 a21, v105
v_accvgpr_write_b32 a22, v106
v_accvgpr_write_b32 a23, v107
v_accvgpr_write_b32 a28, v108
v_accvgpr_write_b32 a29, v109
v_accvgpr_write_b32 a30, v110
v_accvgpr_write_b32 a31, v111
s_waitcnt vmcnt(22)
ds_read_b32 v112, v82 offset:24576
ds_read_b32 v113, v82 offset:24640
ds_read_b32 v114, v82 offset:24832
ds_read_b32 v115, v82 offset:24896
ds_read_b32 v116, v82 offset:24704
ds_read_b32 v117, v82 offset:24768
ds_read_b32 v118, v82 offset:24960
ds_read_b32 v119, v82 offset:25024
s_waitcnt lgkmcnt(6)
v_perm_b32 v104, v113, v112, s46
v_perm_b32 v108, v113, v112, s47
s_waitcnt lgkmcnt(4)
v_perm_b32 v105, v115, v114, s46
v_perm_b32 v109, v115, v114, s47
s_waitcnt lgkmcnt(2)
v_perm_b32 v106, v117, v116, s46
v_perm_b32 v110, v117, v116, s47
s_waitcnt lgkmcnt(0)
v_perm_b32 v107, v119, v118, s46
v_perm_b32 v111, v119, v118, s47
s_add_u32 s45, s88, 0
s_add_u32 m0, s86, 24576
s_nop 0
buffer_load_dwordx4 v80, s[20:23], s45 offen offset:0 lds
buffer_load_dwordx4 v81, s[20:23], s45 offen offset:1024 lds
v_accvgpr_write_b32 a32, v104
v_accvgpr_write_b32 a33, v105
v_accvgpr_write_b32 a34, v106
v_accvgpr_write_b32 a35, v107
v_accvgpr_write_b32 a40, v108
v_accvgpr_write_b32 a41, v109
v_accvgpr_write_b32 a42, v110
v_accvgpr_write_b32 a43, v111
s_waitcnt vmcnt(22)
ds_read_b32 v112, v82 offset:26624
ds_read_b32 v113, v82 offset:26688
ds_read_b32 v114, v82 offset:26880
ds_read_b32 v115, v82 offset:26944
ds_read_b32 v116, v82 offset:26752
ds_read_b32 v117, v82 offset:26816
ds_read_b32 v118, v82 offset:27008
ds_read_b32 v119, v82 offset:27072
s_waitcnt lgkmcnt(6)
v_perm_b32 v104, v113, v112, s46
v_perm_b32 v108, v113, v112, s47
s_waitcnt lgkmcnt(4)
v_perm_b32 v105, v115, v114, s46
v_perm_b32 v109, v115, v114, s47
s_waitcnt lgkmcnt(2)
v_perm_b32 v106, v117, v116, s46
v_perm_b32 v110, v117, v116, s47
s_waitcnt lgkmcnt(0)
v_perm_b32 v107, v119, v118, s46
v_perm_b32 v111, v119, v118, s47
s_add_u32 s45, s88, 262144
s_add_u32 m0, s86, 26624
s_nop 0
buffer_load_dwordx4 v80, s[20:23], s45 offen offset:0 lds
buffer_load_dwordx4 v81, s[20:23], s45 offen offset:1024 lds
v_accvgpr_write_b32 a36, v104
v_accvgpr_write_b32 a37, v105
v_accvgpr_write_b32 a38, v106
v_accvgpr_write_b32 a39, v107
v_accvgpr_write_b32 a44, v108
v_accvgpr_write_b32 a45, v109
v_accvgpr_write_b32 a46, v110
v_accvgpr_write_b32 a47, v111
s_waitcnt vmcnt(22)
ds_read_b32 v112, v82 offset:28672
ds_read_b32 v113, v82 offset:28736
ds_read_b32 v114, v82 offset:28928
ds_read_b32 v115, v82 offset:28992
ds_read_b32 v116, v82 offset:28800
ds_read_b32 v117, v82 offset:28864
ds_read_b32 v118, v82 offset:29056
ds_read_b32 v119, v82 offset:29120
s_waitcnt lgkmcnt(6)
v_perm_b32 v104, v113, v112, s46
v_perm_b32 v108, v113, v112, s47
s_waitcnt lgkmcnt(4)
v_perm_b32 v105, v115, v114, s46
v_perm_b32 v109, v115, v114, s47
s_waitcnt lgkmcnt(2)
v_perm_b32 v106, v117, v116, s46
v_perm_b32 v110, v117, v116, s47
s_waitcnt lgkmcnt(0)
v_perm_b32 v107, v119, v118, s46
v_perm_b32 v111, v119, v118, s47
s_add_u32 s45, s88, 524288
s_add_u32 m0, s86, 28672
s_nop 0
buffer_load_dwordx4 v80, s[20:23], s45 offen offset:0 lds
buffer_load_dwordx4 v81, s[20:23], s45 offen offset:1024 lds
v_accvgpr_write_b32 a48, v104
v_accvgpr_write_b32 a49, v105
v_accvgpr_write_b32 a50, v106
v_accvgpr_write_b32 a51, v107
v_accvgpr_write_b32 a56, v108
v_accvgpr_write_b32 a57, v109
v_accvgpr_write_b32 a58, v110
v_accvgpr_write_b32 a59, v111
s_waitcnt vmcnt(22)
ds_read_b32 v112, v82 offset:30720
ds_read_b32 v113, v82 offset:30784
ds_read_b32 v114, v82 offset:30976
ds_read_b32 v115, v82 offset:31040
ds_read_b32 v116, v82 offset:30848
ds_read_b32 v117, v82 offset:30912
ds_read_b32 v118, v82 offset:31104
ds_read_b32 v119, v82 offset:31168
s_waitcnt lgkmcnt(6)
v_perm_b32 v104, v113, v112, s46
v_perm_b32 v108, v113, v112, s47
s_waitcnt lgkmcnt(4)
v_perm_b32 v105, v115, v114, s46
v_perm_b32 v109, v115, v114, s47
s_waitcnt lgkmcnt(2)
v_perm_b32 v106, v117, v116, s46
v_perm_b32 v110, v117, v116, s47
s_waitcnt lgkmcnt(0)
v_perm_b32 v107, v119, v118, s46
v_perm_b32 v111, v119, v118, s47
s_add_u32 s45, s88, 786432
s_add_u32 m0, s86, 30720
s_nop 0
buffer_load_dwordx4 v80, s[20:23], s45 offen offset:0 lds
buffer_load_dwordx4 v81, s[20:23], s45 offen offset:1024 lds
v_accvgpr_write_b32 a52, v104
v_accvgpr_write_b32 a53, v105
v_accvgpr_write_b32 a54, v106
v_accvgpr_write_b32 a55, v107
v_accvgpr_write_b32 a60, v108
v_accvgpr_write_b32 a61, v109
v_accvgpr_write_b32 a62, v110
v_accvgpr_write_b32 a63, v111
v_lshlrev_b32 v98, 5, v1
buffer_load_dwordx2 v[96:97], v98, s[8:11], 0 offen sc1
s_waitcnt vmcnt(22)
ds_read_b32 v112, v83 offset:0
ds_read_b32 v113, v83 offset:64
ds_read_b32 v114, v83 offset:256
ds_read_b32 v115, v83 offset:320
ds_read_b32 v116, v83 offset:128
ds_read_b32 v117, v83 offset:192
ds_read_b32 v118, v83 offset:384
ds_read_b32 v119, v83 offset:448
s_waitcnt lgkmcnt(6)
v_perm_b32 v104, v113, v112, s46
v_perm_b32 v108, v113, v112, s47
s_waitcnt lgkmcnt(4)
v_perm_b32 v105, v115, v114, s46
v_perm_b32 v109, v115, v114, s47
s_waitcnt lgkmcnt(2)
v_perm_b32 v106, v117, v116, s46
v_perm_b32 v110, v117, v116, s47
s_waitcnt lgkmcnt(0)
v_perm_b32 v107, v119, v118, s46
v_perm_b32 v111, v119, v118, s47
s_add_u32 s45, s88, 1048576
s_add_u32 m0, s87, 0
s_nop 0
buffer_load_dwordx4 v80, s[20:23], s45 offen offset:0 lds
buffer_load_dwordx4 v81, s[20:23], s45 offen offset:1024 lds
v_accvgpr_write_b32 a64, v104
v_accvgpr_write_b32 a65, v105
v_accvgpr_write_b32 a66, v106
v_accvgpr_write_b32 a67, v107
v_accvgpr_write_b32 a72, v108
v_accvgpr_write_b32 a73, v109
v_accvgpr_write_b32 a74, v110
v_accvgpr_write_b32 a75, v111
s_waitcnt vmcnt(22)
ds_read_b32 v112, v83 offset:2048
ds_read_b32 v113, v83 offset:2112
ds_read_b32 v114, v83 offset:2304
ds_read_b32 v115, v83 offset:2368
ds_read_b32 v116, v83 offset:2176
ds_read_b32 v117, v83 offset:2240
ds_read_b32 v118, v83 offset:2432
ds_read_b32 v119, v83 offset:2496
s_waitcnt lgkmcnt(6)
v_perm_b32 v104, v113, v112, s46
v_perm_b32 v108, v113, v112, s47
s_waitcnt lgkmcnt(4)
v_perm_b32 v105, v115, v114, s46
v_perm_b32 v109, v115, v114, s47
s_waitcnt lgkmcnt(2)
v_perm_b32 v106, v117, v116, s46
v_perm_b32 v110, v117, v116, s47
s_waitcnt lgkmcnt(0)
v_perm_b32 v107, v119, v118, s46
v_perm_b32 v111, v119, v118, s47
s_add_u32 s45, s88, 1310720
s_add_u32 m0, s87, 2048
s_nop 0
buffer_load_dwordx4 v80, s[20:23], s45 offen offset:0 lds
buffer_load_dwordx4 v81, s[20:23], s45 offen offset:1024 lds
v_accvgpr_write_b32 a68, v104
v_accvgpr_write_b32 a69, v105
v_accvgpr_write_b32 a70, v106
v_accvgpr_write_b32 a71, v107
v_accvgpr_write_b32 a76, v108
v_accvgpr_write_b32 a77, v109
v_accvgpr_write_b32 a78, v110
v_accvgpr_write_b32 a79, v111
s_waitcnt vmcnt(22)
ds_read_b32 v112, v83 offset:4096
ds_read_b32 v113, v83 offset:4160
ds_read_b32 v114, v83 offset:4352
ds_read_b32 v115, v83 offset:4416
ds_read_b32 v116, v83 offset:4224
ds_read_b32 v117, v83 offset:4288
ds_read_b32 v118, v83 offset:4480
ds_read_b32 v119, v83 offset:4544
s_waitcnt lgkmcnt(6)
v_perm_b32 v104, v113, v112, s46
v_perm_b32 v108, v113, v112, s47
s_waitcnt lgkmcnt(4)
v_perm_b32 v105, v115, v114, s46
v_perm_b32 v109, v115, v114, s47
s_waitcnt lgkmcnt(2)
v_perm_b32 v106, v117, v116, s46
v_perm_b32 v110, v117, v116, s47
s_waitcnt lgkmcnt(0)
v_perm_b32 v107, v119, v118, s46
v_perm_b32 v111, v119, v118, s47
s_add_u32 s45, s88, 1572864
s_add_u32 m0, s87, 4096
s_nop 0
buffer_load_dwordx4 v80, s[20:23], s45 offen offset:0 lds
buffer_load_dwordx4 v81, s[20:23], s45 offen offset:1024 lds
v_accvgpr_write_b32 a80, v104
v_accvgpr_write_b32 a81, v105
v_accvgpr_write_b32 a82, v106
v_accvgpr_write_b32 a83, v107
v_accvgpr_write_b32 a88, v108
v_accvgpr_write_b32 a89, v109
v_accvgpr_write_b32 a90, v110
v_accvgpr_write_b32 a91, v111
s_waitcnt vmcnt(22)
ds_read_b32 v112, v83 offset:6144
ds_read_b32 v113, v83 offset:6208
ds_read_b32 v114, v83 offset:6400
ds_read_b32 v115, v83 offset:6464
ds_read_b32 v116, v83 offset:6272
ds_read_b32 v117, v83 offset:6336
ds_read_b32 v118, v83 offset:6528
ds_read_b32 v119, v83 offset:6592
s_waitcnt lgkmcnt(6)
v_perm_b32 v104, v113, v112, s46
v_perm_b32 v108, v113, v112, s47
s_waitcnt lgkmcnt(4)
v_perm_b32 v105, v115, v114, s46
v_perm_b32 v109, v115, v114, s47
s_waitcnt lgkmcnt(2)
v_perm_b32 v106, v117, v116, s46
v_perm_b32 v110, v117, v116, s47
s_waitcnt lgkmcnt(0)
v_perm_b32 v107, v119, v118, s46
v_perm_b32 v111, v119, v118, s47
s_add_u32 s45, s88, 1835008
s_add_u32 m0, s87, 6144
s_nop 0
buffer_load_dwordx4 v80, s[20:23], s45 offen offset:0 lds
buffer_load_dwordx4 v81, s[20:23], s45 offen offset:1024 lds
v_accvgpr_write_b32 a84, v104
v_accvgpr_write_b32 a85, v105
v_accvgpr_write_b32 a86, v106
v_accvgpr_write_b32 a87, v107
v_accvgpr_write_b32 a92, v108
v_accvgpr_write_b32 a93, v109
v_accvgpr_write_b32 a94, v110
v_accvgpr_write_b32 a95, v111
s_waitcnt vmcnt(22)
ds_read_b32 v112, v82 offset:16384
ds_read_b32 v113, v82 offset:16448
ds_read_b32 v114, v82 offset:16640
ds_read_b32 v115, v82 offset:16704
ds_read_b32 v116, v82 offset:16512
ds_read_b32 v117, v82 offset:16576
ds_read_b32 v118, v82 offset:16768
ds_read_b32 v119, v82 offset:16832
s_waitcnt lgkmcnt(6)
v_perm_b32 v104, v113, v112, s46
v_perm_b32 v108, v113, v112, s47
s_waitcnt lgkmcnt(4)
v_perm_b32 v105, v115, v114, s46
v_perm_b32 v109, v115, v114, s47
s_waitcnt lgkmcnt(2)
v_perm_b32 v106, v117, v116, s46
v_perm_b32 v110, v117, v116, s47
s_waitcnt lgkmcnt(0)
v_perm_b32 v107, v119, v118, s46
v_perm_b32 v111, v119, v118, s47
s_add_u32 s45, s88, 2097152
s_add_u32 m0, s86, 16384
s_nop 0
buffer_load_dwordx4 v80, s[20:23], s45 offen offset:0 lds
buffer_load_dwordx4 v81, s[20:23], s45 offen offset:1024 lds
v_accvgpr_write_b32 a96, v104
v_accvgpr_write_b32 a97, v105
v_accvgpr_write_b32 a98, v106
v_accvgpr_write_b32 a99, v107
v_accvgpr_write_b32 a104, v108
v_accvgpr_write_b32 a105, v109
v_accvgpr_write_b32 a106, v110
v_accvgpr_write_b32 a107, v111
s_waitcnt vmcnt(22)
ds_read_b32 v112, v82 offset:18432
ds_read_b32 v113, v82 offset:18496
ds_read_b32 v114, v82 offset:18688
ds_read_b32 v115, v82 offset:18752
ds_read_b32 v116, v82 offset:18560
ds_read_b32 v117, v82 offset:18624
ds_read_b32 v118, v82 offset:18816
ds_read_b32 v119, v82 offset:18880
s_waitcnt lgkmcnt(6)
v_perm_b32 v104, v113, v112, s46
v_perm_b32 v108, v113, v112, s47
s_waitcnt lgkmcnt(4)
v_perm_b32 v105, v115, v114, s46
v_perm_b32 v109, v115, v114, s47
s_waitcnt lgkmcnt(2)
v_perm_b32 v106, v117, v116, s46
v_perm_b32 v110, v117, v116, s47
s_waitcnt lgkmcnt(0)
v_perm_b32 v107, v119, v118, s46
v_perm_b32 v111, v119, v118, s47
s_add_u32 s45, s88, 2359296
s_add_u32 m0, s86, 18432
s_nop 0
buffer_load_dwordx4 v80, s[20:23], s45 offen offset:0 lds
buffer_load_dwordx4 v81, s[20:23], s45 offen offset:1024 lds
v_accvgpr_write_b32 a100, v104
v_accvgpr_write_b32 a101, v105
v_accvgpr_write_b32 a102, v106
v_accvgpr_write_b32 a103, v107
v_accvgpr_write_b32 a108, v108
v_accvgpr_write_b32 a109, v109
v_accvgpr_write_b32 a110, v110
v_accvgpr_write_b32 a111, v111
s_waitcnt vmcnt(22)
ds_read_b32 v112, v82 offset:20480
ds_read_b32 v113, v82 offset:20544
ds_read_b32 v114, v82 offset:20736
ds_read_b32 v115, v82 offset:20800
ds_read_b32 v116, v82 offset:20608
ds_read_b32 v117, v82 offset:20672
ds_read_b32 v118, v82 offset:20864
ds_read_b32 v119, v82 offset:20928
s_waitcnt lgkmcnt(6)
v_perm_b32 v104, v113, v112, s46
v_perm_b32 v108, v113, v112, s47
s_waitcnt lgkmcnt(4)
v_perm_b32 v105, v115, v114, s46
v_perm_b32 v109, v115, v114, s47
s_waitcnt lgkmcnt(2)
v_perm_b32 v106, v117, v116, s46
v_perm_b32 v110, v117, v116, s47
s_waitcnt lgkmcnt(0)
v_perm_b32 v107, v119, v118, s46
v_perm_b32 v111, v119, v118, s47
s_add_u32 s45, s88, 2621440
s_add_u32 m0, s86, 20480
s_nop 0
buffer_load_dwordx4 v80, s[20:23], s45 offen offset:0 lds
buffer_load_dwordx4 v81, s[20:23], s45 offen offset:1024 lds
v_accvgpr_write_b32 a112, v104
v_accvgpr_write_b32 a113, v105
v_accvgpr_write_b32 a114, v106
v_accvgpr_write_b32 a115, v107
v_accvgpr_write_b32 a120, v108
v_accvgpr_write_b32 a121, v109
v_accvgpr_write_b32 a122, v110
v_accvgpr_write_b32 a123, v111
s_waitcnt vmcnt(22)
ds_read_b32 v112, v82 offset:22528
ds_read_b32 v113, v82 offset:22592
ds_read_b32 v114, v82 offset:22784
ds_read_b32 v115, v82 offset:22848
ds_read_b32 v116, v82 offset:22656
ds_read_b32 v117, v82 offset:22720
ds_read_b32 v118, v82 offset:22912
ds_read_b32 v119, v82 offset:22976
s_waitcnt lgkmcnt(6)
v_perm_b32 v104, v113, v112, s46
v_perm_b32 v108, v113, v112, s47
s_waitcnt lgkmcnt(4)
v_perm_b32 v105, v115, v114, s46
v_perm_b32 v109, v115, v114, s47
s_waitcnt lgkmcnt(2)
v_perm_b32 v106, v117, v116, s46
v_perm_b32 v110, v117, v116, s47
s_waitcnt lgkmcnt(0)
v_perm_b32 v107, v119, v118, s46
v_perm_b32 v111, v119, v118, s47
s_add_u32 s45, s88, 2883584
s_add_u32 m0, s86, 22528
s_nop 0
buffer_load_dwordx4 v80, s[20:23], s45 offen offset:0 lds
buffer_load_dwordx4 v81, s[20:23], s45 offen offset:1024 lds
v_accvgpr_write_b32 a116, v104
v_accvgpr_write_b32 a117, v105
v_accvgpr_write_b32 a118, v106
v_accvgpr_write_b32 a119, v107
v_accvgpr_write_b32 a124, v108
v_accvgpr_write_b32 a125, v109
v_accvgpr_write_b32 a126, v110
v_accvgpr_write_b32 a127, v111
s_waitcnt vmcnt(22)
ds_read_b32 v112, v82 offset:24576
ds_read_b32 v113, v82 offset:24640
ds_read_b32 v114, v82 offset:24832
ds_read_b32 v115, v82 offset:24896
ds_read_b32 v116, v82 offset:24704
ds_read_b32 v117, v82 offset:24768
ds_read_b32 v118, v82 offset:24960
ds_read_b32 v119, v82 offset:25024
s_waitcnt lgkmcnt(6)
v_perm_b32 v104, v113, v112, s46
v_perm_b32 v108, v113, v112, s47
s_waitcnt lgkmcnt(4)
v_perm_b32 v105, v115, v114, s46
v_perm_b32 v109, v115, v114, s47
s_waitcnt lgkmcnt(2)
v_perm_b32 v106, v117, v116, s46
v_perm_b32 v110, v117, v116, s47
s_waitcnt lgkmcnt(0)
v_perm_b32 v107, v119, v118, s46
v_perm_b32 v111, v119, v118, s47
s_add_u32 s45, s88, 3145728
s_add_u32 m0, s86, 24576
s_nop 0
buffer_load_dwordx4 v80, s[20:23], s45 offen offset:0 lds
buffer_load_dwordx4 v81, s[20:23], s45 offen offset:1024 lds
v_accvgpr_write_b32 a128, v104
v_accvgpr_write_b32 a129, v105
v_accvgpr_write_b32 a130, v106
v_accvgpr_write_b32 a131, v107
v_accvgpr_write_b32 a136, v108
v_accvgpr_write_b32 a137, v109
v_accvgpr_write_b32 a138, v110
v_accvgpr_write_b32 a139, v111
s_waitcnt vmcnt(22)
ds_read_b32 v112, v82 offset:26624
ds_read_b32 v113, v82 offset:26688
ds_read_b32 v114, v82 offset:26880
ds_read_b32 v115, v82 offset:26944
ds_read_b32 v116, v82 offset:26752
ds_read_b32 v117, v82 offset:26816
ds_read_b32 v118, v82 offset:27008
ds_read_b32 v119, v82 offset:27072
s_waitcnt lgkmcnt(6)
v_perm_b32 v104, v113, v112, s46
v_perm_b32 v108, v113, v112, s47
s_waitcnt lgkmcnt(4)
v_perm_b32 v105, v115, v114, s46
v_perm_b32 v109, v115, v114, s47
s_waitcnt lgkmcnt(2)
v_perm_b32 v106, v117, v116, s46
v_perm_b32 v110, v117, v116, s47
s_waitcnt lgkmcnt(0)
v_perm_b32 v107, v119, v118, s46
v_perm_b32 v111, v119, v118, s47
s_add_u32 s45, s88, 3407872
s_add_u32 m0, s86, 26624
s_nop 0
buffer_load_dwordx4 v80, s[20:23], s45 offen offset:0 lds
buffer_load_dwordx4 v81, s[20:23], s45 offen offset:1024 lds
v_accvgpr_write_b32 a132, v104
v_accvgpr_write_b32 a133, v105
v_accvgpr_write_b32 a134, v106
v_accvgpr_write_b32 a135, v107
v_accvgpr_write_b32 a140, v108
v_accvgpr_write_b32 a141, v109
v_accvgpr_write_b32 a142, v110
v_accvgpr_write_b32 a143, v111
s_waitcnt vmcnt(22)
ds_read_b32 v112, v82 offset:28672
ds_read_b32 v113, v82 offset:28736
ds_read_b32 v114, v82 offset:28928
ds_read_b32 v115, v82 offset:28992
ds_read_b32 v116, v82 offset:28800
ds_read_b32 v117, v82 offset:28864
ds_read_b32 v118, v82 offset:29056
ds_read_b32 v119, v82 offset:29120
s_waitcnt lgkmcnt(6)
v_perm_b32 v104, v113, v112, s46
v_perm_b32 v108, v113, v112, s47
s_waitcnt lgkmcnt(4)
v_perm_b32 v105, v115, v114, s46
v_perm_b32 v109, v115, v114, s47
s_waitcnt lgkmcnt(2)
v_perm_b32 v106, v117, v116, s46
v_perm_b32 v110, v117, v116, s47
s_waitcnt lgkmcnt(0)
v_perm_b32 v107, v119, v118, s46
v_perm_b32 v111, v119, v118, s47
s_add_u32 s45, s88, 3670016
s_add_u32 m0, s86, 28672
s_nop 0
buffer_load_dwordx4 v80, s[20:23], s45 offen offset:0 lds
buffer_load_dwordx4 v81, s[20:23], s45 offen offset:1024 lds
v_accvgpr_write_b32 a144, v104
v_accvgpr_write_b32 a145, v105
v_accvgpr_write_b32 a146, v106
v_accvgpr_write_b32 a147, v107
v_accvgpr_write_b32 a152, v108
v_accvgpr_write_b32 a153, v109
v_accvgpr_write_b32 a154, v110
v_accvgpr_write_b32 a155, v111
s_waitcnt vmcnt(22)
ds_read_b32 v112, v82 offset:30720
ds_read_b32 v113, v82 offset:30784
ds_read_b32 v114, v82 offset:30976
ds_read_b32 v115, v82 offset:31040
ds_read_b32 v116, v82 offset:30848
ds_read_b32 v117, v82 offset:30912
ds_read_b32 v118, v82 offset:31104
ds_read_b32 v119, v82 offset:31168
s_waitcnt lgkmcnt(6)
v_perm_b32 v104, v113, v112, s46
v_perm_b32 v108, v113, v112, s47
s_waitcnt lgkmcnt(4)
v_perm_b32 v105, v115, v114, s46
v_perm_b32 v109, v115, v114, s47
s_waitcnt lgkmcnt(2)
v_perm_b32 v106, v117, v116, s46
v_perm_b32 v110, v117, v116, s47
s_waitcnt lgkmcnt(0)
v_perm_b32 v107, v119, v118, s46
v_perm_b32 v111, v119, v118, s47
s_add_u32 s45, s88, 3932160
s_add_u32 m0, s86, 30720
s_nop 0
buffer_load_dwordx4 v80, s[20:23], s45 offen offset:0 lds
buffer_load_dwordx4 v81, s[20:23], s45 offen offset:1024 lds
v_accvgpr_write_b32 a148, v104
v_accvgpr_write_b32 a149, v105
v_accvgpr_write_b32 a150, v106
v_accvgpr_write_b32 a151, v107
v_accvgpr_write_b32 a156, v108
v_accvgpr_write_b32 a157, v109
v_accvgpr_write_b32 a158, v110
v_accvgpr_write_b32 a159, v111
s_waitcnt vmcnt(22)
ds_read_b32 v112, v83 offset:0
ds_read_b32 v113, v83 offset:64
ds_read_b32 v114, v83 offset:256
ds_read_b32 v115, v83 offset:320
ds_read_b32 v116, v83 offset:128
ds_read_b32 v117, v83 offset:192
ds_read_b32 v118, v83 offset:384
ds_read_b32 v119, v83 offset:448
s_waitcnt lgkmcnt(6)
v_perm_b32 v104, v113, v112, s46
v_perm_b32 v108, v113, v112, s47
s_waitcnt lgkmcnt(4)
v_perm_b32 v105, v115, v114, s46
v_perm_b32 v109, v115, v114, s47
s_waitcnt lgkmcnt(2)
v_perm_b32 v106, v117, v116, s46
v_perm_b32 v110, v117, v116, s47
s_waitcnt lgkmcnt(0)
v_perm_b32 v107, v119, v118, s46
v_perm_b32 v111, v119, v118, s47
s_add_u32 s45, s88, 0
s_add_u32 m0, s87, 0
s_nop 0
buffer_load_dwordx4 v80, s[12:15], s45 offen offset:0 lds
buffer_load_dwordx4 v81, s[12:15], s45 offen offset:1024 lds
v_accvgpr_write_b32 a160, v104
v_accvgpr_write_b32 a161, v105
v_accvgpr_write_b32 a162, v106
v_accvgpr_write_b32 a163, v107
v_accvgpr_write_b32 a168, v108
v_accvgpr_write_b32 a169, v109
v_accvgpr_write_b32 a170, v110
v_accvgpr_write_b32 a171, v111
L_cen_10:
s_mov_b32 s40, 0
v_readlane_b32 s41, v97, 0
s_nop 0
s_add_u32 s40, s40, s41
v_readlane_b32 s41, v97, 1
s_nop 0
s_add_u32 s40, s40, s41
v_readlane_b32 s41, v97, 2
s_nop 0
s_add_u32 s40, s40, s41
v_readlane_b32 s41, v97, 3
s_nop 0
s_add_u32 s40, s40, s41
v_readlane_b32 s41, v97, 4
s_nop 0
s_add_u32 s40, s40, s41
v_readlane_b32 s41, v97, 5
s_nop 0
s_add_u32 s40, s40, s41
v_readlane_b32 s41, v97, 6
s_nop 0
s_add_u32 s40, s40, s41
v_readlane_b32 s41, v97, 7
s_nop 0
s_add_u32 s40, s40, s41
s_cmp_eq_u32 s40, 256
s_cbranch_scc1 L_cenok_11
s_sub_u32 s36, s36, 1
s_cbranch_scc1 L_end_chain_L
s_sleep 4
buffer_load_dwordx2 v[96:97], v98, s[8:11], 0 offen sc1
s_waitcnt vmcnt(0)
s_branch L_cen_10
L_cenok_11:
v_cmp_ne_u32 vcc, 32, v96
s_nop 0
s_and_b32 s40, vcc_lo, 0xff
s_cbranch_scc1 L_fb_chain
v_mov_b32 v100, -1
v_mov_b32 v101, -1
v_mov_b32 v102, -1
v_mov_b32 v103, -1
s_lshr_b32 s41, s32, 1
s_lshl_b32 s40, s41, 18
s_xor_b32 s40, s40, s77
buffer_store_dwordx4 v[100:103], v2, s[4:7], s40 offen offset:0
buffer_store_dwordx4 v[100:103], v2, s[4:7], s40 offen offset:1024
buffer_store_dwordx4 v[100:103], v2, s[4:7], s40 offen offset:2048
buffer_store_dwordx4 v[100:103], v2, s[4:7], s40 offen offset:3072
s_lshl_b32 s40, s41, 13
s_xor_b32 s40, s40, s79
buffer_store_dword v100, v11, s[4:7], s40 offen
s_add_u32 s40, s40, 32768
s_waitcnt vmcnt(22)
ds_read_b32 v112, v83 offset:2048
ds_read_b32 v113, v83 offset:2112
ds_read_b32 v114, v83 offset:2304
ds_read_b32 v115, v83 offset:2368
ds_read_b32 v116, v83 offset:2176
ds_read_b32 v117, v83 offset:2240
ds_read_b32 v118, v83 offset:2432
ds_read_b32 v119, v83 offset:2496
s_waitcnt lgkmcnt(6)
v_perm_b32 v104, v113, v112, s46
v_perm_b32 v108, v113, v112, s47
s_waitcnt lgkmcnt(4)
v_perm_b32 v105, v115, v114, s46
v_perm_b32 v109, v115, v114, s47
s_waitcnt lgkmcnt(2)
v_perm_b32 v106, v117, v116, s46
v_perm_b32 v110, v117, v116, s47
s_waitcnt lgkmcnt(0)
v_perm_b32 v107, v119, v118, s46
v_perm_b32 v111, v119, v118, s47
s_add_u32 s45, s88, 262144
s_add_u32 m0, s87, 2048
s_nop 0
buffer_load_dwordx4 v80, s[12:15], s45 offen offset:0 lds
buffer_load_dwordx4 v81, s[12:15], s45 offen offset:1024 lds
v_accvgpr_write_b32 a164, v104
v_accvgpr_write_b32 a165, v105
v_accvgpr_write_b32 a166, v106
v_accvgpr_write_b32 a167, v107
v_accvgpr_write_b32 a172, v108
v_accvgpr_write_b32 a173, v109
v_accvgpr_write_b32 a174, v110
v_accvgpr_write_b32 a175, v111
s_waitcnt vmcnt(22)
ds_read_b32 v112, v83 offset:4096
ds_read_b32 v113, v83 offset:4160
ds_read_b32 v114, v83 offset:4352
ds_read_b32 v115, v83 offset:4416
ds_read_b32 v116, v83 offset:4224
ds_read_b32 v117, v83 offset:4288
ds_read_b32 v118, v83 offset:4480
ds_read_b32 v119, v83 offset:4544
s_waitcnt lgkmcnt(6)
v_perm_b32 v104, v113, v112, s46
v_perm_b32 v108, v113, v112, s47
s_waitcnt lgkmcnt(4)
v_perm_b32 v105, v115, v114, s46
v_perm_b32 v109, v115, v114, s47
s_waitcnt lgkmcnt(2)
v_perm_b32 v106, v117, v116, s46
v_perm_b32 v110, v117, v116, s47
s_waitcnt lgkmcnt(0)
v_perm_b32 v107, v119, v118, s46
v_perm_b32 v111, v119, v118, s47
s_add_u32 s45, s88, 524288
s_add_u32 m0, s87, 4096
s_nop 0
buffer_load_dwordx4 v80, s[12:15], s45 offen offset:0 lds
buffer_load_dwordx4 v81, s[12:15], s45 offen offset:1024 lds
v_accvgpr_write_b32 a176, v104
v_accvgpr_write_b32 a177, v105
v_accvgpr_write_b32 a178, v106
v_accvgpr_write_b32 a179, v107
v_accvgpr_write_b32 a184, v108
v_accvgpr_write_b32 a185, v109
v_accvgpr_write_b32 a186, v110
v_accvgpr_write_b32 a187, v111
s_waitcnt vmcnt(22)
ds_read_b32 v112, v83 offset:6144
ds_read_b32 v113, v83 offset:6208
ds_read_b32 v114, v83 offset:6400
ds_read_b32 v115, v83 offset:6464
ds_read_b32 v116, v83 offset:6272
ds_read_b32 v117, v83 offset:6336
ds_read_b32 v118, v83 offset:6528
ds_read_b32 v119, v83 offset:6592
s_waitcnt lgkmcnt(6)
v_perm_b32 v104, v113, v112, s46
v_perm_b32 v108, v113, v112, s47
s_waitcnt lgkmcnt(4)
v_perm_b32 v105, v115, v114, s46
v_perm_b32 v109, v115, v114, s47
s_waitcnt lgkmcnt(2)
v_perm_b32 v106, v117, v116, s46
v_perm_b32 v110, v117, v116, s47
s_waitcnt lgkmcnt(0)
v_perm_b32 v107, v119, v118, s46
v_perm_b32 v111, v119, v118, s47
s_add_u32 s45, s88, 786432
s_add_u32 m0, s87, 6144
s_nop 0
buffer_load_dwordx4 v80, s[12:15], s45 offen offset:0 lds
buffer_load_dwordx4 v81, s[12:15], s45 offen offset:1024 lds
v_accvgpr_write_b32 a180, v104
v_accvgpr_write_b32 a181, v105
v_accvgpr_write_b32 a182, v106
v_accvgpr_write_b32 a183, v107
v_accvgpr_write_b32 a188, v108
v_accvgpr_write_b32 a189, v109
v_accvgpr_write_b32 a190, v110
v_accvgpr_write_b32 a191, v111
s_waitcnt vmcnt(22)
ds_read_b32 v112, v82 offset:16384
ds_read_b32 v113, v82 offset:16448
ds_read_b32 v114, v82 offset:16640
ds_read_b32 v115, v82 offset:16704
ds_read_b32 v116, v82 offset:16512
ds_read_b32 v117, v82 offset:16576
ds_read_b32 v118, v82 offset:16768
ds_read_b32 v119, v82 offset:16832
s_waitcnt lgkmcnt(6)
v_perm_b32 v104, v113, v112, s46
v_perm_b32 v108, v113, v112, s47
s_waitcnt lgkmcnt(4)
v_perm_b32 v105, v115, v114, s46
v_perm_b32 v109, v115, v114, s47
s_waitcnt lgkmcnt(2)
v_perm_b32 v106, v117, v116, s46
v_perm_b32 v110, v117, v116, s47
s_waitcnt lgkmcnt(0)
v_perm_b32 v107, v119, v118, s46
v_perm_b32 v111, v119, v118, s47
s_add_u32 s45, s88, 1048576
s_add_u32 m0, s86, 16384
s_nop 0
buffer_load_dwordx4 v80, s[12:15], s45 offen offset:0 lds
buffer_load_dwordx4 v81, s[12:15], s45 offen offset:1024 lds
v_accvgpr_write_b32 a192, v104
v_accvgpr_write_b32 a193, v105
v_accvgpr_write_b32 a194, v106
v_accvgpr_write_b32 a195, v107
v_accvgpr_write_b32 a200, v108
v_accvgpr_write_b32 a201, v109
v_accvgpr_write_b32 a202, v110
v_accvgpr_write_b32 a203, v111
s_waitcnt vmcnt(22)
ds_read_b32 v112, v82 offset:18432
ds_read_b32 v113, v82 offset:18496
ds_read_b32 v114, v82 offset:18688
ds_read_b32 v115, v82 offset:18752
ds_read_b32 v116, v82 offset:18560
ds_read_b32 v117, v82 offset:18624
ds_read_b32 v118, v82 offset:18816
ds_read_b32 v119, v82 offset:18880
s_waitcnt lgkmcnt(6)
v_perm_b32 v104, v113, v112, s46
v_perm_b32 v108, v113, v112, s47
s_waitcnt lgkmcnt(4)
v_perm_b32 v105, v115, v114, s46
v_perm_b32 v109, v115, v114, s47
s_waitcnt lgkmcnt(2)
v_perm_b32 v106, v117, v116, s46
v_perm_b32 v110, v117, v116, s47
s_waitcnt lgkmcnt(0)
v_perm_b32 v107, v119, v118, s46
v_perm_b32 v111, v119, v118, s47
s_add_u32 s45, s88, 1310720
s_add_u32 m0, s86, 18432
s_nop 0
buffer_load_dwordx4 v80, s[12:15], s45 offen offset:0 lds
buffer_load_dwordx4 v81, s[12:15], s45 offen offset:1024 lds
v_accvgpr_write_b32 a196, v104
v_accvgpr_write_b32 a197, v105
v_accvgpr_write_b32 a198, v106
v_accvgpr_write_b32 a199, v107
v_accvgpr_write_b32 a204, v108
v_accvgpr_write_b32 a205, v109
v_accvgpr_write_b32 a206, v110
v_accvgpr_write_b32 a207, v111
s_waitcnt vmcnt(22)
ds_read_b32 v112, v82 offset:20480
ds_read_b32 v113, v82 offset:20544
ds_read_b32 v114, v82 offset:20736
ds_read_b32 v115, v82 offset:20800
ds_read_b32 v116, v82 offset:20608
ds_read_b32 v117, v82 offset:20672
ds_read_b32 v118, v82 offset:20864
ds_read_b32 v119, v82 offset:20928
s_waitcnt lgkmcnt(6)
v_perm_b32 v104, v113, v112, s46
v_perm_b32 v108, v113, v112, s47
s_waitcnt lgkmcnt(4)
v_perm_b32 v105, v115, v114, s46
v_perm_b32 v109, v115, v114, s47
s_waitcnt lgkmcnt(2)
v_perm_b32 v106, v117, v116, s46
v_perm_b32 v110, v117, v116, s47
s_waitcnt lgkmcnt(0)
v_perm_b32 v107, v119, v118, s46
v_perm_b32 v111, v119, v118, s47
s_add_u32 s45, s88, 1572864
s_add_u32 m0, s86, 20480
s_nop 0
buffer_load_dwordx4 v80, s[12:15], s45 offen offset:0 lds
buffer_load_dwordx4 v81, s[12:15], s45 offen offset:1024 lds
v_accvgpr_write_b32 a208, v104
v_accvgpr_write_b32 a209, v105
v_accvgpr_write_b32 a210, v106
v_accvgpr_write_b32 a211, v107
v_accvgpr_write_b32 a216, v108
v_accvgpr_write_b32 a217, v109
v_accvgpr_write_b32 a218, v110
v_accvgpr_write_b32 a219, v111
s_waitcnt vmcnt(22)
ds_read_b32 v112, v82 offset:22528
ds_read_b32 v113, v82 offset:22592
ds_read_b32 v114, v82 offset:22784
ds_read_b32 v115, v82 offset:22848
ds_read_b32 v116, v82 offset:22656
ds_read_b32 v117, v82 offset:22720
ds_read_b32 v118, v82 offset:22912
ds_read_b32 v119, v82 offset:22976
s_waitcnt lgkmcnt(6)
v_perm_b32 v104, v113, v112, s46
v_perm_b32 v108, v113, v112, s47
s_waitcnt lgkmcnt(4)
v_perm_b32 v105, v115, v114, s46
v_perm_b32 v109, v115, v114, s47
s_waitcnt lgkmcnt(2)
v_perm_b32 v106, v117, v116, s46
v_perm_b32 v110, v117, v116, s47
s_waitcnt lgkmcnt(0)
v_perm_b32 v107, v119, v118, s46
v_perm_b32 v111, v119, v118, s47
s_add_u32 s45, s88, 1835008
s_add_u32 m0, s86, 22528
s_nop 0
buffer_load_dwordx4 v80, s[12:15], s45 offen offset:0 lds
buffer_load_dwordx4 v81, s[12:15], s45 offen offset:1024 lds
v_accvgpr_write_b32 a212, v104
v_accvgpr_write_b32 a213, v105
v_accvgpr_write_b32 a214, v106
v_accvgpr_write_b32 a215, v107
v_accvgpr_write_b32 a220, v108
v_accvgpr_write_b32 a221, v109
v_accvgpr_write_b32 a222, v110
v_accvgpr_write_b32 a223, v111
s_waitcnt vmcnt(22)
ds_read_b32 v112, v82 offset:24576
ds_read_b32 v113, v82 offset:24640
ds_read_b32 v114, v82 offset:24832
ds_read_b32 v115, v82 offset:24896
ds_read_b32 v116, v82 offset:24704
ds_read_b32 v117, v82 offset:24768
ds_read_b32 v118, v82 offset:24960
ds_read_b32 v119, v82 offset:25024
s_waitcnt lgkmcnt(6)
v_perm_b32 v104, v113, v112, s46
v_perm_b32 v108, v113, v112, s47
s_waitcnt lgkmcnt(4)
v_perm_b32 v105, v115, v114, s46
v_perm_b32 v109, v115, v114, s47
s_waitcnt lgkmcnt(2)
v_perm_b32 v106, v117, v116, s46
v_perm_b32 v110, v117, v116, s47
s_waitcnt lgkmcnt(0)
v_perm_b32 v107, v119, v118, s46
v_perm_b32 v111, v119, v118, s47
s_add_u32 s45, s88, 2097152
s_add_u32 m0, s86, 24576
s_nop 0
buffer_load_dwordx4 v80, s[12:15], s45 offen offset:0 lds
buffer_load_dwordx4 v81, s[12:15], s45 offen offset:1024 lds
v_accvgpr_write_b32 a224, v104
v_accvgpr_write_b32 a225, v105
v_accvgpr_write_b32 a226, v106
v_accvgpr_write_b32 a227, v107
v_accvgpr_write_b32 a232, v108
v_accvgpr_write_b32 a233, v109
v_accvgpr_write_b32 a234, v110
v_accvgpr_write_b32 a235, v111
s_waitcnt vmcnt(22)
ds_read_b32 v112, v82 offset:26624
ds_read_b32 v113, v82 offset:26688
ds_read_b32 v114, v82 offset:26880
ds_read_b32 v115, v82 offset:26944
ds_read_b32 v116, v82 offset:26752
ds_read_b32 v117, v82 offset:26816
ds_read_b32 v118, v82 offset:27008
ds_read_b32 v119, v82 offset:27072
s_waitcnt lgkmcnt(6)
v_perm_b32 v104, v113, v112, s46
v_perm_b32 v108, v113, v112, s47
s_waitcnt lgkmcnt(4)
v_perm_b32 v105, v115, v114, s46
v_perm_b32 v109, v115, v114, s47
s_waitcnt lgkmcnt(2)
v_perm_b32 v106, v117, v116, s46
v_perm_b32 v110, v117, v116, s47
s_waitcnt lgkmcnt(0)
v_perm_b32 v107, v119, v118, s46
v_perm_b32 v111, v119, v118, s47
s_add_u32 s45, s88, 2359296
s_add_u32 m0, s86, 26624
s_nop 0
buffer_load_dwordx4 v80, s[12:15], s45 offen offset:0 lds
buffer_load_dwordx4 v81, s[12:15], s45 offen offset:1024 lds
v_accvgpr_write_b32 a228, v104
v_accvgpr_write_b32 a229, v105
v_accvgpr_write_b32 a230, v106
v_accvgpr_write_b32 a231, v107
v_accvgpr_write_b32 a236, v108
v_accvgpr_write_b32 a237, v109
v_accvgpr_write_b32 a238, v110
v_accvgpr_write_b32 a239, v111
s_waitcnt vmcnt(22)
ds_read_b32 v112, v82 offset:28672
ds_read_b32 v113, v82 offset:28736
ds_read_b32 v114, v82 offset:28928
ds_read_b32 v115, v82 offset:28992
ds_read_b32 v116, v82 offset:28800
ds_read_b32 v117, v82 offset:28864
ds_read_b32 v118, v82 offset:29056
ds_read_b32 v119, v82 offset:29120
s_waitcnt lgkmcnt(6)
v_perm_b32 v104, v113, v112, s46
v_perm_b32 v108, v113, v112, s47
s_waitcnt lgkmcnt(4)
v_perm_b32 v105, v115, v114, s46
v_perm_b32 v109, v115, v114, s47
s_waitcnt lgkmcnt(2)
v_perm_b32 v106, v117, v116, s46
v_perm_b32 v110, v117, v116, s47
s_waitcnt lgkmcnt(0)
v_perm_b32 v107, v119, v118, s46
v_perm_b32 v111, v119, v118, s47
s_add_u32 s45, s88, 2621440
s_add_u32 m0, s86, 28672
s_nop 0
buffer_load_dwordx4 v80, s[12:15], s45 offen offset:0 lds
buffer_load_dwordx4 v81, s[12:15], s45 offen offset:1024 lds
v_accvgpr_write_b32 a240, v104
v_accvgpr_write_b32 a241, v105
v_accvgpr_write_b32 a242, v106
v_accvgpr_write_b32 a243, v107
v_accvgpr_write_b32 a248, v108
v_accvgpr_write_b32 a249, v109
v_accvgpr_write_b32 a250, v110
v_accvgpr_write_b32 a251, v111
s_waitcnt vmcnt(22)
ds_read_b32 v112, v82 offset:30720
ds_read_b32 v113, v82 offset:30784
ds_read_b32 v114, v82 offset:30976
ds_read_b32 v115, v82 offset:31040
ds_read_b32 v116, v82 offset:30848
ds_read_b32 v117, v82 offset:30912
ds_read_b32 v118, v82 offset:31104
ds_read_b32 v119, v82 offset:31168
s_waitcnt lgkmcnt(6)
v_perm_b32 v104, v113, v112, s46
v_perm_b32 v108, v113, v112, s47
s_waitcnt lgkmcnt(4)
v_perm_b32 v105, v115, v114, s46
v_perm_b32 v109, v115, v114, s47
s_waitcnt lgkmcnt(2)
v_perm_b32 v106, v117, v116, s46
v_perm_b32 v110, v117, v116, s47
s_waitcnt lgkmcnt(0)
v_perm_b32 v107, v119, v118, s46
v_perm_b32 v111, v119, v118, s47
s_add_u32 s45, s88, 2883584
s_add_u32 m0, s86, 30720
s_nop 0
buffer_load_dwordx4 v80, s[12:15], s45 offen offset:0 lds
buffer_load_dwordx4 v81, s[12:15], s45 offen offset:1024 lds
v_accvgpr_write_b32 a244, v104
v_accvgpr_write_b32 a245, v105
v_accvgpr_write_b32 a246, v106
v_accvgpr_write_b32 a247, v107
v_accvgpr_write_b32 a252, v108
v_accvgpr_write_b32 a253, v109
v_accvgpr_write_b32 a254, v110
v_accvgpr_write_b32 a255, v111
s_waitcnt vmcnt(22)
ds_read_b32 v112, v83 offset:0
ds_read_b32 v113, v83 offset:64
ds_read_b32 v114, v83 offset:256
ds_read_b32 v115, v83 offset:320
ds_read_b32 v116, v83 offset:128
ds_read_b32 v117, v83 offset:192
ds_read_b32 v118, v83 offset:384
ds_read_b32 v119, v83 offset:448
s_waitcnt lgkmcnt(6)
v_perm_b32 v104, v113, v112, s46
v_perm_b32 v108, v113, v112, s47
s_waitcnt lgkmcnt(4)
v_perm_b32 v105, v115, v114, s46
v_perm_b32 v109, v115, v114, s47
s_waitcnt lgkmcnt(2)
v_perm_b32 v106, v117, v116, s46
v_perm_b32 v110, v117, v116, s47
s_waitcnt lgkmcnt(0)
v_perm_b32 v107, v119, v118, s46
v_perm_b32 v111, v119, v118, s47
s_add_u32 s45, s88, 3145728
s_add_u32 m0, s87, 0
s_nop 0
buffer_load_dwordx4 v80, s[12:15], s45 offen offset:0 lds
buffer_load_dwordx4 v81, s[12:15], s45 offen offset:1024 lds
v_mov_b32 v128, v104
v_mov_b32 v129, v105
v_mov_b32 v130, v106
v_mov_b32 v131, v107
ds_write_b128 v3, v[108:111] offset:0
s_waitcnt vmcnt(22)
ds_read_b32 v112, v83 offset:2048
ds_read_b32 v113, v83 offset:2112
ds_read_b32 v114, v83 offset:2304
ds_read_b32 v115, v83 offset:2368
ds_read_b32 v116, v83 offset:2176
ds_read_b32 v117, v83 offset:2240
ds_read_b32 v118, v83 offset:2432
ds_read_b32 v119, v83 offset:2496
s_waitcnt lgkmcnt(6)
v_perm_b32 v104, v113, v112, s46
v_perm_b32 v108, v113, v112, s47
s_waitcnt lgkmcnt(4)
v_perm_b32 v105, v115, v114, s46
v_perm_b32 v109, v115, v114, s47
s_waitcnt lgkmcnt(2)
v_perm_b32 v106, v117, v116, s46
v_perm_b32 v110, v117, v116, s47
s_waitcnt lgkmcnt(0)
v_perm_b32 v107, v119, v118, s46
v_perm_b32 v111, v119, v118, s47
s_add_u32 s45, s88, 3407872
s_add_u32 m0, s87, 2048
s_nop 0
buffer_load_dwordx4 v80, s[12:15], s45 offen offset:0 lds
buffer_load_dwordx4 v81, s[12:15], s45 offen offset:1024 lds
v_mov_b32 v132, v104
v_mov_b32 v133, v105
v_mov_b32 v134, v106
v_mov_b32 v135, v107
ds_write_b128 v3, v[108:111] offset:1024
s_barrier
s_cmp_lg_u32 s32, 0
s_cbranch_scc1 L_ra_12
v_mov_b32 v100, 1
s_lshl_b32 s40, s35, 5
v_mov_b32 v101, s40
s_mov_b64 exec, 1
buffer_atomic_add v100, v101, s[8:11], 0 offen offset:8
s_mov_b64 exec, -1
L_ra_12:
s_waitcnt vmcnt(22)
ds_read_b32 v112, v83 offset:4096
ds_read_b32 v113, v83 offset:4160
ds_read_b32 v114, v83 offset:4352
ds_read_b32 v115, v83 offset:4416
ds_read_b32 v116, v83 offset:4224
ds_read_b32 v117, v83 offset:4288
ds_read_b32 v118, v83 offset:4480
ds_read_b32 v119, v83 offset:4544
s_waitcnt lgkmcnt(6)
v_perm_b32 v104, v113, v112, s46
v_perm_b32 v108, v113, v112, s47
s_waitcnt lgkmcnt(4)
v_perm_b32 v105, v115, v114, s46
v_perm_b32 v109, v115, v114, s47
s_waitcnt lgkmcnt(2)
v_perm_b32 v106, v117, v116, s46
v_perm_b32 v110, v117, v116, s47
s_waitcnt lgkmcnt(0)
v_perm_b32 v107, v119, v118, s46
v_perm_b32 v111, v119, v118, s47
s_add_u32 s45, s88, 3670016
s_add_u32 m0, s87, 4096
s_nop 0
buffer_load_dwordx4 v80, s[12:15], s45 offen offset:0 lds
buffer_load_dwordx4 v81, s[12:15], s45 offen offset:1024 lds
v_mov_b32 v136, v104
v_mov_b32 v137, v105
v_mov_b32 v138, v106
v_mov_b32 v139, v107
ds_write_b128 v3, v[108:111] offset:2048
s_mov_b32 s12, s50
s_mov_b32 s13, s51
s_mov_b32 s14, 8192
s_mov_b32 s15, 0x20000
v_bfe_u32 v86, v1, 3, 2
v_and_b32 v85, 1, v1
v_lshl_add_u32 v86, v86, 1, v85
v_lshlrev_b32 v86, 10, v86
v_bfe_u32 v85, v1, 1, 2
v_lshl_add_u32 v86, v85, 5, v86
v_lshrrev_b32 v85, 5, v1
v_lshl_add_u32 v85, v85, 3, v86
s_lshl_b32 s40, s32, 8
buffer_load_dwordx2 v[120:121], v85, s[12:15], s40 offen
buffer_load_dwordx2 v[122:123], v85, s[12:15], s40 offen offset:16
buffer_load_dwordx2 v[124:125], v85, s[12:15], s40 offen offset:128
buffer_load_dwordx2 v[126:127], v85, s[12:15], s40 offen offset:144
s_lshl_b32 s42, s35, 11
s_add_u32 s42, s42, s34
s_lshl_b32 s40, s42, 6
s_lshl_b32 s41, s32, 2
s_add_u32 s40, s40, s41
s_add_u32 s30, s40, 131072
v_and_b32 v85, 1, v1
v_lshlrev_b32 v86, 4, v85
v_add_u32 v86, 16, v86
v_lshlrev_b32 v85, 2, v85
v_subrev_u32 v85, s41, v85
v_add_u32 v85, 48, v85
v_and_b32 v87, 2, v1
v_cmp_eq_u32 vcc, 0, v87
s_nop 1
v_cndmask_b32 v102, v85, v86, vcc
buffer_load_dword v0, v102, s[4:7], s30 offen sc1
s_lshl_b32 s40, s42, 13
s_lshl_b32 s41, s32, 11
s_add_u32 s40, s40, s41
s_add_u32 s38, s40, 75497472
s_add_u32 s31, s41, 147456
s_waitcnt vmcnt(22)
ds_read_b32 v112, v83 offset:6144
ds_read_b32 v113, v83 offset:6208
ds_read_b32 v114, v83 offset:6400
ds_read_b32 v115, v83 offset:6464
ds_read_b32 v116, v83 offset:6272
ds_read_b32 v117, v83 offset:6336
ds_read_b32 v118, v83 offset:6528
ds_read_b32 v119, v83 offset:6592
s_waitcnt lgkmcnt(6)
v_perm_b32 v104, v113, v112, s46
v_perm_b32 v108, v113, v112, s47
s_waitcnt lgkmcnt(4)
v_perm_b32 v105, v115, v114, s46
v_perm_b32 v109, v115, v114, s47
s_waitcnt lgkmcnt(2)
v_perm_b32 v106, v117, v116, s46
v_perm_b32 v110, v117, v116, s47
s_waitcnt lgkmcnt(0)
v_perm_b32 v107, v119, v118, s46
v_perm_b32 v111, v119, v118, s47
s_add_u32 s45, s88, 3932160
s_add_u32 m0, s87, 6144
s_nop 0
buffer_load_dwordx4 v80, s[12:15], s45 offen offset:0 lds
buffer_load_dwordx4 v81, s[12:15], s45 offen offset:1024 lds
v_mov_b32 v140, v104
v_mov_b32 v141, v105
v_mov_b32 v142, v106
v_mov_b32 v143, v107
ds_write_b128 v3, v[108:111] offset:3072
s_waitcnt vmcnt(22)
ds_read_b32 v112, v82 offset:16384
ds_read_b32 v113, v82 offset:16448
ds_read_b32 v114, v82 offset:16640
ds_read_b32 v115, v82 offset:16704
ds_read_b32 v116, v82 offset:16512
ds_read_b32 v117, v82 offset:16576
ds_read_b32 v118, v82 offset:16768
ds_read_b32 v119, v82 offset:16832
s_waitcnt lgkmcnt(6)
v_perm_b32 v104, v113, v112, s46
v_perm_b32 v108, v113, v112, s47
s_waitcnt lgkmcnt(4)
v_perm_b32 v105, v115, v114, s46
v_perm_b32 v109, v115, v114, s47
s_waitcnt lgkmcnt(2)
v_perm_b32 v106, v117, v116, s46
v_perm_b32 v110, v117, v116, s47
s_waitcnt lgkmcnt(0)
v_perm_b32 v107, v119, v118, s46
v_perm_b32 v111, v119, v118, s47
s_mov_b32 s45, 0
buffer_load_dwordx4 v[16:19], v88, s[24:27], s45 offen offset:0
buffer_load_dwordx4 v[20:23], v88, s[24:27], s45 offen offset:1024
buffer_load_dwordx4 v[24:27], v89, s[24:27], s45 offen offset:0
buffer_load_dwordx4 v[28:31], v89, s[24:27], s45 offen offset:1024
buffer_load_dwordx4 v[32:35], v88, s[24:27], s45 offen offset:2048
buffer_load_dwordx4 v[36:39], v88, s[24:27], s45 offen offset:3072
buffer_load_dwordx4 v[40:43], v89, s[24:27], s45 offen offset:2048
buffer_load_dwordx4 v[44:47], v89, s[24:27], s45 offen offset:3072
v_mov_b32 v144, v104
v_mov_b32 v145, v105
v_mov_b32 v146, v106
v_mov_b32 v147, v107
ds_write_b128 v3, v[108:111] offset:4096
s_waitcnt vmcnt(28)
ds_read_b32 v112, v82 offset:18432
ds_read_b32 v113, v82 offset:18496
ds_read_b32 v114, v82 offset:18688
ds_read_b32 v115, v82 offset:18752
ds_read_b32 v116, v82 offset:18560
ds_read_b32 v117, v82 offset:18624
ds_read_b32 v118, v82 offset:18816
ds_read_b32 v119, v82 offset:18880
s_waitcnt lgkmcnt(6)
v_perm_b32 v104, v113, v112, s46
v_perm_b32 v108, v113, v112, s47
s_waitcnt lgkmcnt(4)
v_perm_b32 v105, v115, v114, s46
v_perm_b32 v109, v115, v114, s47
s_waitcnt lgkmcnt(2)
v_perm_b32 v106, v117, v116, s46
v_perm_b32 v110, v117, v116, s47
s_waitcnt lgkmcnt(0)
v_perm_b32 v107, v119, v118, s46
v_perm_b32 v111, v119, v118, s47
v_mov_b32 v148, v104
v_mov_b32 v149, v105
v_mov_b32 v150, v106
v_mov_b32 v151, v107
ds_write_b128 v3, v[108:111] offset:5120
s_waitcnt vmcnt(26)
ds_read_b32 v112, v82 offset:20480
ds_read_b32 v113, v82 offset:20544
ds_read_b32 v114, v82 offset:20736
ds_read_b32 v115, v82 offset:20800
ds_read_b32 v116, v82 offset:20608
ds_read_b32 v117, v82 offset:20672
ds_read_b32 v118, v82 offset:20864
ds_read_b32 v119, v82 offset:20928
s_waitcnt lgkmcnt(6)
v_perm_b32 v104, v113, v112, s46
v_perm_b32 v108, v113, v112, s47
s_waitcnt lgkmcnt(4)
v_perm_b32 v105, v115, v114, s46
v_perm_b32 v109, v115, v114, s47
s_waitcnt lgkmcnt(2)
v_perm_b32 v106, v117, v116, s46
v_perm_b32 v110, v117, v116, s47
s_waitcnt lgkmcnt(0)
v_perm_b32 v107, v119, v118, s46
v_perm_b32 v111, v119, v118, s47
v_mov_b32 v152, v104
v_mov_b32 v153, v105
v_mov_b32 v154, v106
v_mov_b32 v155, v107
ds_write_b128 v3, v[108:111] offset:6144
s_waitcnt vmcnt(24)
ds_read_b32 v112, v82 offset:22528
ds_read_b32 v113, v82 offset:22592
ds_read_b32 v114, v82 offset:22784
ds_read_b32 v115, v82 offset:22848
ds_read_b32 v116, v82 offset:22656
ds_read_b32 v117, v82 offset:22720
ds_read_b32 v118, v82 offset:22912
ds_read_b32 v119, v82 offset:22976
s_waitcnt lgkmcnt(6)
v_perm_b32 v104, v113, v112, s46
v_perm_b32 v108, v113, v112, s47
s_waitcnt lgkmcnt(4)
v_perm_b32 v105, v115, v114, s46
v_perm_b32 v109, v115, v114, s47
s_waitcnt lgkmcnt(2)
v_perm_b32 v106, v117, v116, s46
v_perm_b32 v110, v117, v116, s47
s_waitcnt lgkmcnt(0)
v_perm_b32 v107, v119, v118, s46
v_perm_b32 v111, v119, v118, s47
v_mov_b32 v156, v104
v_mov_b32 v157, v105
v_mov_b32 v158, v106
v_mov_b32 v159, v107
ds_write_b128 v3, v[108:111] offset:7168
s_waitcnt vmcnt(22)
ds_read_b32 v112, v82 offset:24576
ds_read_b32 v113, v82 offset:24640
ds_read_b32 v114, v82 offset:24832
ds_read_b32 v115, v82 offset:24896
ds_read_b32 v116, v82 offset:24704
ds_read_b32 v117, v82 offset:24768
ds_read_b32 v118, v82 offset:24960
ds_read_b32 v119, v82 offset:25024
s_waitcnt lgkmcnt(6)
v_perm_b32 v104, v113, v112, s46
v_perm_b32 v108, v113, v112, s47
s_waitcnt lgkmcnt(4)
v_perm_b32 v105, v115, v114, s46
v_perm_b32 v109, v115, v114, s47
s_waitcnt lgkmcnt(2)
v_perm_b32 v106, v117, v116, s46
v_perm_b32 v110, v117, v116, s47
s_waitcnt lgkmcnt(0)
v_perm_b32 v107, v119, v118, s46
v_perm_b32 v111, v119, v118, s47
s_mov_b32 s45, 32768
buffer_load_dwordx4 v[48:51], v88, s[24:27], s45 offen offset:0
buffer_load_dwordx4 v[52:55], v88, s[24:27], s45 offen offset:1024
buffer_load_dwordx4 v[56:59], v89, s[24:27], s45 offen offset:0
buffer_load_dwordx4 v[60:63], v89, s[24:27], s45 offen offset:1024
buffer_load_dwordx4 v[64:67], v88, s[24:27], s45 offen offset:2048
buffer_load_dwordx4 v[68:71], v88, s[24:27], s45 offen offset:3072
buffer_load_dwordx4 v[72:75], v89, s[24:27], s45 offen offset:2048
buffer_load_dwordx4 v[76:79], v89, s[24:27], s45 offen offset:3072
v_mov_b32 v160, v104
v_mov_b32 v161, v105
v_mov_b32 v162, v106
v_mov_b32 v163, v107
ds_write_b128 v3, v[108:111] offset:8192
s_waitcnt vmcnt(28)
ds_read_b32 v112, v82 offset:26624
ds_read_b32 v113, v82 offset:26688
ds_read_b32 v114, v82 offset:26880
ds_read_b32 v115, v82 offset:26944
ds_read_b32 v116, v82 offset:26752
ds_read_b32 v117, v82 offset:26816
ds_read_b32 v118, v82 offset:27008
ds_read_b32 v119, v82 offset:27072
s_waitcnt lgkmcnt(6)
v_perm_b32 v104, v113, v112, s46
v_perm_b32 v108, v113, v112, s47
s_waitcnt lgkmcnt(4)
v_perm_b32 v105, v115, v114, s46
v_perm_b32 v109, v115, v114, s47
s_waitcnt lgkmcnt(2)
v_perm_b32 v106, v117, v116, s46
v_perm_b32 v110, v117, v116, s47
s_waitcnt lgkmcnt(0)
v_perm_b32 v107, v119, v118, s46
v_perm_b32 v111, v119, v118, s47
v_mov_b32 v164, v104
v_mov_b32 v165, v105
v_mov_b32 v166, v106
v_mov_b32 v167, v107
ds_write_b128 v3, v[108:111] offset:9216
s_waitcnt vmcnt(26)
ds_read_b32 v112, v82 offset:28672
ds_read_b32 v113, v82 offset:28736
ds_read_b32 v114, v82 offset:28928
ds_read_b32 v115, v82 offset:28992
ds_read_b32 v116, v82 offset:28800
ds_read_b32 v117, v82 offset:28864
ds_read_b32 v118, v82 offset:29056
ds_read_b32 v119, v82 offset:29120
s_waitcnt lgkmcnt(6)
v_perm_b32 v104, v113, v112, s46
v_perm_b32 v108, v113, v112, s47
s_waitcnt lgkmcnt(4)
v_perm_b32 v105, v115, v114, s46
v_perm_b32 v109, v115, v114, s47
s_waitcnt lgkmcnt(2)
v_perm_b32 v106, v117, v116, s46
v_perm_b32 v110, v117, v116, s47
s_waitcnt lgkmcnt(0)
v_perm_b32 v107, v119, v118, s46
v_perm_b32 v111, v119, v118, s47
v_mov_b32 v168, v104
v_mov_b32 v169, v105
v_mov_b32 v170, v106
v_mov_b32 v171, v107
ds_write_b128 v3, v[108:111] offset:10240
s_waitcnt vmcnt(24)
ds_read_b32 v112, v82 offset:30720
ds_read_b32 v113, v82 offset:30784
ds_read_b32 v114, v82 offset:30976
ds_read_b32 v115, v82 offset:31040
ds_read_b32 v116, v82 offset:30848
ds_read_b32 v117, v82 offset:30912
ds_read_b32 v118, v82 offset:31104
ds_read_b32 v119, v82 offset:31168
s_waitcnt lgkmcnt(6)
v_perm_b32 v104, v113, v112, s46
v_perm_b32 v108, v113, v112, s47
s_waitcnt lgkmcnt(4)
v_perm_b32 v105, v115, v114, s46
v_perm_b32 v109, v115, v114, s47
s_waitcnt lgkmcnt(2)
v_perm_b32 v106, v117, v116, s46
v_perm_b32 v110, v117, v116, s47
s_waitcnt lgkmcnt(0)
v_perm_b32 v107, v119, v118, s46
v_perm_b32 v111, v119, v118, s47
v_mov_b32 v172, v104
v_mov_b32 v173, v105
v_mov_b32 v174, v106
v_mov_b32 v175, v107
ds_write_b128 v3, v[108:111] offset:11264
s_waitcnt vmcnt(22)
ds_read_b32 v112, v83 offset:0
ds_read_b32 v113, v83 offset:64
ds_read_b32 v114, v83 offset:256
ds_read_b32 v115, v83 offset:320
ds_read_b32 v116, v83 offset:128
ds_read_b32 v117, v83 offset:192
ds_read_b32 v118, v83 offset:384
ds_read_b32 v119, v83 offset:448
s_waitcnt lgkmcnt(6)
v_perm_b32 v104, v113, v112, s46
v_perm_b32 v108, v113, v112, s47
s_waitcnt lgkmcnt(4)
v_perm_b32 v105, v115, v114, s46
v_perm_b32 v109, v115, v114, s47
s_waitcnt lgkmcnt(2)
v_perm_b32 v106, v117, v116, s46
v_perm_b32 v110, v117, v116, s47
s_waitcnt lgkmcnt(0)
v_perm_b32 v107, v119, v118, s46
v_perm_b32 v111, v119, v118, s47
v_mov_b32 v176, v104
v_mov_b32 v177, v105
v_mov_b32 v178, v106
v_mov_b32 v179, v107
ds_write_b128 v3, v[108:111] offset:12288
s_waitcnt vmcnt(20)
ds_read_b32 v112, v83 offset:2048
ds_read_b32 v113, v83 offset:2112
ds_read_b32 v114, v83 offset:2304
ds_read_b32 v115, v83 offset:2368
ds_read_b32 v116, v83 offset:2176
ds_read_b32 v117, v83 offset:2240
ds_read_b32 v118, v83 offset:2432
ds_read_b32 v119, v83 offset:2496
s_waitcnt lgkmcnt(6)
v_perm_b32 v104, v113, v112, s46
v_perm_b32 v108, v113, v112, s47
s_waitcnt lgkmcnt(4)
v_perm_b32 v105, v115, v114, s46
v_perm_b32 v109, v115, v114, s47
s_waitcnt lgkmcnt(2)
v_perm_b32 v106, v117, v116, s46
v_perm_b32 v110, v117, v116, s47
s_waitcnt lgkmcnt(0)
v_perm_b32 v107, v119, v118, s46
v_perm_b32 v111, v119, v118, s47
v_mov_b32 v180, v104
v_mov_b32 v181, v105
v_mov_b32 v182, v106
v_mov_b32 v183, v107
ds_write_b128 v3, v[108:111] offset:13312
s_waitcnt vmcnt(18)
ds_read_b32 v112, v83 offset:4096
ds_read_b32 v113, v83 offset:4160
ds_read_b32 v114, v83 offset:4352
ds_read_b32 v115, v83 offset:4416
ds_read_b32 v116, v83 offset:4224
ds_read_b32 v117, v83 offset:4288
ds_read_b32 v118, v83 offset:4480
ds_read_b32 v119, v83 offset:4544
s_waitcnt lgkmcnt(6)
v_perm_b32 v104, v113, v112, s46
v_perm_b32 v108, v113, v112, s47
s_waitcnt lgkmcnt(4)
v_perm_b32 v105, v115, v114, s46
v_perm_b32 v109, v115, v114, s47
s_waitcnt lgkmcnt(2)
v_perm_b32 v106, v117, v116, s46
v_perm_b32 v110, v117, v116, s47
s_waitcnt lgkmcnt(0)
v_perm_b32 v107, v119, v118, s46
v_perm_b32 v111, v119, v118, s47
v_mov_b32 v184, v104
v_mov_b32 v185, v105
v_mov_b32 v186, v106
v_mov_b32 v187, v107
ds_write_b128 v3, v[108:111] offset:14336
s_waitcnt vmcnt(16)
ds_read_b32 v112, v83 offset:6144
ds_read_b32 v113, v83 offset:6208
ds_read_b32 v114, v83 offset:6400
ds_read_b32 v115, v83 offset:6464
ds_read_b32 v116, v83 offset:6272
ds_read_b32 v117, v83 offset:6336
ds_read_b32 v118, v83 offset:6528
ds_read_b32 v119, v83 offset:6592
s_waitcnt lgkmcnt(6)
v_perm_b32 v104, v113, v112, s46
v_perm_b32 v108, v113, v112, s47
s_waitcnt lgkmcnt(4)
v_perm_b32 v105, v115, v114, s46
v_perm_b32 v109, v115, v114, s47
s_waitcnt lgkmcnt(2)
v_perm_b32 v106, v117, v116, s46
v_perm_b32 v110, v117, v116, s47
s_waitcnt lgkmcnt(0)
v_perm_b32 v107, v119, v118, s46
v_perm_b32 v111, v119, v118, s47
v_mov_b32 v188, v104
v_mov_b32 v189, v105
v_mov_b32 v190, v106
v_mov_b32 v191, v107
ds_write_b128 v3, v[108:111] offset:15360
s_waitcnt vmcnt(8)
v_perm_b32 v192, v20, v16, s46
v_perm_b32 v193, v28, v24, s46
v_perm_b32 v194, v36, v32, s46
v_perm_b32 v195, v44, v40, s46
v_perm_b32 v104, v20, v16, s47
v_perm_b32 v105, v28, v24, s47
v_perm_b32 v106, v36, v32, s47
v_perm_b32 v107, v44, v40, s47
ds_write_b128 v3, v[104:107] offset:16384
v_perm_b32 v208, v21, v17, s46
v_perm_b32 v209, v29, v25, s46
v_perm_b32 v210, v37, v33, s46
v_perm_b32 v211, v45, v41, s46
v_perm_b32 v108, v21, v17, s47
v_perm_b32 v109, v29, v25, s47
v_perm_b32 v110, v37, v33, s47
v_perm_b32 v111, v45, v41, s47
ds_write_b128 v3, v[108:111] offset:20480
v_perm_b32 v224, v22, v18, s46
v_perm_b32 v225, v30, v26, s46
v_perm_b32 v226, v38, v34, s46
v_perm_b32 v227, v46, v42, s46
v_perm_b32 v104, v22, v18, s47
v_perm_b32 v105, v30, v26, s47
v_perm_b32 v106, v38, v34, s47
v_perm_b32 v107, v46, v42, s47
ds_write_b128 v3, v[104:107] offset:24576
v_perm_b32 v240, v23, v19, s46
v_perm_b32 v241, v31, v27, s46
v_perm_b32 v242, v39, v35, s46
v_perm_b32 v243, v47, v43, s46
v_perm_b32 v108, v23, v19, s47
v_perm_b32 v109, v31, v27, s47
v_perm_b32 v110, v39, v35, s47
v_perm_b32 v111, v47, v43, s47
ds_write_b128 v3, v[108:111] offset:28672
s_mov_b32 s45, 65536
buffer_load_dwordx4 v[16:19], v88, s[24:27], s45 offen offset:0
buffer_load_dwordx4 v[20:23], v88, s[24:27], s45 offen offset:1024
buffer_load_dwordx4 v[24:27], v89, s[24:27], s45 offen offset:0
buffer_load_dwordx4 v[28:31], v89, s[24:27], s45 offen offset:1024
buffer_load_dwordx4 v[32:35], v88, s[24:27], s45 offen offset:2048
buffer_load_dwordx4 v[36:39], v88, s[24:27], s45 offen offset:3072
buffer_load_dwordx4 v[40:43], v89, s[24:27], s45 offen offset:2048
buffer_load_dwordx4 v[44:47], v89, s[24:27], s45 offen offset:3072
s_waitcnt vmcnt(8)
v_perm_b32 v196, v52, v48, s46
v_perm_b32 v197, v60, v56, s46
v_perm_b32 v198, v68, v64, s46
v_perm_b32 v199, v76, v72, s46
v_perm_b32 v104, v52, v48, s47
v_perm_b32 v105, v60, v56, s47
v_perm_b32 v106, v68, v64, s47
v_perm_b32 v107, v76, v72, s47
ds_write_b128 v3, v[104:107] offset:17408
v_perm_b32 v212, v53, v49, s46
v_perm_b32 v213, v61, v57, s46
v_perm_b32 v214, v69, v65, s46
v_perm_b32 v215, v77, v73, s46
v_perm_b32 v108, v53, v49, s47
v_perm_b32 v109, v61, v57, s47
v_perm_b32 v110, v69, v65, s47
v_perm_b32 v111, v77, v73, s47
ds_write_b128 v3, v[108:111] offset:21504
v_perm_b32 v228, v54, v50, s46
v_perm_b32 v229, v62, v58, s46
v_perm_b32 v230, v70, v66, s46
v_perm_b32 v231, v78, v74, s46
v_perm_b32 v104, v54, v50, s47
v_perm_b32 v105, v62, v58, s47
v_perm_b32 v106, v70, v66, s47
v_perm_b32 v107, v78, v74, s47
ds_write_b128 v3, v[104:107] offset:25600
v_perm_b32 v244, v55, v51, s46
v_perm_b32 v245, v63, v59, s46
v_perm_b32 v246, v71, v67, s46
v_perm_b32 v247, v79, v75, s46
v_perm_b32 v108, v55, v51, s47
v_perm_b32 v109, v63, v59, s47
v_perm_b32 v110, v71, v67, s47
v_perm_b32 v111, v79, v75, s47
ds_write_b128 v3, v[108:111] offset:29696
s_mov_b32 s45, 98304
buffer_load_dwordx4 v[48:51], v88, s[24:27], s45 offen offset:0
buffer_load_dwordx4 v[52:55], v88, s[24:27], s45 offen offset:1024
buffer_load_dwordx4 v[56:59], v89, s[24:27], s45 offen offset:0
buffer_load_dwordx4 v[60:63], v89, s[24:27], s45 offen offset:1024
buffer_load_dwordx4 v[64:67], v88, s[24:27], s45 offen offset:2048
buffer_load_dwordx4 v[68:71], v88, s[24:27], s45 offen offset:3072
buffer_load_dwordx4 v[72:75], v89, s[24:27], s45 offen offset:2048
buffer_load_dwordx4 v[76:79], v89, s[24:27], s45 offen offset:3072
s_barrier
L_f0_13:
v_cmp_eq_u32 vcc, 0, v0
s_cbranch_vccz L_f0o_14
s_sub_u32 s36, s36, 1
s_cbranch_scc1 L_end_chain_L
buffer_load_dword v0, v102, s[4:7], s30 offen sc1
s_waitcnt vmcnt(0)
s_branch L_f0_13
L_f0o_14:
s_mov_b32 m0, s31
s_xor_b32 s31, s31, 8192
buffer_load_dwordx4 v2, s[4:7], s38 offen offset:0 sc1 lds
buffer_load_dwordx4 v2, s[4:7], s38 offen offset:1024 sc1 lds
s_lshl_b32 s40, s35, 5
v_mov_b32 v99, s40
buffer_load_dword v103, v99, s[8:11], 0 offen offset:8 sc1
s_waitcnt vmcnt(11)
v_perm_b32 v200, v20, v16, s46
v_perm_b32 v201, v28, v24, s46
v_perm_b32 v202, v36, v32, s46
v_perm_b32 v203, v44, v40, s46
v_perm_b32 v104, v20, v16, s47
v_perm_b32 v105, v28, v24, s47
v_perm_b32 v106, v36, v32, s47
v_perm_b32 v107, v44, v40, s47
ds_write_b128 v3, v[104:107] offset:18432
v_perm_b32 v216, v21, v17, s46
v_perm_b32 v217, v29, v25, s46
v_perm_b32 v218, v37, v33, s46
v_perm_b32 v219, v45, v41, s46
v_perm_b32 v108, v21, v17, s47
v_perm_b32 v109, v29, v25, s47
v_perm_b32 v110, v37, v33, s47
v_perm_b32 v111, v45, v41, s47
ds_write_b128 v3, v[108:111] offset:22528
v_perm_b32 v232, v22, v18, s46
v_perm_b32 v233, v30, v26, s46
v_perm_b32 v234, v38, v34, s46
v_perm_b32 v235, v46, v42, s46
v_perm_b32 v104, v22, v18, s47
v_perm_b32 v105, v30, v26, s47
v_perm_b32 v106, v38, v34, s47
v_perm_b32 v107, v46, v42, s47
ds_write_b128 v3, v[104:107] offset:26624
v_perm_b32 v248, v23, v19, s46
v_perm_b32 v249, v31, v27, s46
v_perm_b32 v250, v39, v35, s46
v_perm_b32 v251, v47, v43, s46
v_perm_b32 v108, v23, v19, s47
v_perm_b32 v109, v31, v27, s47
v_perm_b32 v110, v39, v35, s47
v_perm_b32 v111, v47, v43, s47
ds_write_b128 v3, v[108:111] offset:30720
s_waitcnt vmcnt(3)
v_perm_b32 v204, v52, v48, s46
v_perm_b32 v205, v60, v56, s46
v_perm_b32 v206, v68, v64, s46
v_perm_b32 v207, v76, v72, s46
v_perm_b32 v104, v52, v48, s47
v_perm_b32 v105, v60, v56, s47
v_perm_b32 v106, v68, v64, s47
v_perm_b32 v107, v76, v72, s47
ds_write_b128 v3, v[104:107] offset:19456
v_perm_b32 v220, v53, v49, s46
v_perm_b32 v221, v61, v57, s46
v_perm_b32 v222, v69, v65, s46
v_perm_b32 v223, v77, v73, s46
v_perm_b32 v108, v53, v49, s47
v_perm_b32 v109, v61, v57, s47
v_perm_b32 v110, v69, v65, s47
v_perm_b32 v111, v77, v73, s47
ds_write_b128 v3, v[108:111] offset:23552
v_perm_b32 v236, v54, v50, s46
v_perm_b32 v237, v62, v58, s46
v_perm_b32 v238, v70, v66, s46
v_perm_b32 v239, v78, v74, s46
v_perm_b32 v104, v54, v50, s47
v_perm_b32 v105, v62, v58, s47
v_perm_b32 v106, v70, v66, s47
v_perm_b32 v107, v78, v74, s47
ds_write_b128 v3, v[104:107] offset:27648
v_perm_b32 v252, v55, v51, s46
v_perm_b32 v253, v63, v59, s46
v_perm_b32 v254, v71, v67, s46
v_perm_b32 v255, v79, v75, s46
v_perm_b32 v108, v55, v51, s47
v_perm_b32 v109, v63, v59, s47
v_perm_b32 v110, v71, v67, s47
v_perm_b32 v111, v79, v75, s47
ds_write_b128 v3, v[108:111] offset:31744
s_waitcnt vmcnt(0)
s_lshl_b32 s40, s34, 12
s_lshl_b32 s41, s35, 20
s_add_u32 s40, s40, s41
s_lshl_b32 s41, s32, 9
s_add_u32 s40, s40, s41
s_add_u32 s84, s40, 25165824
v_and_b32 v104, 1, v90
v_bfe_u32 v105, v90, 1, 2
v_and_b32 v106, 1, v91
s_and_b32 s40, s32, 1
s_lshl_b32 s40, s40, 1
v_add_u32 v107, s40, v94
v_and_b32 v108, 2, v105
v_xor_b32 v108, v108, v107
v_lshl_add_u32 v108, v108, 1, v104
v_lshl_add_u32 v108, v106, 3, v108
v_lshl_add_u32 v108, v105, 4, v108
v_lshlrev_b32 v96, 4, v108
s_lshr_b32 s40, s32, 1
s_lshl_b32 s40, s40, 10
s_add_u32 s40, s40, 131072
v_add_u32 v9, s40, v96
v_lshrrev_b32 v97, 2, v90
v_and_b32 v98, 1, v90
v_lshl_add_u32 v96, v97, 1, v98
v_lshlrev_b32 v96, 4, v96
v_lshl_add_u32 v14, v91, 7, v96
v_bfe_u32 v101, v90, 1, 1
v_lshl_add_u32 v14, v101, 30, v14
v_lshlrev_b32 v15, 3, v1
v_and_b32 v108, 2, v97
v_xor_b32 v108, v108, v91
v_lshl_add_u32 v108, v108, 1, v98
v_lshl_add_u32 v108, v101, 3, v108
v_lshl_add_u32 v108, v97, 4, v108
v_lshlrev_b32 v96, 4, v108
v_add_u32 v4, 131072, v96
v_add_u32 v18, 147456, v2
v_and_b32 v104, 1, v1
v_bfe_u32 v105, v1, 1, 2
v_lshrrev_b32 v106, 5, v1
v_bfe_u32 v107, v1, 3, 2
v_and_b32 v108, 2, v107
v_xor_b32 v108, v108, v105
v_lshl_add_u32 v108, v108, 1, v104
v_lshl_add_u32 v108, v106, 3, v108
v_lshl_add_u32 v108, v107, 4, v108
v_lshlrev_b32 v96, 4, v108
s_lshl_b32 s40, s32, 11
s_add_u32 s40, s40, 131072
v_add_u32 v5, s40, v96
v_and_b32 v95, 1, v91
v_lshlrev_b32 v96, 3, v90
v_lshl_add_u32 v96, v95, 2, v96
v_mul_u32_u24 v99, 1088, v94
s_lshl_b32 s40, s32, 8
s_add_u32 s40, s40, 139264
v_add3_u32 v6, v96, v99, s40
v_mul_u32_u24 v96, 192, v91
v_lshl_add_u32 v96, v90, 3, v96
s_mul_i32 s40, s32, 1488
s_add_u32 s40, s40, 141376
v_add_u32 v19, s40, v96
v_lshrrev_b32 v96, 1, v97
v_lshl_add_u32 v96, v91, 2, v96
v_lshlrev_b32 v96, 3, v96
v_and_b32 v95, 1, v97
v_lshl_add_u32 v99, v95, 7, v96
v_mul_u32_u24 v100, 1088, v98
v_add_u32 v99, v99, v100
v_add_u32 v7, 139264, v99
v_mul_u32_u24 v99, 784, v95
v_and_b32 v95, 3, v90
v_mul_u32_u24 v95, 192, v95
v_add3_u32 v96, v96, v99, v95
v_add_u32 v8, 141376, v96
v_add_u32 v26, s40, v96
v_lshrrev_b32 v95, 3, v90
v_lshl_add_u32 v96, v91, 1, v95
v_lshlrev_b32 v96, 12, v96
s_lshl_b32 s40, s32, 15
s_lshl_b32 s41, s34, 7
s_add_u32 s40, s40, s41
v_add3_u32 v10, v96, v93, s40
v_mul_u32_u24 v95, 0xaaaa, v101
v_add_u32 v17, 0x4444, v95
s_mov_b32 s80, 0x3e0293ee
s_mov_b64 s[90:91], -1
s_mov_b32 s89, 1568669696
v_mov_b32 v27, 0x2b800000
s_mov_b32 s82, 0
s_mov_b32 s83, -1
s_mov_b32 s37, 0
v_and_b32 v94, 7, v90
v_mov_b32 v32, 0
v_cmp_eq_u32 vcc, 0, v94
v_mov_b32 v95, 0x3f80
s_nop 0
v_cndmask_b32 v32, v32, v95, vcc
v_cmp_eq_u32 vcc, 1, v94
v_mov_b32 v95, 0x3f800000
s_nop 0
v_cndmask_b32 v32, v32, v95, vcc
v_mov_b32 v36, 0x3f803f80
v_mov_b32 v33, 0
v_cmp_eq_u32 vcc, 2, v94
v_mov_b32 v95, 0x3f80
s_nop 0
v_cndmask_b32 v33, v33, v95, vcc
v_cmp_eq_u32 vcc, 3, v94
v_mov_b32 v95, 0x3f800000
s_nop 0
v_cndmask_b32 v33, v33, v95, vcc
v_mov_b32 v37, 0x3f803f80
v_mov_b32 v34, 0
v_cmp_eq_u32 vcc, 4, v94
v_mov_b32 v95, 0x3f80
s_nop 0
v_cndmask_b32 v34, v34, v95, vcc
v_cmp_eq_u32 vcc, 5, v94
v_mov_b32 v95, 0x3f800000
s_nop 0
v_cndmask_b32 v34, v34, v95, vcc
v_mov_b32 v38, 0x3f803f80
v_mov_b32 v35, 0
v_cmp_eq_u32 vcc, 6, v94
v_mov_b32 v95, 0x3f80
s_nop 0
v_cndmask_b32 v35, v35, v95, vcc
v_cmp_eq_u32 vcc, 7, v94
v_mov_b32 v95, 0x3f800000
s_nop 0
v_cndmask_b32 v35, v35, v95, vcc
v_mov_b32 v39, 0x3f803f80
v_mov_b32 v12, 0
v_mov_b32 v13, 0
v_mov_b32 v30, 0
v_mov_b32 v31, 0
v_mov_b32 v20, 0
v_mov_b32 v21, 0
v_mov_b32 v22, 0
v_mov_b32 v23, 0
v_mov_b32 v24, 0
v_mov_b32 v25, 0
v_mov_b32 v72, 0
v_mov_b32 v73, 0
v_mov_b32 v74, 0
v_mov_b32 v75, 0
ds_write_b128 v5, v[72:75] offset:8192
ds_write_b128 v5, v[72:75] offset:9216
v_mov_b32 v16, v102
ds_write_b128 v5, v[120:123] offset:0
ds_write_b128 v5, v[124:127] offset:1024
v_cmp_ne_u32 vcc, 32, v103
s_cbranch_vccz L_rdy_15
s_mul_i32 s40, s35, 32
s_add_u32 s40, s40, 0
v_mov_b32 v101, s40
L_rw_16:
buffer_load_dword v100, v101, s[8:11], 0 offen offset:8 sc1
s_waitcnt vmcnt(0)
v_cmp_ne_u32 vcc, 32, v100
s_cbranch_vccz L_rwo_17
s_sub_u32 s36, s36, 1
s_cbranch_scc1 L_end_chain_L
s_sleep 2
s_branch L_rw_16
L_rwo_17:
L_rdy_15:
s_and_b32 s29, s37, 7
s_lshl_b32 s29, s29, 17
s_add_u32 s29, s29, s84
s_bfe_u32 s85, s37, 0x10003
s_add_u32 s30, s30, 2048
s_add_u32 s39, s38, 33554432
s_add_u32 s38, s38, 262144
v_mov_b32 v40, -1
v_mov_b32 v104, 0
v_mov_b32 v105, 0
v_mov_b32 v106, 0
v_mov_b32 v107, 0
v_mov_b32 v108, 0
v_mov_b32 v109, 0
v_mov_b32 v110, 0
v_mov_b32 v111, 0
v_mov_b32 v112, 0
v_mov_b32 v113, 0
v_mov_b32 v114, 0
v_mov_b32 v115, 0
v_mov_b32 v116, 0
v_mov_b32 v117, 0
v_mov_b32 v118, 0
v_mov_b32 v119, 0
v_mov_b32 v120, 0
v_mov_b32 v121, 0
v_mov_b32 v122, 0
v_mov_b32 v123, 0
v_mov_b32 v124, 0
v_mov_b32 v125, 0
v_mov_b32 v126, 0
v_mov_b32 v127, 0
ds_read_b128 v[80:83], v3 offset:0
ds_read_b128 v[84:87], v3 offset:1024
ds_read_b128 v[88:91], v3 offset:2048
ds_read_b128 v[92:95], v3 offset:3072
ds_read_b128 v[96:99], v3 offset:4096
ds_read_b128 v[100:103], v3 offset:5120
s_waitcnt lgkmcnt(0)
s_barrier
.p2align 5
L_ch_loop_L:
ds_read_b128 v[48:51], v4 offset:0
ds_read_b128 v[52:55], v4 offset:1024
ds_read_b128 v[56:59], v4 offset:2048
ds_read_b128 v[60:63], v4 offset:3072
ds_read_b128 v[64:67], v4 offset:4096
ds_read_b128 v[68:71], v4 offset:5120
ds_read_b128 v[72:75], v4 offset:6144
ds_read_b128 v[76:79], v4 offset:7168
s_waitcnt lgkmcnt(7)
v_smfmac_f32_16x16x64_bf16 v[112:115], v[48:51], v[128:135], v17
v_smfmac_f32_16x16x64_bf16 v[116:119], v[48:51], v[80:87], v17
ds_read_b128 v[80:83], v3 offset:6144
v_smfmac_f32_16x16x64_bf16 v[120:123], v[48:51], a[0:7], v17
ds_read_b128 v[84:87], v3 offset:7168
v_smfmac_f32_16x16x64_bf16 v[124:127], v[48:51], a[8:15], v17
buffer_load_dword v0, v16, s[4:7], s30 offen sc1
s_waitcnt lgkmcnt(8)
v_smfmac_f32_16x16x64_bf16 v[112:115], v[52:55], v[136:143], v17
v_smfmac_f32_16x16x64_bf16 v[116:119], v[52:55], v[88:95], v17
ds_read_b128 v[88:91], v3 offset:8192
v_smfmac_f32_16x16x64_bf16 v[120:123], v[52:55], a[16:23], v17
ds_read_b128 v[92:95], v3 offset:9216
v_smfmac_f32_16x16x64_bf16 v[124:127], v[52:55], a[24:31], v17
buffer_load_dwordx4 v[40:43], v2, s[4:7], s39 offen offset:0 sc1
s_waitcnt lgkmcnt(4)
v_smfmac_f32_16x16x64_bf16 v[112:115], v[56:59], v[144:151], v17
v_smfmac_f32_16x16x64_bf16 v[116:119], v[56:59], v[96:103], v17
ds_read_b128 v[96:99], v3 offset:10240
v_smfmac_f32_16x16x64_bf16 v[120:123], v[56:59], a[32:39], v17
ds_read_b128 v[100:103], v3 offset:11264
v_smfmac_f32_16x16x64_bf16 v[124:127], v[56:59], a[40:47], v17
buffer_load_dwordx4 v[44:47], v2, s[4:7], s39 offen offset:1024 sc1
v_smfmac_f32_16x16x64_bf16 v[112:115], v[60:63], v[152:159], v17
s_waitcnt lgkmcnt(4)
v_smfmac_f32_16x16x64_bf16 v[116:119], v[60:63], v[80:87], v17
ds_read_b128 v[80:83], v3 offset:12288
v_smfmac_f32_16x16x64_bf16 v[120:123], v[60:63], a[48:55], v17
ds_read_b128 v[84:87], v3 offset:13312
v_smfmac_f32_16x16x64_bf16 v[124:127], v[60:63], a[56:63], v17
v_smfmac_f32_16x16x64_bf16 v[112:115], v[64:67], v[160:167], v17
s_waitcnt lgkmcnt(4)
v_smfmac_f32_16x16x64_bf16 v[116:119], v[64:67], v[88:95], v17
ds_read_b128 v[88:91], v3 offset:14336
ds_read_b128 v[92:95], v3 offset:15360
v_smfmac_f32_16x16x64_bf16 v[112:115], v[68:71], v[168:175], v17
s_waitcnt lgkmcnt(4)
v_smfmac_f32_16x16x64_bf16 v[116:119], v[68:71], v[96:103], v17
v_smfmac_f32_16x16x64_bf16 v[112:115], v[72:75], v[176:183], v17
s_waitcnt lgkmcnt(2)
v_smfmac_f32_16x16x64_bf16 v[116:119], v[72:75], v[80:87], v17
v_smfmac_f32_16x16x64_bf16 v[112:115], v[76:79], v[184:191], v17
s_waitcnt lgkmcnt(0)
v_smfmac_f32_16x16x64_bf16 v[116:119], v[76:79], v[88:95], v17
v_smfmac_f32_16x16x64_bf16 v[120:123], v[64:67], a[64:71], v17
ds_read_b128 v[80:83], v18 offset:0
v_smfmac_f32_16x16x64_bf16 v[124:127], v[64:67], a[72:79], v17
ds_read_b128 v[84:87], v18 offset:1024
s_nop 1
v_smfmac_f32_16x16x64_bf16 v[120:123], v[68:71], a[80:87], v17
v_add_f32 v112, v112, v114
v_smfmac_f32_16x16x64_bf16 v[124:127], v[68:71], a[88:95], v17
v_add_f32 v113, v113, v115
v_smfmac_f32_16x16x64_bf16 v[120:123], v[72:75], a[96:103], v17
v_add_f32 v116, v116, v118
v_smfmac_f32_16x16x64_bf16 v[124:127], v[72:75], a[104:111], v17
v_add_f32 v117, v117, v119
v_smfmac_f32_16x16x64_bf16 v[120:123], v[76:79], a[112:119], v17
v_mul_f32 v112, s80, v112
v_smfmac_f32_16x16x64_bf16 v[124:127], v[76:79], a[120:127], v17
v_mul_f32 v113, s80, v113
v_smfmac_f32_16x16x64_bf16 v[104:107], v[48:51], a[128:135], v17
v_mul_f32 v116, s80, v116
v_mul_f32 v117, s80, v117
v_smfmac_f32_16x16x64_bf16 v[108:111], v[48:51], a[136:143], v17
v_cvt_pk_bf16_f32 v112, v112, v113
v_cvt_pk_bf16_f32 v113, v116, v117
ds_write2_b32 v6, v112, v113 offset0:0 offset1:32
v_add_f32 v120, v120, v122
v_add_f32 v121, v121, v123
v_add_f32 v124, v124, v126
v_add_f32 v125, v125, v127
v_cvt_pk_bf16_f32 v120, v120, v121
v_cvt_pk_bf16_f32 v121, v124, v125
ds_write2_b32 v19, v120, v121 offset0:0 offset1:196
v_smfmac_f32_16x16x64_bf16 v[104:107], v[52:55], a[144:151], v17
ds_read_b128 v[88:91], v18 offset:2048
v_smfmac_f32_16x16x64_bf16 v[108:111], v[52:55], a[152:159], v17
ds_read_b128 v[92:95], v18 offset:3072
v_smfmac_f32_16x16x64_bf16 v[104:107], v[56:59], a[160:167], v17
ds_read_b128 v[96:99], v18 offset:4096
v_smfmac_f32_16x16x64_bf16 v[108:111], v[56:59], a[168:175], v17
ds_read_b128 v[100:103], v18 offset:5120
s_waitcnt lgkmcnt(4)
s_barrier
ds_read_b64_tr_b16 v[112:113], v7 offset:0
ds_read_b64_tr_b16 v[114:115], v7 offset:16
ds_read_b64_tr_b16 v[116:117], v8 offset:0
ds_read_b64_tr_b16 v[118:119], v8 offset:16
ds_read_b64_tr_b16 v[120:121], v7 offset:256
ds_read_b64_tr_b16 v[122:123], v7 offset:272
ds_read_b64_tr_b16 v[124:125], v8 offset:1488
ds_read_b64_tr_b16 v[126:127], v8 offset:1504
v_smfmac_f32_16x16x64_bf16 v[104:107], v[60:63], a[176:183], v17
v_smfmac_f32_16x16x64_bf16 v[108:111], v[60:63], a[184:191], v17
v_smfmac_f32_16x16x64_bf16 v[104:107], v[64:67], a[192:199], v17
v_smfmac_f32_16x16x64_bf16 v[108:111], v[64:67], a[200:207], v17
ds_read_b128 v[60:63], v18 offset:6144
ds_read_b128 v[64:67], v18 offset:7168
s_waitcnt lgkmcnt(8)
v_mfma_f32_16x16x32_bf16 v[48:51], v[80:83], v[112:115], 0
v_mfma_f32_16x16x32_bf16 v[52:55], v[84:87], v[112:115], 0
s_waitcnt lgkmcnt(6)
v_mfma_f32_16x16x32_bf16 v[56:59], v[116:119], v[112:115], 0
ds_read_b64_tr_b16 v[112:113], v7 offset:512
ds_read_b64_tr_b16 v[114:115], v7 offset:528
ds_read_b64_tr_b16 v[116:117], v8 offset:2976
ds_read_b64_tr_b16 v[118:119], v8 offset:2992
s_waitcnt lgkmcnt(8)
v_mfma_f32_16x16x32_bf16 v[48:51], v[88:91], v[120:123], v[48:51]
v_mfma_f32_16x16x32_bf16 v[52:55], v[92:95], v[120:123], v[52:55]
ds_read_b64_tr_b16 v[80:81], v26 offset:0
ds_read_b64_tr_b16 v[82:83], v26 offset:16
s_waitcnt lgkmcnt(8)
v_mfma_f32_16x16x32_bf16 v[56:59], v[124:127], v[120:123], v[56:59]
ds_read_b64_tr_b16 v[120:121], v7 offset:768
ds_read_b64_tr_b16 v[122:123], v7 offset:784
ds_read_b64_tr_b16 v[124:125], v8 offset:4464
ds_read_b64_tr_b16 v[126:127], v8 offset:4480
v_smfmac_f32_16x16x64_bf16 v[104:107], v[68:71], a[208:215], v17
s_waitcnt lgkmcnt(8)
v_mfma_f32_16x16x32_bf16 v[48:51], v[96:99], v[112:115], v[48:51]
s_waitcnt vmcnt(2)
v_cmp_eq_u32 vcc, 0, v0
s_cbranch_vccnz L_fl_18
L_flo_19:
v_mfma_f32_16x16x32_bf16 v[52:55], v[100:103], v[112:115], v[52:55]
s_mov_b32 m0, s31
s_xor_b32 s31, s31, 8192
s_waitcnt lgkmcnt(6)
v_mfma_f32_16x16x32_bf16 v[56:59], v[116:119], v[112:115], v[56:59]
buffer_load_dwordx4 v2, s[4:7], s38 offen offset:0 sc1 lds
v_smfmac_f32_16x16x64_bf16 v[108:111], v[68:71], a[216:223], v17
s_waitcnt lgkmcnt(2)
v_mfma_f32_16x16x32_bf16 v[48:51], v[60:63], v[120:123], v[48:51]
v_bfi_b32 v80, 1, s85, v80
v_bfi_b32 v81, 1, s85, v81
v_mfma_f32_16x16x32_bf16 v[52:55], v[64:67], v[120:123], v[52:55]
v_bfi_b32 v82, 1, s85, v82
v_bfi_b32 v83, 1, s85, v83
s_waitcnt lgkmcnt(0)
v_mfma_f32_16x16x32_bf16 v[56:59], v[124:127], v[120:123], v[56:59]
v_smfmac_f32_16x16x64_bf16 v[104:107], v[72:75], a[224:231], v17
buffer_store_dwordx4 v[80:83], v14, s[4:7], s29 offen sc1
s_bfe_u32 s28, s37, 0x10001
v_smfmac_f32_16x16x64_bf16 v[108:111], v[72:75], a[232:239], v17
ds_read_b128 v[88:91], v3 offset:18432
ds_read_b128 v[92:95], v3 offset:19456
s_nop 0
v_exp_f32 v112, v48
v_smfmac_f32_16x16x64_bf16 v[104:107], v[76:79], a[240:247], v17
v_exp_f32 v113, v52
v_smfmac_f32_16x16x64_bf16 v[108:111], v[76:79], a[248:255], v17
v_exp_f32 v114, v49
v_exp_f32 v115, v53
buffer_load_dwordx4 v2, s[4:7], s38 offen offset:1024 sc1 lds
v_exp_f32 v116, v50
v_exp_f32 v117, v54
v_exp_f32 v118, v51
v_exp_f32 v119, v55
v_exp_f32 v120, v56
v_exp_f32 v121, v57
L_smb_21:
v_cvt_pk_bf16_f32 v76, v112, v113
v_cvt_pk_bf16_f32 v77, v114, v115
v_cvt_pk_bf16_f32 v78, v116, v117
v_cvt_pk_bf16_f32 v79, v118, v119
v_cvt_pk_bf16_f32 v23, v120, v121
v_cvt_pk_bf16_f32 v20, v120, v121
s_waitcnt vmcnt(3)
v_mfma_f32_16x16x32_bf16 v[120:123], v[36:39], v[76:79], 0
v_add_f32 v124, v104, v106
v_add_f32 v125, v105, v107
v_mfma_f32_16x16x32_bf16 v[120:123], v[36:39], v[22:25], v[120:123]
v_add_f32 v126, v108, v110
v_add_f32 v127, v109, v111
v_mfma_f32_16x16x32_bf16 v[112:115], v[40:43], v[76:79], 0
v_cvt_pk_bf16_f32 v28, v124, v125
v_cvt_pk_bf16_f32 v29, v126, v127
v_mfma_f32_16x16x32_bf16 v[116:119], v[44:47], v[76:79], 0
v_bfi_b32 v58, 1, s85, v28
v_bfi_b32 v59, 1, s85, v29
v_mfma_f32_16x16x32_bf16 v[112:115], v[28:31], v[20:23], v[112:115]
buffer_store_dwordx2 v[58:59], v15, s[4:7], s29 offen offset:2048 sc1
v_med3_f32 v121, v120, v27, s89
v_mfma_f32_16x16x32_bf16 v[116:119], v[28:31], v[22:25], v[116:119]
v_cmp_lg_f32 vcc, v121, v120
v_rcp_f32 v120, v120
s_cmp_eq_u32 s37, 63
s_cbranch_scc1 L_ch_last_L
s_and_b64 vcc, vcc, s[90:91]
s_cbranch_vccnz L_smx_20
v_mfma_f32_16x16x16_bf16 v[60:63], v[24:25], v[24:25], 0
ds_read_b128 v[80:83], v3 offset:16384
ds_read_b128 v[84:87], v3 offset:17408
v_mul_f32 v112, v112, v120
v_mul_f32 v113, v113, v120
v_mul_f32 v114, v114, v120
v_mul_f32 v115, v115, v120
v_mul_f32 v116, v116, v120
v_cvt_pk_bf16_f32 v124, v112, v116
v_mul_f32 v117, v117, v120
v_cvt_pk_bf16_f32 v125, v113, v117
v_mul_f32 v118, v118, v120
v_cvt_pk_bf16_f32 v126, v114, v118
v_mul_f32 v119, v119, v120
v_cvt_pk_bf16_f32 v127, v115, v119
ds_write_b128 v9, v[124:127]
v_mfma_f32_16x16x16_bf16 v[64:67], v[24:25], v[24:25], 0
ds_read_b128 v[96:99], v3 offset:20480
ds_read_b128 v[100:103], v3 offset:21504
v_mfma_f32_16x16x16_bf16 v[68:71], v[24:25], v[24:25], 0
ds_read_b128 v[104:107], v3 offset:22528
ds_read_b128 v[108:111], v3 offset:23552
v_mfma_f32_16x16x16_bf16 v[72:75], v[24:25], v[24:25], 0
s_mov_b64 s[90:91], -1
s_waitcnt lgkmcnt(4)
s_barrier
ds_read_b128 v[112:115], v4 offset:0
ds_read_b128 v[116:119], v4 offset:1024
v_mfma_f32_16x16x16_bf16 v[48:51], v[24:25], v[24:25], 0
v_mfma_f32_16x16x16_bf16 v[52:55], v[24:25], v[24:25], 0
v_mfma_f32_16x16x16_bf16 v[56:59], v[24:25], v[24:25], 0
s_waitcnt lgkmcnt(1)
v_smfmac_f32_16x16x64_bf16 v[60:63], v[112:115], v[192:199], v17
v_mov_b32 v76, 0
v_smfmac_f32_16x16x64_bf16 v[68:71], v[112:115], v[80:87], v17
ds_read_b128 v[80:83], v3 offset:24576
ds_read_b128 v[84:87], v3 offset:25600
v_mov_b32 v77, 0
v_smfmac_f32_16x16x64_bf16 v[64:67], v[112:115], v[208:215], v17
v_mov_b32 v78, 0
v_smfmac_f32_16x16x64_bf16 v[72:75], v[112:115], v[96:103], v17
ds_read_b128 v[96:99], v3 offset:28672
ds_read_b128 v[100:103], v3 offset:29696
v_mov_b32 v79, 0
s_waitcnt lgkmcnt(4)
v_smfmac_f32_16x16x64_bf16 v[60:63], v[116:119], v[200:207], v17
v_smfmac_f32_16x16x64_bf16 v[68:71], v[116:119], v[88:95], v17
ds_read_b128 v[88:91], v3 offset:26624
ds_read_b128 v[92:95], v3 offset:27648
v_smfmac_f32_16x16x64_bf16 v[64:67], v[116:119], v[216:223], v17
v_smfmac_f32_16x16x64_bf16 v[72:75], v[116:119], v[104:111], v17
ds_read_b128 v[104:107], v3 offset:30720
ds_read_b128 v[108:111], v3 offset:31744
v_smfmac_f32_16x16x64_bf16 v[48:51], v[112:115], v[224:231], v17
s_waitcnt lgkmcnt(6)
v_smfmac_f32_16x16x64_bf16 v[56:59], v[112:115], v[80:87], v17
v_smfmac_f32_16x16x64_bf16 v[52:55], v[112:115], v[240:247], v17
v_add_f32 v60, v60, v62
v_add_f32 v61, v61, v63
s_waitcnt lgkmcnt(4)
v_smfmac_f32_16x16x64_bf16 v[76:79], v[112:115], v[96:103], v17
v_add_f32 v64, v64, v66
v_add_f32 v65, v65, v67
v_smfmac_f32_16x16x64_bf16 v[48:51], v[116:119], v[232:239], v17
v_add_f32 v68, v68, v70
v_add_f32 v69, v69, v71
s_waitcnt lgkmcnt(2)
v_smfmac_f32_16x16x64_bf16 v[56:59], v[116:119], v[88:95], v17
v_add_f32 v72, v72, v74
v_add_f32 v73, v73, v75
v_smfmac_f32_16x16x64_bf16 v[52:55], v[116:119], v[248:255], v17
v_cvt_pk_bf16_f32 v124, v60, v68
v_cvt_pk_bf16_f32 v125, v64, v72
s_waitcnt lgkmcnt(0)
v_smfmac_f32_16x16x64_bf16 v[76:79], v[116:119], v[104:111], v17
v_cvt_pk_bf16_f32 v126, v61, v69
v_cvt_pk_bf16_f32 v127, v65, v73
s_add_u32 s40, s76, 0
v_bfi_b32 v124, 1, s28, v124
v_bfi_b32 v125, 1, s28, v125
v_bfi_b32 v126, 1, s28, v126
v_bfi_b32 v127, 1, s28, v127
buffer_store_dwordx4 v[124:127], v10, s[4:7], s40 offen
v_pk_add_f32 v[48:49], v[48:49], v[50:51]
v_pk_add_f32 v[52:53], v[52:53], v[54:55]
v_pk_add_f32 v[56:57], v[56:57], v[58:59]
v_pk_add_f32 v[76:77], v[76:77], v[78:79]
v_cvt_pk_bf16_f32 v124, v48, v56
v_cvt_pk_bf16_f32 v125, v52, v76
v_cvt_pk_bf16_f32 v126, v49, v57
v_cvt_pk_bf16_f32 v127, v53, v77
s_add_u32 s40, s76, 131072
v_bfi_b32 v124, 1, s28, v124
v_bfi_b32 v125, 1, s28, v125
v_bfi_b32 v126, 1, s28, v126
v_bfi_b32 v127, 1, s28, v127
buffer_store_dwordx4 v[124:127], v10, s[4:7], s40 offen
s_add_u32 s37, s37, 1
s_and_b32 s29, s37, 7
s_lshl_b32 s29, s29, 17
s_add_u32 s29, s29, s84
s_bfe_u32 s85, s37, 0x10003
s_add_u32 s30, s30, 2048
s_add_u32 s39, s38, 33554432
s_add_u32 s38, s38, 262144
v_xor_b32 v18, 8192, v18
v_mov_b32 v40, -1
ds_read_b128 v[80:83], v3 offset:0
ds_read_b128 v[84:87], v3 offset:1024
ds_read_b128 v[88:91], v3 offset:2048
ds_read_b128 v[92:95], v3 offset:3072
ds_read_b128 v[96:99], v3 offset:4096
ds_read_b128 v[100:103], v3 offset:5120
v_mov_b32 v104, 0
v_mov_b32 v105, 0
v_mov_b32 v106, 0
v_mov_b32 v107, 0
s_cmp_ge_u32 s32, 2
s_cbranch_scc1 L_nored_22
v_mov_b32 v118, -1
s_waitcnt vmcnt(0)
s_cmp_eq_u32 s28, 1
s_cbranch_scc1 L_and_24
L_or_25:
buffer_load_dwordx4 v[48:51], v2, s[4:7], s77 offen offset:0 sc1
buffer_load_dwordx4 v[52:55], v2, s[4:7], s77 offen offset:1024 sc1
buffer_load_dwordx4 v[56:59], v2, s[4:7], s77 offen offset:2048 sc1
buffer_load_dwordx4 v[60:63], v2, s[4:7], s77 offen offset:3072 sc1
s_waitcnt vmcnt(3)
v_mfma_f32_16x16x32_bf16 v[112:115], v[32:35], v[48:51], 0
v_or3_b32 v116, v48, v49, v50
v_or3_b32 v117, v51, v51, v51
s_waitcnt vmcnt(2)
v_mfma_f32_16x16x32_bf16 v[112:115], v[32:35], v[52:55], v[112:115]
v_or3_b32 v116, v116, v52, v53
v_or3_b32 v117, v117, v54, v55
s_waitcnt vmcnt(1)
v_mfma_f32_16x16x32_bf16 v[112:115], v[32:35], v[56:59], v[112:115]
v_or3_b32 v116, v116, v56, v57
v_or3_b32 v117, v117, v58, v59
s_waitcnt vmcnt(0)
v_mfma_f32_16x16x32_bf16 v[112:115], v[32:35], v[60:63], v[112:115]
v_or3_b32 v116, v116, v60, v61
v_or3_b32 v117, v117, v62, v63
v_or3_b32 v116, v116, v117, v117
v_and_b32 v116, 1, v116
v_cmp_ne_u32 vcc, 0, v116
s_cbranch_vccz L_redd_23
s_sub_u32 s36, s36, 1
s_cbranch_scc1 L_end_chain_L
s_branch L_or_25
L_and_24:
buffer_load_dwordx4 v[48:51], v2, s[4:7], s77 offen offset:0 sc1
buffer_load_dwordx4 v[52:55], v2, s[4:7], s77 offen offset:1024 sc1
buffer_load_dwordx4 v[56:59], v2, s[4:7], s77 offen offset:2048 sc1
buffer_load_dwordx4 v[60:63], v2, s[4:7], s77 offen offset:3072 sc1
s_waitcnt vmcnt(3)
v_mfma_f32_16x16x32_bf16 v[112:115], v[32:35], v[48:51], 0
v_bitop3_b32 v116, v48, v49, v50 bitop3:0x80
v_bitop3_b32 v117, v51, v51, v51 bitop3:0x80
s_waitcnt vmcnt(2)
v_mfma_f32_16x16x32_bf16 v[112:115], v[32:35], v[52:55], v[112:115]
v_bitop3_b32 v116, v116, v52, v53 bitop3:0x80
v_bitop3_b32 v117, v117, v54, v55 bitop3:0x80
s_waitcnt vmcnt(1)
v_mfma_f32_16x16x32_bf16 v[112:115], v[32:35], v[56:59], v[112:115]
v_bitop3_b32 v116, v116, v56, v57 bitop3:0x80
v_bitop3_b32 v117, v117, v58, v59 bitop3:0x80
s_waitcnt vmcnt(0)
v_mfma_f32_16x16x32_bf16 v[112:115], v[32:35], v[60:63], v[112:115]
v_bitop3_b32 v116, v116, v60, v61 bitop3:0x80
v_bitop3_b32 v117, v117, v62, v63 bitop3:0x80
v_bitop3_b32 v116, v116, v117, v117 bitop3:0x80
v_and_b32 v116, 1, v116
v_cmp_eq_u32 vcc, 0, v116
s_cbranch_vccz L_redd_23
s_sub_u32 s36, s36, 1
s_cbranch_scc1 L_end_chain_L
s_branch L_and_24
L_redd_23:
s_nop 1
v_cndmask_b32 v112, v112, v114, s[82:83]
v_cndmask_b32 v113, v113, v115, s[82:83]
s_nop 0
v_add_f32_dpp v112, v112, v112 row_ror:8 row_mask:0xf bank_mask:0xf
v_add_f32_dpp v113, v113, v113 row_ror:8 row_mask:0xf bank_mask:0xf
v_cvt_pk_bf16_f32 v116, v112, v113
v_min_u32 v116, -2, v116
buffer_store_dword v116, v11, s[4:7], s79 offen
s_xor_b32 s79, s79, 0x2000
s_add_u32 s40, s79, 0
buffer_store_dword v118, v11, s[4:7], s40 offen
L_nored_22:
s_xor_b32 s77, s77, 0x40000
s_xor_b32 s76, s76, 0x40000
s_barrier
v_mov_b32 v108, 0
v_mov_b32 v109, 0
v_mov_b32 v110, 0
v_mov_b32 v111, 0
v_mov_b32 v120, 0
v_mov_b32 v121, 0
v_mov_b32 v122, 0
v_mov_b32 v123, 0
v_mov_b32 v124, 0
v_mov_b32 v125, 0
v_mov_b32 v126, 0
v_mov_b32 v127, 0
v_mov_b32 v112, 0
v_mov_b32 v113, 0
v_mov_b32 v114, 0
v_mov_b32 v115, 0
v_mov_b32 v116, 0
v_mov_b32 v117, 0
v_mov_b32 v118, 0
v_mov_b32 v119, 0
L_g0_26:
buffer_load_dwordx4 v[64:67], v2, s[4:7], s78 offen offset:0 sc1
buffer_load_dwordx4 v[68:71], v2, s[4:7], s78 offen offset:1024 sc1
s_waitcnt vmcnt(1)
v_max3_u32 v48, v64, v65, v66
s_waitcnt vmcnt(0)
v_max3_u32 v49, v67, v68, v69
v_max3_u32 v48, v48, v70, v71
v_max_u32 v48, v48, v49
v_cmp_eq_u32 vcc, -1, v48
s_cbranch_vccz L_st_27
s_sub_u32 s36, s36, 1
s_cbranch_scc1 L_end_chain_L
s_branch L_g0_26
L_st_27:
ds_write_b128 v5, v[64:67] offset:0
ds_write_b128 v5, v[68:71] offset:1024
L_ste_28:
s_xor_b32 s78, s78, 0x2000
s_waitcnt lgkmcnt(0)
s_barrier
s_branch L_ch_loop_L
L_fl_18:
s_cmp_eq_u32 s37, 63
s_cbranch_scc1 L_flo_19
s_sub_u32 s36, s36, 1
s_cbranch_scc1 L_end_chain_L
buffer_load_dword v0, v16, s[4:7], s30 offen sc1
s_waitcnt vmcnt(0)
v_cmp_eq_u32 vcc, 0, v0
s_cbranch_vccnz L_fl_18
s_branch L_flo_19
L_smx_20:
v_max3_f32 v58, v48, v49, v50
v_max3_f32 v58, v58, v51, v52
v_max3_f32 v58, v58, v53, v54
v_max3_f32 v58, v58, v55, v56
v_max_f32 v58, v58, v57
v_mov_b32 v59, v58
s_nop 1
v_permlane16_swap_b32 v58, v59
v_max_f32 v58, v58, v59
v_mov_b32 v59, v58
s_nop 1
v_permlane32_swap_b32 v58, v59
v_max_f32 v58, v58, v59
v_sub_f32 v48, v48, v58
v_sub_f32 v52, v52, v58
v_sub_f32 v49, v49, v58
v_sub_f32 v53, v53, v58
v_sub_f32 v50, v50, v58
v_sub_f32 v54, v54, v58
v_sub_f32 v51, v51, v58
v_sub_f32 v55, v55, v58
v_sub_f32 v56, v56, v58
v_sub_f32 v57, v57, v58
v_exp_f32 v112, v48
v_exp_f32 v113, v52
v_exp_f32 v114, v49
v_exp_f32 v115, v53
v_exp_f32 v116, v50
v_exp_f32 v117, v54
v_exp_f32 v118, v51
v_exp_f32 v119, v55
v_exp_f32 v120, v56
v_exp_f32 v121, v57
s_mov_b32 s90, 0
s_mov_b32 s91, 0
s_branch L_smb_21
L_ch_last_L:
s_endpgm
L_fb_chain:
s_getpc_b64 s[40:41]
L_fb_chain_pc:
s_add_u32 s40, s40, L_fallback-L_fb_chain_pc
s_addc_u32 s41, s41, -1
s_setpc_b64 s[40:41]
L_end_chain_L:
s_endpgm
.p2align 6
R_qkv_L:
s_mov_b32 s12, s52
s_mov_b32 s13, s53
s_mov_b32 s14, 4194304
s_mov_b32 s15, 0x20000
s_sub_u32 s37, s35, 1
s_cmp_eq_u32 s37, 1
s_cselect_b32 s16, s54, s56
s_cselect_b32 s17, s55, s57
s_mov_b32 s18, 4194304
s_mov_b32 s19, 0x20000
v_and_b32 v20, 15, v1
v_lshrrev_b32 v21, 4, v1
v_lshlrev_b32 v22, 3, v21
s_lshl_b32 s40, s34, 8
s_lshl_b32 s42, s32, 6
s_add_u32 s42, s42, s40
s_lshr_b32 s43, s32, 1
s_lshl_b32 s41, s37, 1
s_add_u32 s43, s43, s41
s_sub_u32 s43, s43, 2
s_lshl_b32 s44, s43, 6
s_add_u32 s44, s44, s40
s_mul_i32 s38, s32, 40960
s_waitcnt vmcnt(0)
s_barrier
s_cmp_lg_u32 s32, 0
s_cbranch_scc1 L_da_29
v_mov_b32 v100, 1
s_lshl_b32 s40, s33, 5
v_mov_b32 v101, s40
s_mov_b64 exec, 1
buffer_atomic_add v100, v101, s[8:11], 0 offen offset:4
s_mov_b64 exec, -1
L_da_29:
v_lshrrev_b32 v23, 2, v1
v_mul_u32_u24 v23, 8192, v23
v_and_b32 v12, 3, v1
v_lshl_add_u32 v12, v12, 4, v23
v_add_u32 v13, 130048, v12
v_and_b32 v23, 15, v1
v_lshlrev_b32 v23, 2, v23
v_lshl_add_u32 v14, v22, 6, v23
v_add_u32 v14, s38, v14
s_add_u32 s45, s42, 0
s_add_u32 m0, s38, 0
s_nop 0
buffer_load_dwordx4 v12, s[16:19], s45 offen offset:0 lds
buffer_load_dwordx4 v13, s[16:19], s45 offen offset:1024 lds
s_add_u32 s45, s42, 262144
s_add_u32 m0, s38, 2048
s_nop 0
buffer_load_dwordx4 v12, s[16:19], s45 offen offset:0 lds
buffer_load_dwordx4 v13, s[16:19], s45 offen offset:1024 lds
s_add_u32 s45, s42, 524288
s_add_u32 m0, s38, 4096
s_nop 0
buffer_load_dwordx4 v12, s[16:19], s45 offen offset:0 lds
buffer_load_dwordx4 v13, s[16:19], s45 offen offset:1024 lds
s_add_u32 s45, s42, 786432
s_add_u32 m0, s38, 6144
s_nop 0
buffer_load_dwordx4 v12, s[16:19], s45 offen offset:0 lds
buffer_load_dwordx4 v13, s[16:19], s45 offen offset:1024 lds
s_add_u32 s45, s42, 1048576
s_add_u32 m0, s38, 8192
s_nop 0
buffer_load_dwordx4 v12, s[16:19], s45 offen offset:0 lds
buffer_load_dwordx4 v13, s[16:19], s45 offen offset:1024 lds
s_add_u32 s45, s42, 1310720
s_add_u32 m0, s38, 10240
s_nop 0
buffer_load_dwordx4 v12, s[16:19], s45 offen offset:0 lds
buffer_load_dwordx4 v13, s[16:19], s45 offen offset:1024 lds
s_add_u32 s45, s42, 1572864
s_add_u32 m0, s38, 12288
s_nop 0
buffer_load_dwordx4 v12, s[16:19], s45 offen offset:0 lds
buffer_load_dwordx4 v13, s[16:19], s45 offen offset:1024 lds
s_add_u32 s45, s42, 1835008
s_add_u32 m0, s38, 14336
s_nop 0
buffer_load_dwordx4 v12, s[16:19], s45 offen offset:0 lds
buffer_load_dwordx4 v13, s[16:19], s45 offen offset:1024 lds
s_add_u32 s45, s42, 2097152
s_add_u32 m0, s38, 16384
s_nop 0
buffer_load_dwordx4 v12, s[16:19], s45 offen offset:0 lds
buffer_load_dwordx4 v13, s[16:19], s45 offen offset:1024 lds
s_add_u32 s45, s42, 2359296
s_add_u32 m0, s38, 18432
s_nop 0
buffer_load_dwordx4 v12, s[16:19], s45 offen offset:0 lds
buffer_load_dwordx4 v13, s[16:19], s45 offen offset:1024 lds
s_add_u32 s45, s42, 2621440
s_add_u32 m0, s38, 20480
s_nop 0
buffer_load_dwordx4 v12, s[16:19], s45 offen offset:0 lds
buffer_load_dwordx4 v13, s[16:19], s45 offen offset:1024 lds
s_add_u32 s45, s42, 2883584
s_add_u32 m0, s38, 22528
s_nop 0
buffer_load_dwordx4 v12, s[16:19], s45 offen offset:0 lds
buffer_load_dwordx4 v13, s[16:19], s45 offen offset:1024 lds
s_add_u32 s45, s42, 3145728
s_add_u32 m0, s38, 24576
s_nop 0
buffer_load_dwordx4 v12, s[16:19], s45 offen offset:0 lds
buffer_load_dwordx4 v13, s[16:19], s45 offen offset:1024 lds
s_add_u32 s45, s42, 3407872
s_add_u32 m0, s38, 26624
s_nop 0
buffer_load_dwordx4 v12, s[16:19], s45 offen offset:0 lds
buffer_load_dwordx4 v13, s[16:19], s45 offen offset:1024 lds
s_add_u32 s45, s42, 3670016
s_add_u32 m0, s38, 28672
s_nop 0
buffer_load_dwordx4 v12, s[16:19], s45 offen offset:0 lds
buffer_load_dwordx4 v13, s[16:19], s45 offen offset:1024 lds
s_add_u32 s45, s42, 3932160
s_add_u32 m0, s38, 30720
s_nop 0
buffer_load_dwordx4 v12, s[16:19], s45 offen offset:0 lds
buffer_load_dwordx4 v13, s[16:19], s45 offen offset:1024 lds
s_add_u32 s45, s44, 0
s_add_u32 m0, s38, 32768
s_nop 0
buffer_load_dwordx4 v12, s[12:15], s45 offen offset:0 lds
buffer_load_dwordx4 v13, s[12:15], s45 offen offset:1024 lds
s_add_u32 s45, s44, 262144
s_add_u32 m0, s38, 34816
s_nop 0
buffer_load_dwordx4 v12, s[12:15], s45 offen offset:0 lds
buffer_load_dwordx4 v13, s[12:15], s45 offen offset:1024 lds
s_add_u32 s45, s44, 524288
s_add_u32 m0, s38, 36864
s_nop 0
buffer_load_dwordx4 v12, s[12:15], s45 offen offset:0 lds
buffer_load_dwordx4 v13, s[12:15], s45 offen offset:1024 lds
s_add_u32 s45, s44, 786432
s_add_u32 m0, s38, 38912
s_nop 0
buffer_load_dwordx4 v12, s[12:15], s45 offen offset:0 lds
buffer_load_dwordx4 v13, s[12:15], s45 offen offset:1024 lds
s_waitcnt vmcnt(38)
ds_read_b32 v40, v14 offset:0
ds_read_b32 v41, v14 offset:64
ds_read_b32 v42, v14 offset:128
ds_read_b32 v43, v14 offset:192
ds_read_b32 v44, v14 offset:256
ds_read_b32 v45, v14 offset:320
ds_read_b32 v46, v14 offset:384
ds_read_b32 v47, v14 offset:448
s_waitcnt lgkmcnt(6)
v_perm_b32 v32, v41, v40, s46
v_perm_b32 v36, v41, v40, s47
s_waitcnt lgkmcnt(4)
v_perm_b32 v33, v43, v42, s46
v_perm_b32 v37, v43, v42, s47
s_waitcnt lgkmcnt(2)
v_perm_b32 v34, v45, v44, s46
v_perm_b32 v38, v45, v44, s47
s_waitcnt lgkmcnt(0)
v_perm_b32 v35, v47, v46, s46
v_perm_b32 v39, v47, v46, s47
s_add_u32 s45, s44, 1048576
s_add_u32 m0, s38, 0
s_nop 0
buffer_load_dwordx4 v12, s[12:15], s45 offen offset:0 lds
buffer_load_dwordx4 v13, s[12:15], s45 offen offset:1024 lds
v_accvgpr_write_b32 a0, v32
v_accvgpr_write_b32 a1, v33
v_accvgpr_write_b32 a2, v34
v_accvgpr_write_b32 a3, v35
v_accvgpr_write_b32 a4, v36
v_accvgpr_write_b32 a5, v37
v_accvgpr_write_b32 a6, v38
v_accvgpr_write_b32 a7, v39
s_waitcnt vmcnt(38)
ds_read_b32 v40, v14 offset:2048
ds_read_b32 v41, v14 offset:2112
ds_read_b32 v42, v14 offset:2176
ds_read_b32 v43, v14 offset:2240
ds_read_b32 v44, v14 offset:2304
ds_read_b32 v45, v14 offset:2368
ds_read_b32 v46, v14 offset:2432
ds_read_b32 v47, v14 offset:2496
s_waitcnt lgkmcnt(6)
v_perm_b32 v32, v41, v40, s46
v_perm_b32 v36, v41, v40, s47
s_waitcnt lgkmcnt(4)
v_perm_b32 v33, v43, v42, s46
v_perm_b32 v37, v43, v42, s47
s_waitcnt lgkmcnt(2)
v_perm_b32 v34, v45, v44, s46
v_perm_b32 v38, v45, v44, s47
s_waitcnt lgkmcnt(0)
v_perm_b32 v35, v47, v46, s46
v_perm_b32 v39, v47, v46, s47
s_add_u32 s45, s44, 1310720
s_add_u32 m0, s38, 2048
s_nop 0
buffer_load_dwordx4 v12, s[12:15], s45 offen offset:0 lds
buffer_load_dwordx4 v13, s[12:15], s45 offen offset:1024 lds
v_accvgpr_write_b32 a8, v32
v_accvgpr_write_b32 a9, v33
v_accvgpr_write_b32 a10, v34
v_accvgpr_write_b32 a11, v35
v_accvgpr_write_b32 a12, v36
v_accvgpr_write_b32 a13, v37
v_accvgpr_write_b32 a14, v38
v_accvgpr_write_b32 a15, v39
s_waitcnt vmcnt(38)
ds_read_b32 v40, v14 offset:4096
ds_read_b32 v41, v14 offset:4160
ds_read_b32 v42, v14 offset:4224
ds_read_b32 v43, v14 offset:4288
ds_read_b32 v44, v14 offset:4352
ds_read_b32 v45, v14 offset:4416
ds_read_b32 v46, v14 offset:4480
ds_read_b32 v47, v14 offset:4544
s_waitcnt lgkmcnt(6)
v_perm_b32 v32, v41, v40, s46
v_perm_b32 v36, v41, v40, s47
s_waitcnt lgkmcnt(4)
v_perm_b32 v33, v43, v42, s46
v_perm_b32 v37, v43, v42, s47
s_waitcnt lgkmcnt(2)
v_perm_b32 v34, v45, v44, s46
v_perm_b32 v38, v45, v44, s47
s_waitcnt lgkmcnt(0)
v_perm_b32 v35, v47, v46, s46
v_perm_b32 v39, v47, v46, s47
s_add_u32 s45, s44, 1572864
s_add_u32 m0, s38, 4096
s_nop 0
buffer_load_dwordx4 v12, s[12:15], s45 offen offset:0 lds
buffer_load_dwordx4 v13, s[12:15], s45 offen offset:1024 lds
v_accvgpr_write_b32 a16, v32
v_accvgpr_write_b32 a17, v33
v_accvgpr_write_b32 a18, v34
v_accvgpr_write_b32 a19, v35
v_accvgpr_write_b32 a20, v36
v_accvgpr_write_b32 a21, v37
v_accvgpr_write_b32 a22, v38
v_accvgpr_write_b32 a23, v39
s_waitcnt vmcnt(38)
ds_read_b32 v40, v14 offset:6144
ds_read_b32 v41, v14 offset:6208
ds_read_b32 v42, v14 offset:6272
ds_read_b32 v43, v14 offset:6336
ds_read_b32 v44, v14 offset:6400
ds_read_b32 v45, v14 offset:6464
ds_read_b32 v46, v14 offset:6528
ds_read_b32 v47, v14 offset:6592
s_waitcnt lgkmcnt(6)
v_perm_b32 v32, v41, v40, s46
v_perm_b32 v36, v41, v40, s47
s_waitcnt lgkmcnt(4)
v_perm_b32 v33, v43, v42, s46
v_perm_b32 v37, v43, v42, s47
s_waitcnt lgkmcnt(2)
v_perm_b32 v34, v45, v44, s46
v_perm_b32 v38, v45, v44, s47
s_waitcnt lgkmcnt(0)
v_perm_b32 v35, v47, v46, s46
v_perm_b32 v39, v47, v46, s47
s_add_u32 s45, s44, 1835008
s_add_u32 m0, s38, 6144
s_nop 0
buffer_load_dwordx4 v12, s[12:15], s45 offen offset:0 lds
buffer_load_dwordx4 v13, s[12:15], s45 offen offset:1024 lds
v_accvgpr_write_b32 a24, v32
v_accvgpr_write_b32 a25, v33
v_accvgpr_write_b32 a26, v34
v_accvgpr_write_b32 a27, v35
v_accvgpr_write_b32 a28, v36
v_accvgpr_write_b32 a29, v37
v_accvgpr_write_b32 a30, v38
v_accvgpr_write_b32 a31, v39
s_waitcnt vmcnt(38)
ds_read_b32 v40, v14 offset:8192
ds_read_b32 v41, v14 offset:8256
ds_read_b32 v42, v14 offset:8320
ds_read_b32 v43, v14 offset:8384
ds_read_b32 v44, v14 offset:8448
ds_read_b32 v45, v14 offset:8512
ds_read_b32 v46, v14 offset:8576
ds_read_b32 v47, v14 offset:8640
s_waitcnt lgkmcnt(6)
v_perm_b32 v32, v41, v40, s46
v_perm_b32 v36, v41, v40, s47
s_waitcnt lgkmcnt(4)
v_perm_b32 v33, v43, v42, s46
v_perm_b32 v37, v43, v42, s47
s_waitcnt lgkmcnt(2)
v_perm_b32 v34, v45, v44, s46
v_perm_b32 v38, v45, v44, s47
s_waitcnt lgkmcnt(0)
v_perm_b32 v35, v47, v46, s46
v_perm_b32 v39, v47, v46, s47
s_add_u32 s45, s44, 2097152
s_add_u32 m0, s38, 8192
s_nop 0
buffer_load_dwordx4 v12, s[12:15], s45 offen offset:0 lds
buffer_load_dwordx4 v13, s[12:15], s45 offen offset:1024 lds
v_accvgpr_write_b32 a32, v32
v_accvgpr_write_b32 a33, v33
v_accvgpr_write_b32 a34, v34
v_accvgpr_write_b32 a35, v35
v_accvgpr_write_b32 a36, v36
v_accvgpr_write_b32 a37, v37
v_accvgpr_write_b32 a38, v38
v_accvgpr_write_b32 a39, v39
s_waitcnt vmcnt(38)
ds_read_b32 v40, v14 offset:10240
ds_read_b32 v41, v14 offset:10304
ds_read_b32 v42, v14 offset:10368
ds_read_b32 v43, v14 offset:10432
ds_read_b32 v44, v14 offset:10496
ds_read_b32 v45, v14 offset:10560
ds_read_b32 v46, v14 offset:10624
ds_read_b32 v47, v14 offset:10688
s_waitcnt lgkmcnt(6)
v_perm_b32 v32, v41, v40, s46
v_perm_b32 v36, v41, v40, s47
s_waitcnt lgkmcnt(4)
v_perm_b32 v33, v43, v42, s46
v_perm_b32 v37, v43, v42, s47
s_waitcnt lgkmcnt(2)
v_perm_b32 v34, v45, v44, s46
v_perm_b32 v38, v45, v44, s47
s_waitcnt lgkmcnt(0)
v_perm_b32 v35, v47, v46, s46
v_perm_b32 v39, v47, v46, s47
s_add_u32 s45, s44, 2359296
s_add_u32 m0, s38, 10240
s_nop 0
buffer_load_dwordx4 v12, s[12:15], s45 offen offset:0 lds
buffer_load_dwordx4 v13, s[12:15], s45 offen offset:1024 lds
v_accvgpr_write_b32 a40, v32
v_accvgpr_write_b32 a41, v33
v_accvgpr_write_b32 a42, v34
v_accvgpr_write_b32 a43, v35
v_accvgpr_write_b32 a44, v36
v_accvgpr_write_b32 a45, v37
v_accvgpr_write_b32 a46, v38
v_accvgpr_write_b32 a47, v39
s_waitcnt vmcnt(38)
ds_read_b32 v40, v14 offset:12288
ds_read_b32 v41, v14 offset:12352
ds_read_b32 v42, v14 offset:12416
ds_read_b32 v43, v14 offset:12480
ds_read_b32 v44, v14 offset:12544
ds_read_b32 v45, v14 offset:12608
ds_read_b32 v46, v14 offset:12672
ds_read_b32 v47, v14 offset:12736
s_waitcnt lgkmcnt(6)
v_perm_b32 v32, v41, v40, s46
v_perm_b32 v36, v41, v40, s47
s_waitcnt lgkmcnt(4)
v_perm_b32 v33, v43, v42, s46
v_perm_b32 v37, v43, v42, s47
s_waitcnt lgkmcnt(2)
v_perm_b32 v34, v45, v44, s46
v_perm_b32 v38, v45, v44, s47
s_waitcnt lgkmcnt(0)
v_perm_b32 v35, v47, v46, s46
v_perm_b32 v39, v47, v46, s47
s_add_u32 s45, s44, 2621440
s_add_u32 m0, s38, 12288
s_nop 0
buffer_load_dwordx4 v12, s[12:15], s45 offen offset:0 lds
buffer_load_dwordx4 v13, s[12:15], s45 offen offset:1024 lds
v_accvgpr_write_b32 a48, v32
v_accvgpr_write_b32 a49, v33
v_accvgpr_write_b32 a50, v34
v_accvgpr_write_b32 a51, v35
v_accvgpr_write_b32 a52, v36
v_accvgpr_write_b32 a53, v37
v_accvgpr_write_b32 a54, v38
v_accvgpr_write_b32 a55, v39
s_waitcnt vmcnt(38)
ds_read_b32 v40, v14 offset:14336
ds_read_b32 v41, v14 offset:14400
ds_read_b32 v42, v14 offset:14464
ds_read_b32 v43, v14 offset:14528
ds_read_b32 v44, v14 offset:14592
ds_read_b32 v45, v14 offset:14656
ds_read_b32 v46, v14 offset:14720
ds_read_b32 v47, v14 offset:14784
s_waitcnt lgkmcnt(6)
v_perm_b32 v32, v41, v40, s46
v_perm_b32 v36, v41, v40, s47
s_waitcnt lgkmcnt(4)
v_perm_b32 v33, v43, v42, s46
v_perm_b32 v37, v43, v42, s47
s_waitcnt lgkmcnt(2)
v_perm_b32 v34, v45, v44, s46
v_perm_b32 v38, v45, v44, s47
s_waitcnt lgkmcnt(0)
v_perm_b32 v35, v47, v46, s46
v_perm_b32 v39, v47, v46, s47
s_add_u32 s45, s44, 2883584
s_add_u32 m0, s38, 14336
s_nop 0
buffer_load_dwordx4 v12, s[12:15], s45 offen offset:0 lds
buffer_load_dwordx4 v13, s[12:15], s45 offen offset:1024 lds
v_accvgpr_write_b32 a56, v32
v_accvgpr_write_b32 a57, v33
v_accvgpr_write_b32 a58, v34
v_accvgpr_write_b32 a59, v35
v_accvgpr_write_b32 a60, v36
v_accvgpr_write_b32 a61, v37
v_accvgpr_write_b32 a62, v38
v_accvgpr_write_b32 a63, v39
s_waitcnt vmcnt(38)
ds_read_b32 v40, v14 offset:16384
ds_read_b32 v41, v14 offset:16448
ds_read_b32 v42, v14 offset:16512
ds_read_b32 v43, v14 offset:16576
ds_read_b32 v44, v14 offset:16640
ds_read_b32 v45, v14 offset:16704
ds_read_b32 v46, v14 offset:16768
ds_read_b32 v47, v14 offset:16832
s_waitcnt lgkmcnt(6)
v_perm_b32 v32, v41, v40, s46
v_perm_b32 v36, v41, v40, s47
s_waitcnt lgkmcnt(4)
v_perm_b32 v33, v43, v42, s46
v_perm_b32 v37, v43, v42, s47
s_waitcnt lgkmcnt(2)
v_perm_b32 v34, v45, v44, s46
v_perm_b32 v38, v45, v44, s47
s_waitcnt lgkmcnt(0)
v_perm_b32 v35, v47, v46, s46
v_perm_b32 v39, v47, v46, s47
s_add_u32 s45, s44, 3145728
s_add_u32 m0, s38, 16384
s_nop 0
buffer_load_dwordx4 v12, s[12:15], s45 offen offset:0 lds
buffer_load_dwordx4 v13, s[12:15], s45 offen offset:1024 lds
v_accvgpr_write_b32 a64, v32
v_accvgpr_write_b32 a65, v33
v_accvgpr_write_b32 a66, v34
v_accvgpr_write_b32 a67, v35
v_accvgpr_write_b32 a68, v36
v_accvgpr_write_b32 a69, v37
v_accvgpr_write_b32 a70, v38
v_accvgpr_write_b32 a71, v39
s_waitcnt vmcnt(38)
ds_read_b32 v40, v14 offset:18432
ds_read_b32 v41, v14 offset:18496
ds_read_b32 v42, v14 offset:18560
ds_read_b32 v43, v14 offset:18624
ds_read_b32 v44, v14 offset:18688
ds_read_b32 v45, v14 offset:18752
ds_read_b32 v46, v14 offset:18816
ds_read_b32 v47, v14 offset:18880
s_waitcnt lgkmcnt(6)
v_perm_b32 v32, v41, v40, s46
v_perm_b32 v36, v41, v40, s47
s_waitcnt lgkmcnt(4)
v_perm_b32 v33, v43, v42, s46
v_perm_b32 v37, v43, v42, s47
s_waitcnt lgkmcnt(2)
v_perm_b32 v34, v45, v44, s46
v_perm_b32 v38, v45, v44, s47
s_waitcnt lgkmcnt(0)
v_perm_b32 v35, v47, v46, s46
v_perm_b32 v39, v47, v46, s47
s_add_u32 s45, s44, 3407872
s_add_u32 m0, s38, 18432
s_nop 0
buffer_load_dwordx4 v12, s[12:15], s45 offen offset:0 lds
buffer_load_dwordx4 v13, s[12:15], s45 offen offset:1024 lds
v_accvgpr_write_b32 a72, v32
v_accvgpr_write_b32 a73, v33
v_accvgpr_write_b32 a74, v34
v_accvgpr_write_b32 a75, v35
v_accvgpr_write_b32 a76, v36
v_accvgpr_write_b32 a77, v37
v_accvgpr_write_b32 a78, v38
v_accvgpr_write_b32 a79, v39
s_waitcnt vmcnt(38)
ds_read_b32 v40, v14 offset:20480
ds_read_b32 v41, v14 offset:20544
ds_read_b32 v42, v14 offset:20608
ds_read_b32 v43, v14 offset:20672
ds_read_b32 v44, v14 offset:20736
ds_read_b32 v45, v14 offset:20800
ds_read_b32 v46, v14 offset:20864
ds_read_b32 v47, v14 offset:20928
s_waitcnt lgkmcnt(6)
v_perm_b32 v32, v41, v40, s46
v_perm_b32 v36, v41, v40, s47
s_waitcnt lgkmcnt(4)
v_perm_b32 v33, v43, v42, s46
v_perm_b32 v37, v43, v42, s47
s_waitcnt lgkmcnt(2)
v_perm_b32 v34, v45, v44, s46
v_perm_b32 v38, v45, v44, s47
s_waitcnt lgkmcnt(0)
v_perm_b32 v35, v47, v46, s46
v_perm_b32 v39, v47, v46, s47
s_add_u32 s45, s44, 3670016
s_add_u32 m0, s38, 20480
s_nop 0
buffer_load_dwordx4 v12, s[12:15], s45 offen offset:0 lds
buffer_load_dwordx4 v13, s[12:15], s45 offen offset:1024 lds
v_accvgpr_write_b32 a80, v32
v_accvgpr_write_b32 a81, v33
v_accvgpr_write_b32 a82, v34
v_accvgpr_write_b32 a83, v35
v_accvgpr_write_b32 a84, v36
v_accvgpr_write_b32 a85, v37
v_accvgpr_write_b32 a86, v38
v_accvgpr_write_b32 a87, v39
s_waitcnt vmcnt(38)
ds_read_b32 v40, v14 offset:22528
ds_read_b32 v41, v14 offset:22592
ds_read_b32 v42, v14 offset:22656
ds_read_b32 v43, v14 offset:22720
ds_read_b32 v44, v14 offset:22784
ds_read_b32 v45, v14 offset:22848
ds_read_b32 v46, v14 offset:22912
ds_read_b32 v47, v14 offset:22976
s_waitcnt lgkmcnt(6)
v_perm_b32 v32, v41, v40, s46
v_perm_b32 v36, v41, v40, s47
s_waitcnt lgkmcnt(4)
v_perm_b32 v33, v43, v42, s46
v_perm_b32 v37, v43, v42, s47
s_waitcnt lgkmcnt(2)
v_perm_b32 v34, v45, v44, s46
v_perm_b32 v38, v45, v44, s47
s_waitcnt lgkmcnt(0)
v_perm_b32 v35, v47, v46, s46
v_perm_b32 v39, v47, v46, s47
s_add_u32 s45, s44, 3932160
s_add_u32 m0, s38, 22528
s_nop 0
buffer_load_dwordx4 v12, s[12:15], s45 offen offset:0 lds
buffer_load_dwordx4 v13, s[12:15], s45 offen offset:1024 lds
v_accvgpr_write_b32 a88, v32
v_accvgpr_write_b32 a89, v33
v_accvgpr_write_b32 a90, v34
v_accvgpr_write_b32 a91, v35
v_accvgpr_write_b32 a92, v36
v_accvgpr_write_b32 a93, v37
v_accvgpr_write_b32 a94, v38
v_accvgpr_write_b32 a95, v39
s_waitcnt vmcnt(38)
ds_read_b32 v40, v14 offset:24576
ds_read_b32 v41, v14 offset:24640
ds_read_b32 v42, v14 offset:24704
ds_read_b32 v43, v14 offset:24768
ds_read_b32 v44, v14 offset:24832
ds_read_b32 v45, v14 offset:24896
ds_read_b32 v46, v14 offset:24960
ds_read_b32 v47, v14 offset:25024
s_waitcnt lgkmcnt(6)
v_perm_b32 v32, v41, v40, s46
v_perm_b32 v36, v41, v40, s47
s_waitcnt lgkmcnt(4)
v_perm_b32 v33, v43, v42, s46
v_perm_b32 v37, v43, v42, s47
s_waitcnt lgkmcnt(2)
v_perm_b32 v34, v45, v44, s46
v_perm_b32 v38, v45, v44, s47
s_waitcnt lgkmcnt(0)
v_perm_b32 v35, v47, v46, s46
v_perm_b32 v39, v47, v46, s47
v_accvgpr_write_b32 a96, v32
v_accvgpr_write_b32 a97, v33
v_accvgpr_write_b32 a98, v34
v_accvgpr_write_b32 a99, v35
v_accvgpr_write_b32 a100, v36
v_accvgpr_write_b32 a101, v37
v_accvgpr_write_b32 a102, v38
v_accvgpr_write_b32 a103, v39
s_waitcnt vmcnt(36)
ds_read_b32 v40, v14 offset:26624
ds_read_b32 v41, v14 offset:26688
ds_read_b32 v42, v14 offset:26752
ds_read_b32 v43, v14 offset:26816
ds_read_b32 v44, v14 offset:26880
ds_read_b32 v45, v14 offset:26944
ds_read_b32 v46, v14 offset:27008
ds_read_b32 v47, v14 offset:27072
s_waitcnt lgkmcnt(6)
v_perm_b32 v32, v41, v40, s46
v_perm_b32 v36, v41, v40, s47
s_waitcnt lgkmcnt(4)
v_perm_b32 v33, v43, v42, s46
v_perm_b32 v37, v43, v42, s47
s_waitcnt lgkmcnt(2)
v_perm_b32 v34, v45, v44, s46
v_perm_b32 v38, v45, v44, s47
s_waitcnt lgkmcnt(0)
v_perm_b32 v35, v47, v46, s46
v_perm_b32 v39, v47, v46, s47
v_accvgpr_write_b32 a104, v32
v_accvgpr_write_b32 a105, v33
v_accvgpr_write_b32 a106, v34
v_accvgpr_write_b32 a107, v35
v_accvgpr_write_b32 a108, v36
v_accvgpr_write_b32 a109, v37
v_accvgpr_write_b32 a110, v38
v_accvgpr_write_b32 a111, v39
s_waitcnt vmcnt(34)
ds_read_b32 v40, v14 offset:28672
ds_read_b32 v41, v14 offset:28736
ds_read_b32 v42, v14 offset:28800
ds_read_b32 v43, v14 offset:28864
ds_read_b32 v44, v14 offset:28928
ds_read_b32 v45, v14 offset:28992
ds_read_b32 v46, v14 offset:29056
ds_read_b32 v47, v14 offset:29120
s_waitcnt lgkmcnt(6)
v_perm_b32 v32, v41, v40, s46
v_perm_b32 v36, v41, v40, s47
s_waitcnt lgkmcnt(4)
v_perm_b32 v33, v43, v42, s46
v_perm_b32 v37, v43, v42, s47
s_waitcnt lgkmcnt(2)
v_perm_b32 v34, v45, v44, s46
v_perm_b32 v38, v45, v44, s47
s_waitcnt lgkmcnt(0)
v_perm_b32 v35, v47, v46, s46
v_perm_b32 v39, v47, v46, s47
v_accvgpr_write_b32 a112, v32
v_accvgpr_write_b32 a113, v33
v_accvgpr_write_b32 a114, v34
v_accvgpr_write_b32 a115, v35
v_accvgpr_write_b32 a116, v36
v_accvgpr_write_b32 a117, v37
v_accvgpr_write_b32 a118, v38
v_accvgpr_write_b32 a119, v39
s_waitcnt vmcnt(32)
ds_read_b32 v40, v14 offset:30720
ds_read_b32 v41, v14 offset:30784
ds_read_b32 v42, v14 offset:30848
ds_read_b32 v43, v14 offset:30912
ds_read_b32 v44, v14 offset:30976
ds_read_b32 v45, v14 offset:31040
ds_read_b32 v46, v14 offset:31104
ds_read_b32 v47, v14 offset:31168
s_waitcnt lgkmcnt(6)
v_perm_b32 v32, v41, v40, s46
v_perm_b32 v36, v41, v40, s47
s_waitcnt lgkmcnt(4)
v_perm_b32 v33, v43, v42, s46
v_perm_b32 v37, v43, v42, s47
s_waitcnt lgkmcnt(2)
v_perm_b32 v34, v45, v44, s46
v_perm_b32 v38, v45, v44, s47
s_waitcnt lgkmcnt(0)
v_perm_b32 v35, v47, v46, s46
v_perm_b32 v39, v47, v46, s47
v_accvgpr_write_b32 a120, v32
v_accvgpr_write_b32 a121, v33
v_accvgpr_write_b32 a122, v34
v_accvgpr_write_b32 a123, v35
v_accvgpr_write_b32 a124, v36
v_accvgpr_write_b32 a125, v37
v_accvgpr_write_b32 a126, v38
v_accvgpr_write_b32 a127, v39
s_waitcnt vmcnt(30)
ds_read_b32 v40, v14 offset:32768
ds_read_b32 v41, v14 offset:32832
ds_read_b32 v42, v14 offset:32896
ds_read_b32 v43, v14 offset:32960
ds_read_b32 v44, v14 offset:33024
ds_read_b32 v45, v14 offset:33088
ds_read_b32 v46, v14 offset:33152
ds_read_b32 v47, v14 offset:33216
s_waitcnt lgkmcnt(6)
v_perm_b32 v32, v41, v40, s46
v_perm_b32 v36, v41, v40, s47
s_waitcnt lgkmcnt(4)
v_perm_b32 v33, v43, v42, s46
v_perm_b32 v37, v43, v42, s47
s_waitcnt lgkmcnt(2)
v_perm_b32 v34, v45, v44, s46
v_perm_b32 v38, v45, v44, s47
s_waitcnt lgkmcnt(0)
v_perm_b32 v35, v47, v46, s46
v_perm_b32 v39, v47, v46, s47
v_accvgpr_write_b32 a128, v32
v_accvgpr_write_b32 a129, v33
v_accvgpr_write_b32 a130, v34
v_accvgpr_write_b32 a131, v35
v_accvgpr_write_b32 a132, v36
v_accvgpr_write_b32 a133, v37
v_accvgpr_write_b32 a134, v38
v_accvgpr_write_b32 a135, v39
s_waitcnt vmcnt(28)
ds_read_b32 v40, v14 offset:34816
ds_read_b32 v41, v14 offset:34880
ds_read_b32 v42, v14 offset:34944
ds_read_b32 v43, v14 offset:35008
ds_read_b32 v44, v14 offset:35072
ds_read_b32 v45, v14 offset:35136
ds_read_b32 v46, v14 offset:35200
ds_read_b32 v47, v14 offset:35264
s_waitcnt lgkmcnt(6)
v_perm_b32 v32, v41, v40, s46
v_perm_b32 v36, v41, v40, s47
s_waitcnt lgkmcnt(4)
v_perm_b32 v33, v43, v42, s46
v_perm_b32 v37, v43, v42, s47
s_waitcnt lgkmcnt(2)
v_perm_b32 v34, v45, v44, s46
v_perm_b32 v38, v45, v44, s47
s_waitcnt lgkmcnt(0)
v_perm_b32 v35, v47, v46, s46
v_perm_b32 v39, v47, v46, s47
v_accvgpr_write_b32 a136, v32
v_accvgpr_write_b32 a137, v33
v_accvgpr_write_b32 a138, v34
v_accvgpr_write_b32 a139, v35
v_accvgpr_write_b32 a140, v36
v_accvgpr_write_b32 a141, v37
v_accvgpr_write_b32 a142, v38
v_accvgpr_write_b32 a143, v39
s_waitcnt vmcnt(26)
ds_read_b32 v40, v14 offset:36864
ds_read_b32 v41, v14 offset:36928
ds_read_b32 v42, v14 offset:36992
ds_read_b32 v43, v14 offset:37056
ds_read_b32 v44, v14 offset:37120
ds_read_b32 v45, v14 offset:37184
ds_read_b32 v46, v14 offset:37248
ds_read_b32 v47, v14 offset:37312
s_waitcnt lgkmcnt(6)
v_perm_b32 v32, v41, v40, s46
v_perm_b32 v36, v41, v40, s47
s_waitcnt lgkmcnt(4)
v_perm_b32 v33, v43, v42, s46
v_perm_b32 v37, v43, v42, s47
s_waitcnt lgkmcnt(2)
v_perm_b32 v34, v45, v44, s46
v_perm_b32 v38, v45, v44, s47
s_waitcnt lgkmcnt(0)
v_perm_b32 v35, v47, v46, s46
v_perm_b32 v39, v47, v46, s47
v_accvgpr_write_b32 a144, v32
v_accvgpr_write_b32 a145, v33
v_accvgpr_write_b32 a146, v34
v_accvgpr_write_b32 a147, v35
v_accvgpr_write_b32 a148, v36
v_accvgpr_write_b32 a149, v37
v_accvgpr_write_b32 a150, v38
v_accvgpr_write_b32 a151, v39
s_waitcnt vmcnt(24)
ds_read_b32 v40, v14 offset:38912
ds_read_b32 v41, v14 offset:38976
ds_read_b32 v42, v14 offset:39040
ds_read_b32 v43, v14 offset:39104
ds_read_b32 v44, v14 offset:39168
ds_read_b32 v45, v14 offset:39232
ds_read_b32 v46, v14 offset:39296
ds_read_b32 v47, v14 offset:39360
s_waitcnt lgkmcnt(6)
v_perm_b32 v32, v41, v40, s46
v_perm_b32 v36, v41, v40, s47
s_waitcnt lgkmcnt(4)
v_perm_b32 v33, v43, v42, s46
v_perm_b32 v37, v43, v42, s47
s_waitcnt lgkmcnt(2)
v_perm_b32 v34, v45, v44, s46
v_perm_b32 v38, v45, v44, s47
s_waitcnt lgkmcnt(0)
v_perm_b32 v35, v47, v46, s46
v_perm_b32 v39, v47, v46, s47
v_accvgpr_write_b32 a152, v32
v_accvgpr_write_b32 a153, v33
v_accvgpr_write_b32 a154, v34
v_accvgpr_write_b32 a155, v35
v_accvgpr_write_b32 a156, v36
v_accvgpr_write_b32 a157, v37
v_accvgpr_write_b32 a158, v38
v_accvgpr_write_b32 a159, v39
s_waitcnt vmcnt(22)
ds_read_b32 v40, v14 offset:0
ds_read_b32 v41, v14 offset:64
ds_read_b32 v42, v14 offset:128
ds_read_b32 v43, v14 offset:192
ds_read_b32 v44, v14 offset:256
ds_read_b32 v45, v14 offset:320
ds_read_b32 v46, v14 offset:384
ds_read_b32 v47, v14 offset:448
s_waitcnt lgkmcnt(6)
v_perm_b32 v32, v41, v40, s46
v_perm_b32 v36, v41, v40, s47
s_waitcnt lgkmcnt(4)
v_perm_b32 v33, v43, v42, s46
v_perm_b32 v37, v43, v42, s47
s_waitcnt lgkmcnt(2)
v_perm_b32 v34, v45, v44, s46
v_perm_b32 v38, v45, v44, s47
s_waitcnt lgkmcnt(0)
v_perm_b32 v35, v47, v46, s46
v_perm_b32 v39, v47, v46, s47
v_accvgpr_write_b32 a160, v32
v_accvgpr_write_b32 a161, v33
v_accvgpr_write_b32 a162, v34
v_accvgpr_write_b32 a163, v35
v_accvgpr_write_b32 a164, v36
v_accvgpr_write_b32 a165, v37
v_accvgpr_write_b32 a166, v38
v_accvgpr_write_b32 a167, v39
s_waitcnt vmcnt(20)
ds_read_b32 v40, v14 offset:2048
ds_read_b32 v41, v14 offset:2112
ds_read_b32 v42, v14 offset:2176
ds_read_b32 v43, v14 offset:2240
ds_read_b32 v44, v14 offset:2304
ds_read_b32 v45, v14 offset:2368
ds_read_b32 v46, v14 offset:2432
ds_read_b32 v47, v14 offset:2496
s_waitcnt lgkmcnt(6)
v_perm_b32 v32, v41, v40, s46
v_perm_b32 v36, v41, v40, s47
s_waitcnt lgkmcnt(4)
v_perm_b32 v33, v43, v42, s46
v_perm_b32 v37, v43, v42, s47
s_waitcnt lgkmcnt(2)
v_perm_b32 v34, v45, v44, s46
v_perm_b32 v38, v45, v44, s47
s_waitcnt lgkmcnt(0)
v_perm_b32 v35, v47, v46, s46
v_perm_b32 v39, v47, v46, s47
v_accvgpr_write_b32 a168, v32
v_accvgpr_write_b32 a169, v33
v_accvgpr_write_b32 a170, v34
v_accvgpr_write_b32 a171, v35
v_accvgpr_write_b32 a172, v36
v_accvgpr_write_b32 a173, v37
v_accvgpr_write_b32 a174, v38
v_accvgpr_write_b32 a175, v39
s_waitcnt vmcnt(18)
ds_read_b32 v40, v14 offset:4096
ds_read_b32 v41, v14 offset:4160
ds_read_b32 v42, v14 offset:4224
ds_read_b32 v43, v14 offset:4288
ds_read_b32 v44, v14 offset:4352
ds_read_b32 v45, v14 offset:4416
ds_read_b32 v46, v14 offset:4480
ds_read_b32 v47, v14 offset:4544
s_waitcnt lgkmcnt(6)
v_perm_b32 v32, v41, v40, s46
v_perm_b32 v36, v41, v40, s47
s_waitcnt lgkmcnt(4)
v_perm_b32 v33, v43, v42, s46
v_perm_b32 v37, v43, v42, s47
s_waitcnt lgkmcnt(2)
v_perm_b32 v34, v45, v44, s46
v_perm_b32 v38, v45, v44, s47
s_waitcnt lgkmcnt(0)
v_perm_b32 v35, v47, v46, s46
v_perm_b32 v39, v47, v46, s47
v_accvgpr_write_b32 a176, v32
v_accvgpr_write_b32 a177, v33
v_accvgpr_write_b32 a178, v34
v_accvgpr_write_b32 a179, v35
v_accvgpr_write_b32 a180, v36
v_accvgpr_write_b32 a181, v37
v_accvgpr_write_b32 a182, v38
v_accvgpr_write_b32 a183, v39
s_waitcnt vmcnt(16)
ds_read_b32 v40, v14 offset:6144
ds_read_b32 v41, v14 offset:6208
ds_read_b32 v42, v14 offset:6272
ds_read_b32 v43, v14 offset:6336
ds_read_b32 v44, v14 offset:6400
ds_read_b32 v45, v14 offset:6464
ds_read_b32 v46, v14 offset:6528
ds_read_b32 v47, v14 offset:6592
s_waitcnt lgkmcnt(6)
v_perm_b32 v32, v41, v40, s46
v_perm_b32 v36, v41, v40, s47
s_waitcnt lgkmcnt(4)
v_perm_b32 v33, v43, v42, s46
v_perm_b32 v37, v43, v42, s47
s_waitcnt lgkmcnt(2)
v_perm_b32 v34, v45, v44, s46
v_perm_b32 v38, v45, v44, s47
s_waitcnt lgkmcnt(0)
v_perm_b32 v35, v47, v46, s46
v_perm_b32 v39, v47, v46, s47
v_accvgpr_write_b32 a184, v32
v_accvgpr_write_b32 a185, v33
v_accvgpr_write_b32 a186, v34
v_accvgpr_write_b32 a187, v35
v_accvgpr_write_b32 a188, v36
v_accvgpr_write_b32 a189, v37
v_accvgpr_write_b32 a190, v38
v_accvgpr_write_b32 a191, v39
s_waitcnt vmcnt(14)
ds_read_b32 v40, v14 offset:8192
ds_read_b32 v41, v14 offset:8256
ds_read_b32 v42, v14 offset:8320
ds_read_b32 v43, v14 offset:8384
ds_read_b32 v44, v14 offset:8448
ds_read_b32 v45, v14 offset:8512
ds_read_b32 v46, v14 offset:8576
ds_read_b32 v47, v14 offset:8640
s_waitcnt lgkmcnt(6)
v_perm_b32 v32, v41, v40, s46
v_perm_b32 v36, v41, v40, s47
s_waitcnt lgkmcnt(4)
v_perm_b32 v33, v43, v42, s46
v_perm_b32 v37, v43, v42, s47
s_waitcnt lgkmcnt(2)
v_perm_b32 v34, v45, v44, s46
v_perm_b32 v38, v45, v44, s47
s_waitcnt lgkmcnt(0)
v_perm_b32 v35, v47, v46, s46
v_perm_b32 v39, v47, v46, s47
v_accvgpr_write_b32 a192, v32
v_accvgpr_write_b32 a193, v33
v_accvgpr_write_b32 a194, v34
v_accvgpr_write_b32 a195, v35
v_accvgpr_write_b32 a196, v36
v_accvgpr_write_b32 a197, v37
v_accvgpr_write_b32 a198, v38
v_accvgpr_write_b32 a199, v39
s_waitcnt vmcnt(12)
ds_read_b32 v40, v14 offset:10240
ds_read_b32 v41, v14 offset:10304
ds_read_b32 v42, v14 offset:10368
ds_read_b32 v43, v14 offset:10432
ds_read_b32 v44, v14 offset:10496
ds_read_b32 v45, v14 offset:10560
ds_read_b32 v46, v14 offset:10624
ds_read_b32 v47, v14 offset:10688
s_waitcnt lgkmcnt(6)
v_perm_b32 v32, v41, v40, s46
v_perm_b32 v36, v41, v40, s47
s_waitcnt lgkmcnt(4)
v_perm_b32 v33, v43, v42, s46
v_perm_b32 v37, v43, v42, s47
s_waitcnt lgkmcnt(2)
v_perm_b32 v34, v45, v44, s46
v_perm_b32 v38, v45, v44, s47
s_waitcnt lgkmcnt(0)
v_perm_b32 v35, v47, v46, s46
v_perm_b32 v39, v47, v46, s47
v_accvgpr_write_b32 a200, v32
v_accvgpr_write_b32 a201, v33
v_accvgpr_write_b32 a202, v34
v_accvgpr_write_b32 a203, v35
v_accvgpr_write_b32 a204, v36
v_accvgpr_write_b32 a205, v37
v_accvgpr_write_b32 a206, v38
v_accvgpr_write_b32 a207, v39
s_waitcnt vmcnt(10)
ds_read_b32 v40, v14 offset:12288
ds_read_b32 v41, v14 offset:12352
ds_read_b32 v42, v14 offset:12416
ds_read_b32 v43, v14 offset:12480
ds_read_b32 v44, v14 offset:12544
ds_read_b32 v45, v14 offset:12608
ds_read_b32 v46, v14 offset:12672
ds_read_b32 v47, v14 offset:12736
s_waitcnt lgkmcnt(6)
v_perm_b32 v32, v41, v40, s46
v_perm_b32 v36, v41, v40, s47
s_waitcnt lgkmcnt(4)
v_perm_b32 v33, v43, v42, s46
v_perm_b32 v37, v43, v42, s47
s_waitcnt lgkmcnt(2)
v_perm_b32 v34, v45, v44, s46
v_perm_b32 v38, v45, v44, s47
s_waitcnt lgkmcnt(0)
v_perm_b32 v35, v47, v46, s46
v_perm_b32 v39, v47, v46, s47
v_accvgpr_write_b32 a208, v32
v_accvgpr_write_b32 a209, v33
v_accvgpr_write_b32 a210, v34
v_accvgpr_write_b32 a211, v35
v_accvgpr_write_b32 a212, v36
v_accvgpr_write_b32 a213, v37
v_accvgpr_write_b32 a214, v38
v_accvgpr_write_b32 a215, v39
s_waitcnt vmcnt(8)
ds_read_b32 v40, v14 offset:14336
ds_read_b32 v41, v14 offset:14400
ds_read_b32 v42, v14 offset:14464
ds_read_b32 v43, v14 offset:14528
ds_read_b32 v44, v14 offset:14592
ds_read_b32 v45, v14 offset:14656
ds_read_b32 v46, v14 offset:14720
ds_read_b32 v47, v14 offset:14784
s_waitcnt lgkmcnt(6)
v_perm_b32 v32, v41, v40, s46
v_perm_b32 v36, v41, v40, s47
s_waitcnt lgkmcnt(4)
v_perm_b32 v33, v43, v42, s46
v_perm_b32 v37, v43, v42, s47
s_waitcnt lgkmcnt(2)
v_perm_b32 v34, v45, v44, s46
v_perm_b32 v38, v45, v44, s47
s_waitcnt lgkmcnt(0)
v_perm_b32 v35, v47, v46, s46
v_perm_b32 v39, v47, v46, s47
v_accvgpr_write_b32 a216, v32
v_accvgpr_write_b32 a217, v33
v_accvgpr_write_b32 a218, v34
v_accvgpr_write_b32 a219, v35
v_accvgpr_write_b32 a220, v36
v_accvgpr_write_b32 a221, v37
v_accvgpr_write_b32 a222, v38
v_accvgpr_write_b32 a223, v39
s_waitcnt vmcnt(6)
ds_read_b32 v40, v14 offset:16384
ds_read_b32 v41, v14 offset:16448
ds_read_b32 v42, v14 offset:16512
ds_read_b32 v43, v14 offset:16576
ds_read_b32 v44, v14 offset:16640
ds_read_b32 v45, v14 offset:16704
ds_read_b32 v46, v14 offset:16768
ds_read_b32 v47, v14 offset:16832
s_waitcnt lgkmcnt(6)
v_perm_b32 v32, v41, v40, s46
v_perm_b32 v36, v41, v40, s47
s_waitcnt lgkmcnt(4)
v_perm_b32 v33, v43, v42, s46
v_perm_b32 v37, v43, v42, s47
s_waitcnt lgkmcnt(2)
v_perm_b32 v34, v45, v44, s46
v_perm_b32 v38, v45, v44, s47
s_waitcnt lgkmcnt(0)
v_perm_b32 v35, v47, v46, s46
v_perm_b32 v39, v47, v46, s47
v_accvgpr_write_b32 a224, v32
v_accvgpr_write_b32 a225, v33
v_accvgpr_write_b32 a226, v34
v_accvgpr_write_b32 a227, v35
v_accvgpr_write_b32 a228, v36
v_accvgpr_write_b32 a229, v37
v_accvgpr_write_b32 a230, v38
v_accvgpr_write_b32 a231, v39
s_waitcnt vmcnt(4)
ds_read_b32 v40, v14 offset:18432
ds_read_b32 v41, v14 offset:18496
ds_read_b32 v42, v14 offset:18560
ds_read_b32 v43, v14 offset:18624
ds_read_b32 v44, v14 offset:18688
ds_read_b32 v45, v14 offset:18752
ds_read_b32 v46, v14 offset:18816
ds_read_b32 v47, v14 offset:18880
s_waitcnt lgkmcnt(6)
v_perm_b32 v32, v41, v40, s46
v_perm_b32 v36, v41, v40, s47
s_waitcnt lgkmcnt(4)
v_perm_b32 v33, v43, v42, s46
v_perm_b32 v37, v43, v42, s47
s_waitcnt lgkmcnt(2)
v_perm_b32 v34, v45, v44, s46
v_perm_b32 v38, v45, v44, s47
s_waitcnt lgkmcnt(0)
v_perm_b32 v35, v47, v46, s46
v_perm_b32 v39, v47, v46, s47
v_accvgpr_write_b32 a232, v32
v_accvgpr_write_b32 a233, v33
v_accvgpr_write_b32 a234, v34
v_accvgpr_write_b32 a235, v35
v_accvgpr_write_b32 a236, v36
v_accvgpr_write_b32 a237, v37
v_accvgpr_write_b32 a238, v38
v_accvgpr_write_b32 a239, v39
s_waitcnt vmcnt(2)
ds_read_b32 v40, v14 offset:20480
ds_read_b32 v41, v14 offset:20544
ds_read_b32 v42, v14 offset:20608
ds_read_b32 v43, v14 offset:20672
ds_read_b32 v44, v14 offset:20736
ds_read_b32 v45, v14 offset:20800
ds_read_b32 v46, v14 offset:20864
ds_read_b32 v47, v14 offset:20928
s_waitcnt lgkmcnt(6)
v_perm_b32 v32, v41, v40, s46
v_perm_b32 v36, v41, v40, s47
s_waitcnt lgkmcnt(4)
v_perm_b32 v33, v43, v42, s46
v_perm_b32 v37, v43, v42, s47
s_waitcnt lgkmcnt(2)
v_perm_b32 v34, v45, v44, s46
v_perm_b32 v38, v45, v44, s47
s_waitcnt lgkmcnt(0)
v_perm_b32 v35, v47, v46, s46
v_perm_b32 v39, v47, v46, s47
v_accvgpr_write_b32 a240, v32
v_accvgpr_write_b32 a241, v33
v_accvgpr_write_b32 a242, v34
v_accvgpr_write_b32 a243, v35
v_accvgpr_write_b32 a244, v36
v_accvgpr_write_b32 a245, v37
v_accvgpr_write_b32 a246, v38
v_accvgpr_write_b32 a247, v39
s_waitcnt vmcnt(0)
ds_read_b32 v40, v14 offset:22528
ds_read_b32 v41, v14 offset:22592
ds_read_b32 v42, v14 offset:22656
ds_read_b32 v43, v14 offset:22720
ds_read_b32 v44, v14 offset:22784
ds_read_b32 v45, v14 offset:22848
ds_read_b32 v46, v14 offset:22912
ds_read_b32 v47, v14 offset:22976
s_waitcnt lgkmcnt(6)
v_perm_b32 v32, v41, v40, s46
v_perm_b32 v36, v41, v40, s47
s_waitcnt lgkmcnt(4)
v_perm_b32 v33, v43, v42, s46
v_perm_b32 v37, v43, v42, s47
s_waitcnt lgkmcnt(2)
v_perm_b32 v34, v45, v44, s46
v_perm_b32 v38, v45, v44, s47
s_waitcnt lgkmcnt(0)
v_perm_b32 v35, v47, v46, s46
v_perm_b32 v39, v47, v46, s47
v_accvgpr_write_b32 a248, v32
v_accvgpr_write_b32 a249, v33
v_accvgpr_write_b32 a250, v34
v_accvgpr_write_b32 a251, v35
v_accvgpr_write_b32 a252, v36
v_accvgpr_write_b32 a253, v37
v_accvgpr_write_b32 a254, v38
v_accvgpr_write_b32 a255, v39
s_lshl_b32 s40, s43, 11
s_lshl_b32 s41, s32, 11
s_sub_u32 s40, s40, s41
s_lshl_b32 s41, s37, 25
s_sub_u32 s81, s40, s41
v_lshlrev_b32 v34, 5, v1
buffer_load_dwordx2 v[32:33], v34, s[8:11], 0 offen sc1
s_waitcnt vmcnt(0)
L_cen_30:
s_mov_b32 s40, 0
v_readlane_b32 s41, v33, 0
s_nop 0
s_add_u32 s40, s40, s41
v_readlane_b32 s41, v33, 1
s_nop 0
s_add_u32 s40, s40, s41
v_readlane_b32 s41, v33, 2
s_nop 0
s_add_u32 s40, s40, s41
v_readlane_b32 s41, v33, 3
s_nop 0
s_add_u32 s40, s40, s41
v_readlane_b32 s41, v33, 4
s_nop 0
s_add_u32 s40, s40, s41
v_readlane_b32 s41, v33, 5
s_nop 0
s_add_u32 s40, s40, s41
v_readlane_b32 s41, v33, 6
s_nop 0
s_add_u32 s40, s40, s41
v_readlane_b32 s41, v33, 7
s_nop 0
s_add_u32 s40, s40, s41
s_cmp_eq_u32 s40, 256
s_cbranch_scc1 L_cenok_31
s_sub_u32 s36, s36, 1
s_cbranch_scc1 L_end_qkv_L
s_sleep 4
buffer_load_dwordx2 v[32:33], v34, s[8:11], 0 offen sc1
s_waitcnt vmcnt(0)
s_branch L_cen_30
L_cenok_31:
v_cmp_ne_u32 vcc, 32, v32
s_nop 0
s_and_b32 s40, vcc_lo, 0xff
s_cbranch_scc1 L_fb_qkv
s_barrier
s_and_b32 s42, s32, 1
s_lshl_b32 s43, s42, 10
v_add_u32 v28, s43, v2
v_xor_b32 v29, 1024, v28
s_lshl_b32 s42, s42, 8
v_add_u32 v23, 0, v21
v_xor_b32 v23, v23, v20
v_lshlrev_b32 v23, 4, v23
v_lshl_add_u32 v23, v20, 9, v23
v_add_u32 v4, s42, v23
v_xor_b32 v8, 256, v4
v_add_u32 v100, 65536, v4
v_add_u32 v104, 65536, v8
v_add_u32 v23, 4, v21
v_xor_b32 v23, v23, v20
v_lshlrev_b32 v23, 4, v23
v_lshl_add_u32 v23, v20, 9, v23
v_add_u32 v5, s42, v23
v_xor_b32 v9, 256, v5
v_add_u32 v101, 65536, v5
v_add_u32 v105, 65536, v9
v_add_u32 v23, 8, v21
v_xor_b32 v23, v23, v20
v_lshlrev_b32 v23, 4, v23
v_lshl_add_u32 v23, v20, 9, v23
v_add_u32 v6, s42, v23
v_xor_b32 v10, 256, v6
v_add_u32 v102, 65536, v6
v_add_u32 v106, 65536, v10
v_add_u32 v23, 12, v21
v_xor_b32 v23, v23, v20
v_lshlrev_b32 v23, 4, v23
v_lshl_add_u32 v23, v20, 9, v23
v_add_u32 v7, s42, v23
v_xor_b32 v11, 256, v7
v_add_u32 v103, 65536, v7
v_add_u32 v107, 65536, v11
v_mov_b32 v25, 1
v_mov_b32 v24, 0
v_and_b32 v23, 31, v1
v_lshlrev_b32 v27, 2, v23
v_lshlrev_b32 v23, 4, v20
v_lshl_add_u32 v30, v21, 10, v23
v_add_u32 v31, 3072, v30
s_lshl_b32 s40, s32, 13
s_add_u32 s39, s40, 10485760
s_add_u32 s90, s40, 12550144
s_add_u32 s28, s40, 14680064
s_lshl_b32 s40, s37, 25
s_lshl_b32 s41, s34, 13
s_add_u32 s40, s40, s41
s_lshl_b32 s78, s32, 11
s_add_u32 s40, s40, s78
s_add_u32 s29, s40, 41943040
s_add_u32 s30, s40, 58720256
s_add_u32 s84, s40, 143654912
s_lshl_b32 s40, s34, 6
s_lshl_b32 s41, s37, 4
s_add_u32 s40, s40, s41
s_lshl_b32 s41, s32, 2
s_add_u32 s40, s40, s41
s_add_u32 s31, s40, 131072
s_add_u32 s76, s40, 262144
s_add_u32 s82, s40, 393216
s_mov_b32 s83, s82
s_lshl_b32 s40, s32, 7
s_add_u32 s77, s40, 49152
s_add_u32 s79, s78, 65536
s_mov_b32 s38, 0
s_and_b32 s85, s32, 1
s_lshl_b32 s85, s85, 4
s_cmp_eq_u32 s37, 2
s_cbranch_scc1 L_qkv_v_L
s_add_u32 m0, s79, 0
s_add_u32 s41, s39, 0
buffer_load_dwordx4 v30, s[4:7], s41 offen offset:0 sc1 lds
buffer_load_dwordx4 v31, s[4:7], s41 offen offset:1024 sc1 lds
s_add_u32 m0, s79, 8192
s_add_u32 s41, s39, 256
buffer_load_dwordx4 v30, s[4:7], s41 offen offset:0 sc1 lds
buffer_load_dwordx4 v31, s[4:7], s41 offen offset:1024 sc1 lds
s_add_u32 m0, s79, 16384
s_add_u32 s41, s39, 512
buffer_load_dwordx4 v30, s[4:7], s41 offen offset:0 sc1 lds
buffer_load_dwordx4 v31, s[4:7], s41 offen offset:1024 sc1 lds
s_add_u32 m0, s79, 24576
s_add_u32 s41, s39, 768
buffer_load_dwordx4 v30, s[4:7], s41 offen offset:0 sc1 lds
buffer_load_dwordx4 v31, s[4:7], s41 offen offset:1024 sc1 lds
s_add_u32 s39, s39, 32768
s_min_u32 s39, s39, s90
s_xor_b32 s79, s79, 32768
L_qkv_p1_k_L:
s_waitcnt vmcnt(0)
buffer_store_dword v25, v24, s[4:7], s82 offen sc1
s_barrier
ds_read_b128 v[32:35], v100 offset:0
ds_read_b128 v[36:39], v104 offset:0
ds_read_b128 v[40:43], v101 offset:0
ds_read_b128 v[44:47], v105 offset:0
ds_read_b128 v[48:51], v102 offset:0
ds_read_b128 v[52:55], v106 offset:0
s_waitcnt lgkmcnt(5)
v_mfma_f32_16x16x32_bf16 v[64:67], a[0:3], v[32:35], 0
s_add_u32 m0, s79, 0
s_add_u32 s41, s39, 0
v_mfma_f32_16x16x32_bf16 v[68:71], a[4:7], v[32:35], 0
buffer_load_dwordx4 v30, s[4:7], s41 offen offset:0 sc1 lds
v_mfma_f32_16x16x32_bf16 v[80:83], a[128:131], v[32:35], 0
v_mfma_f32_16x16x32_bf16 v[84:87], a[132:135], v[32:35], 0
s_waitcnt lgkmcnt(4)
v_mfma_f32_16x16x32_bf16 v[72:75], a[0:3], v[36:39], 0
v_mfma_f32_16x16x32_bf16 v[76:79], a[4:7], v[36:39], 0
ds_read_b128 v[56:59], v103 offset:0
ds_read_b128 v[60:63], v107 offset:0
s_waitcnt lgkmcnt(5)
v_mfma_f32_16x16x32_bf16 v[64:67], a[8:11], v[40:43], v[64:67]
buffer_load_dwordx4 v31, s[4:7], s41 offen offset:1024 sc1 lds
s_add_u32 m0, s79, 8192
v_mfma_f32_16x16x32_bf16 v[68:71], a[12:15], v[40:43], v[68:71]
s_add_u32 s41, s39, 256
v_mfma_f32_16x16x32_bf16 v[80:83], a[136:139], v[40:43], v[80:83]
v_mfma_f32_16x16x32_bf16 v[84:87], a[140:143], v[40:43], v[84:87]
s_waitcnt lgkmcnt(4)
v_mfma_f32_16x16x32_bf16 v[72:75], a[8:11], v[44:47], v[72:75]
buffer_load_dwordx4 v30, s[4:7], s41 offen offset:0 sc1 lds
v_mfma_f32_16x16x32_bf16 v[76:79], a[12:15], v[44:47], v[76:79]
ds_read_b128 v[32:35], v100 offset:8192
ds_read_b128 v[36:39], v104 offset:8192
s_waitcnt lgkmcnt(5)
v_mfma_f32_16x16x32_bf16 v[64:67], a[16:19], v[48:51], v[64:67]
v_mfma_f32_16x16x32_bf16 v[68:71], a[20:23], v[48:51], v[68:71]
v_mfma_f32_16x16x32_bf16 v[80:83], a[144:147], v[48:51], v[80:83]
buffer_load_dwordx4 v31, s[4:7], s41 offen offset:1024 sc1 lds
s_add_u32 m0, s79, 16384
v_mfma_f32_16x16x32_bf16 v[84:87], a[148:151], v[48:51], v[84:87]
s_add_u32 s41, s39, 512
s_waitcnt lgkmcnt(4)
v_mfma_f32_16x16x32_bf16 v[72:75], a[16:19], v[52:55], v[72:75]
v_mfma_f32_16x16x32_bf16 v[76:79], a[20:23], v[52:55], v[76:79]
ds_read_b128 v[40:43], v101 offset:8192
ds_read_b128 v[44:47], v105 offset:8192
s_waitcnt lgkmcnt(5)
v_mfma_f32_16x16x32_bf16 v[64:67], a[24:27], v[56:59], v[64:67]
buffer_load_dwordx4 v30, s[4:7], s41 offen offset:0 sc1 lds
v_mfma_f32_16x16x32_bf16 v[68:71], a[28:31], v[56:59], v[68:71]
v_mfma_f32_16x16x32_bf16 v[80:83], a[152:155], v[56:59], v[80:83]
v_mfma_f32_16x16x32_bf16 v[84:87], a[156:159], v[56:59], v[84:87]
s_waitcnt lgkmcnt(4)
v_mfma_f32_16x16x32_bf16 v[72:75], a[24:27], v[60:63], v[72:75]
buffer_load_dwordx4 v31, s[4:7], s41 offen offset:1024 sc1 lds
s_add_u32 m0, s79, 24576
v_mfma_f32_16x16x32_bf16 v[76:79], a[28:31], v[60:63], v[76:79]
ds_read_b128 v[48:51], v102 offset:8192
ds_read_b128 v[52:55], v106 offset:8192
s_waitcnt lgkmcnt(5)
v_mfma_f32_16x16x32_bf16 v[64:67], a[32:35], v[32:35], v[64:67]
s_add_u32 s41, s39, 768
v_mfma_f32_16x16x32_bf16 v[68:71], a[36:39], v[32:35], v[68:71]
v_mfma_f32_16x16x32_bf16 v[80:83], a[160:163], v[32:35], v[80:83]
buffer_load_dwordx4 v30, s[4:7], s41 offen offset:0 sc1 lds
v_mfma_f32_16x16x32_bf16 v[84:87], a[164:167], v[32:35], v[84:87]
s_waitcnt lgkmcnt(4)
v_mfma_f32_16x16x32_bf16 v[72:75], a[32:35], v[36:39], v[72:75]
v_mfma_f32_16x16x32_bf16 v[76:79], a[36:39], v[36:39], v[76:79]
ds_read_b128 v[56:59], v103 offset:8192
ds_read_b128 v[60:63], v107 offset:8192
s_waitcnt lgkmcnt(5)
v_mfma_f32_16x16x32_bf16 v[64:67], a[40:43], v[40:43], v[64:67]
buffer_load_dwordx4 v31, s[4:7], s41 offen offset:1024 sc1 lds
s_add_u32 s39, s39, 32768
v_mfma_f32_16x16x32_bf16 v[68:71], a[44:47], v[40:43], v[68:71]
s_min_u32 s39, s39, s90
s_xor_b32 s79, s79, 32768
v_mfma_f32_16x16x32_bf16 v[80:83], a[168:171], v[40:43], v[80:83]
v_mfma_f32_16x16x32_bf16 v[84:87], a[172:175], v[40:43], v[84:87]
s_waitcnt lgkmcnt(4)
v_mfma_f32_16x16x32_bf16 v[72:75], a[40:43], v[44:47], v[72:75]
v_mfma_f32_16x16x32_bf16 v[76:79], a[44:47], v[44:47], v[76:79]
ds_read_b128 v[32:35], v100 offset:16384
ds_read_b128 v[36:39], v104 offset:16384
s_waitcnt lgkmcnt(5)
v_mfma_f32_16x16x32_bf16 v[64:67], a[48:51], v[48:51], v[64:67]
v_mfma_f32_16x16x32_bf16 v[68:71], a[52:55], v[48:51], v[68:71]
v_mfma_f32_16x16x32_bf16 v[80:83], a[176:179], v[48:51], v[80:83]
v_mfma_f32_16x16x32_bf16 v[84:87], a[180:183], v[48:51], v[84:87]
s_waitcnt lgkmcnt(4)
v_mfma_f32_16x16x32_bf16 v[72:75], a[48:51], v[52:55], v[72:75]
v_mfma_f32_16x16x32_bf16 v[76:79], a[52:55], v[52:55], v[76:79]
ds_read_b128 v[40:43], v101 offset:16384
ds_read_b128 v[44:47], v105 offset:16384
s_waitcnt lgkmcnt(5)
v_mfma_f32_16x16x32_bf16 v[64:67], a[56:59], v[56:59], v[64:67]
v_mfma_f32_16x16x32_bf16 v[68:71], a[60:63], v[56:59], v[68:71]
v_mfma_f32_16x16x32_bf16 v[80:83], a[184:187], v[56:59], v[80:83]
v_mfma_f32_16x16x32_bf16 v[84:87], a[188:191], v[56:59], v[84:87]
s_waitcnt lgkmcnt(4)
v_mfma_f32_16x16x32_bf16 v[72:75], a[56:59], v[60:63], v[72:75]
v_mfma_f32_16x16x32_bf16 v[76:79], a[60:63], v[60:63], v[76:79]
ds_read_b128 v[48:51], v102 offset:16384
ds_read_b128 v[52:55], v106 offset:16384
s_waitcnt lgkmcnt(5)
v_mfma_f32_16x16x32_bf16 v[64:67], a[64:67], v[32:35], v[64:67]
v_mfma_f32_16x16x32_bf16 v[68:71], a[68:71], v[32:35], v[68:71]
v_mfma_f32_16x16x32_bf16 v[80:83], a[192:195], v[32:35], v[80:83]
v_mfma_f32_16x16x32_bf16 v[84:87], a[196:199], v[32:35], v[84:87]
s_waitcnt lgkmcnt(4)
v_mfma_f32_16x16x32_bf16 v[72:75], a[64:67], v[36:39], v[72:75]
v_mfma_f32_16x16x32_bf16 v[76:79], a[68:71], v[36:39], v[76:79]
ds_read_b128 v[56:59], v103 offset:16384
ds_read_b128 v[60:63], v107 offset:16384
s_waitcnt lgkmcnt(5)
v_mfma_f32_16x16x32_bf16 v[64:67], a[72:75], v[40:43], v[64:67]
v_mfma_f32_16x16x32_bf16 v[68:71], a[76:79], v[40:43], v[68:71]
v_mfma_f32_16x16x32_bf16 v[80:83], a[200:203], v[40:43], v[80:83]
v_mfma_f32_16x16x32_bf16 v[84:87], a[204:207], v[40:43], v[84:87]
s_waitcnt lgkmcnt(4)
v_mfma_f32_16x16x32_bf16 v[72:75], a[72:75], v[44:47], v[72:75]
v_mfma_f32_16x16x32_bf16 v[76:79], a[76:79], v[44:47], v[76:79]
ds_read_b128 v[32:35], v100 offset:24576
ds_read_b128 v[36:39], v104 offset:24576
s_waitcnt lgkmcnt(5)
v_mfma_f32_16x16x32_bf16 v[64:67], a[80:83], v[48:51], v[64:67]
v_mfma_f32_16x16x32_bf16 v[68:71], a[84:87], v[48:51], v[68:71]
v_mfma_f32_16x16x32_bf16 v[80:83], a[208:211], v[48:51], v[80:83]
v_mfma_f32_16x16x32_bf16 v[84:87], a[212:215], v[48:51], v[84:87]
s_waitcnt lgkmcnt(4)
v_mfma_f32_16x16x32_bf16 v[72:75], a[80:83], v[52:55], v[72:75]
v_mfma_f32_16x16x32_bf16 v[76:79], a[84:87], v[52:55], v[76:79]
ds_read_b128 v[40:43], v101 offset:24576
ds_read_b128 v[44:47], v105 offset:24576
s_waitcnt lgkmcnt(5)
v_mfma_f32_16x16x32_bf16 v[64:67], a[88:91], v[56:59], v[64:67]
v_mfma_f32_16x16x32_bf16 v[68:71], a[92:95], v[56:59], v[68:71]
v_mfma_f32_16x16x32_bf16 v[80:83], a[216:219], v[56:59], v[80:83]
v_mfma_f32_16x16x32_bf16 v[84:87], a[220:223], v[56:59], v[84:87]
s_waitcnt lgkmcnt(4)
v_mfma_f32_16x16x32_bf16 v[72:75], a[88:91], v[60:63], v[72:75]
v_mfma_f32_16x16x32_bf16 v[76:79], a[92:95], v[60:63], v[76:79]
ds_read_b128 v[48:51], v102 offset:24576
ds_read_b128 v[52:55], v106 offset:24576
s_waitcnt lgkmcnt(5)
v_mfma_f32_16x16x32_bf16 v[64:67], a[96:99], v[32:35], v[64:67]
v_mfma_f32_16x16x32_bf16 v[68:71], a[100:103], v[32:35], v[68:71]
v_mfma_f32_16x16x32_bf16 v[80:83], a[224:227], v[32:35], v[80:83]
v_mfma_f32_16x16x32_bf16 v[84:87], a[228:231], v[32:35], v[84:87]
s_waitcnt lgkmcnt(4)
v_mfma_f32_16x16x32_bf16 v[72:75], a[96:99], v[36:39], v[72:75]
v_mfma_f32_16x16x32_bf16 v[76:79], a[100:103], v[36:39], v[76:79]
ds_read_b128 v[56:59], v103 offset:24576
ds_read_b128 v[60:63], v107 offset:24576
s_waitcnt lgkmcnt(5)
v_mfma_f32_16x16x32_bf16 v[64:67], a[104:107], v[40:43], v[64:67]
v_mfma_f32_16x16x32_bf16 v[68:71], a[108:111], v[40:43], v[68:71]
v_mfma_f32_16x16x32_bf16 v[80:83], a[232:235], v[40:43], v[80:83]
v_mfma_f32_16x16x32_bf16 v[84:87], a[236:239], v[40:43], v[84:87]
s_waitcnt lgkmcnt(4)
v_mfma_f32_16x16x32_bf16 v[72:75], a[104:107], v[44:47], v[72:75]
v_mfma_f32_16x16x32_bf16 v[76:79], a[108:111], v[44:47], v[76:79]
s_waitcnt lgkmcnt(3)
v_mfma_f32_16x16x32_bf16 v[64:67], a[112:115], v[48:51], v[64:67]
v_mfma_f32_16x16x32_bf16 v[68:71], a[116:119], v[48:51], v[68:71]
v_mfma_f32_16x16x32_bf16 v[80:83], a[240:243], v[48:51], v[80:83]
v_mfma_f32_16x16x32_bf16 v[84:87], a[244:247], v[48:51], v[84:87]
s_waitcnt lgkmcnt(2)
v_mfma_f32_16x16x32_bf16 v[72:75], a[112:115], v[52:55], v[72:75]
v_mfma_f32_16x16x32_bf16 v[76:79], a[116:119], v[52:55], v[76:79]
s_waitcnt lgkmcnt(1)
v_mfma_f32_16x16x32_bf16 v[64:67], a[120:123], v[56:59], v[64:67]
v_mfma_f32_16x16x32_bf16 v[68:71], a[124:127], v[56:59], v[68:71]
v_mfma_f32_16x16x32_bf16 v[80:83], a[248:251], v[56:59], v[80:83]
v_mfma_f32_16x16x32_bf16 v[84:87], a[252:255], v[56:59], v[84:87]
s_waitcnt lgkmcnt(0)
v_mfma_f32_16x16x32_bf16 v[72:75], a[120:123], v[60:63], v[72:75]
v_mfma_f32_16x16x32_bf16 v[76:79], a[124:127], v[60:63], v[76:79]
s_nop 4
v_cvt_pk_bf16_f32 v96, v80, v84
v_cvt_pk_bf16_f32 v97, v81, v85
v_cvt_pk_bf16_f32 v98, v82, v86
v_cvt_pk_bf16_f32 v99, v83, v87
v_cvt_pk_bf16_f32 v88, v64, v68
v_cvt_pk_bf16_f32 v89, v65, v69
v_cvt_pk_bf16_f32 v90, v66, v70
v_cvt_pk_bf16_f32 v91, v67, v71
v_cvt_pk_bf16_f32 v92, v72, v76
v_cvt_pk_bf16_f32 v93, v73, v77
v_cvt_pk_bf16_f32 v94, v74, v78
v_cvt_pk_bf16_f32 v95, v75, v79
s_add_u32 s40, s29, s81
buffer_store_dwordx4 v[96:99], v28, s[4:7], s40 offen sc1
buffer_store_dwordx4 v[88:91], v28, s[4:7], s29 offen sc1
buffer_store_dwordx4 v[92:95], v29, s[4:7], s29 offen sc1
v_xor_b32 v100, 32768, v100
v_xor_b32 v101, 32768, v101
v_xor_b32 v102, 32768, v102
v_xor_b32 v103, 32768, v103
v_xor_b32 v104, 32768, v104
v_xor_b32 v105, 32768, v105
v_xor_b32 v106, 32768, v106
v_xor_b32 v107, 32768, v107
s_mov_b32 s82, s31
s_add_u32 s29, s29, 262144
s_add_u32 s31, s31, 2048
s_add_u32 s38, s38, 1
s_cmp_lt_u32 s38, 14
s_cbranch_scc1 L_qkv_p1_k_L
buffer_load_dword v26, v27, s[4:7], s77 offen sc1
s_waitcnt vmcnt(0)
buffer_store_dword v25, v24, s[4:7], s82 offen sc1
s_barrier
s_add_u32 m0, s79, 0
s_add_u32 s41, s39, 0
buffer_load_dwordx4 v30, s[4:7], s41 offen offset:0 sc1 lds
buffer_load_dwordx4 v31, s[4:7], s41 offen offset:1024 sc1 lds
s_add_u32 m0, s79, 8192
s_add_u32 s41, s39, 256
buffer_load_dwordx4 v30, s[4:7], s41 offen offset:0 sc1 lds
buffer_load_dwordx4 v31, s[4:7], s41 offen offset:1024 sc1 lds
s_add_u32 m0, s79, 16384
s_add_u32 s41, s39, 512
buffer_load_dwordx4 v30, s[4:7], s41 offen offset:0 sc1 lds
buffer_load_dwordx4 v31, s[4:7], s41 offen offset:1024 sc1 lds
s_add_u32 m0, s79, 24576
s_add_u32 s41, s39, 768
buffer_load_dwordx4 v30, s[4:7], s41 offen offset:0 sc1 lds
buffer_load_dwordx4 v31, s[4:7], s41 offen offset:1024 sc1 lds
s_add_u32 s39, s39, 32768
s_min_u32 s39, s39, s90
s_xor_b32 s79, s79, 32768
s_mov_b32 s88, s84
s_mov_b32 s89, s83
ds_read_b128 v[32:35], v100 offset:0
ds_read_b128 v[36:39], v104 offset:0
ds_read_b128 v[40:43], v101 offset:0
ds_read_b128 v[44:47], v105 offset:0
L_qkv_loop_k_L:
s_waitcnt vmcnt(8)
v_cmp_eq_u32 s[86:87], 0, v26
ds_read_b128 v[48:51], v102 offset:0
ds_read_b128 v[52:55], v106 offset:0
s_waitcnt lgkmcnt(5)
v_mfma_f32_16x16x32_bf16 v[64:67], a[0:3], v[32:35], 0
s_add_u32 m0, s78, 0
s_add_u32 s41, s28, 0
v_cvt_pk_bf16_f32 v144, v128, v132
v_mfma_f32_16x16x32_bf16 v[68:71], a[4:7], v[32:35], 0
buffer_load_dwordx4 v30, s[4:7], s41 offen offset:0 sc1 lds
v_cvt_pk_bf16_f32 v145, v129, v133
v_mfma_f32_16x16x32_bf16 v[80:83], a[128:131], v[32:35], 0
v_cvt_pk_bf16_f32 v146, v130, v134
v_cvt_pk_bf16_f32 v147, v131, v135
v_mfma_f32_16x16x32_bf16 v[84:87], a[132:135], v[32:35], 0
v_cvt_pk_bf16_f32 v136, v112, v116
v_cvt_pk_bf16_f32 v137, v113, v117
s_waitcnt lgkmcnt(4)
v_mfma_f32_16x16x32_bf16 v[72:75], a[0:3], v[36:39], 0
v_cvt_pk_bf16_f32 v138, v114, v118
v_cvt_pk_bf16_f32 v139, v115, v119
v_mfma_f32_16x16x32_bf16 v[76:79], a[4:7], v[36:39], 0
ds_read_b128 v[56:59], v103 offset:0
ds_read_b128 v[60:63], v107 offset:0
s_waitcnt lgkmcnt(5)
v_mfma_f32_16x16x32_bf16 v[64:67], a[8:11], v[40:43], v[64:67]
buffer_load_dwordx4 v31, s[4:7], s41 offen offset:1024 sc1 lds
s_add_u32 m0, s78, 8192
v_mfma_f32_16x16x32_bf16 v[68:71], a[12:15], v[40:43], v[68:71]
s_add_u32 s41, s28, 256
v_cvt_pk_bf16_f32 v140, v120, v124
v_cvt_pk_bf16_f32 v141, v121, v125
v_mfma_f32_16x16x32_bf16 v[80:83], a[136:139], v[40:43], v[80:83]
v_cvt_pk_bf16_f32 v142, v122, v126
v_cvt_pk_bf16_f32 v143, v123, v127
v_mfma_f32_16x16x32_bf16 v[84:87], a[140:143], v[40:43], v[84:87]
s_waitcnt lgkmcnt(4)
v_mfma_f32_16x16x32_bf16 v[72:75], a[8:11], v[44:47], v[72:75]
buffer_load_dwordx4 v30, s[4:7], s41 offen offset:0 sc1 lds
v_mfma_f32_16x16x32_bf16 v[76:79], a[12:15], v[44:47], v[76:79]
ds_read_b128 v[32:35], v100 offset:8192
ds_read_b128 v[36:39], v104 offset:8192
s_waitcnt lgkmcnt(5)
v_mfma_f32_16x16x32_bf16 v[64:67], a[16:19], v[48:51], v[64:67]
v_mfma_f32_16x16x32_bf16 v[68:71], a[20:23], v[48:51], v[68:71]
v_mfma_f32_16x16x32_bf16 v[80:83], a[144:147], v[48:51], v[80:83]
buffer_load_dwordx4 v31, s[4:7], s41 offen offset:1024 sc1 lds
v_mfma_f32_16x16x32_bf16 v[84:87], a[148:151], v[48:51], v[84:87]
s_waitcnt lgkmcnt(4)
v_mfma_f32_16x16x32_bf16 v[72:75], a[16:19], v[52:55], v[72:75]
v_mfma_f32_16x16x32_bf16 v[76:79], a[20:23], v[52:55], v[76:79]
s_barrier
ds_read_b128 v[40:43], v101 offset:8192
ds_read_b128 v[44:47], v105 offset:8192
s_waitcnt lgkmcnt(5)
v_mfma_f32_16x16x32_bf16 v[64:67], a[24:27], v[56:59], v[64:67]
s_add_u32 s40, s84, s81
v_mfma_f32_16x16x32_bf16 v[68:71], a[28:31], v[56:59], v[68:71]
buffer_store_dwordx4 v[144:147], v28, s[4:7], s40 offen sc1
v_mfma_f32_16x16x32_bf16 v[80:83], a[152:155], v[56:59], v[80:83]
v_mfma_f32_16x16x32_bf16 v[84:87], a[156:159], v[56:59], v[84:87]
s_waitcnt lgkmcnt(4)
v_mfma_f32_16x16x32_bf16 v[72:75], a[24:27], v[60:63], v[72:75]
v_mfma_f32_16x16x32_bf16 v[76:79], a[28:31], v[60:63], v[76:79]
ds_read_b128 v[48:51], v102 offset:8192
ds_read_b128 v[52:55], v106 offset:8192
s_waitcnt lgkmcnt(5)
v_mfma_f32_16x16x32_bf16 v[64:67], a[32:35], v[32:35], v[64:67]
buffer_store_dwordx4 v[136:139], v28, s[4:7], s84 offen sc1
v_mfma_f32_16x16x32_bf16 v[68:71], a[36:39], v[32:35], v[68:71]
v_mfma_f32_16x16x32_bf16 v[80:83], a[160:163], v[32:35], v[80:83]
v_mfma_f32_16x16x32_bf16 v[84:87], a[164:167], v[32:35], v[84:87]
s_waitcnt lgkmcnt(4)
v_mfma_f32_16x16x32_bf16 v[72:75], a[32:35], v[36:39], v[72:75]
v_mfma_f32_16x16x32_bf16 v[76:79], a[36:39], v[36:39], v[76:79]
ds_read_b128 v[56:59], v103 offset:8192
ds_read_b128 v[60:63], v107 offset:8192
s_waitcnt lgkmcnt(5)
v_mfma_f32_16x16x32_bf16 v[64:67], a[40:43], v[40:43], v[64:67]
buffer_store_dwordx4 v[140:143], v29, s[4:7], s84 offen sc1
v_mfma_f32_16x16x32_bf16 v[68:71], a[44:47], v[40:43], v[68:71]
s_add_u32 m0, s78, 16384
s_add_u32 s41, s28, 512
v_mfma_f32_16x16x32_bf16 v[80:83], a[168:171], v[40:43], v[80:83]
v_mfma_f32_16x16x32_bf16 v[84:87], a[172:175], v[40:43], v[84:87]
s_waitcnt lgkmcnt(4)
v_mfma_f32_16x16x32_bf16 v[72:75], a[40:43], v[44:47], v[72:75]
v_mfma_f32_16x16x32_bf16 v[76:79], a[44:47], v[44:47], v[76:79]
ds_read_b128 v[32:35], v100 offset:16384
ds_read_b128 v[36:39], v104 offset:16384
s_waitcnt lgkmcnt(5)
v_mfma_f32_16x16x32_bf16 v[64:67], a[48:51], v[48:51], v[64:67]
buffer_load_dwordx4 v30, s[4:7], s41 offen offset:0 sc1 lds
v_mfma_f32_16x16x32_bf16 v[68:71], a[52:55], v[48:51], v[68:71]
v_mfma_f32_16x16x32_bf16 v[80:83], a[176:179], v[48:51], v[80:83]
v_mfma_f32_16x16x32_bf16 v[84:87], a[180:183], v[48:51], v[84:87]
s_waitcnt lgkmcnt(4)
v_mfma_f32_16x16x32_bf16 v[72:75], a[48:51], v[52:55], v[72:75]
v_mfma_f32_16x16x32_bf16 v[76:79], a[52:55], v[52:55], v[76:79]
ds_read_b128 v[40:43], v101 offset:16384
ds_read_b128 v[44:47], v105 offset:16384
s_waitcnt lgkmcnt(5)
v_mfma_f32_16x16x32_bf16 v[64:67], a[56:59], v[56:59], v[64:67]
buffer_load_dwordx4 v31, s[4:7], s41 offen offset:1024 sc1 lds
s_add_u32 m0, s78, 24576
v_mfma_f32_16x16x32_bf16 v[68:71], a[60:63], v[56:59], v[68:71]
s_add_u32 s41, s28, 768
v_mfma_f32_16x16x32_bf16 v[80:83], a[184:187], v[56:59], v[80:83]
v_mfma_f32_16x16x32_bf16 v[84:87], a[188:191], v[56:59], v[84:87]
s_waitcnt lgkmcnt(4)
v_mfma_f32_16x16x32_bf16 v[72:75], a[56:59], v[60:63], v[72:75]
v_mfma_f32_16x16x32_bf16 v[76:79], a[60:63], v[60:63], v[76:79]
ds_read_b128 v[48:51], v102 offset:16384
ds_read_b128 v[52:55], v106 offset:16384
s_waitcnt lgkmcnt(5)
v_mfma_f32_16x16x32_bf16 v[64:67], a[64:67], v[32:35], v[64:67]
buffer_load_dwordx4 v30, s[4:7], s41 offen offset:0 sc1 lds
v_mfma_f32_16x16x32_bf16 v[68:71], a[68:71], v[32:35], v[68:71]
v_mfma_f32_16x16x32_bf16 v[80:83], a[192:195], v[32:35], v[80:83]
v_mfma_f32_16x16x32_bf16 v[84:87], a[196:199], v[32:35], v[84:87]
s_waitcnt lgkmcnt(4)
v_mfma_f32_16x16x32_bf16 v[72:75], a[64:67], v[36:39], v[72:75]
v_mfma_f32_16x16x32_bf16 v[76:79], a[68:71], v[36:39], v[76:79]
ds_read_b128 v[56:59], v103 offset:16384
ds_read_b128 v[60:63], v107 offset:16384
s_waitcnt lgkmcnt(5)
v_mfma_f32_16x16x32_bf16 v[64:67], a[72:75], v[40:43], v[64:67]
buffer_load_dwordx4 v31, s[4:7], s41 offen offset:1024 sc1 lds
s_add_u32 s40, s88, s81
v_mfma_f32_16x16x32_bf16 v[68:71], a[76:79], v[40:43], v[68:71]
v_mfma_f32_16x16x32_bf16 v[80:83], a[200:203], v[40:43], v[80:83]
v_mfma_f32_16x16x32_bf16 v[84:87], a[204:207], v[40:43], v[84:87]
s_waitcnt lgkmcnt(4)
v_mfma_f32_16x16x32_bf16 v[72:75], a[72:75], v[44:47], v[72:75]
v_mfma_f32_16x16x32_bf16 v[76:79], a[76:79], v[44:47], v[76:79]
ds_read_b128 v[32:35], v100 offset:24576
ds_read_b128 v[36:39], v104 offset:24576
s_waitcnt lgkmcnt(5)
v_mfma_f32_16x16x32_bf16 v[64:67], a[80:83], v[48:51], v[64:67]
buffer_store_dwordx4 v[96:99], v28, s[4:7], s40 offen sc1
v_mfma_f32_16x16x32_bf16 v[68:71], a[84:87], v[48:51], v[68:71]
v_mfma_f32_16x16x32_bf16 v[80:83], a[208:211], v[48:51], v[80:83]
v_mfma_f32_16x16x32_bf16 v[84:87], a[212:215], v[48:51], v[84:87]
s_waitcnt lgkmcnt(4)
v_mfma_f32_16x16x32_bf16 v[72:75], a[80:83], v[52:55], v[72:75]
v_mfma_f32_16x16x32_bf16 v[76:79], a[84:87], v[52:55], v[76:79]
ds_read_b128 v[40:43], v101 offset:24576
ds_read_b128 v[44:47], v105 offset:24576
s_waitcnt lgkmcnt(5)
v_mfma_f32_16x16x32_bf16 v[64:67], a[88:91], v[56:59], v[64:67]
buffer_store_dwordx4 v[88:91], v28, s[4:7], s88 offen sc1
v_mfma_f32_16x16x32_bf16 v[68:71], a[92:95], v[56:59], v[68:71]
v_mfma_f32_16x16x32_bf16 v[80:83], a[216:219], v[56:59], v[80:83]
v_mfma_f32_16x16x32_bf16 v[84:87], a[220:223], v[56:59], v[84:87]
s_waitcnt lgkmcnt(4)
v_mfma_f32_16x16x32_bf16 v[72:75], a[88:91], v[60:63], v[72:75]
v_mfma_f32_16x16x32_bf16 v[76:79], a[92:95], v[60:63], v[76:79]
ds_read_b128 v[48:51], v102 offset:24576
ds_read_b128 v[52:55], v106 offset:24576
s_waitcnt lgkmcnt(5)
v_mfma_f32_16x16x32_bf16 v[64:67], a[96:99], v[32:35], v[64:67]
buffer_store_dwordx4 v[92:95], v29, s[4:7], s88 offen sc1
v_mfma_f32_16x16x32_bf16 v[68:71], a[100:103], v[32:35], v[68:71]
v_mfma_f32_16x16x32_bf16 v[80:83], a[224:227], v[32:35], v[80:83]
v_mfma_f32_16x16x32_bf16 v[84:87], a[228:231], v[32:35], v[84:87]
s_waitcnt lgkmcnt(4)
v_mfma_f32_16x16x32_bf16 v[72:75], a[96:99], v[36:39], v[72:75]
v_mfma_f32_16x16x32_bf16 v[76:79], a[100:103], v[36:39], v[76:79]
ds_read_b128 v[56:59], v103 offset:24576
ds_read_b128 v[60:63], v107 offset:24576
s_waitcnt lgkmcnt(5)
v_mfma_f32_16x16x32_bf16 v[64:67], a[104:107], v[40:43], v[64:67]
v_mfma_f32_16x16x32_bf16 v[68:71], a[108:111], v[40:43], v[68:71]
v_mfma_f32_16x16x32_bf16 v[80:83], a[232:235], v[40:43], v[80:83]
v_mfma_f32_16x16x32_bf16 v[84:87], a[236:239], v[40:43], v[84:87]
s_waitcnt lgkmcnt(4)
v_mfma_f32_16x16x32_bf16 v[72:75], a[104:107], v[44:47], v[72:75]
v_mfma_f32_16x16x32_bf16 v[76:79], a[108:111], v[44:47], v[76:79]
s_cmp_lg_u32 s86, 0
s_cbranch_scc1 L_spin_32
L_go_33:
s_waitcnt vmcnt(7)
s_barrier
buffer_store_dword v25, v24, s[4:7], s83 offen sc1
s_add_u32 s28, s28, 32768
s_add_u32 s77, s77, 512
ds_read_b128 v[32:35], v4 offset:0
ds_read_b128 v[36:39], v8 offset:0
s_waitcnt lgkmcnt(5)
v_mfma_f32_16x16x32_bf16 v[64:67], a[112:115], v[48:51], v[64:67]
v_mfma_f32_16x16x32_bf16 v[68:71], a[116:119], v[48:51], v[68:71]
v_mfma_f32_16x16x32_bf16 v[80:83], a[240:243], v[48:51], v[80:83]
v_mfma_f32_16x16x32_bf16 v[84:87], a[244:247], v[48:51], v[84:87]
s_waitcnt lgkmcnt(4)
v_mfma_f32_16x16x32_bf16 v[72:75], a[112:115], v[52:55], v[72:75]
v_mfma_f32_16x16x32_bf16 v[76:79], a[116:119], v[52:55], v[76:79]
ds_read_b128 v[40:43], v5 offset:0
ds_read_b128 v[44:47], v9 offset:0
s_waitcnt lgkmcnt(5)
v_mfma_f32_16x16x32_bf16 v[64:67], a[120:123], v[56:59], v[64:67]
v_mfma_f32_16x16x32_bf16 v[68:71], a[124:127], v[56:59], v[68:71]
v_mfma_f32_16x16x32_bf16 v[80:83], a[248:251], v[56:59], v[80:83]
v_mfma_f32_16x16x32_bf16 v[84:87], a[252:255], v[56:59], v[84:87]
s_waitcnt lgkmcnt(4)
v_mfma_f32_16x16x32_bf16 v[72:75], a[120:123], v[60:63], v[72:75]
v_mfma_f32_16x16x32_bf16 v[76:79], a[124:127], v[60:63], v[76:79]
ds_read_b128 v[48:51], v6 offset:0
ds_read_b128 v[52:55], v10 offset:0
s_waitcnt lgkmcnt(5)
v_mfma_f32_16x16x32_bf16 v[112:115], a[0:3], v[32:35], 0
v_mfma_f32_16x16x32_bf16 v[116:119], a[4:7], v[32:35], 0
v_mfma_f32_16x16x32_bf16 v[128:131], a[128:131], v[32:35], 0
v_mfma_f32_16x16x32_bf16 v[132:135], a[132:135], v[32:35], 0
s_waitcnt lgkmcnt(4)
v_mfma_f32_16x16x32_bf16 v[120:123], a[0:3], v[36:39], 0
v_mfma_f32_16x16x32_bf16 v[124:127], a[4:7], v[36:39], 0
ds_read_b128 v[56:59], v7 offset:0
ds_read_b128 v[60:63], v11 offset:0
s_waitcnt lgkmcnt(5)
v_mfma_f32_16x16x32_bf16 v[112:115], a[8:11], v[40:43], v[112:115]
v_mfma_f32_16x16x32_bf16 v[116:119], a[12:15], v[40:43], v[116:119]
v_mfma_f32_16x16x32_bf16 v[128:131], a[136:139], v[40:43], v[128:131]
v_mfma_f32_16x16x32_bf16 v[132:135], a[140:143], v[40:43], v[132:135]
s_waitcnt lgkmcnt(4)
v_mfma_f32_16x16x32_bf16 v[120:123], a[8:11], v[44:47], v[120:123]
v_mfma_f32_16x16x32_bf16 v[124:127], a[12:15], v[44:47], v[124:127]
ds_read_b128 v[32:35], v4 offset:8192
ds_read_b128 v[36:39], v8 offset:8192
s_waitcnt lgkmcnt(5)
v_mfma_f32_16x16x32_bf16 v[112:115], a[16:19], v[48:51], v[112:115]
v_cvt_pk_bf16_f32 v96, v80, v84
v_cvt_pk_bf16_f32 v97, v81, v85
v_mfma_f32_16x16x32_bf16 v[116:119], a[20:23], v[48:51], v[116:119]
v_cvt_pk_bf16_f32 v98, v82, v86
v_cvt_pk_bf16_f32 v99, v83, v87
v_mfma_f32_16x16x32_bf16 v[128:131], a[144:147], v[48:51], v[128:131]
v_cvt_pk_bf16_f32 v88, v64, v68
v_cvt_pk_bf16_f32 v89, v65, v69
v_mfma_f32_16x16x32_bf16 v[132:135], a[148:151], v[48:51], v[132:135]
v_cvt_pk_bf16_f32 v90, v66, v70
v_cvt_pk_bf16_f32 v91, v67, v71
s_waitcnt lgkmcnt(4)
v_mfma_f32_16x16x32_bf16 v[120:123], a[16:19], v[52:55], v[120:123]
v_cvt_pk_bf16_f32 v92, v72, v76
v_cvt_pk_bf16_f32 v93, v73, v77
v_mfma_f32_16x16x32_bf16 v[124:127], a[20:23], v[52:55], v[124:127]
ds_read_b128 v[40:43], v5 offset:8192
ds_read_b128 v[44:47], v9 offset:8192
s_waitcnt lgkmcnt(5)
v_mfma_f32_16x16x32_bf16 v[112:115], a[24:27], v[56:59], v[112:115]
v_cvt_pk_bf16_f32 v94, v74, v78
v_cvt_pk_bf16_f32 v95, v75, v79
v_mfma_f32_16x16x32_bf16 v[116:119], a[28:31], v[56:59], v[116:119]
v_xor_b32 v100, 32768, v100
v_xor_b32 v101, 32768, v101
v_mfma_f32_16x16x32_bf16 v[128:131], a[152:155], v[56:59], v[128:131]
v_xor_b32 v102, 32768, v102
v_xor_b32 v103, 32768, v103
v_mfma_f32_16x16x32_bf16 v[132:135], a[156:159], v[56:59], v[132:135]
v_xor_b32 v104, 32768, v104
v_xor_b32 v105, 32768, v105
s_waitcnt lgkmcnt(4)
v_mfma_f32_16x16x32_bf16 v[120:123], a[24:27], v[60:63], v[120:123]
v_xor_b32 v106, 32768, v106
v_xor_b32 v107, 32768, v107
s_mov_b32 s88, s29
v_mfma_f32_16x16x32_bf16 v[124:127], a[28:31], v[60:63], v[124:127]
buffer_load_dword v26, v27, s[4:7], s77 offen sc1
ds_read_b128 v[48:51], v6 offset:8192
ds_read_b128 v[52:55], v10 offset:8192
s_waitcnt lgkmcnt(5)
v_mfma_f32_16x16x32_bf16 v[112:115], a[32:35], v[32:35], v[112:115]
s_mov_b32 s82, s31
s_add_u32 s29, s29, 262144
s_add_u32 s31, s31, 2048
v_mfma_f32_16x16x32_bf16 v[116:119], a[36:39], v[32:35], v[116:119]
v_mfma_f32_16x16x32_bf16 v[128:131], a[160:163], v[32:35], v[128:131]
v_mfma_f32_16x16x32_bf16 v[132:135], a[164:167], v[32:35], v[132:135]
s_waitcnt lgkmcnt(4)
v_mfma_f32_16x16x32_bf16 v[120:123], a[32:35], v[36:39], v[120:123]
v_mfma_f32_16x16x32_bf16 v[124:127], a[36:39], v[36:39], v[124:127]
ds_read_b128 v[56:59], v7 offset:8192
ds_read_b128 v[60:63], v11 offset:8192
s_waitcnt lgkmcnt(5)
v_mfma_f32_16x16x32_bf16 v[112:115], a[40:43], v[40:43], v[112:115]
v_mfma_f32_16x16x32_bf16 v[116:119], a[44:47], v[40:43], v[116:119]
v_mfma_f32_16x16x32_bf16 v[128:131], a[168:171], v[40:43], v[128:131]
v_mfma_f32_16x16x32_bf16 v[132:135], a[172:175], v[40:43], v[132:135]
s_waitcnt lgkmcnt(4)
v_mfma_f32_16x16x32_bf16 v[120:123], a[40:43], v[44:47], v[120:123]
v_mfma_f32_16x16x32_bf16 v[124:127], a[44:47], v[44:47], v[124:127]
s_waitcnt vmcnt(2)
s_barrier
buffer_store_dword v25, v24, s[4:7], s89 offen sc1
s_mov_b32 s89, s82
ds_read_b128 v[32:35], v4 offset:16384
ds_read_b128 v[36:39], v8 offset:16384
s_waitcnt lgkmcnt(5)
v_mfma_f32_16x16x32_bf16 v[112:115], a[48:51], v[48:51], v[112:115]
s_add_u32 m0, s79, 0
s_add_u32 s41, s39, 0
v_mfma_f32_16x16x32_bf16 v[116:119], a[52:55], v[48:51], v[116:119]
buffer_load_dwordx4 v30, s[4:7], s41 offen offset:0 sc1 lds
v_mfma_f32_16x16x32_bf16 v[128:131], a[176:179], v[48:51], v[128:131]
v_mfma_f32_16x16x32_bf16 v[132:135], a[180:183], v[48:51], v[132:135]
s_waitcnt lgkmcnt(4)
v_mfma_f32_16x16x32_bf16 v[120:123], a[48:51], v[52:55], v[120:123]
v_mfma_f32_16x16x32_bf16 v[124:127], a[52:55], v[52:55], v[124:127]
ds_read_b128 v[40:43], v5 offset:16384
ds_read_b128 v[44:47], v9 offset:16384
s_waitcnt lgkmcnt(5)
v_mfma_f32_16x16x32_bf16 v[112:115], a[56:59], v[56:59], v[112:115]
buffer_load_dwordx4 v31, s[4:7], s41 offen offset:1024 sc1 lds
s_add_u32 m0, s79, 8192
v_mfma_f32_16x16x32_bf16 v[116:119], a[60:63], v[56:59], v[116:119]
s_add_u32 s41, s39, 256
v_mfma_f32_16x16x32_bf16 v[128:131], a[184:187], v[56:59], v[128:131]
v_mfma_f32_16x16x32_bf16 v[132:135], a[188:191], v[56:59], v[132:135]
s_waitcnt lgkmcnt(4)
v_mfma_f32_16x16x32_bf16 v[120:123], a[56:59], v[60:63], v[120:123]
v_mfma_f32_16x16x32_bf16 v[124:127], a[60:63], v[60:63], v[124:127]
ds_read_b128 v[48:51], v6 offset:16384
ds_read_b128 v[52:55], v10 offset:16384
s_waitcnt lgkmcnt(5)
v_mfma_f32_16x16x32_bf16 v[112:115], a[64:67], v[32:35], v[112:115]
buffer_load_dwordx4 v30, s[4:7], s41 offen offset:0 sc1 lds
v_mfma_f32_16x16x32_bf16 v[116:119], a[68:71], v[32:35], v[116:119]
v_mfma_f32_16x16x32_bf16 v[128:131], a[192:195], v[32:35], v[128:131]
v_mfma_f32_16x16x32_bf16 v[132:135], a[196:199], v[32:35], v[132:135]
s_waitcnt lgkmcnt(4)
v_mfma_f32_16x16x32_bf16 v[120:123], a[64:67], v[36:39], v[120:123]
v_mfma_f32_16x16x32_bf16 v[124:127], a[68:71], v[36:39], v[124:127]
ds_read_b128 v[56:59], v7 offset:16384
ds_read_b128 v[60:63], v11 offset:16384
s_waitcnt lgkmcnt(5)
v_mfma_f32_16x16x32_bf16 v[112:115], a[72:75], v[40:43], v[112:115]
buffer_load_dwordx4 v31, s[4:7], s41 offen offset:1024 sc1 lds
s_add_u32 m0, s79, 16384
v_mfma_f32_16x16x32_bf16 v[116:119], a[76:79], v[40:43], v[116:119]
s_add_u32 s41, s39, 512
v_mfma_f32_16x16x32_bf16 v[128:131], a[200:203], v[40:43], v[128:131]
v_mfma_f32_16x16x32_bf16 v[132:135], a[204:207], v[40:43], v[132:135]
s_waitcnt lgkmcnt(4)
v_mfma_f32_16x16x32_bf16 v[120:123], a[72:75], v[44:47], v[120:123]
v_mfma_f32_16x16x32_bf16 v[124:127], a[76:79], v[44:47], v[124:127]
ds_read_b128 v[32:35], v4 offset:24576
ds_read_b128 v[36:39], v8 offset:24576
s_waitcnt lgkmcnt(5)
v_mfma_f32_16x16x32_bf16 v[112:115], a[80:83], v[48:51], v[112:115]
buffer_load_dwordx4 v30, s[4:7], s41 offen offset:0 sc1 lds
v_mfma_f32_16x16x32_bf16 v[116:119], a[84:87], v[48:51], v[116:119]
v_mfma_f32_16x16x32_bf16 v[128:131], a[208:211], v[48:51], v[128:131]
v_mfma_f32_16x16x32_bf16 v[132:135], a[212:215], v[48:51], v[132:135]
s_waitcnt lgkmcnt(4)
v_mfma_f32_16x16x32_bf16 v[120:123], a[80:83], v[52:55], v[120:123]
v_mfma_f32_16x16x32_bf16 v[124:127], a[84:87], v[52:55], v[124:127]
ds_read_b128 v[40:43], v5 offset:24576
ds_read_b128 v[44:47], v9 offset:24576
s_waitcnt lgkmcnt(5)
v_mfma_f32_16x16x32_bf16 v[112:115], a[88:91], v[56:59], v[112:115]
buffer_load_dwordx4 v31, s[4:7], s41 offen offset:1024 sc1 lds
s_add_u32 m0, s79, 24576
v_mfma_f32_16x16x32_bf16 v[116:119], a[92:95], v[56:59], v[116:119]
s_add_u32 s41, s39, 768
v_mfma_f32_16x16x32_bf16 v[128:131], a[216:219], v[56:59], v[128:131]
v_mfma_f32_16x16x32_bf16 v[132:135], a[220:223], v[56:59], v[132:135]
s_waitcnt lgkmcnt(4)
v_mfma_f32_16x16x32_bf16 v[120:123], a[88:91], v[60:63], v[120:123]
v_mfma_f32_16x16x32_bf16 v[124:127], a[92:95], v[60:63], v[124:127]
s_barrier
ds_read_b128 v[48:51], v6 offset:24576
ds_read_b128 v[52:55], v10 offset:24576
s_waitcnt lgkmcnt(5)
v_mfma_f32_16x16x32_bf16 v[112:115], a[96:99], v[32:35], v[112:115]
buffer_load_dwordx4 v30, s[4:7], s41 offen offset:0 sc1 lds
v_mfma_f32_16x16x32_bf16 v[116:119], a[100:103], v[32:35], v[116:119]
v_mfma_f32_16x16x32_bf16 v[128:131], a[224:227], v[32:35], v[128:131]
v_mfma_f32_16x16x32_bf16 v[132:135], a[228:231], v[32:35], v[132:135]
s_waitcnt lgkmcnt(4)
v_mfma_f32_16x16x32_bf16 v[120:123], a[96:99], v[36:39], v[120:123]
v_mfma_f32_16x16x32_bf16 v[124:127], a[100:103], v[36:39], v[124:127]
ds_read_b128 v[56:59], v7 offset:24576
ds_read_b128 v[60:63], v11 offset:24576
s_waitcnt lgkmcnt(5)
v_mfma_f32_16x16x32_bf16 v[112:115], a[104:107], v[40:43], v[112:115]
buffer_load_dwordx4 v31, s[4:7], s41 offen offset:1024 sc1 lds
s_add_u32 s39, s39, 32768
v_mfma_f32_16x16x32_bf16 v[116:119], a[108:111], v[40:43], v[116:119]
s_min_u32 s39, s39, s90
s_xor_b32 s79, s79, 32768
v_mfma_f32_16x16x32_bf16 v[128:131], a[232:235], v[40:43], v[128:131]
v_mfma_f32_16x16x32_bf16 v[132:135], a[236:239], v[40:43], v[132:135]
s_waitcnt lgkmcnt(4)
v_mfma_f32_16x16x32_bf16 v[120:123], a[104:107], v[44:47], v[120:123]
v_mfma_f32_16x16x32_bf16 v[124:127], a[108:111], v[44:47], v[124:127]
ds_read_b128 v[32:35], v100 offset:0
ds_read_b128 v[36:39], v104 offset:0
s_waitcnt lgkmcnt(5)
v_mfma_f32_16x16x32_bf16 v[112:115], a[112:115], v[48:51], v[112:115]
v_mfma_f32_16x16x32_bf16 v[116:119], a[116:119], v[48:51], v[116:119]
v_mfma_f32_16x16x32_bf16 v[128:131], a[240:243], v[48:51], v[128:131]
v_mfma_f32_16x16x32_bf16 v[132:135], a[244:247], v[48:51], v[132:135]
s_waitcnt lgkmcnt(4)
v_mfma_f32_16x16x32_bf16 v[120:123], a[112:115], v[52:55], v[120:123]
v_mfma_f32_16x16x32_bf16 v[124:127], a[116:119], v[52:55], v[124:127]
ds_read_b128 v[40:43], v101 offset:0
ds_read_b128 v[44:47], v105 offset:0
s_waitcnt lgkmcnt(5)
v_mfma_f32_16x16x32_bf16 v[112:115], a[120:123], v[56:59], v[112:115]
v_mfma_f32_16x16x32_bf16 v[116:119], a[124:127], v[56:59], v[116:119]
v_mfma_f32_16x16x32_bf16 v[128:131], a[248:251], v[56:59], v[128:131]
v_mfma_f32_16x16x32_bf16 v[132:135], a[252:255], v[56:59], v[132:135]
s_waitcnt lgkmcnt(4)
v_mfma_f32_16x16x32_bf16 v[120:123], a[120:123], v[60:63], v[120:123]
v_mfma_f32_16x16x32_bf16 v[124:127], a[124:127], v[60:63], v[124:127]
s_mov_b32 s84, s30
s_mov_b32 s83, s76
s_add_u32 s30, s30, 262144
s_add_u32 s76, s76, 2048
s_add_u32 s38, s38, 1
s_cmp_lt_u32 s38, 64
s_cbranch_scc1 L_qkv_loop_k_L
s_add_u32 s40, s88, s81
buffer_store_dwordx4 v[96:99], v28, s[4:7], s40 offen sc1
buffer_store_dwordx4 v[88:91], v28, s[4:7], s88 offen sc1
buffer_store_dwordx4 v[92:95], v29, s[4:7], s88 offen sc1
s_mov_b32 s82, s89
L_qkv_p3_k_L:
v_cvt_pk_bf16_f32 v144, v128, v132
v_cvt_pk_bf16_f32 v145, v129, v133
v_cvt_pk_bf16_f32 v146, v130, v134
v_cvt_pk_bf16_f32 v147, v131, v135
v_cvt_pk_bf16_f32 v136, v112, v116
v_cvt_pk_bf16_f32 v137, v113, v117
v_cvt_pk_bf16_f32 v138, v114, v118
v_cvt_pk_bf16_f32 v139, v115, v119
v_cvt_pk_bf16_f32 v140, v120, v124
v_cvt_pk_bf16_f32 v141, v121, v125
v_cvt_pk_bf16_f32 v142, v122, v126
v_cvt_pk_bf16_f32 v143, v123, v127
s_add_u32 s40, s84, s81
buffer_store_dwordx4 v[144:147], v28, s[4:7], s40 offen sc1
buffer_store_dwordx4 v[136:139], v28, s[4:7], s84 offen sc1
buffer_store_dwordx4 v[140:143], v29, s[4:7], s84 offen sc1
buffer_load_dword v26, v27, s[4:7], s77 offen sc1
s_waitcnt vmcnt(0) lgkmcnt(0)
buffer_store_dword v25, v24, s[4:7], s83 offen sc1
buffer_store_dword v25, v24, s[4:7], s82 offen sc1
s_cmp_eq_u32 s38, 78
s_cbranch_scc1 L_end_qkv_L
s_barrier
L_p3_34:
v_cmp_eq_u32 vcc, 0, v26
s_cbranch_vccz L_p3o_35
s_sub_u32 s36, s36, 1
s_cbranch_scc1 L_end_qkv_L
buffer_load_dword v26, v27, s[4:7], s77 offen sc1
s_waitcnt vmcnt(0)
s_branch L_p3_34
L_p3o_35:
s_add_u32 m0, s78, 0
s_add_u32 s41, s28, 0
buffer_load_dwordx4 v30, s[4:7], s41 offen offset:0 sc1 lds
buffer_load_dwordx4 v31, s[4:7], s41 offen offset:1024 sc1 lds
s_add_u32 m0, s78, 8192
s_add_u32 s41, s28, 256
buffer_load_dwordx4 v30, s[4:7], s41 offen offset:0 sc1 lds
buffer_load_dwordx4 v31, s[4:7], s41 offen offset:1024 sc1 lds
s_add_u32 m0, s78, 16384
s_add_u32 s41, s28, 512
buffer_load_dwordx4 v30, s[4:7], s41 offen offset:0 sc1 lds
buffer_load_dwordx4 v31, s[4:7], s41 offen offset:1024 sc1 lds
s_add_u32 m0, s78, 24576
s_add_u32 s41, s28, 768
buffer_load_dwordx4 v30, s[4:7], s41 offen offset:0 sc1 lds
buffer_load_dwordx4 v31, s[4:7], s41 offen offset:1024 sc1 lds
s_add_u32 s28, s28, 32768
s_add_u32 s77, s77, 512
s_waitcnt vmcnt(6)
s_barrier
ds_read_b128 v[32:35], v4 offset:0
ds_read_b128 v[36:39], v8 offset:0
ds_read_b128 v[40:43], v5 offset:0
ds_read_b128 v[44:47], v9 offset:0
ds_read_b128 v[48:51], v6 offset:0
ds_read_b128 v[52:55], v10 offset:0
s_waitcnt lgkmcnt(5)
v_mfma_f32_16x16x32_bf16 v[112:115], a[0:3], v[32:35], 0
v_mfma_f32_16x16x32_bf16 v[116:119], a[4:7], v[32:35], 0
v_mfma_f32_16x16x32_bf16 v[128:131], a[128:131], v[32:35], 0
v_mfma_f32_16x16x32_bf16 v[132:135], a[132:135], v[32:35], 0
s_waitcnt lgkmcnt(4)
v_mfma_f32_16x16x32_bf16 v[120:123], a[0:3], v[36:39], 0
v_mfma_f32_16x16x32_bf16 v[124:127], a[4:7], v[36:39], 0
ds_read_b128 v[56:59], v7 offset:0
ds_read_b128 v[60:63], v11 offset:0
s_waitcnt lgkmcnt(5)
v_mfma_f32_16x16x32_bf16 v[112:115], a[8:11], v[40:43], v[112:115]
v_mfma_f32_16x16x32_bf16 v[116:119], a[12:15], v[40:43], v[116:119]
v_mfma_f32_16x16x32_bf16 v[128:131], a[136:139], v[40:43], v[128:131]
v_mfma_f32_16x16x32_bf16 v[132:135], a[140:143], v[40:43], v[132:135]
s_waitcnt lgkmcnt(4)
v_mfma_f32_16x16x32_bf16 v[120:123], a[8:11], v[44:47], v[120:123]
v_mfma_f32_16x16x32_bf16 v[124:127], a[12:15], v[44:47], v[124:127]
s_waitcnt vmcnt(4)
s_barrier
ds_read_b128 v[32:35], v4 offset:8192
ds_read_b128 v[36:39], v8 offset:8192
s_waitcnt lgkmcnt(5)
v_mfma_f32_16x16x32_bf16 v[112:115], a[16:19], v[48:51], v[112:115]
v_mfma_f32_16x16x32_bf16 v[116:119], a[20:23], v[48:51], v[116:119]
v_mfma_f32_16x16x32_bf16 v[128:131], a[144:147], v[48:51], v[128:131]
v_mfma_f32_16x16x32_bf16 v[132:135], a[148:151], v[48:51], v[132:135]
s_waitcnt lgkmcnt(4)
v_mfma_f32_16x16x32_bf16 v[120:123], a[16:19], v[52:55], v[120:123]
v_mfma_f32_16x16x32_bf16 v[124:127], a[20:23], v[52:55], v[124:127]
ds_read_b128 v[40:43], v5 offset:8192
ds_read_b128 v[44:47], v9 offset:8192
s_waitcnt lgkmcnt(5)
v_mfma_f32_16x16x32_bf16 v[112:115], a[24:27], v[56:59], v[112:115]
v_mfma_f32_16x16x32_bf16 v[116:119], a[28:31], v[56:59], v[116:119]
v_mfma_f32_16x16x32_bf16 v[128:131], a[152:155], v[56:59], v[128:131]
v_mfma_f32_16x16x32_bf16 v[132:135], a[156:159], v[56:59], v[132:135]
s_waitcnt lgkmcnt(4)
v_mfma_f32_16x16x32_bf16 v[120:123], a[24:27], v[60:63], v[120:123]
v_mfma_f32_16x16x32_bf16 v[124:127], a[28:31], v[60:63], v[124:127]
ds_read_b128 v[48:51], v6 offset:8192
ds_read_b128 v[52:55], v10 offset:8192
s_waitcnt lgkmcnt(5)
v_mfma_f32_16x16x32_bf16 v[112:115], a[32:35], v[32:35], v[112:115]
v_mfma_f32_16x16x32_bf16 v[116:119], a[36:39], v[32:35], v[116:119]
v_mfma_f32_16x16x32_bf16 v[128:131], a[160:163], v[32:35], v[128:131]
v_mfma_f32_16x16x32_bf16 v[132:135], a[164:167], v[32:35], v[132:135]
s_waitcnt lgkmcnt(4)
v_mfma_f32_16x16x32_bf16 v[120:123], a[32:35], v[36:39], v[120:123]
v_mfma_f32_16x16x32_bf16 v[124:127], a[36:39], v[36:39], v[124:127]
ds_read_b128 v[56:59], v7 offset:8192
ds_read_b128 v[60:63], v11 offset:8192
s_waitcnt lgkmcnt(5)
v_mfma_f32_16x16x32_bf16 v[112:115], a[40:43], v[40:43], v[112:115]
v_mfma_f32_16x16x32_bf16 v[116:119], a[44:47], v[40:43], v[116:119]
v_mfma_f32_16x16x32_bf16 v[128:131], a[168:171], v[40:43], v[128:131]
v_mfma_f32_16x16x32_bf16 v[132:135], a[172:175], v[40:43], v[132:135]
s_waitcnt lgkmcnt(4)
v_mfma_f32_16x16x32_bf16 v[120:123], a[40:43], v[44:47], v[120:123]
v_mfma_f32_16x16x32_bf16 v[124:127], a[44:47], v[44:47], v[124:127]
s_waitcnt vmcnt(2)
s_barrier
ds_read_b128 v[32:35], v4 offset:16384
ds_read_b128 v[36:39], v8 offset:16384
s_waitcnt lgkmcnt(5)
v_mfma_f32_16x16x32_bf16 v[112:115], a[48:51], v[48:51], v[112:115]
v_mfma_f32_16x16x32_bf16 v[116:119], a[52:55], v[48:51], v[116:119]
v_mfma_f32_16x16x32_bf16 v[128:131], a[176:179], v[48:51], v[128:131]
v_mfma_f32_16x16x32_bf16 v[132:135], a[180:183], v[48:51], v[132:135]
s_waitcnt lgkmcnt(4)
v_mfma_f32_16x16x32_bf16 v[120:123], a[48:51], v[52:55], v[120:123]
v_mfma_f32_16x16x32_bf16 v[124:127], a[52:55], v[52:55], v[124:127]
ds_read_b128 v[40:43], v5 offset:16384
ds_read_b128 v[44:47], v9 offset:16384
s_waitcnt lgkmcnt(5)
v_mfma_f32_16x16x32_bf16 v[112:115], a[56:59], v[56:59], v[112:115]
v_mfma_f32_16x16x32_bf16 v[116:119], a[60:63], v[56:59], v[116:119]
v_mfma_f32_16x16x32_bf16 v[128:131], a[184:187], v[56:59], v[128:131]
v_mfma_f32_16x16x32_bf16 v[132:135], a[188:191], v[56:59], v[132:135]
s_waitcnt lgkmcnt(4)
v_mfma_f32_16x16x32_bf16 v[120:123], a[56:59], v[60:63], v[120:123]
v_mfma_f32_16x16x32_bf16 v[124:127], a[60:63], v[60:63], v[124:127]
ds_read_b128 v[48:51], v6 offset:16384
ds_read_b128 v[52:55], v10 offset:16384
s_waitcnt lgkmcnt(5)
v_mfma_f32_16x16x32_bf16 v[112:115], a[64:67], v[32:35], v[112:115]
v_mfma_f32_16x16x32_bf16 v[116:119], a[68:71], v[32:35], v[116:119]
v_mfma_f32_16x16x32_bf16 v[128:131], a[192:195], v[32:35], v[128:131]
v_mfma_f32_16x16x32_bf16 v[132:135], a[196:199], v[32:35], v[132:135]
s_waitcnt lgkmcnt(4)
v_mfma_f32_16x16x32_bf16 v[120:123], a[64:67], v[36:39], v[120:123]
v_mfma_f32_16x16x32_bf16 v[124:127], a[68:71], v[36:39], v[124:127]
ds_read_b128 v[56:59], v7 offset:16384
ds_read_b128 v[60:63], v11 offset:16384
s_waitcnt lgkmcnt(5)
v_mfma_f32_16x16x32_bf16 v[112:115], a[72:75], v[40:43], v[112:115]
v_mfma_f32_16x16x32_bf16 v[116:119], a[76:79], v[40:43], v[116:119]
v_mfma_f32_16x16x32_bf16 v[128:131], a[200:203], v[40:43], v[128:131]
v_mfma_f32_16x16x32_bf16 v[132:135], a[204:207], v[40:43], v[132:135]
s_waitcnt lgkmcnt(4)
v_mfma_f32_16x16x32_bf16 v[120:123], a[72:75], v[44:47], v[120:123]
v_mfma_f32_16x16x32_bf16 v[124:127], a[76:79], v[44:47], v[124:127]
s_waitcnt vmcnt(0)
s_barrier
ds_read_b128 v[32:35], v4 offset:24576
ds_read_b128 v[36:39], v8 offset:24576
s_waitcnt lgkmcnt(5)
v_mfma_f32_16x16x32_bf16 v[112:115], a[80:83], v[48:51], v[112:115]
v_mfma_f32_16x16x32_bf16 v[116:119], a[84:87], v[48:51], v[116:119]
v_mfma_f32_16x16x32_bf16 v[128:131], a[208:211], v[48:51], v[128:131]
v_mfma_f32_16x16x32_bf16 v[132:135], a[212:215], v[48:51], v[132:135]
s_waitcnt lgkmcnt(4)
v_mfma_f32_16x16x32_bf16 v[120:123], a[80:83], v[52:55], v[120:123]
v_mfma_f32_16x16x32_bf16 v[124:127], a[84:87], v[52:55], v[124:127]
ds_read_b128 v[40:43], v5 offset:24576
ds_read_b128 v[44:47], v9 offset:24576
s_waitcnt lgkmcnt(5)
v_mfma_f32_16x16x32_bf16 v[112:115], a[88:91], v[56:59], v[112:115]
v_mfma_f32_16x16x32_bf16 v[116:119], a[92:95], v[56:59], v[116:119]
v_mfma_f32_16x16x32_bf16 v[128:131], a[216:219], v[56:59], v[128:131]
v_mfma_f32_16x16x32_bf16 v[132:135], a[220:223], v[56:59], v[132:135]
s_waitcnt lgkmcnt(4)
v_mfma_f32_16x16x32_bf16 v[120:123], a[88:91], v[60:63], v[120:123]
v_mfma_f32_16x16x32_bf16 v[124:127], a[92:95], v[60:63], v[124:127]
ds_read_b128 v[48:51], v6 offset:24576
ds_read_b128 v[52:55], v10 offset:24576
s_waitcnt lgkmcnt(5)
v_mfma_f32_16x16x32_bf16 v[112:115], a[96:99], v[32:35], v[112:115]
v_mfma_f32_16x16x32_bf16 v[116:119], a[100:103], v[32:35], v[116:119]
v_mfma_f32_16x16x32_bf16 v[128:131], a[224:227], v[32:35], v[128:131]
v_mfma_f32_16x16x32_bf16 v[132:135], a[228:231], v[32:35], v[132:135]
s_waitcnt lgkmcnt(4)
v_mfma_f32_16x16x32_bf16 v[120:123], a[96:99], v[36:39], v[120:123]
v_mfma_f32_16x16x32_bf16 v[124:127], a[100:103], v[36:39], v[124:127]
ds_read_b128 v[56:59], v7 offset:24576
ds_read_b128 v[60:63], v11 offset:24576
s_waitcnt lgkmcnt(5)
v_mfma_f32_16x16x32_bf16 v[112:115], a[104:107], v[40:43], v[112:115]
v_mfma_f32_16x16x32_bf16 v[116:119], a[108:111], v[40:43], v[116:119]
v_mfma_f32_16x16x32_bf16 v[128:131], a[232:235], v[40:43], v[128:131]
v_mfma_f32_16x16x32_bf16 v[132:135], a[236:239], v[40:43], v[132:135]
s_waitcnt lgkmcnt(4)
v_mfma_f32_16x16x32_bf16 v[120:123], a[104:107], v[44:47], v[120:123]
v_mfma_f32_16x16x32_bf16 v[124:127], a[108:111], v[44:47], v[124:127]
s_waitcnt lgkmcnt(3)
v_mfma_f32_16x16x32_bf16 v[112:115], a[112:115], v[48:51], v[112:115]
v_mfma_f32_16x16x32_bf16 v[116:119], a[116:119], v[48:51], v[116:119]
v_mfma_f32_16x16x32_bf16 v[128:131], a[240:243], v[48:51], v[128:131]
v_mfma_f32_16x16x32_bf16 v[132:135], a[244:247], v[48:51], v[132:135]
s_waitcnt lgkmcnt(2)
v_mfma_f32_16x16x32_bf16 v[120:123], a[112:115], v[52:55], v[120:123]
v_mfma_f32_16x16x32_bf16 v[124:127], a[116:119], v[52:55], v[124:127]
s_waitcnt lgkmcnt(1)
v_mfma_f32_16x16x32_bf16 v[112:115], a[120:123], v[56:59], v[112:115]
v_mfma_f32_16x16x32_bf16 v[116:119], a[124:127], v[56:59], v[116:119]
v_mfma_f32_16x16x32_bf16 v[128:131], a[248:251], v[56:59], v[128:131]
v_mfma_f32_16x16x32_bf16 v[132:135], a[252:255], v[56:59], v[132:135]
s_waitcnt lgkmcnt(0)
v_mfma_f32_16x16x32_bf16 v[120:123], a[120:123], v[60:63], v[120:123]
v_mfma_f32_16x16x32_bf16 v[124:127], a[124:127], v[60:63], v[124:127]
s_mov_b32 s84, s30
s_mov_b32 s83, s76
s_add_u32 s30, s30, 262144
s_add_u32 s76, s76, 2048
s_add_u32 s38, s38, 1
s_branch L_qkv_p3_k_L
L_spin_32:
buffer_load_dword v26, v27, s[4:7], s77 offen sc1
s_waitcnt vmcnt(0)
buffer_store_dword v25, v24, s[4:7], s83 offen sc1
buffer_store_dword v25, v24, s[4:7], s89 offen sc1
L_spin2_36:
v_cmp_eq_u32 vcc, 0, v26
s_cbranch_vccz L_spin2_36o
s_sub_u32 s36, s36, 1
s_cbranch_scc1 L_end_qkv_L
buffer_load_dword v26, v27, s[4:7], s77 offen sc1
s_waitcnt vmcnt(0)
s_branch L_spin2_36
L_spin2_36o:
s_add_u32 m0, s78, 0
s_add_u32 s41, s28, 0
buffer_load_dwordx4 v30, s[4:7], s41 offen offset:0 sc1 lds
buffer_load_dwordx4 v31, s[4:7], s41 offen offset:1024 sc1 lds
s_add_u32 m0, s78, 8192
s_add_u32 s41, s28, 256
buffer_load_dwordx4 v30, s[4:7], s41 offen offset:0 sc1 lds
buffer_load_dwordx4 v31, s[4:7], s41 offen offset:1024 sc1 lds
s_add_u32 m0, s78, 16384
s_add_u32 s41, s28, 512
buffer_load_dwordx4 v30, s[4:7], s41 offen offset:0 sc1 lds
buffer_load_dwordx4 v31, s[4:7], s41 offen offset:1024 sc1 lds
s_add_u32 m0, s78, 24576
s_add_u32 s41, s28, 768
buffer_load_dwordx4 v30, s[4:7], s41 offen offset:0 sc1 lds
buffer_load_dwordx4 v31, s[4:7], s41 offen offset:1024 sc1 lds
s_waitcnt vmcnt(4)
s_branch L_go_33
L_qkv_v_L:
s_add_u32 m0, s79, 0
s_add_u32 s41, s39, 0
buffer_load_dwordx4 v30, s[4:7], s41 offen offset:0 sc1 lds
buffer_load_dwordx4 v31, s[4:7], s41 offen offset:1024 sc1 lds
s_add_u32 m0, s79, 8192
s_add_u32 s41, s39, 256
buffer_load_dwordx4 v30, s[4:7], s41 offen offset:0 sc1 lds
buffer_load_dwordx4 v31, s[4:7], s41 offen offset:1024 sc1 lds
s_add_u32 m0, s79, 16384
s_add_u32 s41, s39, 512
buffer_load_dwordx4 v30, s[4:7], s41 offen offset:0 sc1 lds
buffer_load_dwordx4 v31, s[4:7], s41 offen offset:1024 sc1 lds
s_add_u32 m0, s79, 24576
s_add_u32 s41, s39, 768
buffer_load_dwordx4 v30, s[4:7], s41 offen offset:0 sc1 lds
buffer_load_dwordx4 v31, s[4:7], s41 offen offset:1024 sc1 lds
s_add_u32 s39, s39, 32768
s_min_u32 s39, s39, s90
s_xor_b32 s79, s79, 32768
L_qkv_p1_v_L:
s_waitcnt vmcnt(0)
buffer_store_dword v25, v24, s[4:7], s82 offen sc1
s_barrier
ds_read_b128 v[32:35], v100 offset:0
ds_read_b128 v[36:39], v104 offset:0
ds_read_b128 v[40:43], v101 offset:0
ds_read_b128 v[44:47], v105 offset:0
ds_read_b128 v[48:51], v102 offset:0
ds_read_b128 v[52:55], v106 offset:0
s_waitcnt lgkmcnt(5)
v_mfma_f32_16x16x32_bf16 v[64:67], v[32:35], a[0:3], 0
s_add_u32 m0, s79, 0
s_add_u32 s41, s39, 0
v_mfma_f32_16x16x32_bf16 v[68:71], v[32:35], a[4:7], 0
buffer_load_dwordx4 v30, s[4:7], s41 offen offset:0 sc1 lds
v_mfma_f32_16x16x32_bf16 v[80:83], a[128:131], v[32:35], 0
v_mfma_f32_16x16x32_bf16 v[84:87], a[132:135], v[32:35], 0
s_waitcnt lgkmcnt(4)
v_mfma_f32_16x16x32_bf16 v[72:75], v[36:39], a[0:3], 0
v_mfma_f32_16x16x32_bf16 v[76:79], v[36:39], a[4:7], 0
ds_read_b128 v[56:59], v103 offset:0
ds_read_b128 v[60:63], v107 offset:0
s_waitcnt lgkmcnt(5)
v_mfma_f32_16x16x32_bf16 v[64:67], v[40:43], a[8:11], v[64:67]
buffer_load_dwordx4 v31, s[4:7], s41 offen offset:1024 sc1 lds
s_add_u32 m0, s79, 8192
v_mfma_f32_16x16x32_bf16 v[68:71], v[40:43], a[12:15], v[68:71]
s_add_u32 s41, s39, 256
v_mfma_f32_16x16x32_bf16 v[80:83], a[136:139], v[40:43], v[80:83]
v_mfma_f32_16x16x32_bf16 v[84:87], a[140:143], v[40:43], v[84:87]
s_waitcnt lgkmcnt(4)
v_mfma_f32_16x16x32_bf16 v[72:75], v[44:47], a[8:11], v[72:75]
v_mfma_f32_16x16x32_bf16 v[76:79], v[44:47], a[12:15], v[76:79]
ds_read_b128 v[32:35], v100 offset:8192
ds_read_b128 v[36:39], v104 offset:8192
s_waitcnt lgkmcnt(5)
v_mfma_f32_16x16x32_bf16 v[64:67], v[48:51], a[16:19], v[64:67]
buffer_load_dwordx4 v30, s[4:7], s41 offen offset:0 sc1 lds
v_mfma_f32_16x16x32_bf16 v[68:71], v[48:51], a[20:23], v[68:71]
v_mfma_f32_16x16x32_bf16 v[80:83], a[144:147], v[48:51], v[80:83]
v_mfma_f32_16x16x32_bf16 v[84:87], a[148:151], v[48:51], v[84:87]
s_waitcnt lgkmcnt(4)
v_mfma_f32_16x16x32_bf16 v[72:75], v[52:55], a[16:19], v[72:75]
v_mfma_f32_16x16x32_bf16 v[76:79], v[52:55], a[20:23], v[76:79]
ds_read_b128 v[40:43], v101 offset:8192
ds_read_b128 v[44:47], v105 offset:8192
s_waitcnt lgkmcnt(5)
v_mfma_f32_16x16x32_bf16 v[64:67], v[56:59], a[24:27], v[64:67]
buffer_load_dwordx4 v31, s[4:7], s41 offen offset:1024 sc1 lds
s_add_u32 m0, s79, 16384
v_mfma_f32_16x16x32_bf16 v[68:71], v[56:59], a[28:31], v[68:71]
s_add_u32 s41, s39, 512
v_mfma_f32_16x16x32_bf16 v[80:83], a[152:155], v[56:59], v[80:83]
v_mfma_f32_16x16x32_bf16 v[84:87], a[156:159], v[56:59], v[84:87]
s_waitcnt lgkmcnt(4)
v_mfma_f32_16x16x32_bf16 v[72:75], v[60:63], a[24:27], v[72:75]
v_mfma_f32_16x16x32_bf16 v[76:79], v[60:63], a[28:31], v[76:79]
ds_read_b128 v[48:51], v102 offset:8192
ds_read_b128 v[52:55], v106 offset:8192
s_waitcnt lgkmcnt(5)
v_mfma_f32_16x16x32_bf16 v[64:67], v[32:35], a[32:35], v[64:67]
buffer_load_dwordx4 v30, s[4:7], s41 offen offset:0 sc1 lds
v_mfma_f32_16x16x32_bf16 v[68:71], v[32:35], a[36:39], v[68:71]
v_mfma_f32_16x16x32_bf16 v[80:83], a[160:163], v[32:35], v[80:83]
v_mfma_f32_16x16x32_bf16 v[84:87], a[164:167], v[32:35], v[84:87]
s_waitcnt lgkmcnt(4)
v_mfma_f32_16x16x32_bf16 v[72:75], v[36:39], a[32:35], v[72:75]
v_mfma_f32_16x16x32_bf16 v[76:79], v[36:39], a[36:39], v[76:79]
ds_read_b128 v[56:59], v103 offset:8192
ds_read_b128 v[60:63], v107 offset:8192
s_waitcnt lgkmcnt(5)
v_mfma_f32_16x16x32_bf16 v[64:67], v[40:43], a[40:43], v[64:67]
buffer_load_dwordx4 v31, s[4:7], s41 offen offset:1024 sc1 lds
s_add_u32 m0, s79, 24576
v_mfma_f32_16x16x32_bf16 v[68:71], v[40:43], a[44:47], v[68:71]
s_add_u32 s41, s39, 768
v_mfma_f32_16x16x32_bf16 v[80:83], a[168:171], v[40:43], v[80:83]
v_mfma_f32_16x16x32_bf16 v[84:87], a[172:175], v[40:43], v[84:87]
s_waitcnt lgkmcnt(4)
v_mfma_f32_16x16x32_bf16 v[72:75], v[44:47], a[40:43], v[72:75]
v_mfma_f32_16x16x32_bf16 v[76:79], v[44:47], a[44:47], v[76:79]
ds_read_b128 v[32:35], v100 offset:16384
ds_read_b128 v[36:39], v104 offset:16384
s_waitcnt lgkmcnt(5)
v_mfma_f32_16x16x32_bf16 v[64:67], v[48:51], a[48:51], v[64:67]
buffer_load_dwordx4 v30, s[4:7], s41 offen offset:0 sc1 lds
v_mfma_f32_16x16x32_bf16 v[68:71], v[48:51], a[52:55], v[68:71]
v_mfma_f32_16x16x32_bf16 v[80:83], a[176:179], v[48:51], v[80:83]
v_mfma_f32_16x16x32_bf16 v[84:87], a[180:183], v[48:51], v[84:87]
s_waitcnt lgkmcnt(4)
v_mfma_f32_16x16x32_bf16 v[72:75], v[52:55], a[48:51], v[72:75]
v_mfma_f32_16x16x32_bf16 v[76:79], v[52:55], a[52:55], v[76:79]
ds_read_b128 v[40:43], v101 offset:16384
ds_read_b128 v[44:47], v105 offset:16384
s_waitcnt lgkmcnt(5)
v_mfma_f32_16x16x32_bf16 v[64:67], v[56:59], a[56:59], v[64:67]
buffer_load_dwordx4 v31, s[4:7], s41 offen offset:1024 sc1 lds
s_add_u32 s39, s39, 32768
v_mfma_f32_16x16x32_bf16 v[68:71], v[56:59], a[60:63], v[68:71]
s_min_u32 s39, s39, s90
s_xor_b32 s79, s79, 32768
v_mfma_f32_16x16x32_bf16 v[80:83], a[184:187], v[56:59], v[80:83]
v_mfma_f32_16x16x32_bf16 v[84:87], a[188:191], v[56:59], v[84:87]
s_waitcnt lgkmcnt(4)
v_mfma_f32_16x16x32_bf16 v[72:75], v[60:63], a[56:59], v[72:75]
v_mfma_f32_16x16x32_bf16 v[76:79], v[60:63], a[60:63], v[76:79]
ds_read_b128 v[48:51], v102 offset:16384
ds_read_b128 v[52:55], v106 offset:16384
s_waitcnt lgkmcnt(5)
v_mfma_f32_16x16x32_bf16 v[64:67], v[32:35], a[64:67], v[64:67]
v_mfma_f32_16x16x32_bf16 v[68:71], v[32:35], a[68:71], v[68:71]
v_mfma_f32_16x16x32_bf16 v[80:83], a[192:195], v[32:35], v[80:83]
v_mfma_f32_16x16x32_bf16 v[84:87], a[196:199], v[32:35], v[84:87]
s_waitcnt lgkmcnt(4)
v_mfma_f32_16x16x32_bf16 v[72:75], v[36:39], a[64:67], v[72:75]
v_mfma_f32_16x16x32_bf16 v[76:79], v[36:39], a[68:71], v[76:79]
ds_read_b128 v[56:59], v103 offset:16384
ds_read_b128 v[60:63], v107 offset:16384
s_waitcnt lgkmcnt(5)
v_mfma_f32_16x16x32_bf16 v[64:67], v[40:43], a[72:75], v[64:67]
v_mfma_f32_16x16x32_bf16 v[68:71], v[40:43], a[76:79], v[68:71]
v_mfma_f32_16x16x32_bf16 v[80:83], a[200:203], v[40:43], v[80:83]
v_mfma_f32_16x16x32_bf16 v[84:87], a[204:207], v[40:43], v[84:87]
s_waitcnt lgkmcnt(4)
v_mfma_f32_16x16x32_bf16 v[72:75], v[44:47], a[72:75], v[72:75]
v_mfma_f32_16x16x32_bf16 v[76:79], v[44:47], a[76:79], v[76:79]
ds_read_b128 v[32:35], v100 offset:24576
ds_read_b128 v[36:39], v104 offset:24576
s_waitcnt lgkmcnt(5)
v_mfma_f32_16x16x32_bf16 v[64:67], v[48:51], a[80:83], v[64:67]
v_mfma_f32_16x16x32_bf16 v[68:71], v[48:51], a[84:87], v[68:71]
v_mfma_f32_16x16x32_bf16 v[80:83], a[208:211], v[48:51], v[80:83]
v_mfma_f32_16x16x32_bf16 v[84:87], a[212:215], v[48:51], v[84:87]
s_waitcnt lgkmcnt(4)
v_mfma_f32_16x16x32_bf16 v[72:75], v[52:55], a[80:83], v[72:75]
v_mfma_f32_16x16x32_bf16 v[76:79], v[52:55], a[84:87], v[76:79]
ds_read_b128 v[40:43], v101 offset:24576
ds_read_b128 v[44:47], v105 offset:24576
s_waitcnt lgkmcnt(5)
v_mfma_f32_16x16x32_bf16 v[64:67], v[56:59], a[88:91], v[64:67]
v_mfma_f32_16x16x32_bf16 v[68:71], v[56:59], a[92:95], v[68:71]
v_mfma_f32_16x16x32_bf16 v[80:83], a[216:219], v[56:59], v[80:83]
v_mfma_f32_16x16x32_bf16 v[84:87], a[220:223], v[56:59], v[84:87]
s_waitcnt lgkmcnt(4)
v_mfma_f32_16x16x32_bf16 v[72:75], v[60:63], a[88:91], v[72:75]
v_mfma_f32_16x16x32_bf16 v[76:79], v[60:63], a[92:95], v[76:79]
ds_read_b128 v[48:51], v102 offset:24576
ds_read_b128 v[52:55], v106 offset:24576
s_waitcnt lgkmcnt(5)
v_mfma_f32_16x16x32_bf16 v[64:67], v[32:35], a[96:99], v[64:67]
v_mfma_f32_16x16x32_bf16 v[68:71], v[32:35], a[100:103], v[68:71]
v_mfma_f32_16x16x32_bf16 v[80:83], a[224:227], v[32:35], v[80:83]
v_mfma_f32_16x16x32_bf16 v[84:87], a[228:231], v[32:35], v[84:87]
s_waitcnt lgkmcnt(4)
v_mfma_f32_16x16x32_bf16 v[72:75], v[36:39], a[96:99], v[72:75]
v_mfma_f32_16x16x32_bf16 v[76:79], v[36:39], a[100:103], v[76:79]
ds_read_b128 v[56:59], v103 offset:24576
ds_read_b128 v[60:63], v107 offset:24576
s_waitcnt lgkmcnt(5)
v_mfma_f32_16x16x32_bf16 v[64:67], v[40:43], a[104:107], v[64:67]
v_mfma_f32_16x16x32_bf16 v[68:71], v[40:43], a[108:111], v[68:71]
v_mfma_f32_16x16x32_bf16 v[80:83], a[232:235], v[40:43], v[80:83]
v_mfma_f32_16x16x32_bf16 v[84:87], a[236:239], v[40:43], v[84:87]
s_waitcnt lgkmcnt(4)
v_mfma_f32_16x16x32_bf16 v[72:75], v[44:47], a[104:107], v[72:75]
v_mfma_f32_16x16x32_bf16 v[76:79], v[44:47], a[108:111], v[76:79]
s_waitcnt lgkmcnt(3)
v_mfma_f32_16x16x32_bf16 v[64:67], v[48:51], a[112:115], v[64:67]
v_mfma_f32_16x16x32_bf16 v[68:71], v[48:51], a[116:119], v[68:71]
v_mfma_f32_16x16x32_bf16 v[80:83], a[240:243], v[48:51], v[80:83]
v_mfma_f32_16x16x32_bf16 v[84:87], a[244:247], v[48:51], v[84:87]
s_waitcnt lgkmcnt(2)
v_mfma_f32_16x16x32_bf16 v[72:75], v[52:55], a[112:115], v[72:75]
v_mfma_f32_16x16x32_bf16 v[76:79], v[52:55], a[116:119], v[76:79]
s_waitcnt lgkmcnt(1)
v_mfma_f32_16x16x32_bf16 v[64:67], v[56:59], a[120:123], v[64:67]
v_mfma_f32_16x16x32_bf16 v[68:71], v[56:59], a[124:127], v[68:71]
v_mfma_f32_16x16x32_bf16 v[80:83], a[248:251], v[56:59], v[80:83]
v_mfma_f32_16x16x32_bf16 v[84:87], a[252:255], v[56:59], v[84:87]
s_waitcnt lgkmcnt(0)
v_mfma_f32_16x16x32_bf16 v[72:75], v[60:63], a[120:123], v[72:75]
v_mfma_f32_16x16x32_bf16 v[76:79], v[60:63], a[124:127], v[76:79]
s_nop 4
v_cvt_pk_bf16_f32 v96, v80, v84
v_cvt_pk_bf16_f32 v97, v81, v85
v_cvt_pk_bf16_f32 v98, v82, v86
v_cvt_pk_bf16_f32 v99, v83, v87
v_cvt_pk_bf16_f32 v88, v64, v72
v_cvt_pk_bf16_f32 v89, v65, v73
v_cvt_pk_bf16_f32 v90, v66, v74
v_cvt_pk_bf16_f32 v91, v67, v75
v_cvt_pk_bf16_f32 v92, v68, v76
v_cvt_pk_bf16_f32 v93, v69, v77
v_cvt_pk_bf16_f32 v94, v70, v78
v_cvt_pk_bf16_f32 v95, v71, v79
v_alignbit_b32 v88, v88, v88, s85
v_alignbit_b32 v89, v89, v89, s85
v_alignbit_b32 v90, v90, v90, s85
v_alignbit_b32 v91, v91, v91, s85
v_alignbit_b32 v92, v92, v92, s85
v_alignbit_b32 v93, v93, v93, s85
v_alignbit_b32 v94, v94, v94, s85
v_alignbit_b32 v95, v95, v95, s85
s_add_u32 s40, s29, s81
buffer_store_dwordx4 v[96:99], v28, s[4:7], s40 offen sc1
buffer_store_dwordx4 v[88:91], v2, s[4:7], s29 offen offset:0 sc1
buffer_store_dwordx4 v[92:95], v2, s[4:7], s29 offen offset:1024 sc1
v_xor_b32 v100, 32768, v100
v_xor_b32 v101, 32768, v101
v_xor_b32 v102, 32768, v102
v_xor_b32 v103, 32768, v103
v_xor_b32 v104, 32768, v104
v_xor_b32 v105, 32768, v105
v_xor_b32 v106, 32768, v106
v_xor_b32 v107, 32768, v107
s_mov_b32 s82, s31
s_add_u32 s29, s29, 262144
s_add_u32 s31, s31, 2048
s_add_u32 s38, s38, 1
s_cmp_lt_u32 s38, 14
s_cbranch_scc1 L_qkv_p1_v_L
buffer_load_dword v26, v27, s[4:7], s77 offen sc1
s_waitcnt vmcnt(0)
buffer_store_dword v25, v24, s[4:7], s82 offen sc1
s_barrier
s_add_u32 m0, s79, 0
s_add_u32 s41, s39, 0
buffer_load_dwordx4 v30, s[4:7], s41 offen offset:0 sc1 lds
buffer_load_dwordx4 v31, s[4:7], s41 offen offset:1024 sc1 lds
s_add_u32 m0, s79, 8192
s_add_u32 s41, s39, 256
buffer_load_dwordx4 v30, s[4:7], s41 offen offset:0 sc1 lds
buffer_load_dwordx4 v31, s[4:7], s41 offen offset:1024 sc1 lds
s_add_u32 m0, s79, 16384
s_add_u32 s41, s39, 512
buffer_load_dwordx4 v30, s[4:7], s41 offen offset:0 sc1 lds
buffer_load_dwordx4 v31, s[4:7], s41 offen offset:1024 sc1 lds
s_add_u32 m0, s79, 24576
s_add_u32 s41, s39, 768
buffer_load_dwordx4 v30, s[4:7], s41 offen offset:0 sc1 lds
buffer_load_dwordx4 v31, s[4:7], s41 offen offset:1024 sc1 lds
s_add_u32 s39, s39, 32768
s_min_u32 s39, s39, s90
s_xor_b32 s79, s79, 32768
s_mov_b32 s88, s84
s_mov_b32 s89, s83
ds_read_b128 v[32:35], v100 offset:0
ds_read_b128 v[36:39], v104 offset:0
ds_read_b128 v[40:43], v101 offset:0
ds_read_b128 v[44:47], v105 offset:0
L_qkv_loop_v_L:
s_waitcnt vmcnt(8)
v_cmp_eq_u32 s[86:87], 0, v26
ds_read_b128 v[48:51], v102 offset:0
ds_read_b128 v[52:55], v106 offset:0
s_waitcnt lgkmcnt(5)
v_mfma_f32_16x16x32_bf16 v[64:67], v[32:35], a[0:3], 0
s_add_u32 m0, s78, 0
s_add_u32 s41, s28, 0
v_cvt_pk_bf16_f32 v144, v128, v132
v_mfma_f32_16x16x32_bf16 v[68:71], v[32:35], a[4:7], 0
buffer_load_dwordx4 v30, s[4:7], s41 offen offset:0 sc1 lds
v_cvt_pk_bf16_f32 v145, v129, v133
v_mfma_f32_16x16x32_bf16 v[80:83], a[128:131], v[32:35], 0
v_cvt_pk_bf16_f32 v146, v130, v134
v_cvt_pk_bf16_f32 v147, v131, v135
v_mfma_f32_16x16x32_bf16 v[84:87], a[132:135], v[32:35], 0
v_cvt_pk_bf16_f32 v136, v112, v120
v_cvt_pk_bf16_f32 v137, v113, v121
s_waitcnt lgkmcnt(4)
v_mfma_f32_16x16x32_bf16 v[72:75], v[36:39], a[0:3], 0
v_cvt_pk_bf16_f32 v138, v114, v122
v_cvt_pk_bf16_f32 v139, v115, v123
v_mfma_f32_16x16x32_bf16 v[76:79], v[36:39], a[4:7], 0
ds_read_b128 v[56:59], v103 offset:0
ds_read_b128 v[60:63], v107 offset:0
s_waitcnt lgkmcnt(5)
v_mfma_f32_16x16x32_bf16 v[64:67], v[40:43], a[8:11], v[64:67]
buffer_load_dwordx4 v31, s[4:7], s41 offen offset:1024 sc1 lds
s_add_u32 m0, s78, 8192
v_mfma_f32_16x16x32_bf16 v[68:71], v[40:43], a[12:15], v[68:71]
s_add_u32 s41, s28, 256
v_cvt_pk_bf16_f32 v140, v116, v124
v_cvt_pk_bf16_f32 v141, v117, v125
v_mfma_f32_16x16x32_bf16 v[80:83], a[136:139], v[40:43], v[80:83]
v_cvt_pk_bf16_f32 v142, v118, v126
v_cvt_pk_bf16_f32 v143, v119, v127
v_mfma_f32_16x16x32_bf16 v[84:87], a[140:143], v[40:43], v[84:87]
v_alignbit_b32 v136, v136, v136, s85
v_alignbit_b32 v137, v137, v137, s85
s_waitcnt lgkmcnt(4)
v_mfma_f32_16x16x32_bf16 v[72:75], v[44:47], a[8:11], v[72:75]
buffer_load_dwordx4 v30, s[4:7], s41 offen offset:0 sc1 lds
v_alignbit_b32 v138, v138, v138, s85
v_mfma_f32_16x16x32_bf16 v[76:79], v[44:47], a[12:15], v[76:79]
ds_read_b128 v[32:35], v100 offset:8192
ds_read_b128 v[36:39], v104 offset:8192
s_waitcnt lgkmcnt(5)
v_mfma_f32_16x16x32_bf16 v[64:67], v[48:51], a[16:19], v[64:67]
v_alignbit_b32 v139, v139, v139, s85
v_alignbit_b32 v140, v140, v140, s85
v_mfma_f32_16x16x32_bf16 v[68:71], v[48:51], a[20:23], v[68:71]
v_alignbit_b32 v141, v141, v141, s85
v_alignbit_b32 v142, v142, v142, s85
v_mfma_f32_16x16x32_bf16 v[80:83], a[144:147], v[48:51], v[80:83]
buffer_load_dwordx4 v31, s[4:7], s41 offen offset:1024 sc1 lds
v_alignbit_b32 v143, v143, v143, s85
v_mfma_f32_16x16x32_bf16 v[84:87], a[148:151], v[48:51], v[84:87]
s_waitcnt lgkmcnt(4)
v_mfma_f32_16x16x32_bf16 v[72:75], v[52:55], a[16:19], v[72:75]
v_mfma_f32_16x16x32_bf16 v[76:79], v[52:55], a[20:23], v[76:79]
s_barrier
ds_read_b128 v[40:43], v101 offset:8192
ds_read_b128 v[44:47], v105 offset:8192
s_waitcnt lgkmcnt(5)
v_mfma_f32_16x16x32_bf16 v[64:67], v[56:59], a[24:27], v[64:67]
s_add_u32 s40, s84, s81
v_mfma_f32_16x16x32_bf16 v[68:71], v[56:59], a[28:31], v[68:71]
buffer_store_dwordx4 v[144:147], v28, s[4:7], s40 offen sc1
v_mfma_f32_16x16x32_bf16 v[80:83], a[152:155], v[56:59], v[80:83]
v_mfma_f32_16x16x32_bf16 v[84:87], a[156:159], v[56:59], v[84:87]
s_waitcnt lgkmcnt(4)
v_mfma_f32_16x16x32_bf16 v[72:75], v[60:63], a[24:27], v[72:75]
v_mfma_f32_16x16x32_bf16 v[76:79], v[60:63], a[28:31], v[76:79]
ds_read_b128 v[48:51], v102 offset:8192
ds_read_b128 v[52:55], v106 offset:8192
s_waitcnt lgkmcnt(5)
v_mfma_f32_16x16x32_bf16 v[64:67], v[32:35], a[32:35], v[64:67]
buffer_store_dwordx4 v[136:139], v2, s[4:7], s84 offen offset:0 sc1
v_mfma_f32_16x16x32_bf16 v[68:71], v[32:35], a[36:39], v[68:71]
v_mfma_f32_16x16x32_bf16 v[80:83], a[160:163], v[32:35], v[80:83]
v_mfma_f32_16x16x32_bf16 v[84:87], a[164:167], v[32:35], v[84:87]
s_waitcnt lgkmcnt(4)
v_mfma_f32_16x16x32_bf16 v[72:75], v[36:39], a[32:35], v[72:75]
v_mfma_f32_16x16x32_bf16 v[76:79], v[36:39], a[36:39], v[76:79]
ds_read_b128 v[56:59], v103 offset:8192
ds_read_b128 v[60:63], v107 offset:8192
s_waitcnt lgkmcnt(5)
v_mfma_f32_16x16x32_bf16 v[64:67], v[40:43], a[40:43], v[64:67]
buffer_store_dwordx4 v[140:143], v2, s[4:7], s84 offen offset:1024 sc1
v_mfma_f32_16x16x32_bf16 v[68:71], v[40:43], a[44:47], v[68:71]
s_add_u32 m0, s78, 16384
s_add_u32 s41, s28, 512
v_mfma_f32_16x16x32_bf16 v[80:83], a[168:171], v[40:43], v[80:83]
v_mfma_f32_16x16x32_bf16 v[84:87], a[172:175], v[40:43], v[84:87]
s_waitcnt lgkmcnt(4)
v_mfma_f32_16x16x32_bf16 v[72:75], v[44:47], a[40:43], v[72:75]
v_mfma_f32_16x16x32_bf16 v[76:79], v[44:47], a[44:47], v[76:79]
ds_read_b128 v[32:35], v100 offset:16384
ds_read_b128 v[36:39], v104 offset:16384
s_waitcnt lgkmcnt(5)
v_mfma_f32_16x16x32_bf16 v[64:67], v[48:51], a[48:51], v[64:67]
buffer_load_dwordx4 v30, s[4:7], s41 offen offset:0 sc1 lds
v_mfma_f32_16x16x32_bf16 v[68:71], v[48:51], a[52:55], v[68:71]
v_mfma_f32_16x16x32_bf16 v[80:83], a[176:179], v[48:51], v[80:83]
v_mfma_f32_16x16x32_bf16 v[84:87], a[180:183], v[48:51], v[84:87]
s_waitcnt lgkmcnt(4)
v_mfma_f32_16x16x32_bf16 v[72:75], v[52:55], a[48:51], v[72:75]
v_mfma_f32_16x16x32_bf16 v[76:79], v[52:55], a[52:55], v[76:79]
ds_read_b128 v[40:43], v101 offset:16384
ds_read_b128 v[44:47], v105 offset:16384
s_waitcnt lgkmcnt(5)
v_mfma_f32_16x16x32_bf16 v[64:67], v[56:59], a[56:59], v[64:67]
buffer_load_dwordx4 v31, s[4:7], s41 offen offset:1024 sc1 lds
s_add_u32 m0, s78, 24576
v_mfma_f32_16x16x32_bf16 v[68:71], v[56:59], a[60:63], v[68:71]
s_add_u32 s41, s28, 768
v_mfma_f32_16x16x32_bf16 v[80:83], a[184:187], v[56:59], v[80:83]
v_mfma_f32_16x16x32_bf16 v[84:87], a[188:191], v[56:59], v[84:87]
s_waitcnt lgkmcnt(4)
v_mfma_f32_16x16x32_bf16 v[72:75], v[60:63], a[56:59], v[72:75]
v_mfma_f32_16x16x32_bf16 v[76:79], v[60:63], a[60:63], v[76:79]
ds_read_b128 v[48:51], v102 offset:16384
ds_read_b128 v[52:55], v106 offset:16384
s_waitcnt lgkmcnt(5)
v_mfma_f32_16x16x32_bf16 v[64:67], v[32:35], a[64:67], v[64:67]
buffer_load_dwordx4 v30, s[4:7], s41 offen offset:0 sc1 lds
v_mfma_f32_16x16x32_bf16 v[68:71], v[32:35], a[68:71], v[68:71]
v_mfma_f32_16x16x32_bf16 v[80:83], a[192:195], v[32:35], v[80:83]
v_mfma_f32_16x16x32_bf16 v[84:87], a[196:199], v[32:35], v[84:87]
s_waitcnt lgkmcnt(4)
v_mfma_f32_16x16x32_bf16 v[72:75], v[36:39], a[64:67], v[72:75]
v_mfma_f32_16x16x32_bf16 v[76:79], v[36:39], a[68:71], v[76:79]
ds_read_b128 v[56:59], v103 offset:16384
ds_read_b128 v[60:63], v107 offset:16384
s_waitcnt lgkmcnt(5)
v_mfma_f32_16x16x32_bf16 v[64:67], v[40:43], a[72:75], v[64:67]
buffer_load_dwordx4 v31, s[4:7], s41 offen offset:1024 sc1 lds
s_add_u32 s40, s88, s81
v_mfma_f32_16x16x32_bf16 v[68:71], v[40:43], a[76:79], v[68:71]
v_mfma_f32_16x16x32_bf16 v[80:83], a[200:203], v[40:43], v[80:83]
v_mfma_f32_16x16x32_bf16 v[84:87], a[204:207], v[40:43], v[84:87]
s_waitcnt lgkmcnt(4)
v_mfma_f32_16x16x32_bf16 v[72:75], v[44:47], a[72:75], v[72:75]
v_mfma_f32_16x16x32_bf16 v[76:79], v[44:47], a[76:79], v[76:79]
ds_read_b128 v[32:35], v100 offset:24576
ds_read_b128 v[36:39], v104 offset:24576
s_waitcnt lgkmcnt(5)
v_mfma_f32_16x16x32_bf16 v[64:67], v[48:51], a[80:83], v[64:67]
buffer_store_dwordx4 v[96:99], v28, s[4:7], s40 offen sc1
v_mfma_f32_16x16x32_bf16 v[68:71], v[48:51], a[84:87], v[68:71]
v_mfma_f32_16x16x32_bf16 v[80:83], a[208:211], v[48:51], v[80:83]
v_mfma_f32_16x16x32_bf16 v[84:87], a[212:215], v[48:51], v[84:87]
s_waitcnt lgkmcnt(4)
v_mfma_f32_16x16x32_bf16 v[72:75], v[52:55], a[80:83], v[72:75]
v_mfma_f32_16x16x32_bf16 v[76:79], v[52:55], a[84:87], v[76:79]
ds_read_b128 v[40:43], v101 offset:24576
ds_read_b128 v[44:47], v105 offset:24576
s_waitcnt lgkmcnt(5)
v_mfma_f32_16x16x32_bf16 v[64:67], v[56:59], a[88:91], v[64:67]
buffer_store_dwordx4 v[88:91], v2, s[4:7], s88 offen offset:0 sc1
v_mfma_f32_16x16x32_bf16 v[68:71], v[56:59], a[92:95], v[68:71]
v_mfma_f32_16x16x32_bf16 v[80:83], a[216:219], v[56:59], v[80:83]
v_mfma_f32_16x16x32_bf16 v[84:87], a[220:223], v[56:59], v[84:87]
s_waitcnt lgkmcnt(4)
v_mfma_f32_16x16x32_bf16 v[72:75], v[60:63], a[88:91], v[72:75]
v_mfma_f32_16x16x32_bf16 v[76:79], v[60:63], a[92:95], v[76:79]
ds_read_b128 v[48:51], v102 offset:24576
ds_read_b128 v[52:55], v106 offset:24576
s_waitcnt lgkmcnt(5)
v_mfma_f32_16x16x32_bf16 v[64:67], v[32:35], a[96:99], v[64:67]
buffer_store_dwordx4 v[92:95], v2, s[4:7], s88 offen offset:1024 sc1
v_mfma_f32_16x16x32_bf16 v[68:71], v[32:35], a[100:103], v[68:71]
v_mfma_f32_16x16x32_bf16 v[80:83], a[224:227], v[32:35], v[80:83]
v_mfma_f32_16x16x32_bf16 v[84:87], a[228:231], v[32:35], v[84:87]
s_waitcnt lgkmcnt(4)
v_mfma_f32_16x16x32_bf16 v[72:75], v[36:39], a[96:99], v[72:75]
v_mfma_f32_16x16x32_bf16 v[76:79], v[36:39], a[100:103], v[76:79]
ds_read_b128 v[56:59], v103 offset:24576
ds_read_b128 v[60:63], v107 offset:24576
s_waitcnt lgkmcnt(5)
v_mfma_f32_16x16x32_bf16 v[64:67], v[40:43], a[104:107], v[64:67]
v_mfma_f32_16x16x32_bf16 v[68:71], v[40:43], a[108:111], v[68:71]
v_mfma_f32_16x16x32_bf16 v[80:83], a[232:235], v[40:43], v[80:83]
v_mfma_f32_16x16x32_bf16 v[84:87], a[236:239], v[40:43], v[84:87]
s_waitcnt lgkmcnt(4)
v_mfma_f32_16x16x32_bf16 v[72:75], v[44:47], a[104:107], v[72:75]
v_mfma_f32_16x16x32_bf16 v[76:79], v[44:47], a[108:111], v[76:79]
s_cmp_lg_u32 s86, 0
s_cbranch_scc1 L_spin_37
L_go_38:
s_waitcnt vmcnt(7)
s_barrier
buffer_store_dword v25, v24, s[4:7], s83 offen sc1
s_add_u32 s28, s28, 32768
s_add_u32 s77, s77, 512
ds_read_b128 v[32:35], v4 offset:0
ds_read_b128 v[36:39], v8 offset:0
s_waitcnt lgkmcnt(5)
v_mfma_f32_16x16x32_bf16 v[64:67], v[48:51], a[112:115], v[64:67]
v_mfma_f32_16x16x32_bf16 v[68:71], v[48:51], a[116:119], v[68:71]
v_mfma_f32_16x16x32_bf16 v[80:83], a[240:243], v[48:51], v[80:83]
v_mfma_f32_16x16x32_bf16 v[84:87], a[244:247], v[48:51], v[84:87]
s_waitcnt lgkmcnt(4)
v_mfma_f32_16x16x32_bf16 v[72:75], v[52:55], a[112:115], v[72:75]
v_mfma_f32_16x16x32_bf16 v[76:79], v[52:55], a[116:119], v[76:79]
ds_read_b128 v[40:43], v5 offset:0
ds_read_b128 v[44:47], v9 offset:0
s_waitcnt lgkmcnt(5)
v_mfma_f32_16x16x32_bf16 v[64:67], v[56:59], a[120:123], v[64:67]
v_mfma_f32_16x16x32_bf16 v[68:71], v[56:59], a[124:127], v[68:71]
v_mfma_f32_16x16x32_bf16 v[80:83], a[248:251], v[56:59], v[80:83]
v_mfma_f32_16x16x32_bf16 v[84:87], a[252:255], v[56:59], v[84:87]
s_waitcnt lgkmcnt(4)
v_mfma_f32_16x16x32_bf16 v[72:75], v[60:63], a[120:123], v[72:75]
v_mfma_f32_16x16x32_bf16 v[76:79], v[60:63], a[124:127], v[76:79]
ds_read_b128 v[48:51], v6 offset:0
ds_read_b128 v[52:55], v10 offset:0
s_waitcnt lgkmcnt(5)
v_mfma_f32_16x16x32_bf16 v[112:115], v[32:35], a[0:3], 0
v_mfma_f32_16x16x32_bf16 v[116:119], v[32:35], a[4:7], 0
v_mfma_f32_16x16x32_bf16 v[128:131], a[128:131], v[32:35], 0
v_mfma_f32_16x16x32_bf16 v[132:135], a[132:135], v[32:35], 0
s_waitcnt lgkmcnt(4)
v_mfma_f32_16x16x32_bf16 v[120:123], v[36:39], a[0:3], 0
v_mfma_f32_16x16x32_bf16 v[124:127], v[36:39], a[4:7], 0
ds_read_b128 v[56:59], v7 offset:0
ds_read_b128 v[60:63], v11 offset:0
s_waitcnt lgkmcnt(5)
v_mfma_f32_16x16x32_bf16 v[112:115], v[40:43], a[8:11], v[112:115]
v_mfma_f32_16x16x32_bf16 v[116:119], v[40:43], a[12:15], v[116:119]
v_mfma_f32_16x16x32_bf16 v[128:131], a[136:139], v[40:43], v[128:131]
v_mfma_f32_16x16x32_bf16 v[132:135], a[140:143], v[40:43], v[132:135]
s_waitcnt lgkmcnt(4)
v_mfma_f32_16x16x32_bf16 v[120:123], v[44:47], a[8:11], v[120:123]
v_mfma_f32_16x16x32_bf16 v[124:127], v[44:47], a[12:15], v[124:127]
ds_read_b128 v[32:35], v4 offset:8192
ds_read_b128 v[36:39], v8 offset:8192
s_waitcnt lgkmcnt(5)
v_mfma_f32_16x16x32_bf16 v[112:115], v[48:51], a[16:19], v[112:115]
v_cvt_pk_bf16_f32 v96, v80, v84
v_cvt_pk_bf16_f32 v97, v81, v85
v_mfma_f32_16x16x32_bf16 v[116:119], v[48:51], a[20:23], v[116:119]
v_cvt_pk_bf16_f32 v98, v82, v86
v_cvt_pk_bf16_f32 v99, v83, v87
v_mfma_f32_16x16x32_bf16 v[128:131], a[144:147], v[48:51], v[128:131]
v_cvt_pk_bf16_f32 v88, v64, v72
v_cvt_pk_bf16_f32 v89, v65, v73
v_mfma_f32_16x16x32_bf16 v[132:135], a[148:151], v[48:51], v[132:135]
v_cvt_pk_bf16_f32 v90, v66, v74
v_cvt_pk_bf16_f32 v91, v67, v75
s_waitcnt lgkmcnt(4)
v_mfma_f32_16x16x32_bf16 v[120:123], v[52:55], a[16:19], v[120:123]
v_cvt_pk_bf16_f32 v92, v68, v76
v_cvt_pk_bf16_f32 v93, v69, v77
v_mfma_f32_16x16x32_bf16 v[124:127], v[52:55], a[20:23], v[124:127]
ds_read_b128 v[40:43], v5 offset:8192
ds_read_b128 v[44:47], v9 offset:8192
s_waitcnt lgkmcnt(5)
v_mfma_f32_16x16x32_bf16 v[112:115], v[56:59], a[24:27], v[112:115]
v_cvt_pk_bf16_f32 v94, v70, v78
v_cvt_pk_bf16_f32 v95, v71, v79
v_mfma_f32_16x16x32_bf16 v[116:119], v[56:59], a[28:31], v[116:119]
v_alignbit_b32 v88, v88, v88, s85
v_alignbit_b32 v89, v89, v89, s85
v_mfma_f32_16x16x32_bf16 v[128:131], a[152:155], v[56:59], v[128:131]
v_alignbit_b32 v90, v90, v90, s85
v_alignbit_b32 v91, v91, v91, s85
v_mfma_f32_16x16x32_bf16 v[132:135], a[156:159], v[56:59], v[132:135]
v_alignbit_b32 v92, v92, v92, s85
v_alignbit_b32 v93, v93, v93, s85
s_waitcnt lgkmcnt(4)
v_mfma_f32_16x16x32_bf16 v[120:123], v[60:63], a[24:27], v[120:123]
v_alignbit_b32 v94, v94, v94, s85
v_alignbit_b32 v95, v95, v95, s85
v_mfma_f32_16x16x32_bf16 v[124:127], v[60:63], a[28:31], v[124:127]
buffer_load_dword v26, v27, s[4:7], s77 offen sc1
ds_read_b128 v[48:51], v6 offset:8192
ds_read_b128 v[52:55], v10 offset:8192
s_waitcnt lgkmcnt(5)
v_mfma_f32_16x16x32_bf16 v[112:115], v[32:35], a[32:35], v[112:115]
v_xor_b32 v100, 32768, v100
v_xor_b32 v101, 32768, v101
v_mfma_f32_16x16x32_bf16 v[116:119], v[32:35], a[36:39], v[116:119]
v_xor_b32 v102, 32768, v102
v_xor_b32 v103, 32768, v103
v_mfma_f32_16x16x32_bf16 v[128:131], a[160:163], v[32:35], v[128:131]
v_xor_b32 v104, 32768, v104
v_xor_b32 v105, 32768, v105
v_mfma_f32_16x16x32_bf16 v[132:135], a[164:167], v[32:35], v[132:135]
v_xor_b32 v106, 32768, v106
v_xor_b32 v107, 32768, v107
s_waitcnt lgkmcnt(4)
v_mfma_f32_16x16x32_bf16 v[120:123], v[36:39], a[32:35], v[120:123]
s_mov_b32 s88, s29
s_mov_b32 s82, s31
s_add_u32 s29, s29, 262144
v_mfma_f32_16x16x32_bf16 v[124:127], v[36:39], a[36:39], v[124:127]
ds_read_b128 v[56:59], v7 offset:8192
ds_read_b128 v[60:63], v11 offset:8192
s_waitcnt lgkmcnt(5)
v_mfma_f32_16x16x32_bf16 v[112:115], v[40:43], a[40:43], v[112:115]
s_add_u32 s31, s31, 2048
v_mfma_f32_16x16x32_bf16 v[116:119], v[40:43], a[44:47], v[116:119]
v_mfma_f32_16x16x32_bf16 v[128:131], a[168:171], v[40:43], v[128:131]
v_mfma_f32_16x16x32_bf16 v[132:135], a[172:175], v[40:43], v[132:135]
s_waitcnt lgkmcnt(4)
v_mfma_f32_16x16x32_bf16 v[120:123], v[44:47], a[40:43], v[120:123]
v_mfma_f32_16x16x32_bf16 v[124:127], v[44:47], a[44:47], v[124:127]
s_waitcnt vmcnt(2)
s_barrier
buffer_store_dword v25, v24, s[4:7], s89 offen sc1
s_mov_b32 s89, s82
ds_read_b128 v[32:35], v4 offset:16384
ds_read_b128 v[36:39], v8 offset:16384
s_waitcnt lgkmcnt(5)
v_mfma_f32_16x16x32_bf16 v[112:115], v[48:51], a[48:51], v[112:115]
s_add_u32 m0, s79, 0
s_add_u32 s41, s39, 0
v_mfma_f32_16x16x32_bf16 v[116:119], v[48:51], a[52:55], v[116:119]
buffer_load_dwordx4 v30, s[4:7], s41 offen offset:0 sc1 lds
v_mfma_f32_16x16x32_bf16 v[128:131], a[176:179], v[48:51], v[128:131]
v_mfma_f32_16x16x32_bf16 v[132:135], a[180:183], v[48:51], v[132:135]
s_waitcnt lgkmcnt(4)
v_mfma_f32_16x16x32_bf16 v[120:123], v[52:55], a[48:51], v[120:123]
v_mfma_f32_16x16x32_bf16 v[124:127], v[52:55], a[52:55], v[124:127]
ds_read_b128 v[40:43], v5 offset:16384
ds_read_b128 v[44:47], v9 offset:16384
s_waitcnt lgkmcnt(5)
v_mfma_f32_16x16x32_bf16 v[112:115], v[56:59], a[56:59], v[112:115]
buffer_load_dwordx4 v31, s[4:7], s41 offen offset:1024 sc1 lds
s_add_u32 m0, s79, 8192
v_mfma_f32_16x16x32_bf16 v[116:119], v[56:59], a[60:63], v[116:119]
s_add_u32 s41, s39, 256
v_mfma_f32_16x16x32_bf16 v[128:131], a[184:187], v[56:59], v[128:131]
v_mfma_f32_16x16x32_bf16 v[132:135], a[188:191], v[56:59], v[132:135]
s_waitcnt lgkmcnt(4)
v_mfma_f32_16x16x32_bf16 v[120:123], v[60:63], a[56:59], v[120:123]
v_mfma_f32_16x16x32_bf16 v[124:127], v[60:63], a[60:63], v[124:127]
ds_read_b128 v[48:51], v6 offset:16384
ds_read_b128 v[52:55], v10 offset:16384
s_waitcnt lgkmcnt(5)
v_mfma_f32_16x16x32_bf16 v[112:115], v[32:35], a[64:67], v[112:115]
buffer_load_dwordx4 v30, s[4:7], s41 offen offset:0 sc1 lds
v_mfma_f32_16x16x32_bf16 v[116:119], v[32:35], a[68:71], v[116:119]
v_mfma_f32_16x16x32_bf16 v[128:131], a[192:195], v[32:35], v[128:131]
v_mfma_f32_16x16x32_bf16 v[132:135], a[196:199], v[32:35], v[132:135]
s_waitcnt lgkmcnt(4)
v_mfma_f32_16x16x32_bf16 v[120:123], v[36:39], a[64:67], v[120:123]
v_mfma_f32_16x16x32_bf16 v[124:127], v[36:39], a[68:71], v[124:127]
ds_read_b128 v[56:59], v7 offset:16384
ds_read_b128 v[60:63], v11 offset:16384
s_waitcnt lgkmcnt(5)
v_mfma_f32_16x16x32_bf16 v[112:115], v[40:43], a[72:75], v[112:115]
buffer_load_dwordx4 v31, s[4:7], s41 offen offset:1024 sc1 lds
s_add_u32 m0, s79, 16384
v_mfma_f32_16x16x32_bf16 v[116:119], v[40:43], a[76:79], v[116:119]
s_add_u32 s41, s39, 512
v_mfma_f32_16x16x32_bf16 v[128:131], a[200:203], v[40:43], v[128:131]
v_mfma_f32_16x16x32_bf16 v[132:135], a[204:207], v[40:43], v[132:135]
s_waitcnt lgkmcnt(4)
v_mfma_f32_16x16x32_bf16 v[120:123], v[44:47], a[72:75], v[120:123]
v_mfma_f32_16x16x32_bf16 v[124:127], v[44:47], a[76:79], v[124:127]
ds_read_b128 v[32:35], v4 offset:24576
ds_read_b128 v[36:39], v8 offset:24576
s_waitcnt lgkmcnt(5)
v_mfma_f32_16x16x32_bf16 v[112:115], v[48:51], a[80:83], v[112:115]
buffer_load_dwordx4 v30, s[4:7], s41 offen offset:0 sc1 lds
v_mfma_f32_16x16x32_bf16 v[116:119], v[48:51], a[84:87], v[116:119]
v_mfma_f32_16x16x32_bf16 v[128:131], a[208:211], v[48:51], v[128:131]
v_mfma_f32_16x16x32_bf16 v[132:135], a[212:215], v[48:51], v[132:135]
s_waitcnt lgkmcnt(4)
v_mfma_f32_16x16x32_bf16 v[120:123], v[52:55], a[80:83], v[120:123]
v_mfma_f32_16x16x32_bf16 v[124:127], v[52:55], a[84:87], v[124:127]
ds_read_b128 v[40:43], v5 offset:24576
ds_read_b128 v[44:47], v9 offset:24576
s_waitcnt lgkmcnt(5)
v_mfma_f32_16x16x32_bf16 v[112:115], v[56:59], a[88:91], v[112:115]
buffer_load_dwordx4 v31, s[4:7], s41 offen offset:1024 sc1 lds
s_add_u32 m0, s79, 24576
v_mfma_f32_16x16x32_bf16 v[116:119], v[56:59], a[92:95], v[116:119]
s_add_u32 s41, s39, 768
v_mfma_f32_16x16x32_bf16 v[128:131], a[216:219], v[56:59], v[128:131]
v_mfma_f32_16x16x32_bf16 v[132:135], a[220:223], v[56:59], v[132:135]
s_waitcnt lgkmcnt(4)
v_mfma_f32_16x16x32_bf16 v[120:123], v[60:63], a[88:91], v[120:123]
v_mfma_f32_16x16x32_bf16 v[124:127], v[60:63], a[92:95], v[124:127]
s_barrier
ds_read_b128 v[48:51], v6 offset:24576
ds_read_b128 v[52:55], v10 offset:24576
s_waitcnt lgkmcnt(5)
v_mfma_f32_16x16x32_bf16 v[112:115], v[32:35], a[96:99], v[112:115]
buffer_load_dwordx4 v30, s[4:7], s41 offen offset:0 sc1 lds
v_mfma_f32_16x16x32_bf16 v[116:119], v[32:35], a[100:103], v[116:119]
v_mfma_f32_16x16x32_bf16 v[128:131], a[224:227], v[32:35], v[128:131]
v_mfma_f32_16x16x32_bf16 v[132:135], a[228:231], v[32:35], v[132:135]
s_waitcnt lgkmcnt(4)
v_mfma_f32_16x16x32_bf16 v[120:123], v[36:39], a[96:99], v[120:123]
v_mfma_f32_16x16x32_bf16 v[124:127], v[36:39], a[100:103], v[124:127]
ds_read_b128 v[56:59], v7 offset:24576
ds_read_b128 v[60:63], v11 offset:24576
s_waitcnt lgkmcnt(5)
v_mfma_f32_16x16x32_bf16 v[112:115], v[40:43], a[104:107], v[112:115]
buffer_load_dwordx4 v31, s[4:7], s41 offen offset:1024 sc1 lds
s_add_u32 s39, s39, 32768
v_mfma_f32_16x16x32_bf16 v[116:119], v[40:43], a[108:111], v[116:119]
s_min_u32 s39, s39, s90
s_xor_b32 s79, s79, 32768
v_mfma_f32_16x16x32_bf16 v[128:131], a[232:235], v[40:43], v[128:131]
v_mfma_f32_16x16x32_bf16 v[132:135], a[236:239], v[40:43], v[132:135]
s_waitcnt lgkmcnt(4)
v_mfma_f32_16x16x32_bf16 v[120:123], v[44:47], a[104:107], v[120:123]
v_mfma_f32_16x16x32_bf16 v[124:127], v[44:47], a[108:111], v[124:127]
ds_read_b128 v[32:35], v100 offset:0
ds_read_b128 v[36:39], v104 offset:0
s_waitcnt lgkmcnt(5)
v_mfma_f32_16x16x32_bf16 v[112:115], v[48:51], a[112:115], v[112:115]
v_mfma_f32_16x16x32_bf16 v[116:119], v[48:51], a[116:119], v[116:119]
v_mfma_f32_16x16x32_bf16 v[128:131], a[240:243], v[48:51], v[128:131]
v_mfma_f32_16x16x32_bf16 v[132:135], a[244:247], v[48:51], v[132:135]
s_waitcnt lgkmcnt(4)
v_mfma_f32_16x16x32_bf16 v[120:123], v[52:55], a[112:115], v[120:123]
v_mfma_f32_16x16x32_bf16 v[124:127], v[52:55], a[116:119], v[124:127]
ds_read_b128 v[40:43], v101 offset:0
ds_read_b128 v[44:47], v105 offset:0
s_waitcnt lgkmcnt(5)
v_mfma_f32_16x16x32_bf16 v[112:115], v[56:59], a[120:123], v[112:115]
v_mfma_f32_16x16x32_bf16 v[116:119], v[56:59], a[124:127], v[116:119]
v_mfma_f32_16x16x32_bf16 v[128:131], a[248:251], v[56:59], v[128:131]
v_mfma_f32_16x16x32_bf16 v[132:135], a[252:255], v[56:59], v[132:135]
s_waitcnt lgkmcnt(4)
v_mfma_f32_16x16x32_bf16 v[120:123], v[60:63], a[120:123], v[120:123]
v_mfma_f32_16x16x32_bf16 v[124:127], v[60:63], a[124:127], v[124:127]
s_mov_b32 s84, s30
s_mov_b32 s83, s76
s_add_u32 s30, s30, 262144
s_add_u32 s76, s76, 2048
s_add_u32 s38, s38, 1
s_cmp_lt_u32 s38, 64
s_cbranch_scc1 L_qkv_loop_v_L
s_add_u32 s40, s88, s81
buffer_store_dwordx4 v[96:99], v28, s[4:7], s40 offen sc1
buffer_store_dwordx4 v[88:91], v2, s[4:7], s88 offen offset:0 sc1
buffer_store_dwordx4 v[92:95], v2, s[4:7], s88 offen offset:1024 sc1
s_mov_b32 s82, s89
L_qkv_p3_v_L:
v_cvt_pk_bf16_f32 v144, v128, v132
v_cvt_pk_bf16_f32 v145, v129, v133
v_cvt_pk_bf16_f32 v146, v130, v134
v_cvt_pk_bf16_f32 v147, v131, v135
v_cvt_pk_bf16_f32 v136, v112, v120
v_cvt_pk_bf16_f32 v137, v113, v121
v_cvt_pk_bf16_f32 v138, v114, v122
v_cvt_pk_bf16_f32 v139, v115, v123
v_cvt_pk_bf16_f32 v140, v116, v124
v_cvt_pk_bf16_f32 v141, v117, v125
v_cvt_pk_bf16_f32 v142, v118, v126
v_cvt_pk_bf16_f32 v143, v119, v127
v_alignbit_b32 v136, v136, v136, s85
v_alignbit_b32 v137, v137, v137, s85
v_alignbit_b32 v138, v138, v138, s85
v_alignbit_b32 v139, v139, v139, s85
v_alignbit_b32 v140, v140, v140, s85
v_alignbit_b32 v141, v141, v141, s85
v_alignbit_b32 v142, v142, v142, s85
v_alignbit_b32 v143, v143, v143, s85
s_add_u32 s40, s84, s81
buffer_store_dwordx4 v[144:147], v28, s[4:7], s40 offen sc1
buffer_store_dwordx4 v[136:139], v2, s[4:7], s84 offen offset:0 sc1
buffer_store_dwordx4 v[140:143], v2, s[4:7], s84 offen offset:1024 sc1
buffer_load_dword v26, v27, s[4:7], s77 offen sc1
s_waitcnt vmcnt(0) lgkmcnt(0)
buffer_store_dword v25, v24, s[4:7], s83 offen sc1
buffer_store_dword v25, v24, s[4:7], s82 offen sc1
s_cmp_eq_u32 s38, 78
s_cbranch_scc1 L_end_qkv_L
s_barrier
L_p3_39:
v_cmp_eq_u32 vcc, 0, v26
s_cbranch_vccz L_p3o_40
s_sub_u32 s36, s36, 1
s_cbranch_scc1 L_end_qkv_L
buffer_load_dword v26, v27, s[4:7], s77 offen sc1
s_waitcnt vmcnt(0)
s_branch L_p3_39
L_p3o_40:
s_add_u32 m0, s78, 0
s_add_u32 s41, s28, 0
buffer_load_dwordx4 v30, s[4:7], s41 offen offset:0 sc1 lds
buffer_load_dwordx4 v31, s[4:7], s41 offen offset:1024 sc1 lds
s_add_u32 m0, s78, 8192
s_add_u32 s41, s28, 256
buffer_load_dwordx4 v30, s[4:7], s41 offen offset:0 sc1 lds
buffer_load_dwordx4 v31, s[4:7], s41 offen offset:1024 sc1 lds
s_add_u32 m0, s78, 16384
s_add_u32 s41, s28, 512
buffer_load_dwordx4 v30, s[4:7], s41 offen offset:0 sc1 lds
buffer_load_dwordx4 v31, s[4:7], s41 offen offset:1024 sc1 lds
s_add_u32 m0, s78, 24576
s_add_u32 s41, s28, 768
buffer_load_dwordx4 v30, s[4:7], s41 offen offset:0 sc1 lds
buffer_load_dwordx4 v31, s[4:7], s41 offen offset:1024 sc1 lds
s_add_u32 s28, s28, 32768
s_add_u32 s77, s77, 512
s_waitcnt vmcnt(6)
s_barrier
ds_read_b128 v[32:35], v4 offset:0
ds_read_b128 v[36:39], v8 offset:0
ds_read_b128 v[40:43], v5 offset:0
ds_read_b128 v[44:47], v9 offset:0
ds_read_b128 v[48:51], v6 offset:0
ds_read_b128 v[52:55], v10 offset:0
s_waitcnt lgkmcnt(5)
v_mfma_f32_16x16x32_bf16 v[112:115], v[32:35], a[0:3], 0
v_mfma_f32_16x16x32_bf16 v[116:119], v[32:35], a[4:7], 0
v_mfma_f32_16x16x32_bf16 v[128:131], a[128:131], v[32:35], 0
v_mfma_f32_16x16x32_bf16 v[132:135], a[132:135], v[32:35], 0
s_waitcnt lgkmcnt(4)
v_mfma_f32_16x16x32_bf16 v[120:123], v[36:39], a[0:3], 0
v_mfma_f32_16x16x32_bf16 v[124:127], v[36:39], a[4:7], 0
ds_read_b128 v[56:59], v7 offset:0
ds_read_b128 v[60:63], v11 offset:0
s_waitcnt lgkmcnt(5)
v_mfma_f32_16x16x32_bf16 v[112:115], v[40:43], a[8:11], v[112:115]
v_mfma_f32_16x16x32_bf16 v[116:119], v[40:43], a[12:15], v[116:119]
v_mfma_f32_16x16x32_bf16 v[128:131], a[136:139], v[40:43], v[128:131]
v_mfma_f32_16x16x32_bf16 v[132:135], a[140:143], v[40:43], v[132:135]
s_waitcnt lgkmcnt(4)
v_mfma_f32_16x16x32_bf16 v[120:123], v[44:47], a[8:11], v[120:123]
v_mfma_f32_16x16x32_bf16 v[124:127], v[44:47], a[12:15], v[124:127]
s_waitcnt vmcnt(4)
s_barrier
ds_read_b128 v[32:35], v4 offset:8192
ds_read_b128 v[36:39], v8 offset:8192
s_waitcnt lgkmcnt(5)
v_mfma_f32_16x16x32_bf16 v[112:115], v[48:51], a[16:19], v[112:115]
v_mfma_f32_16x16x32_bf16 v[116:119], v[48:51], a[20:23], v[116:119]
v_mfma_f32_16x16x32_bf16 v[128:131], a[144:147], v[48:51], v[128:131]
v_mfma_f32_16x16x32_bf16 v[132:135], a[148:151], v[48:51], v[132:135]
s_waitcnt lgkmcnt(4)
v_mfma_f32_16x16x32_bf16 v[120:123], v[52:55], a[16:19], v[120:123]
v_mfma_f32_16x16x32_bf16 v[124:127], v[52:55], a[20:23], v[124:127]
ds_read_b128 v[40:43], v5 offset:8192
ds_read_b128 v[44:47], v9 offset:8192
s_waitcnt lgkmcnt(5)
v_mfma_f32_16x16x32_bf16 v[112:115], v[56:59], a[24:27], v[112:115]
v_mfma_f32_16x16x32_bf16 v[116:119], v[56:59], a[28:31], v[116:119]
v_mfma_f32_16x16x32_bf16 v[128:131], a[152:155], v[56:59], v[128:131]
v_mfma_f32_16x16x32_bf16 v[132:135], a[156:159], v[56:59], v[132:135]
s_waitcnt lgkmcnt(4)
v_mfma_f32_16x16x32_bf16 v[120:123], v[60:63], a[24:27], v[120:123]
v_mfma_f32_16x16x32_bf16 v[124:127], v[60:63], a[28:31], v[124:127]
ds_read_b128 v[48:51], v6 offset:8192
ds_read_b128 v[52:55], v10 offset:8192
s_waitcnt lgkmcnt(5)
v_mfma_f32_16x16x32_bf16 v[112:115], v[32:35], a[32:35], v[112:115]
v_mfma_f32_16x16x32_bf16 v[116:119], v[32:35], a[36:39], v[116:119]
v_mfma_f32_16x16x32_bf16 v[128:131], a[160:163], v[32:35], v[128:131]
v_mfma_f32_16x16x32_bf16 v[132:135], a[164:167], v[32:35], v[132:135]
s_waitcnt lgkmcnt(4)
v_mfma_f32_16x16x32_bf16 v[120:123], v[36:39], a[32:35], v[120:123]
v_mfma_f32_16x16x32_bf16 v[124:127], v[36:39], a[36:39], v[124:127]
ds_read_b128 v[56:59], v7 offset:8192
ds_read_b128 v[60:63], v11 offset:8192
s_waitcnt lgkmcnt(5)
v_mfma_f32_16x16x32_bf16 v[112:115], v[40:43], a[40:43], v[112:115]
v_mfma_f32_16x16x32_bf16 v[116:119], v[40:43], a[44:47], v[116:119]
v_mfma_f32_16x16x32_bf16 v[128:131], a[168:171], v[40:43], v[128:131]
v_mfma_f32_16x16x32_bf16 v[132:135], a[172:175], v[40:43], v[132:135]
s_waitcnt lgkmcnt(4)
v_mfma_f32_16x16x32_bf16 v[120:123], v[44:47], a[40:43], v[120:123]
v_mfma_f32_16x16x32_bf16 v[124:127], v[44:47], a[44:47], v[124:127]
s_waitcnt vmcnt(2)
s_barrier
ds_read_b128 v[32:35], v4 offset:16384
ds_read_b128 v[36:39], v8 offset:16384
s_waitcnt lgkmcnt(5)
v_mfma_f32_16x16x32_bf16 v[112:115], v[48:51], a[48:51], v[112:115]
v_mfma_f32_16x16x32_bf16 v[116:119], v[48:51], a[52:55], v[116:119]
v_mfma_f32_16x16x32_bf16 v[128:131], a[176:179], v[48:51], v[128:131]
v_mfma_f32_16x16x32_bf16 v[132:135], a[180:183], v[48:51], v[132:135]
s_waitcnt lgkmcnt(4)
v_mfma_f32_16x16x32_bf16 v[120:123], v[52:55], a[48:51], v[120:123]
v_mfma_f32_16x16x32_bf16 v[124:127], v[52:55], a[52:55], v[124:127]
ds_read_b128 v[40:43], v5 offset:16384
ds_read_b128 v[44:47], v9 offset:16384
s_waitcnt lgkmcnt(5)
v_mfma_f32_16x16x32_bf16 v[112:115], v[56:59], a[56:59], v[112:115]
v_mfma_f32_16x16x32_bf16 v[116:119], v[56:59], a[60:63], v[116:119]
v_mfma_f32_16x16x32_bf16 v[128:131], a[184:187], v[56:59], v[128:131]
v_mfma_f32_16x16x32_bf16 v[132:135], a[188:191], v[56:59], v[132:135]
s_waitcnt lgkmcnt(4)
v_mfma_f32_16x16x32_bf16 v[120:123], v[60:63], a[56:59], v[120:123]
v_mfma_f32_16x16x32_bf16 v[124:127], v[60:63], a[60:63], v[124:127]
ds_read_b128 v[48:51], v6 offset:16384
ds_read_b128 v[52:55], v10 offset:16384
s_waitcnt lgkmcnt(5)
v_mfma_f32_16x16x32_bf16 v[112:115], v[32:35], a[64:67], v[112:115]
v_mfma_f32_16x16x32_bf16 v[116:119], v[32:35], a[68:71], v[116:119]
v_mfma_f32_16x16x32_bf16 v[128:131], a[192:195], v[32:35], v[128:131]
v_mfma_f32_16x16x32_bf16 v[132:135], a[196:199], v[32:35], v[132:135]
s_waitcnt lgkmcnt(4)
v_mfma_f32_16x16x32_bf16 v[120:123], v[36:39], a[64:67], v[120:123]
v_mfma_f32_16x16x32_bf16 v[124:127], v[36:39], a[68:71], v[124:127]
ds_read_b128 v[56:59], v7 offset:16384
ds_read_b128 v[60:63], v11 offset:16384
s_waitcnt lgkmcnt(5)
v_mfma_f32_16x16x32_bf16 v[112:115], v[40:43], a[72:75], v[112:115]
v_mfma_f32_16x16x32_bf16 v[116:119], v[40:43], a[76:79], v[116:119]
v_mfma_f32_16x16x32_bf16 v[128:131], a[200:203], v[40:43], v[128:131]
v_mfma_f32_16x16x32_bf16 v[132:135], a[204:207], v[40:43], v[132:135]
s_waitcnt lgkmcnt(4)
v_mfma_f32_16x16x32_bf16 v[120:123], v[44:47], a[72:75], v[120:123]
v_mfma_f32_16x16x32_bf16 v[124:127], v[44:47], a[76:79], v[124:127]
s_waitcnt vmcnt(0)
s_barrier
ds_read_b128 v[32:35], v4 offset:24576
ds_read_b128 v[36:39], v8 offset:24576
s_waitcnt lgkmcnt(5)
v_mfma_f32_16x16x32_bf16 v[112:115], v[48:51], a[80:83], v[112:115]
v_mfma_f32_16x16x32_bf16 v[116:119], v[48:51], a[84:87], v[116:119]
v_mfma_f32_16x16x32_bf16 v[128:131], a[208:211], v[48:51], v[128:131]
v_mfma_f32_16x16x32_bf16 v[132:135], a[212:215], v[48:51], v[132:135]
s_waitcnt lgkmcnt(4)
v_mfma_f32_16x16x32_bf16 v[120:123], v[52:55], a[80:83], v[120:123]
v_mfma_f32_16x16x32_bf16 v[124:127], v[52:55], a[84:87], v[124:127]
ds_read_b128 v[40:43], v5 offset:24576
ds_read_b128 v[44:47], v9 offset:24576
s_waitcnt lgkmcnt(5)
v_mfma_f32_16x16x32_bf16 v[112:115], v[56:59], a[88:91], v[112:115]
v_mfma_f32_16x16x32_bf16 v[116:119], v[56:59], a[92:95], v[116:119]
v_mfma_f32_16x16x32_bf16 v[128:131], a[216:219], v[56:59], v[128:131]
v_mfma_f32_16x16x32_bf16 v[132:135], a[220:223], v[56:59], v[132:135]
s_waitcnt lgkmcnt(4)
v_mfma_f32_16x16x32_bf16 v[120:123], v[60:63], a[88:91], v[120:123]
v_mfma_f32_16x16x32_bf16 v[124:127], v[60:63], a[92:95], v[124:127]
ds_read_b128 v[48:51], v6 offset:24576
ds_read_b128 v[52:55], v10 offset:24576
s_waitcnt lgkmcnt(5)
v_mfma_f32_16x16x32_bf16 v[112:115], v[32:35], a[96:99], v[112:115]
v_mfma_f32_16x16x32_bf16 v[116:119], v[32:35], a[100:103], v[116:119]
v_mfma_f32_16x16x32_bf16 v[128:131], a[224:227], v[32:35], v[128:131]
v_mfma_f32_16x16x32_bf16 v[132:135], a[228:231], v[32:35], v[132:135]
s_waitcnt lgkmcnt(4)
v_mfma_f32_16x16x32_bf16 v[120:123], v[36:39], a[96:99], v[120:123]
v_mfma_f32_16x16x32_bf16 v[124:127], v[36:39], a[100:103], v[124:127]
ds_read_b128 v[56:59], v7 offset:24576
ds_read_b128 v[60:63], v11 offset:24576
s_waitcnt lgkmcnt(5)
v_mfma_f32_16x16x32_bf16 v[112:115], v[40:43], a[104:107], v[112:115]
v_mfma_f32_16x16x32_bf16 v[116:119], v[40:43], a[108:111], v[116:119]
v_mfma_f32_16x16x32_bf16 v[128:131], a[232:235], v[40:43], v[128:131]
v_mfma_f32_16x16x32_bf16 v[132:135], a[236:239], v[40:43], v[132:135]
s_waitcnt lgkmcnt(4)
v_mfma_f32_16x16x32_bf16 v[120:123], v[44:47], a[104:107], v[120:123]
v_mfma_f32_16x16x32_bf16 v[124:127], v[44:47], a[108:111], v[124:127]
s_waitcnt lgkmcnt(3)
v_mfma_f32_16x16x32_bf16 v[112:115], v[48:51], a[112:115], v[112:115]
v_mfma_f32_16x16x32_bf16 v[116:119], v[48:51], a[116:119], v[116:119]
v_mfma_f32_16x16x32_bf16 v[128:131], a[240:243], v[48:51], v[128:131]
v_mfma_f32_16x16x32_bf16 v[132:135], a[244:247], v[48:51], v[132:135]
s_waitcnt lgkmcnt(2)
v_mfma_f32_16x16x32_bf16 v[120:123], v[52:55], a[112:115], v[120:123]
v_mfma_f32_16x16x32_bf16 v[124:127], v[52:55], a[116:119], v[124:127]
s_waitcnt lgkmcnt(1)
v_mfma_f32_16x16x32_bf16 v[112:115], v[56:59], a[120:123], v[112:115]
v_mfma_f32_16x16x32_bf16 v[116:119], v[56:59], a[124:127], v[116:119]
v_mfma_f32_16x16x32_bf16 v[128:131], a[248:251], v[56:59], v[128:131]
v_mfma_f32_16x16x32_bf16 v[132:135], a[252:255], v[56:59], v[132:135]
s_waitcnt lgkmcnt(0)
v_mfma_f32_16x16x32_bf16 v[120:123], v[60:63], a[120:123], v[120:123]
v_mfma_f32_16x16x32_bf16 v[124:127], v[60:63], a[124:127], v[124:127]
s_mov_b32 s84, s30
s_mov_b32 s83, s76
s_add_u32 s30, s30, 262144
s_add_u32 s76, s76, 2048
s_add_u32 s38, s38, 1
s_branch L_qkv_p3_v_L
L_spin_37:
buffer_load_dword v26, v27, s[4:7], s77 offen sc1
s_waitcnt vmcnt(0)
buffer_store_dword v25, v24, s[4:7], s83 offen sc1
buffer_store_dword v25, v24, s[4:7], s89 offen sc1
L_spin2_41:
v_cmp_eq_u32 vcc, 0, v26
s_cbranch_vccz L_spin2_41o
s_sub_u32 s36, s36, 1
s_cbranch_scc1 L_end_qkv_L
buffer_load_dword v26, v27, s[4:7], s77 offen sc1
s_waitcnt vmcnt(0)
s_branch L_spin2_41
L_spin2_41o:
s_add_u32 m0, s78, 0
s_add_u32 s41, s28, 0
buffer_load_dwordx4 v30, s[4:7], s41 offen offset:0 sc1 lds
buffer_load_dwordx4 v31, s[4:7], s41 offen offset:1024 sc1 lds
s_add_u32 m0, s78, 8192
s_add_u32 s41, s28, 256
buffer_load_dwordx4 v30, s[4:7], s41 offen offset:0 sc1 lds
buffer_load_dwordx4 v31, s[4:7], s41 offen offset:1024 sc1 lds
s_add_u32 m0, s78, 16384
s_add_u32 s41, s28, 512
buffer_load_dwordx4 v30, s[4:7], s41 offen offset:0 sc1 lds
buffer_load_dwordx4 v31, s[4:7], s41 offen offset:1024 sc1 lds
s_add_u32 m0, s78, 24576
s_add_u32 s41, s28, 768
buffer_load_dwordx4 v30, s[4:7], s41 offen offset:0 sc1 lds
buffer_load_dwordx4 v31, s[4:7], s41 offen offset:1024 sc1 lds
s_waitcnt vmcnt(4)
s_branch L_go_38
L_fb_qkv:
s_getpc_b64 s[40:41]
L_fb_qkv_pc:
s_add_u32 s40, s40, L_fallback-L_fb_qkv_pc
s_addc_u32 s41, s41, -1
s_setpc_b64 s[40:41]
L_end_qkv_L:
s_endpgm
.p2align 6
R_att_L:
s_sub_u32 s38, s35, 4
s_lshr_b32 s38, s38, 1
v_and_b32 v3, 15, v1
v_lshrrev_b32 v4, 4, v1
s_and_b32 s98, s34, 15
s_lshr_b32 s99, s34, 4
s_sub_u32 s40, s35, 4
s_lshl_b32 s40, s40, 1
s_add_u32 s40, s40, s99
s_lshl_b32 s40, s40, 20
s_add_u32 s39, s40, 2097152
s_lshl_b32 s40, s98, 15
s_lshl_b32 s41, s32, 8
s_add_u32 s40, s40, s41
v_lshlrev_b32 v232, 4, v3
v_lshl_add_u32 v233, v4, 10, v232
v_add_u32 v5, s40, v233
s_and_b32 s3, s32, 1
s_lshl_b32 s42, s3, 14
v_add_u32 v5, s42, v5
v_xor_b32 v252, 16384, v5
s_lshl_b32 s40, s98, 10
s_add_u32 s40, s40, s41
v_lshl_add_u32 v233, v4, 17, v232
v_add3_u32 v8, v233, s40, 0
v_add_u32 v8, s42, v8
v_xor_b32 v253, 16384, v8
v_and_b32 v233, 1, v4
v_lshlrev_b32 v233, 3, v233
v_lshrrev_b32 v234, 1, v4
v_lshl_add_u32 v233, v234, 10, v233
s_lshl_b32 s40, s34, 11
s_add_u32 s40, s40, s41
v_add3_u32 v6, v232, v233, s40
v_and_b32 v254, 0xfffffc00, v6
v_xor_b32 v232, s98, v3
v_lshlrev_b32 v232, 4, v232
v_add3_u32 v7, v232, v233, s40
v_mov_b32 v9, 1
v_lshlrev_b32 v234, 6, v234
v_add_u32 v11, 163712, v234
s_lshl_b32 s40, s32, 2
v_and_b32 v234, 1, v4
v_lshlrev_b32 v234, 4, v234
v_add3_u32 v10, v234, v11, s40
s_mov_b32 s37, s99
s_mov_b32 s76, 0
s_mov_b32 s101, 0
s_lshl_b32 s42, s3, 3
v_xor_b32 v234, s42, v3
v_mov_b32 v12, 0
v_cmp_eq_u32 vcc, 0, v234
v_mov_b32 v233, 0x3f80
s_nop 0
v_cndmask_b32 v12, v12, v233, vcc
v_cmp_eq_u32 vcc, 1, v234
v_mov_b32 v233, 0x3f800000
s_nop 0
v_cndmask_b32 v12, v12, v233, vcc
v_mov_b32 v16, 0
v_cmp_eq_u32 vcc, 8, v234
v_mov_b32 v233, 0x3f80
s_nop 0
v_cndmask_b32 v16, v16, v233, vcc
v_cmp_eq_u32 vcc, 9, v234
v_mov_b32 v233, 0x3f800000
s_nop 0
v_cndmask_b32 v16, v16, v233, vcc
v_mov_b32 v13, 0
v_cmp_eq_u32 vcc, 2, v234
v_mov_b32 v233, 0x3f80
s_nop 0
v_cndmask_b32 v13, v13, v233, vcc
v_cmp_eq_u32 vcc, 3, v234
v_mov_b32 v233, 0x3f800000
s_nop 0
v_cndmask_b32 v13, v13, v233, vcc
v_mov_b32 v17, 0
v_cmp_eq_u32 vcc, 10, v234
v_mov_b32 v233, 0x3f80
s_nop 0
v_cndmask_b32 v17, v17, v233, vcc
v_cmp_eq_u32 vcc, 11, v234
v_mov_b32 v233, 0x3f800000
s_nop 0
v_cndmask_b32 v17, v17, v233, vcc
v_mov_b32 v14, 0
v_cmp_eq_u32 vcc, 4, v234
v_mov_b32 v233, 0x3f80
s_nop 0
v_cndmask_b32 v14, v14, v233, vcc
v_cmp_eq_u32 vcc, 5, v234
v_mov_b32 v233, 0x3f800000
s_nop 0
v_cndmask_b32 v14, v14, v233, vcc
v_mov_b32 v18, 0
v_cmp_eq_u32 vcc, 12, v234
v_mov_b32 v233, 0x3f80
s_nop 0
v_cndmask_b32 v18, v18, v233, vcc
v_cmp_eq_u32 vcc, 13, v234
v_mov_b32 v233, 0x3f800000
s_nop 0
v_cndmask_b32 v18, v18, v233, vcc
v_mov_b32 v15, 0
v_cmp_eq_u32 vcc, 6, v234
v_mov_b32 v233, 0x3f80
s_nop 0
v_cndmask_b32 v15, v15, v233, vcc
v_cmp_eq_u32 vcc, 7, v234
v_mov_b32 v233, 0x3f800000
s_nop 0
v_cndmask_b32 v15, v15, v233, vcc
v_mov_b32 v19, 0
v_cmp_eq_u32 vcc, 14, v234
v_mov_b32 v233, 0x3f80
s_nop 0
v_cndmask_b32 v19, v19, v233, vcc
v_cmp_eq_u32 vcc, 15, v234
v_mov_b32 v233, 0x3f800000
s_nop 0
v_cndmask_b32 v19, v19, v233, vcc
s_cmp_eq_u32 s38, 0
s_cselect_b32 s16, s48, s74
s_cselect_b32 s17, s49, s75
s_cselect_b32 s18, 2097152, s6
s_mov_b32 s19, 0x20000
s_cselect_b32 s28, 0, 20971520
s_lshl_b32 s40, s38, 22
s_add_u32 s29, s40, 18874368
s_add_u32 s30, s40, 12582912
s_lshl_b32 s40, s38, 16
s_lshl_b32 s41, s34, 5
s_add_u32 s40, s40, s41
s_lshl_b32 s43, s32, 2
s_add_u32 s40, s40, s43
s_add_u32 s31, s40, 16384
s_lshl_b32 s40, s38, 6
s_add_u32 s40, s40, s99
s_lshl_b32 s40, s40, 5
s_lshl_b32 s41, s98, 1
s_add_u32 s40, s40, s41
s_lshl_b32 s41, s40, 13
s_lshl_b32 s42, s32, 11
s_add_u32 s41, s41, s42
s_add_u32 s77, s41, 41943040
s_lshl_b32 s41, s40, 6
s_add_u32 s79, s41, 131072
s_lshr_b32 s42, s32, 1
s_lshl_b32 s41, s42, 6
s_add_u32 s26, s79, s41
s_and_b32 s41, s32, 1
s_lshl_b32 s41, s41, 2
s_add_u32 s26, s26, s41
s_add_u32 s26, s26, 48
s_lshl_b32 s41, s98, 1
s_add_u32 s41, s41, s42
s_lshl_b32 s41, s41, 12
s_lshl_b32 s42, s38, 20
s_add_u32 s41, s41, s42
s_add_u32 s24, s41, 25165824
v_lshlrev_b32 v38, 2, v1
s_mov_b32 s80, 0
s_mov_b32 s81, 0x3e0293ee
v_mov_b32 v25, 0xff800000
v_mov_b32 v39, 1133903872
s_and_b32 s40, s32, 1
s_lshr_b32 s42, s32, 1
s_mul_i32 s41, s42, 24576
v_add_u32 v27, s41, v2
s_lshl_b32 s41, s40, 10
v_add_u32 v20, s41, v27
v_lshrrev_b32 v232, 2, v3
v_and_b32 v233, 1, v3
v_lshl_add_u32 v232, v232, 1, v233
v_lshlrev_b32 v232, 4, v232
v_lshl_add_u32 v21, v4, 7, v232
v_lshlrev_b32 v22, 3, v1
s_lshl_b32 s41, s32, 12
s_add_u32 s41, s41, 98304
v_add_u32 v26, s41, v2
v_lshl_add_u32 v232, v3, 1, s40
v_lshlrev_b32 v233, 3, v4
v_sub_u32 v232, v232, v233
v_cmp_le_i32 s[82:83], 0, v232
v_cmp_le_i32 s[84:85], 2, v232
v_cmp_le_i32 s[86:87], 4, v232
v_cmp_le_i32 s[88:89], 6, v232
v_cmp_le_i32 s[90:91], 1, v232
v_cmp_le_i32 s[92:93], 3, v232
v_cmp_le_i32 s[94:95], 5, v232
v_cmp_le_i32 s[96:97], 7, v232
v_mov_b32 v28, 0x3f803f80
v_mov_b32 v29, 0x3f803f80
v_mov_b32 v30, 0x3f803f80
v_mov_b32 v31, 0x3f803f80
v_mov_b32 v32, 0
v_mov_b32 v33, 0
v_mov_b32 v34, 0
v_mov_b32 v35, 0
v_mov_b32 v36, 0
v_mov_b32 v37, 0
v_mov_b32 v140, 0
v_mov_b32 v141, 0
v_mov_b32 v142, 0
v_mov_b32 v143, 0
v_mov_b32 v144, 0
v_mov_b32 v145, 0
v_mov_b32 v146, 0
v_mov_b32 v147, 0
v_mov_b32 v148, 0
v_mov_b32 v149, 0
v_mov_b32 v150, 0
v_mov_b32 v151, 0
v_mov_b32 v152, 0
v_mov_b32 v153, 0
v_mov_b32 v154, 0
v_mov_b32 v155, 0
s_waitcnt vmcnt(0)
s_barrier
s_cmp_lg_u32 s32, 0
s_cbranch_scc1 L_da_42
v_mov_b32 v236, 1
s_lshl_b32 s40, s33, 5
v_mov_b32 v237, s40
s_mov_b64 exec, 1
buffer_atomic_add v236, v237, s[8:11], 0 offen offset:4
s_mov_b64 exec, -1
L_da_42:
s_sub_u32 s40, s35, 4
s_lshl_b32 s40, s40, 5
s_add_u32 s40, s40, s34
s_lshl_b32 s40, s40, 2
s_add_u32 s40, s40, s32
s_mul_i32 s40, s40, 7168
s_mov_b32 s12, s54
s_mov_b32 s13, s55
s_mov_b32 s14, 4194304
s_mov_b32 s15, 0x20000
s_add_u32 s41, s40, 0
buffer_load_dwordx4 v[240:243], v2, s[12:15], s41 offen offset:0
buffer_load_dwordx4 v[240:243], v2, s[12:15], s41 offen offset:1024
buffer_load_dwordx4 v[240:243], v2, s[12:15], s41 offen offset:2048
buffer_load_dwordx4 v[240:243], v2, s[12:15], s41 offen offset:3072
s_add_u32 s41, s40, 4096
buffer_load_dwordx4 v[240:243], v2, s[12:15], s41 offen offset:0
buffer_load_dwordx4 v[240:243], v2, s[12:15], s41 offen offset:1024
buffer_load_dwordx4 v[240:243], v2, s[12:15], s41 offen offset:2048
s_mov_b32 s12, s56
s_mov_b32 s13, s57
s_mov_b32 s14, 4194304
s_mov_b32 s15, 0x20000
s_add_u32 s41, s40, 0
buffer_load_dwordx4 v[240:243], v2, s[12:15], s41 offen offset:0
buffer_load_dwordx4 v[240:243], v2, s[12:15], s41 offen offset:1024
buffer_load_dwordx4 v[240:243], v2, s[12:15], s41 offen offset:2048
buffer_load_dwordx4 v[240:243], v2, s[12:15], s41 offen offset:3072
s_add_u32 s41, s40, 4096
buffer_load_dwordx4 v[240:243], v2, s[12:15], s41 offen offset:0
buffer_load_dwordx4 v[240:243], v2, s[12:15], s41 offen offset:1024
buffer_load_dwordx4 v[240:243], v2, s[12:15], s41 offen offset:2048
s_mov_b32 s12, s52
s_mov_b32 s13, s53
s_mov_b32 s14, 4194304
s_mov_b32 s15, 0x20000
s_add_u32 s41, s40, 0
buffer_load_dwordx4 v[240:243], v2, s[12:15], s41 offen offset:0
buffer_load_dwordx4 v[240:243], v2, s[12:15], s41 offen offset:1024
buffer_load_dwordx4 v[240:243], v2, s[12:15], s41 offen offset:2048
buffer_load_dwordx4 v[240:243], v2, s[12:15], s41 offen offset:3072
s_add_u32 s41, s40, 4096
buffer_load_dwordx4 v[240:243], v2, s[12:15], s41 offen offset:0
buffer_load_dwordx4 v[240:243], v2, s[12:15], s41 offen offset:1024
buffer_load_dwordx4 v[240:243], v2, s[12:15], s41 offen offset:2048
s_mov_b32 s12, s58
s_mov_b32 s13, s59
s_mov_b32 s14, 4194304
s_mov_b32 s15, 0x20000
s_add_u32 s41, s40, 0
buffer_load_dwordx4 v[240:243], v2, s[12:15], s41 offen offset:0
buffer_load_dwordx4 v[240:243], v2, s[12:15], s41 offen offset:1024
buffer_load_dwordx4 v[240:243], v2, s[12:15], s41 offen offset:2048
buffer_load_dwordx4 v[240:243], v2, s[12:15], s41 offen offset:3072
s_add_u32 s41, s40, 4096
buffer_load_dwordx4 v[240:243], v2, s[12:15], s41 offen offset:0
buffer_load_dwordx4 v[240:243], v2, s[12:15], s41 offen offset:1024
buffer_load_dwordx4 v[240:243], v2, s[12:15], s41 offen offset:2048
v_lshlrev_b32 v238, 5, v1
buffer_load_dwordx2 v[236:237], v238, s[8:11], 0 offen sc1
s_waitcnt vmcnt(0)
L_cen_43:
s_mov_b32 s40, 0
v_readlane_b32 s41, v237, 0
s_nop 0
s_add_u32 s40, s40, s41
v_readlane_b32 s41, v237, 1
s_nop 0
s_add_u32 s40, s40, s41
v_readlane_b32 s41, v237, 2
s_nop 0
s_add_u32 s40, s40, s41
v_readlane_b32 s41, v237, 3
s_nop 0
s_add_u32 s40, s40, s41
v_readlane_b32 s41, v237, 4
s_nop 0
s_add_u32 s40, s40, s41
v_readlane_b32 s41, v237, 5
s_nop 0
s_add_u32 s40, s40, s41
v_readlane_b32 s41, v237, 6
s_nop 0
s_add_u32 s40, s40, s41
v_readlane_b32 s41, v237, 7
s_nop 0
s_add_u32 s40, s40, s41
s_cmp_eq_u32 s40, 256
s_cbranch_scc1 L_cenok_44
s_sub_u32 s36, s36, 1
s_cbranch_scc1 L_end_att_L
s_sleep 4
buffer_load_dwordx2 v[236:237], v238, s[8:11], 0 offen sc1
s_waitcnt vmcnt(0)
s_branch L_cen_43
L_cenok_44:
v_cmp_ne_u32 vcc, 32, v236
s_nop 0
s_and_b32 s40, vcc_lo, 0xff
s_cbranch_scc1 L_fb_att
v_mov_b32 v232, -1
v_mov_b32 v233, -1
v_mov_b32 v234, -1
v_mov_b32 v235, -1
s_and_b32 s41, s32, 1
s_lshl_b32 s41, s41, 11
s_lshl_b32 s42, s99, 17
s_add_u32 s42, s42, s41
s_add_u32 s42, s42, s24
buffer_store_dwordx4 v[232:235], v2, s[4:7], s42 offen offset:0 sc1
buffer_store_dwordx4 v[232:235], v2, s[4:7], s42 offen offset:1024 sc1
s_add_u32 s42, s42, 262144
buffer_store_dwordx4 v[232:235], v2, s[4:7], s42 offen offset:0 sc1
buffer_store_dwordx4 v[232:235], v2, s[4:7], s42 offen offset:1024 sc1
s_add_u32 s42, s42, 262144
buffer_store_dwordx4 v[232:235], v2, s[4:7], s42 offen offset:0 sc1
buffer_store_dwordx4 v[232:235], v2, s[4:7], s42 offen offset:1024 sc1
s_add_u32 s42, s42, 262144
buffer_store_dwordx4 v[232:235], v2, s[4:7], s42 offen offset:0 sc1
buffer_store_dwordx4 v[232:235], v2, s[4:7], s42 offen offset:1024 sc1
s_add_u32 s42, s42, 262144
s_nop 0
v_mov_b32 v232, -1
v_mov_b32 v233, -1
v_mov_b32 v234, -1
v_mov_b32 v235, -1
s_add_u32 s40, s39, 0
buffer_store_dwordx4 v[232:235], v5, s[4:7], s40 offen
s_add_u32 s40, s39, 4096
buffer_store_dwordx4 v[232:235], v5, s[4:7], s40 offen
s_add_u32 s40, s39, 8192
buffer_store_dwordx4 v[232:235], v5, s[4:7], s40 offen
s_add_u32 s40, s39, 12288
buffer_store_dwordx4 v[232:235], v5, s[4:7], s40 offen
s_add_u32 s40, s39, 0
buffer_store_dwordx4 v[232:235], v252, s[4:7], s40 offen
s_add_u32 s40, s39, 4096
buffer_store_dwordx4 v[232:235], v252, s[4:7], s40 offen
s_add_u32 s40, s39, 8192
buffer_store_dwordx4 v[232:235], v252, s[4:7], s40 offen
s_add_u32 s40, s39, 12288
buffer_store_dwordx4 v[232:235], v252, s[4:7], s40 offen
s_add_u32 s40, s39, 524288
buffer_store_dwordx4 v[232:235], v5, s[4:7], s40 offen
s_add_u32 s40, s39, 528384
buffer_store_dwordx4 v[232:235], v5, s[4:7], s40 offen
s_add_u32 s40, s39, 532480
buffer_store_dwordx4 v[232:235], v5, s[4:7], s40 offen
s_add_u32 s40, s39, 536576
buffer_store_dwordx4 v[232:235], v5, s[4:7], s40 offen
s_add_u32 s40, s39, 524288
buffer_store_dwordx4 v[232:235], v252, s[4:7], s40 offen
s_add_u32 s40, s39, 528384
buffer_store_dwordx4 v[232:235], v252, s[4:7], s40 offen
s_add_u32 s40, s39, 532480
buffer_store_dwordx4 v[232:235], v252, s[4:7], s40 offen
s_add_u32 s40, s39, 536576
buffer_store_dwordx4 v[232:235], v252, s[4:7], s40 offen
s_cmp_eq_u32 s38, 0
s_cbranch_scc1 L_go_45
s_mul_i32 s40, s35, 0
s_add_u32 s40, s40, 0
v_mov_b32 v237, s40
L_rw_46:
buffer_load_dword v236, v237, s[8:11], 0 offen offset:8 sc1
s_waitcnt vmcnt(0)
v_cmp_ne_u32 vcc, 32, v236
s_cbranch_vccz L_rwo_47
s_sub_u32 s36, s36, 1
s_cbranch_scc1 L_end_att_L
s_sleep 2
s_branch L_rw_46
L_rwo_47:
L_go_45:
s_mov_b32 s20, s58
s_mov_b32 s21, s59
s_mov_b32 s22, 4194304
s_mov_b32 s23, 0x20000
s_lshl_b32 s40, s98, 18
s_lshl_b32 s41, s32, 8
s_add_u32 s40, s40, s41
v_lshlrev_b32 v240, 4, v3
v_lshl_add_u32 v240, v4, 13, v240
v_add_u32 v240, s40, v240
v_add_u32 v241, 4096, v240
s_lshr_b32 s44, s32, 1
s_lshl_b32 s44, s44, 17
s_xor_b32 s45, s44, 0
buffer_load_dwordx4 v[44:47], v240, s[20:23], s45 offen
buffer_load_dwordx4 v[48:51], v240, s[20:23], s45 offen offset:1024
buffer_load_dwordx4 v[52:55], v240, s[20:23], s45 offen offset:2048
buffer_load_dwordx4 v[56:59], v240, s[20:23], s45 offen offset:3072
buffer_load_dwordx4 v[60:63], v241, s[20:23], s45 offen
buffer_load_dwordx4 v[64:67], v241, s[20:23], s45 offen offset:1024
buffer_load_dwordx4 v[68:71], v241, s[20:23], s45 offen offset:2048
buffer_load_dwordx4 v[72:75], v241, s[20:23], s45 offen offset:3072
s_xor_b32 s45, s44, 32768
buffer_load_dwordx4 v[76:79], v240, s[20:23], s45 offen
buffer_load_dwordx4 v[80:83], v240, s[20:23], s45 offen offset:1024
buffer_load_dwordx4 v[84:87], v240, s[20:23], s45 offen offset:2048
buffer_load_dwordx4 v[88:91], v240, s[20:23], s45 offen offset:3072
buffer_load_dwordx4 v[92:95], v241, s[20:23], s45 offen
buffer_load_dwordx4 v[96:99], v241, s[20:23], s45 offen offset:1024
buffer_load_dwordx4 v[100:103], v241, s[20:23], s45 offen offset:2048
buffer_load_dwordx4 v[104:107], v241, s[20:23], s45 offen offset:3072
s_xor_b32 s45, s44, 65536
buffer_load_dwordx4 v[108:111], v240, s[20:23], s45 offen
buffer_load_dwordx4 v[112:115], v240, s[20:23], s45 offen offset:1024
buffer_load_dwordx4 v[116:119], v240, s[20:23], s45 offen offset:2048
buffer_load_dwordx4 v[120:123], v240, s[20:23], s45 offen offset:3072
buffer_load_dwordx4 v[124:127], v241, s[20:23], s45 offen
buffer_load_dwordx4 v[128:131], v241, s[20:23], s45 offen offset:1024
buffer_load_dwordx4 v[132:135], v241, s[20:23], s45 offen offset:2048
buffer_load_dwordx4 v[136:139], v241, s[20:23], s45 offen offset:3072
s_xor_b32 s45, s44, 98304
buffer_load_dwordx4 v[140:143], v240, s[20:23], s45 offen
buffer_load_dwordx4 v[144:147], v240, s[20:23], s45 offen offset:1024
buffer_load_dwordx4 v[148:151], v240, s[20:23], s45 offen offset:2048
buffer_load_dwordx4 v[152:155], v240, s[20:23], s45 offen offset:3072
buffer_load_dwordx4 v[156:159], v241, s[20:23], s45 offen
buffer_load_dwordx4 v[160:163], v241, s[20:23], s45 offen offset:1024
buffer_load_dwordx4 v[164:167], v241, s[20:23], s45 offen offset:2048
buffer_load_dwordx4 v[168:171], v241, s[20:23], s45 offen offset:3072
s_waitcnt vmcnt(24)
s_barrier
s_cmp_lg_u32 s32, 0
s_cbranch_scc1 L_ra_48
v_mov_b32 v236, 1
s_lshl_b32 s40, s35, 5
v_mov_b32 v237, s40
s_mov_b64 exec, 1
buffer_atomic_add v236, v237, s[8:11], 0 offen offset:8
s_mov_b64 exec, -1
L_ra_48:
buffer_store_dword v9, v33, s[4:7], s26 offen sc1
s_add_u32 s26, s26, 4096
buffer_store_dword v9, v33, s[4:7], s26 offen sc1
s_add_u32 s26, s26, 4096
buffer_store_dword v9, v33, s[4:7], s26 offen sc1
s_add_u32 s26, s26, 4096
buffer_store_dword v9, v33, s[4:7], s26 offen sc1
s_add_u32 s26, s26, 4096
v_perm_b32 v172, v48, v44, s46
v_accvgpr_write_b32 a0, v172
v_perm_b32 v173, v56, v52, s46
v_accvgpr_write_b32 a1, v173
v_perm_b32 v174, v64, v60, s46
v_accvgpr_write_b32 a2, v174
v_perm_b32 v175, v72, v68, s46
v_accvgpr_write_b32 a3, v175
v_perm_b32 v176, v48, v44, s47
v_accvgpr_write_b32 a4, v176
v_perm_b32 v177, v56, v52, s47
v_accvgpr_write_b32 a5, v177
v_perm_b32 v178, v64, v60, s47
v_accvgpr_write_b32 a6, v178
v_perm_b32 v179, v72, v68, s47
v_accvgpr_write_b32 a7, v179
v_perm_b32 v172, v49, v45, s46
v_accvgpr_write_b32 a8, v172
v_perm_b32 v173, v57, v53, s46
v_accvgpr_write_b32 a9, v173
v_perm_b32 v174, v65, v61, s46
v_accvgpr_write_b32 a10, v174
v_perm_b32 v175, v73, v69, s46
v_accvgpr_write_b32 a11, v175
v_perm_b32 v176, v49, v45, s47
v_accvgpr_write_b32 a12, v176
v_perm_b32 v177, v57, v53, s47
v_accvgpr_write_b32 a13, v177
v_perm_b32 v178, v65, v61, s47
v_accvgpr_write_b32 a14, v178
v_perm_b32 v179, v73, v69, s47
v_accvgpr_write_b32 a15, v179
v_perm_b32 v172, v50, v46, s46
v_accvgpr_write_b32 a16, v172
v_perm_b32 v173, v58, v54, s46
v_accvgpr_write_b32 a17, v173
v_perm_b32 v174, v66, v62, s46
v_accvgpr_write_b32 a18, v174
v_perm_b32 v175, v74, v70, s46
v_accvgpr_write_b32 a19, v175
v_perm_b32 v176, v50, v46, s47
v_accvgpr_write_b32 a20, v176
v_perm_b32 v177, v58, v54, s47
v_accvgpr_write_b32 a21, v177
v_perm_b32 v178, v66, v62, s47
v_accvgpr_write_b32 a22, v178
v_perm_b32 v179, v74, v70, s47
v_accvgpr_write_b32 a23, v179
v_perm_b32 v172, v51, v47, s46
v_accvgpr_write_b32 a24, v172
v_perm_b32 v173, v59, v55, s46
v_accvgpr_write_b32 a25, v173
v_perm_b32 v174, v67, v63, s46
v_accvgpr_write_b32 a26, v174
v_perm_b32 v175, v75, v71, s46
v_accvgpr_write_b32 a27, v175
v_perm_b32 v176, v51, v47, s47
v_accvgpr_write_b32 a28, v176
v_perm_b32 v177, v59, v55, s47
v_accvgpr_write_b32 a29, v177
v_perm_b32 v178, v67, v63, s47
v_accvgpr_write_b32 a30, v178
v_perm_b32 v179, v75, v71, s47
v_accvgpr_write_b32 a31, v179
s_xor_b32 s45, s44, 131072
buffer_load_dwordx4 v[44:47], v240, s[20:23], s45 offen
buffer_load_dwordx4 v[48:51], v240, s[20:23], s45 offen offset:1024
buffer_load_dwordx4 v[52:55], v240, s[20:23], s45 offen offset:2048
buffer_load_dwordx4 v[56:59], v240, s[20:23], s45 offen offset:3072
buffer_load_dwordx4 v[60:63], v241, s[20:23], s45 offen
buffer_load_dwordx4 v[64:67], v241, s[20:23], s45 offen offset:1024
buffer_load_dwordx4 v[68:71], v241, s[20:23], s45 offen offset:2048
buffer_load_dwordx4 v[72:75], v241, s[20:23], s45 offen offset:3072
s_waitcnt vmcnt(24)
v_perm_b32 v172, v80, v76, s46
v_accvgpr_write_b32 a32, v172
v_perm_b32 v173, v88, v84, s46
v_accvgpr_write_b32 a33, v173
v_perm_b32 v174, v96, v92, s46
v_accvgpr_write_b32 a34, v174
v_perm_b32 v175, v104, v100, s46
v_accvgpr_write_b32 a35, v175
v_perm_b32 v176, v80, v76, s47
v_accvgpr_write_b32 a36, v176
v_perm_b32 v177, v88, v84, s47
v_accvgpr_write_b32 a37, v177
v_perm_b32 v178, v96, v92, s47
v_accvgpr_write_b32 a38, v178
v_perm_b32 v179, v104, v100, s47
v_accvgpr_write_b32 a39, v179
v_perm_b32 v172, v81, v77, s46
v_accvgpr_write_b32 a40, v172
v_perm_b32 v173, v89, v85, s46
v_accvgpr_write_b32 a41, v173
v_perm_b32 v174, v97, v93, s46
v_accvgpr_write_b32 a42, v174
v_perm_b32 v175, v105, v101, s46
v_accvgpr_write_b32 a43, v175
v_perm_b32 v176, v81, v77, s47
v_accvgpr_write_b32 a44, v176
v_perm_b32 v177, v89, v85, s47
v_accvgpr_write_b32 a45, v177
v_perm_b32 v178, v97, v93, s47
v_accvgpr_write_b32 a46, v178
v_perm_b32 v179, v105, v101, s47
v_accvgpr_write_b32 a47, v179
v_perm_b32 v172, v82, v78, s46
v_accvgpr_write_b32 a48, v172
v_perm_b32 v173, v90, v86, s46
v_accvgpr_write_b32 a49, v173
v_perm_b32 v174, v98, v94, s46
v_accvgpr_write_b32 a50, v174
v_perm_b32 v175, v106, v102, s46
v_accvgpr_write_b32 a51, v175
v_perm_b32 v176, v82, v78, s47
v_accvgpr_write_b32 a52, v176
v_perm_b32 v177, v90, v86, s47
v_accvgpr_write_b32 a53, v177
v_perm_b32 v178, v98, v94, s47
v_accvgpr_write_b32 a54, v178
v_perm_b32 v179, v106, v102, s47
v_accvgpr_write_b32 a55, v179
v_perm_b32 v172, v83, v79, s46
v_accvgpr_write_b32 a56, v172
v_perm_b32 v173, v91, v87, s46
v_accvgpr_write_b32 a57, v173
v_perm_b32 v174, v99, v95, s46
v_accvgpr_write_b32 a58, v174
v_perm_b32 v175, v107, v103, s46
v_accvgpr_write_b32 a59, v175
v_perm_b32 v176, v83, v79, s47
v_accvgpr_write_b32 a60, v176
v_perm_b32 v177, v91, v87, s47
v_accvgpr_write_b32 a61, v177
v_perm_b32 v178, v99, v95, s47
v_accvgpr_write_b32 a62, v178
v_perm_b32 v179, v107, v103, s47
v_accvgpr_write_b32 a63, v179
s_xor_b32 s45, s44, 163840
buffer_load_dwordx4 v[76:79], v240, s[20:23], s45 offen
buffer_load_dwordx4 v[80:83], v240, s[20:23], s45 offen offset:1024
buffer_load_dwordx4 v[84:87], v240, s[20:23], s45 offen offset:2048
buffer_load_dwordx4 v[88:91], v240, s[20:23], s45 offen offset:3072
buffer_load_dwordx4 v[92:95], v241, s[20:23], s45 offen
buffer_load_dwordx4 v[96:99], v241, s[20:23], s45 offen offset:1024
buffer_load_dwordx4 v[100:103], v241, s[20:23], s45 offen offset:2048
buffer_load_dwordx4 v[104:107], v241, s[20:23], s45 offen offset:3072
s_waitcnt vmcnt(24)
v_perm_b32 v172, v112, v108, s46
v_accvgpr_write_b32 a64, v172
v_perm_b32 v173, v120, v116, s46
v_accvgpr_write_b32 a65, v173
v_perm_b32 v174, v128, v124, s46
v_accvgpr_write_b32 a66, v174
v_perm_b32 v175, v136, v132, s46
v_accvgpr_write_b32 a67, v175
v_perm_b32 v176, v112, v108, s47
v_accvgpr_write_b32 a68, v176
v_perm_b32 v177, v120, v116, s47
v_accvgpr_write_b32 a69, v177
v_perm_b32 v178, v128, v124, s47
v_accvgpr_write_b32 a70, v178
v_perm_b32 v179, v136, v132, s47
v_accvgpr_write_b32 a71, v179
v_perm_b32 v172, v113, v109, s46
v_accvgpr_write_b32 a72, v172
v_perm_b32 v173, v121, v117, s46
v_accvgpr_write_b32 a73, v173
v_perm_b32 v174, v129, v125, s46
v_accvgpr_write_b32 a74, v174
v_perm_b32 v175, v137, v133, s46
v_accvgpr_write_b32 a75, v175
v_perm_b32 v176, v113, v109, s47
v_accvgpr_write_b32 a76, v176
v_perm_b32 v177, v121, v117, s47
v_accvgpr_write_b32 a77, v177
v_perm_b32 v178, v129, v125, s47
v_accvgpr_write_b32 a78, v178
v_perm_b32 v179, v137, v133, s47
v_accvgpr_write_b32 a79, v179
v_perm_b32 v172, v114, v110, s46
v_accvgpr_write_b32 a80, v172
v_perm_b32 v173, v122, v118, s46
v_accvgpr_write_b32 a81, v173
v_perm_b32 v174, v130, v126, s46
v_accvgpr_write_b32 a82, v174
v_perm_b32 v175, v138, v134, s46
v_accvgpr_write_b32 a83, v175
v_perm_b32 v176, v114, v110, s47
v_accvgpr_write_b32 a84, v176
v_perm_b32 v177, v122, v118, s47
v_accvgpr_write_b32 a85, v177
v_perm_b32 v178, v130, v126, s47
v_accvgpr_write_b32 a86, v178
v_perm_b32 v179, v138, v134, s47
v_accvgpr_write_b32 a87, v179
v_perm_b32 v172, v115, v111, s46
v_accvgpr_write_b32 a88, v172
v_perm_b32 v173, v123, v119, s46
v_accvgpr_write_b32 a89, v173
v_perm_b32 v174, v131, v127, s46
v_accvgpr_write_b32 a90, v174
v_perm_b32 v175, v139, v135, s46
v_accvgpr_write_b32 a91, v175
v_perm_b32 v176, v115, v111, s47
v_accvgpr_write_b32 a92, v176
v_perm_b32 v177, v123, v119, s47
v_accvgpr_write_b32 a93, v177
v_perm_b32 v178, v131, v127, s47
v_accvgpr_write_b32 a94, v178
v_perm_b32 v179, v139, v135, s47
v_accvgpr_write_b32 a95, v179
s_xor_b32 s45, s44, 196608
buffer_load_dwordx4 v[108:111], v240, s[20:23], s45 offen
buffer_load_dwordx4 v[112:115], v240, s[20:23], s45 offen offset:1024
buffer_load_dwordx4 v[116:119], v240, s[20:23], s45 offen offset:2048
buffer_load_dwordx4 v[120:123], v240, s[20:23], s45 offen offset:3072
buffer_load_dwordx4 v[124:127], v241, s[20:23], s45 offen
buffer_load_dwordx4 v[128:131], v241, s[20:23], s45 offen offset:1024
buffer_load_dwordx4 v[132:135], v241, s[20:23], s45 offen offset:2048
buffer_load_dwordx4 v[136:139], v241, s[20:23], s45 offen offset:3072
s_waitcnt vmcnt(24)
v_perm_b32 v172, v144, v140, s46
v_accvgpr_write_b32 a96, v172
v_perm_b32 v173, v152, v148, s46
v_accvgpr_write_b32 a97, v173
v_perm_b32 v174, v160, v156, s46
v_accvgpr_write_b32 a98, v174
v_perm_b32 v175, v168, v164, s46
v_accvgpr_write_b32 a99, v175
v_perm_b32 v176, v144, v140, s47
v_accvgpr_write_b32 a100, v176
v_perm_b32 v177, v152, v148, s47
v_accvgpr_write_b32 a101, v177
v_perm_b32 v178, v160, v156, s47
v_accvgpr_write_b32 a102, v178
v_perm_b32 v179, v168, v164, s47
v_accvgpr_write_b32 a103, v179
v_perm_b32 v172, v145, v141, s46
v_accvgpr_write_b32 a104, v172
v_perm_b32 v173, v153, v149, s46
v_accvgpr_write_b32 a105, v173
v_perm_b32 v174, v161, v157, s46
v_accvgpr_write_b32 a106, v174
v_perm_b32 v175, v169, v165, s46
v_accvgpr_write_b32 a107, v175
v_perm_b32 v176, v145, v141, s47
v_accvgpr_write_b32 a108, v176
v_perm_b32 v177, v153, v149, s47
v_accvgpr_write_b32 a109, v177
v_perm_b32 v178, v161, v157, s47
v_accvgpr_write_b32 a110, v178
v_perm_b32 v179, v169, v165, s47
v_accvgpr_write_b32 a111, v179
v_perm_b32 v172, v146, v142, s46
v_accvgpr_write_b32 a112, v172
v_perm_b32 v173, v154, v150, s46
v_accvgpr_write_b32 a113, v173
v_perm_b32 v174, v162, v158, s46
v_accvgpr_write_b32 a114, v174
v_perm_b32 v175, v170, v166, s46
v_accvgpr_write_b32 a115, v175
v_perm_b32 v176, v146, v142, s47
v_accvgpr_write_b32 a116, v176
v_perm_b32 v177, v154, v150, s47
v_accvgpr_write_b32 a117, v177
v_perm_b32 v178, v162, v158, s47
v_accvgpr_write_b32 a118, v178
v_perm_b32 v179, v170, v166, s47
v_accvgpr_write_b32 a119, v179
v_perm_b32 v172, v147, v143, s46
v_accvgpr_write_b32 a120, v172
v_perm_b32 v173, v155, v151, s46
v_accvgpr_write_b32 a121, v173
v_perm_b32 v174, v163, v159, s46
v_accvgpr_write_b32 a122, v174
v_perm_b32 v175, v171, v167, s46
v_accvgpr_write_b32 a123, v175
v_perm_b32 v176, v147, v143, s47
v_accvgpr_write_b32 a124, v176
v_perm_b32 v177, v155, v151, s47
v_accvgpr_write_b32 a125, v177
v_perm_b32 v178, v163, v159, s47
v_accvgpr_write_b32 a126, v178
v_perm_b32 v179, v171, v167, s47
v_accvgpr_write_b32 a127, v179
s_xor_b32 s45, s44, 229376
buffer_load_dwordx4 v[140:143], v240, s[20:23], s45 offen
buffer_load_dwordx4 v[144:147], v240, s[20:23], s45 offen offset:1024
buffer_load_dwordx4 v[148:151], v240, s[20:23], s45 offen offset:2048
buffer_load_dwordx4 v[152:155], v240, s[20:23], s45 offen offset:3072
buffer_load_dwordx4 v[156:159], v241, s[20:23], s45 offen
buffer_load_dwordx4 v[160:163], v241, s[20:23], s45 offen offset:1024
buffer_load_dwordx4 v[164:167], v241, s[20:23], s45 offen offset:2048
buffer_load_dwordx4 v[168:171], v241, s[20:23], s45 offen offset:3072
s_waitcnt vmcnt(24)
v_perm_b32 v172, v48, v44, s46
v_accvgpr_write_b32 a128, v172
v_perm_b32 v173, v56, v52, s46
v_accvgpr_write_b32 a129, v173
v_perm_b32 v174, v64, v60, s46
v_accvgpr_write_b32 a130, v174
v_perm_b32 v175, v72, v68, s46
v_accvgpr_write_b32 a131, v175
v_perm_b32 v176, v48, v44, s47
v_accvgpr_write_b32 a132, v176
v_perm_b32 v177, v56, v52, s47
v_accvgpr_write_b32 a133, v177
v_perm_b32 v178, v64, v60, s47
v_accvgpr_write_b32 a134, v178
v_perm_b32 v179, v72, v68, s47
v_accvgpr_write_b32 a135, v179
v_perm_b32 v172, v49, v45, s46
v_accvgpr_write_b32 a136, v172
v_perm_b32 v173, v57, v53, s46
v_accvgpr_write_b32 a137, v173
v_perm_b32 v174, v65, v61, s46
v_accvgpr_write_b32 a138, v174
v_perm_b32 v175, v73, v69, s46
v_accvgpr_write_b32 a139, v175
v_perm_b32 v176, v49, v45, s47
v_accvgpr_write_b32 a140, v176
v_perm_b32 v177, v57, v53, s47
v_accvgpr_write_b32 a141, v177
v_perm_b32 v178, v65, v61, s47
v_accvgpr_write_b32 a142, v178
v_perm_b32 v179, v73, v69, s47
v_accvgpr_write_b32 a143, v179
v_perm_b32 v172, v50, v46, s46
v_accvgpr_write_b32 a144, v172
v_perm_b32 v173, v58, v54, s46
v_accvgpr_write_b32 a145, v173
v_perm_b32 v174, v66, v62, s46
v_accvgpr_write_b32 a146, v174
v_perm_b32 v175, v74, v70, s46
v_accvgpr_write_b32 a147, v175
v_perm_b32 v176, v50, v46, s47
v_accvgpr_write_b32 a148, v176
v_perm_b32 v177, v58, v54, s47
v_accvgpr_write_b32 a149, v177
v_perm_b32 v178, v66, v62, s47
v_accvgpr_write_b32 a150, v178
v_perm_b32 v179, v74, v70, s47
v_accvgpr_write_b32 a151, v179
v_perm_b32 v172, v51, v47, s46
v_accvgpr_write_b32 a152, v172
v_perm_b32 v173, v59, v55, s46
v_accvgpr_write_b32 a153, v173
v_perm_b32 v174, v67, v63, s46
v_accvgpr_write_b32 a154, v174
v_perm_b32 v175, v75, v71, s46
v_accvgpr_write_b32 a155, v175
v_perm_b32 v176, v51, v47, s47
v_accvgpr_write_b32 a156, v176
v_perm_b32 v177, v59, v55, s47
v_accvgpr_write_b32 a157, v177
v_perm_b32 v178, v67, v63, s47
v_accvgpr_write_b32 a158, v178
v_perm_b32 v179, v75, v71, s47
v_accvgpr_write_b32 a159, v179
s_waitcnt vmcnt(16)
v_perm_b32 v172, v80, v76, s46
v_accvgpr_write_b32 a160, v172
v_perm_b32 v173, v88, v84, s46
v_accvgpr_write_b32 a161, v173
v_perm_b32 v174, v96, v92, s46
v_accvgpr_write_b32 a162, v174
v_perm_b32 v175, v104, v100, s46
v_accvgpr_write_b32 a163, v175
v_perm_b32 v176, v80, v76, s47
v_accvgpr_write_b32 a164, v176
v_perm_b32 v177, v88, v84, s47
v_accvgpr_write_b32 a165, v177
v_perm_b32 v178, v96, v92, s47
v_accvgpr_write_b32 a166, v178
v_perm_b32 v179, v104, v100, s47
v_accvgpr_write_b32 a167, v179
v_perm_b32 v172, v81, v77, s46
v_accvgpr_write_b32 a168, v172
v_perm_b32 v173, v89, v85, s46
v_accvgpr_write_b32 a169, v173
v_perm_b32 v174, v97, v93, s46
v_accvgpr_write_b32 a170, v174
v_perm_b32 v175, v105, v101, s46
v_accvgpr_write_b32 a171, v175
v_perm_b32 v176, v81, v77, s47
v_accvgpr_write_b32 a172, v176
v_perm_b32 v177, v89, v85, s47
v_accvgpr_write_b32 a173, v177
v_perm_b32 v178, v97, v93, s47
v_accvgpr_write_b32 a174, v178
v_perm_b32 v179, v105, v101, s47
v_accvgpr_write_b32 a175, v179
v_perm_b32 v172, v82, v78, s46
v_accvgpr_write_b32 a176, v172
v_perm_b32 v173, v90, v86, s46
v_accvgpr_write_b32 a177, v173
v_perm_b32 v174, v98, v94, s46
v_accvgpr_write_b32 a178, v174
v_perm_b32 v175, v106, v102, s46
v_accvgpr_write_b32 a179, v175
v_perm_b32 v176, v82, v78, s47
v_accvgpr_write_b32 a180, v176
v_perm_b32 v177, v90, v86, s47
v_accvgpr_write_b32 a181, v177
v_perm_b32 v178, v98, v94, s47
v_accvgpr_write_b32 a182, v178
v_perm_b32 v179, v106, v102, s47
v_accvgpr_write_b32 a183, v179
v_perm_b32 v172, v83, v79, s46
v_accvgpr_write_b32 a184, v172
v_perm_b32 v173, v91, v87, s46
v_accvgpr_write_b32 a185, v173
v_perm_b32 v174, v99, v95, s46
v_accvgpr_write_b32 a186, v174
v_perm_b32 v175, v107, v103, s46
v_accvgpr_write_b32 a187, v175
v_perm_b32 v176, v83, v79, s47
v_accvgpr_write_b32 a188, v176
v_perm_b32 v177, v91, v87, s47
v_accvgpr_write_b32 a189, v177
v_perm_b32 v178, v99, v95, s47
v_accvgpr_write_b32 a190, v178
v_perm_b32 v179, v107, v103, s47
v_accvgpr_write_b32 a191, v179
s_waitcnt vmcnt(8)
v_perm_b32 v172, v112, v108, s46
v_accvgpr_write_b32 a192, v172
v_perm_b32 v173, v120, v116, s46
v_accvgpr_write_b32 a193, v173
v_perm_b32 v174, v128, v124, s46
v_accvgpr_write_b32 a194, v174
v_perm_b32 v175, v136, v132, s46
v_accvgpr_write_b32 a195, v175
v_perm_b32 v176, v112, v108, s47
v_accvgpr_write_b32 a196, v176
v_perm_b32 v177, v120, v116, s47
v_accvgpr_write_b32 a197, v177
v_perm_b32 v178, v128, v124, s47
v_accvgpr_write_b32 a198, v178
v_perm_b32 v179, v136, v132, s47
v_accvgpr_write_b32 a199, v179
v_perm_b32 v172, v113, v109, s46
v_accvgpr_write_b32 a200, v172
v_perm_b32 v173, v121, v117, s46
v_accvgpr_write_b32 a201, v173
v_perm_b32 v174, v129, v125, s46
v_accvgpr_write_b32 a202, v174
v_perm_b32 v175, v137, v133, s46
v_accvgpr_write_b32 a203, v175
v_perm_b32 v176, v113, v109, s47
v_accvgpr_write_b32 a204, v176
v_perm_b32 v177, v121, v117, s47
v_accvgpr_write_b32 a205, v177
v_perm_b32 v178, v129, v125, s47
v_accvgpr_write_b32 a206, v178
v_perm_b32 v179, v137, v133, s47
v_accvgpr_write_b32 a207, v179
v_perm_b32 v172, v114, v110, s46
v_accvgpr_write_b32 a208, v172
v_perm_b32 v173, v122, v118, s46
v_accvgpr_write_b32 a209, v173
v_perm_b32 v174, v130, v126, s46
v_accvgpr_write_b32 a210, v174
v_perm_b32 v175, v138, v134, s46
v_accvgpr_write_b32 a211, v175
v_perm_b32 v176, v114, v110, s47
v_accvgpr_write_b32 a212, v176
v_perm_b32 v177, v122, v118, s47
v_accvgpr_write_b32 a213, v177
v_perm_b32 v178, v130, v126, s47
v_accvgpr_write_b32 a214, v178
v_perm_b32 v179, v138, v134, s47
v_accvgpr_write_b32 a215, v179
v_perm_b32 v172, v115, v111, s46
v_accvgpr_write_b32 a216, v172
v_perm_b32 v173, v123, v119, s46
v_accvgpr_write_b32 a217, v173
v_perm_b32 v174, v131, v127, s46
v_accvgpr_write_b32 a218, v174
v_perm_b32 v175, v139, v135, s46
v_accvgpr_write_b32 a219, v175
v_perm_b32 v176, v115, v111, s47
v_accvgpr_write_b32 a220, v176
v_perm_b32 v177, v123, v119, s47
v_accvgpr_write_b32 a221, v177
v_perm_b32 v178, v131, v127, s47
v_accvgpr_write_b32 a222, v178
v_perm_b32 v179, v139, v135, s47
v_accvgpr_write_b32 a223, v179
s_waitcnt vmcnt(0)
v_perm_b32 v172, v144, v140, s46
v_accvgpr_write_b32 a224, v172
v_perm_b32 v173, v152, v148, s46
v_accvgpr_write_b32 a225, v173
v_perm_b32 v174, v160, v156, s46
v_accvgpr_write_b32 a226, v174
v_perm_b32 v175, v168, v164, s46
v_accvgpr_write_b32 a227, v175
v_perm_b32 v176, v144, v140, s47
v_accvgpr_write_b32 a228, v176
v_perm_b32 v177, v152, v148, s47
v_accvgpr_write_b32 a229, v177
v_perm_b32 v178, v160, v156, s47
v_accvgpr_write_b32 a230, v178
v_perm_b32 v179, v168, v164, s47
v_accvgpr_write_b32 a231, v179
v_perm_b32 v172, v145, v141, s46
v_accvgpr_write_b32 a232, v172
v_perm_b32 v173, v153, v149, s46
v_accvgpr_write_b32 a233, v173
v_perm_b32 v174, v161, v157, s46
v_accvgpr_write_b32 a234, v174
v_perm_b32 v175, v169, v165, s46
v_accvgpr_write_b32 a235, v175
v_perm_b32 v176, v145, v141, s47
v_accvgpr_write_b32 a236, v176
v_perm_b32 v177, v153, v149, s47
v_accvgpr_write_b32 a237, v177
v_perm_b32 v178, v161, v157, s47
v_accvgpr_write_b32 a238, v178
v_perm_b32 v179, v169, v165, s47
v_accvgpr_write_b32 a239, v179
v_perm_b32 v172, v146, v142, s46
v_accvgpr_write_b32 a240, v172
v_perm_b32 v173, v154, v150, s46
v_accvgpr_write_b32 a241, v173
v_perm_b32 v174, v162, v158, s46
v_accvgpr_write_b32 a242, v174
v_perm_b32 v175, v170, v166, s46
v_accvgpr_write_b32 a243, v175
v_perm_b32 v176, v146, v142, s47
v_accvgpr_write_b32 a244, v176
v_perm_b32 v177, v154, v150, s47
v_accvgpr_write_b32 a245, v177
v_perm_b32 v178, v162, v158, s47
v_accvgpr_write_b32 a246, v178
v_perm_b32 v179, v170, v166, s47
v_accvgpr_write_b32 a247, v179
v_perm_b32 v172, v147, v143, s46
v_accvgpr_write_b32 a248, v172
v_perm_b32 v173, v155, v151, s46
v_accvgpr_write_b32 a249, v173
v_perm_b32 v174, v163, v159, s46
v_accvgpr_write_b32 a250, v174
v_perm_b32 v175, v171, v167, s46
v_accvgpr_write_b32 a251, v175
v_perm_b32 v176, v147, v143, s47
v_accvgpr_write_b32 a252, v176
v_perm_b32 v177, v155, v151, s47
v_accvgpr_write_b32 a253, v177
v_perm_b32 v178, v163, v159, s47
v_accvgpr_write_b32 a254, v178
v_perm_b32 v179, v171, v167, s47
v_accvgpr_write_b32 a255, v179
s_mul_i32 s40, s35, 32
s_add_u32 s40, s40, 0
v_mov_b32 v237, s40
L_rw_49:
buffer_load_dword v236, v237, s[8:11], 0 offen offset:8 sc1
s_waitcnt vmcnt(0)
v_cmp_ne_u32 vcc, 32, v236
s_cbranch_vccz L_rwo_50
s_sub_u32 s36, s36, 1
s_cbranch_scc1 L_end_att_L
s_sleep 2
s_branch L_rw_49
L_rwo_50:
v_mov_b32 v140, 0
v_mov_b32 v141, 0
v_mov_b32 v142, 0
v_mov_b32 v143, 0
v_mov_b32 v144, 0
v_mov_b32 v145, 0
v_mov_b32 v146, 0
v_mov_b32 v147, 0
v_mov_b32 v148, 0
v_mov_b32 v149, 0
v_mov_b32 v150, 0
v_mov_b32 v151, 0
v_mov_b32 v152, 0
v_mov_b32 v153, 0
v_mov_b32 v154, 0
v_mov_b32 v155, 0
v_and_b32 v38, 124, v38
buffer_load_dword v24, v38, s[4:7], s79 offen sc1
s_waitcnt vmcnt(0)
v_cmp_eq_u32 vcc, 0, v24
s_nop 0
s_and_b32 s40, vcc_lo, 0x0ff00ff0
s_cbranch_scc1 L_sp_51
L_spo_52:
s_lshl_b32 s42, s32, 11
s_add_u32 s42, s42, s80
s_add_u32 m0, s42, 0
s_add_u32 s41, s77, 0
buffer_load_dwordx4 v2, s[4:7], s41 offen offset:0 sc1 lds
buffer_load_dwordx4 v2, s[4:7], s41 offen offset:1024 sc1 lds
s_add_u32 m0, s42, 8192
s_add_u32 s41, s77, 33554432
buffer_load_dwordx4 v2, s[4:7], s41 offen offset:0 sc1 lds
buffer_load_dwordx4 v2, s[4:7], s41 offen offset:1024 sc1 lds
s_add_u32 m0, s42, 16384
s_add_u32 s41, s77, 67108864
buffer_load_dwordx4 v2, s[4:7], s41 offen offset:0 sc1 lds
buffer_load_dwordx4 v2, s[4:7], s41 offen offset:1024 sc1 lds
s_add_u32 m0, s42, 24576
s_add_u32 s41, s77, 8192
buffer_load_dwordx4 v2, s[4:7], s41 offen offset:0 sc1 lds
buffer_load_dwordx4 v2, s[4:7], s41 offen offset:1024 sc1 lds
s_add_u32 m0, s42, 32768
s_add_u32 s41, s77, 33562624
buffer_load_dwordx4 v2, s[4:7], s41 offen offset:0 sc1 lds
buffer_load_dwordx4 v2, s[4:7], s41 offen offset:1024 sc1 lds
s_add_u32 m0, s42, 40960
s_add_u32 s41, s77, 67117056
buffer_load_dwordx4 v2, s[4:7], s41 offen offset:0 sc1 lds
buffer_load_dwordx4 v2, s[4:7], s41 offen offset:1024 sc1 lds
s_add_u32 s77, s77, 524288
s_add_u32 s79, s79, 4096
s_add_u32 s41, s37, 0
s_bfe_u32 s25, s41, 0x10003
s_and_b32 s41, s41, 7
s_lshl_b32 s41, s41, 17
s_add_u32 s78, s41, s24
buffer_load_dword v24, v38, s[4:7], s79 offen sc1
buffer_load_dwordx4 v[92:95], v21, s[4:7], s78 offen offset:0 sc1
buffer_load_dwordx4 v[96:99], v21, s[4:7], s78 offen offset:512 sc1
buffer_load_dwordx4 v[100:103], v21, s[4:7], s78 offen offset:1024 sc1
buffer_load_dwordx4 v[104:107], v21, s[4:7], s78 offen offset:1536 sc1
s_mov_b32 s27, 0
s_waitcnt vmcnt(5)
s_barrier
L_att_loop_L:
v_add_u32 v246, s80, v27
v_add_u32 v247, s80, v20
s_xor_b32 s80, s80, 49152
ds_read_b128 v[44:47], v247 offset:0
ds_read_b128 v[60:63], v246 offset:8192
ds_read_b128 v[64:67], v246 offset:9216
ds_read_b128 v[48:51], v247 offset:2048
ds_read_b128 v[68:71], v246 offset:10240
ds_read_b128 v[72:75], v246 offset:11264
ds_read_b128 v[52:55], v247 offset:4096
ds_read_b128 v[76:79], v246 offset:12288
ds_read_b128 v[80:83], v246 offset:13312
ds_read_b128 v[56:59], v247 offset:6144
ds_read_b128 v[84:87], v246 offset:14336
ds_read_b128 v[88:91], v246 offset:15360
s_waitcnt lgkmcnt(9)
v_mfma_f32_16x16x32_bf16 v[156:159], v[60:63], v[44:47], 0
v_mfma_f32_16x16x32_bf16 v[160:163], v[64:67], v[44:47], 0
s_waitcnt lgkmcnt(6)
v_mfma_f32_16x16x32_bf16 v[156:159], v[68:71], v[48:51], v[156:159]
v_mfma_f32_16x16x32_bf16 v[160:163], v[72:75], v[48:51], v[160:163]
s_waitcnt lgkmcnt(3)
v_mfma_f32_16x16x32_bf16 v[156:159], v[76:79], v[52:55], v[156:159]
v_mfma_f32_16x16x32_bf16 v[160:163], v[80:83], v[52:55], v[160:163]
s_waitcnt lgkmcnt(0)
v_mfma_f32_16x16x32_bf16 v[156:159], v[84:87], v[56:59], v[156:159]
v_mfma_f32_16x16x32_bf16 v[160:163], v[88:91], v[56:59], v[160:163]
ds_read_b128 v[108:111], v246 offset:16384
ds_read_b128 v[112:115], v246 offset:17408
ds_read_b128 v[116:119], v246 offset:18432
ds_read_b128 v[120:123], v246 offset:19456
ds_read_b128 v[124:127], v246 offset:20480
ds_read_b128 v[128:131], v246 offset:21504
ds_read_b128 v[132:135], v246 offset:22528
ds_read_b128 v[136:139], v246 offset:23552
v_cndmask_b32 v156, v25, v156, s[82:83]
v_cndmask_b32 v157, v25, v157, s[84:85]
v_cndmask_b32 v158, v25, v158, s[86:87]
v_cndmask_b32 v159, v25, v159, s[88:89]
v_cndmask_b32 v160, v25, v160, s[90:91]
v_cndmask_b32 v161, v25, v161, s[92:93]
v_cndmask_b32 v162, v25, v162, s[94:95]
v_cndmask_b32 v163, v25, v163, s[96:97]
v_max3_f32 v248, v156, v157, v158
v_max3_f32 v249, v159, v160, v161
v_max3_f32 v248, v248, v162, v163
s_cmp_eq_u32 s27, 1
s_cbranch_scc1 L_kv_56
s_cmp_lt_u32 s37, 2
s_cbranch_scc1 L_km_53
s_waitcnt vmcnt(2)
L_kmo_54:
v_mfma_f32_16x16x32_bf16 v[164:167], v[92:95], v[44:47], 0
v_bitop3_b32 v168, v92, v93, s25 bitop3:0x7e
v_bitop3_b32 v169, v94, v95, s25 bitop3:0x7e
v_bitop3_b32 v170, v96, v97, s25 bitop3:0x7e
v_mfma_f32_16x16x32_bf16 v[164:167], v[96:99], v[48:51], v[164:167]
v_bitop3_b32 v171, v98, v99, s25 bitop3:0x7e
v_bitop3_b32 v172, v100, v101, s25 bitop3:0x7e
v_bitop3_b32 v173, v102, v103, s25 bitop3:0x7e
v_mfma_f32_16x16x32_bf16 v[164:167], v[100:103], v[52:55], v[164:167]
v_bitop3_b32 v174, v104, v105, s25 bitop3:0x7e
v_bitop3_b32 v175, v106, v107, s25 bitop3:0x7e
v_or3_b32 v168, v168, v169, v170
v_mfma_f32_16x16x32_bf16 v[164:167], v[104:107], v[56:59], v[164:167]
v_or3_b32 v168, v168, v171, v172
v_or3_b32 v168, v168, v173, v174
v_or3_b32 v168, v168, v175, v175
v_and_b32 v168, 1, v168
v_cmp_ne_u32 vcc, 0, v168
s_cbranch_vccnz L_km2_55
L_kj_57:
s_nop 6
v_max3_f32 v249, v249, v164, v165
v_max_f32 v248, v248, v249
v_cmp_gt_f32 vcc, abs(v248), v39
s_cbranch_vccnz L_smx_59
L_smb_60:
v_mul_f32 v156, s81, v156
v_mul_f32 v157, s81, v157
v_mul_f32 v158, s81, v158
v_mul_f32 v159, s81, v159
v_mul_f32 v160, s81, v160
v_mul_f32 v161, s81, v161
v_mul_f32 v162, s81, v162
v_mul_f32 v163, s81, v163
v_mul_f32 v164, s81, v164
v_mul_f32 v165, s81, v165
s_cmp_eq_u32 s27, 1
s_cbranch_scc1 L_vx_58
buffer_load_dwordx2 v[140:141], v22, s[4:7], s78 offen offset:2048 sc1
buffer_load_dwordx2 v[144:145], v22, s[4:7], s78 offen offset:2560 sc1
buffer_load_dwordx2 v[148:149], v22, s[4:7], s78 offen offset:3072 sc1
buffer_load_dwordx2 v[152:153], v22, s[4:7], s78 offen offset:3584 sc1
L_vx_58:
v_exp_f32 v156, v156
v_exp_f32 v157, v157
v_exp_f32 v158, v158
v_exp_f32 v159, v159
v_exp_f32 v160, v160
v_exp_f32 v161, v161
v_exp_f32 v162, v162
v_exp_f32 v163, v163
v_exp_f32 v164, v164
v_exp_f32 v165, v165
v_cvt_pk_bf16_f32 v40, v156, v160
v_cvt_pk_bf16_f32 v41, v157, v161
v_cvt_pk_bf16_f32 v42, v158, v162
v_cvt_pk_bf16_f32 v43, v159, v163
v_cvt_pk_bf16_f32 v35, v164, v165
s_nop 0
v_mfma_f32_16x16x32_bf16 v[200:203], v[28:31], v[40:43], 0
v_mfma_f32_16x16x32_bf16 v[200:203], v[28:31], v[34:37], v[200:203]
s_waitcnt lgkmcnt(6)
v_mfma_f32_16x16x32_bf16 v[168:171], v[108:111], v[40:43], 0
v_mfma_f32_16x16x32_bf16 v[172:175], v[112:115], v[40:43], 0
s_waitcnt lgkmcnt(4)
v_mfma_f32_16x16x32_bf16 v[176:179], v[116:119], v[40:43], 0
v_mfma_f32_16x16x32_bf16 v[180:183], v[120:123], v[40:43], 0
s_waitcnt lgkmcnt(2)
v_mfma_f32_16x16x32_bf16 v[184:187], v[124:127], v[40:43], 0
v_mfma_f32_16x16x32_bf16 v[188:191], v[128:131], v[40:43], 0
s_waitcnt lgkmcnt(0)
v_mfma_f32_16x16x32_bf16 v[192:195], v[132:135], v[40:43], 0
v_rcp_f32 v200, v200
v_mfma_f32_16x16x32_bf16 v[196:199], v[136:139], v[40:43], 0
v_mul_f32 v164, v164, v200
v_mul_f32 v165, v165, v200
v_cvt_pk_bf16_f32 v32, v164, v165
v_cvt_pk_bf16_f32 v35, v164, v165
v_mul_f32 v168, v168, v200
v_mul_f32 v169, v169, v200
v_mul_f32 v170, v170, v200
v_mul_f32 v171, v171, v200
v_mul_f32 v172, v172, v200
v_mul_f32 v173, v173, v200
v_mul_f32 v174, v174, v200
v_mul_f32 v175, v175, v200
v_mul_f32 v176, v176, v200
v_mul_f32 v177, v177, v200
v_mul_f32 v178, v178, v200
v_mul_f32 v179, v179, v200
v_mul_f32 v180, v180, v200
v_mul_f32 v181, v181, v200
v_mul_f32 v182, v182, v200
v_mul_f32 v183, v183, v200
v_mul_f32 v184, v184, v200
v_mul_f32 v185, v185, v200
v_mul_f32 v186, v186, v200
v_mul_f32 v187, v187, v200
v_mul_f32 v188, v188, v200
v_mul_f32 v189, v189, v200
v_mul_f32 v190, v190, v200
v_mul_f32 v191, v191, v200
v_mul_f32 v192, v192, v200
v_mul_f32 v193, v193, v200
v_mul_f32 v194, v194, v200
v_mul_f32 v195, v195, v200
v_mul_f32 v196, v196, v200
v_mul_f32 v197, v197, v200
v_mul_f32 v198, v198, v200
v_mul_f32 v199, v199, v200
s_waitcnt vmcnt(2)
s_cmp_eq_u32 s27, 1
s_cbranch_scc1 L_vy_63
L_vmo_62:
s_waitcnt vmcnt(0)
L_vy_63:
v_bitop3_b32 v60, v140, v141, s25 bitop3:0x7e
v_bitop3_b32 v61, v144, v145, s25 bitop3:0x7e
v_bitop3_b32 v62, v148, v149, s25 bitop3:0x7e
v_bitop3_b32 v63, v152, v153, s25 bitop3:0x7e
v_or3_b32 v60, v60, v61, v62
v_or3_b32 v60, v60, v63, v63
v_and_b32 v60, 1, v60
v_cmp_ne_u32 vcc, 0, v60
s_cbranch_vccnz L_vm_61
v_mfma_f32_16x16x32_bf16 v[168:171], v[140:143], v[32:35], v[168:171]
v_mfma_f32_16x16x32_bf16 v[172:175], v[140:143], v[34:37], v[172:175]
v_mfma_f32_16x16x32_bf16 v[176:179], v[144:147], v[32:35], v[176:179]
v_mfma_f32_16x16x32_bf16 v[180:183], v[144:147], v[34:37], v[180:183]
v_mfma_f32_16x16x32_bf16 v[184:187], v[148:151], v[32:35], v[184:187]
v_mfma_f32_16x16x32_bf16 v[188:191], v[148:151], v[34:37], v[188:191]
v_mfma_f32_16x16x32_bf16 v[192:195], v[152:155], v[32:35], v[192:195]
s_nop 2
v_cvt_pk_bf16_f32 v204, v168, v172
v_cvt_pk_bf16_f32 v205, v169, v173
v_mfma_f32_16x16x32_bf16 v[196:199], v[152:155], v[34:37], v[196:199]
v_cvt_pk_bf16_f32 v206, v170, v174
v_cvt_pk_bf16_f32 v207, v171, v175
ds_write_b128 v26, v[204:207] offset:0
s_nop 0
v_mfma_f32_16x16x32_bf16 v[44:47], v[204:207], a[0:3], 0
v_cvt_pk_bf16_f32 v208, v176, v180
v_cvt_pk_bf16_f32 v209, v177, v181
v_mfma_f32_16x16x32_bf16 v[48:51], v[204:207], a[4:7], 0
v_cvt_pk_bf16_f32 v210, v178, v182
v_cvt_pk_bf16_f32 v211, v179, v183
v_mfma_f32_16x16x32_bf16 v[52:55], v[204:207], a[8:11], 0
ds_write_b128 v26, v[208:211] offset:1024
v_mfma_f32_16x16x32_bf16 v[56:59], v[204:207], a[12:15], 0
v_cvt_pk_bf16_f32 v212, v184, v188
v_cvt_pk_bf16_f32 v213, v185, v189
v_mfma_f32_16x16x32_bf16 v[60:63], v[204:207], a[16:19], 0
v_cvt_pk_bf16_f32 v214, v186, v190
v_cvt_pk_bf16_f32 v215, v187, v191
v_mfma_f32_16x16x32_bf16 v[64:67], v[204:207], a[20:23], 0
ds_write_b128 v26, v[212:215] offset:2048
v_mfma_f32_16x16x32_bf16 v[68:71], v[204:207], a[24:27], 0
v_cvt_pk_bf16_f32 v216, v192, v196
v_cvt_pk_bf16_f32 v217, v193, v197
v_mfma_f32_16x16x32_bf16 v[72:75], v[204:207], a[28:31], 0
v_cvt_pk_bf16_f32 v218, v194, v198
v_mfma_f32_16x16x32_bf16 v[44:47], v[208:211], a[32:35], v[44:47]
v_cvt_pk_bf16_f32 v219, v195, v199
v_mfma_f32_16x16x32_bf16 v[48:51], v[208:211], a[36:39], v[48:51]
ds_write_b128 v26, v[216:219] offset:3072
v_mfma_f32_16x16x32_bf16 v[52:55], v[208:211], a[40:43], v[52:55]
v_xor_b32 v245, 8192, v26
v_xor_b32 v244, 4096, v26
v_mfma_f32_16x16x32_bf16 v[56:59], v[208:211], a[44:47], v[56:59]
v_xor_b32 v232, 12288, v26
v_mfma_f32_16x16x32_bf16 v[60:63], v[208:211], a[48:51], v[60:63]
v_mfma_f32_16x16x32_bf16 v[64:67], v[208:211], a[52:55], v[64:67]
v_mfma_f32_16x16x32_bf16 v[68:71], v[208:211], a[56:59], v[68:71]
v_mfma_f32_16x16x32_bf16 v[72:75], v[208:211], a[60:63], v[72:75]
s_waitcnt lgkmcnt(0)
s_barrier
ds_read_b128 v[112:115], v245 offset:0
v_cmp_eq_u32 vcc, 0, v24
s_nop 0
s_and_b32 s40, vcc_lo, 0x0ff00ff0
s_cbranch_scc1 L_sp_64
L_spo_65:
s_cmp_ge_u32 s37, 56
s_cbranch_scc1 L_rel_66
buffer_store_dword v9, v33, s[4:7], s26 offen sc1
s_add_u32 s26, s26, 4096
L_rel_66:
v_mfma_f32_16x16x32_bf16 v[44:47], v[212:215], a[64:67], v[44:47]
s_cmp_ge_u32 s37, 62
s_cselect_b32 s42, 524288, 0
s_sub_u32 s77, s77, s42
v_mfma_f32_16x16x32_bf16 v[48:51], v[212:215], a[68:71], v[48:51]
s_add_u32 s79, s79, 4096
buffer_load_dwordx2 v[228:229], v6, s[16:19], s28 offen sc1
v_mfma_f32_16x16x32_bf16 v[52:55], v[212:215], a[72:75], v[52:55]
buffer_load_ushort v230, v254, s[16:19], s28 offen sc1
s_lshl_b32 s42, s32, 11
v_mfma_f32_16x16x32_bf16 v[56:59], v[212:215], a[76:79], v[56:59]
s_add_u32 s42, s42, s80
s_add_u32 m0, s42, 0
s_add_u32 s41, s77, 0
v_mfma_f32_16x16x32_bf16 v[60:63], v[212:215], a[80:83], v[60:63]
buffer_load_dwordx4 v2, s[4:7], s41 offen offset:0 sc1 lds
v_mfma_f32_16x16x32_bf16 v[64:67], v[212:215], a[84:87], v[64:67]
v_mfma_f32_16x16x32_bf16 v[68:71], v[212:215], a[88:91], v[68:71]
v_mfma_f32_16x16x32_bf16 v[72:75], v[212:215], a[92:95], v[72:75]
ds_read_b128 v[116:119], v245 offset:1024
v_mfma_f32_16x16x32_bf16 v[44:47], v[216:219], a[96:99], v[44:47]
buffer_load_dwordx4 v2, s[4:7], s41 offen offset:1024 sc1 lds
s_add_u32 m0, s42, 8192
v_mfma_f32_16x16x32_bf16 v[48:51], v[216:219], a[100:103], v[48:51]
s_add_u32 s41, s77, 33554432
v_mfma_f32_16x16x32_bf16 v[52:55], v[216:219], a[104:107], v[52:55]
v_mfma_f32_16x16x32_bf16 v[56:59], v[216:219], a[108:111], v[56:59]
v_mfma_f32_16x16x32_bf16 v[60:63], v[216:219], a[112:115], v[60:63]
buffer_load_dwordx4 v2, s[4:7], s41 offen offset:0 sc1 lds
v_mfma_f32_16x16x32_bf16 v[64:67], v[216:219], a[116:119], v[64:67]
v_mfma_f32_16x16x32_bf16 v[68:71], v[216:219], a[120:123], v[68:71]
v_mfma_f32_16x16x32_bf16 v[72:75], v[216:219], a[124:127], v[72:75]
ds_read_b128 v[108:111], v245 offset:2048
s_waitcnt vmcnt(5)
s_cmp_eq_u32 s76, 0
s_cbranch_scc1 L_np_67
s_mov_b64 exec, 3
buffer_store_dword v9, v2, s[4:7], s76 offen sc1
s_mov_b64 exec, -1
s_mov_b32 s76, 0
L_np_67:
s_waitcnt lgkmcnt(2)
v_mfma_f32_16x16x32_bf16 v[44:47], v[112:115], a[128:131], v[44:47]
buffer_load_dwordx4 v2, s[4:7], s41 offen offset:1024 sc1 lds
s_add_u32 m0, s42, 16384
v_mfma_f32_16x16x32_bf16 v[48:51], v[112:115], a[132:135], v[48:51]
s_add_u32 s41, s77, 67108864
v_mfma_f32_16x16x32_bf16 v[52:55], v[112:115], a[136:139], v[52:55]
v_mfma_f32_16x16x32_bf16 v[56:59], v[112:115], a[140:143], v[56:59]
v_mfma_f32_16x16x32_bf16 v[60:63], v[112:115], a[144:147], v[60:63]
buffer_load_dwordx4 v2, s[4:7], s41 offen offset:0 sc1 lds
v_mfma_f32_16x16x32_bf16 v[64:67], v[112:115], a[148:151], v[64:67]
v_mfma_f32_16x16x32_bf16 v[68:71], v[112:115], a[152:155], v[68:71]
v_mfma_f32_16x16x32_bf16 v[72:75], v[112:115], a[156:159], v[72:75]
ds_read_b128 v[112:115], v245 offset:3072
s_waitcnt lgkmcnt(2)
v_mfma_f32_16x16x32_bf16 v[44:47], v[116:119], a[160:163], v[44:47]
buffer_load_dwordx4 v2, s[4:7], s41 offen offset:1024 sc1 lds
s_add_u32 m0, s42, 24576
v_mfma_f32_16x16x32_bf16 v[48:51], v[116:119], a[164:167], v[48:51]
s_add_u32 s41, s77, 8192
v_mfma_f32_16x16x32_bf16 v[52:55], v[116:119], a[168:171], v[52:55]
v_mfma_f32_16x16x32_bf16 v[56:59], v[116:119], a[172:175], v[56:59]
v_mfma_f32_16x16x32_bf16 v[60:63], v[116:119], a[176:179], v[60:63]
buffer_load_dwordx4 v2, s[4:7], s41 offen offset:0 sc1 lds
v_mfma_f32_16x16x32_bf16 v[64:67], v[116:119], a[180:183], v[64:67]
v_mfma_f32_16x16x32_bf16 v[68:71], v[116:119], a[184:187], v[68:71]
v_mfma_f32_16x16x32_bf16 v[72:75], v[116:119], a[188:191], v[72:75]
ds_read_b128 v[116:119], v244 offset:0
s_waitcnt lgkmcnt(2)
v_mfma_f32_16x16x32_bf16 v[44:47], v[108:111], a[192:195], v[44:47]
buffer_load_dwordx4 v2, s[4:7], s41 offen offset:1024 sc1 lds
s_add_u32 m0, s42, 32768
v_mfma_f32_16x16x32_bf16 v[48:51], v[108:111], a[196:199], v[48:51]
s_add_u32 s41, s77, 33562624
v_mfma_f32_16x16x32_bf16 v[52:55], v[108:111], a[200:203], v[52:55]
v_mfma_f32_16x16x32_bf16 v[56:59], v[108:111], a[204:207], v[56:59]
v_mfma_f32_16x16x32_bf16 v[60:63], v[108:111], a[208:211], v[60:63]
buffer_load_dwordx4 v2, s[4:7], s41 offen offset:0 sc1 lds
v_mfma_f32_16x16x32_bf16 v[64:67], v[108:111], a[212:215], v[64:67]
v_mfma_f32_16x16x32_bf16 v[68:71], v[108:111], a[216:219], v[68:71]
v_mfma_f32_16x16x32_bf16 v[72:75], v[108:111], a[220:223], v[72:75]
ds_read_b128 v[108:111], v244 offset:1024
s_waitcnt lgkmcnt(2)
v_mfma_f32_16x16x32_bf16 v[44:47], v[112:115], a[224:227], v[44:47]
buffer_load_dwordx4 v2, s[4:7], s41 offen offset:1024 sc1 lds
s_add_u32 m0, s42, 40960
v_mfma_f32_16x16x32_bf16 v[48:51], v[112:115], a[228:231], v[48:51]
s_add_u32 s41, s77, 67117056
v_mfma_f32_16x16x32_bf16 v[52:55], v[112:115], a[232:235], v[52:55]
v_mfma_f32_16x16x32_bf16 v[56:59], v[112:115], a[236:239], v[56:59]
v_mfma_f32_16x16x32_bf16 v[60:63], v[112:115], a[240:243], v[60:63]
buffer_load_dwordx4 v2, s[4:7], s41 offen offset:0 sc1 lds
v_mfma_f32_16x16x32_bf16 v[64:67], v[112:115], a[244:247], v[64:67]
v_mfma_f32_16x16x32_bf16 v[68:71], v[112:115], a[248:251], v[68:71]
v_mfma_f32_16x16x32_bf16 v[72:75], v[112:115], a[252:255], v[72:75]
ds_read_b128 v[112:115], v244 offset:2048
s_waitcnt lgkmcnt(2)
v_mfma_f32_16x16x32_bf16 v[76:79], v[116:119], a[0:3], 0
buffer_load_dwordx4 v2, s[4:7], s41 offen offset:1024 sc1 lds
s_add_u32 s77, s77, 524288
v_mfma_f32_16x16x32_bf16 v[80:83], v[116:119], a[4:7], 0
v_cvt_pk_bf16_f32 v220, v44, v48
v_cvt_pk_bf16_f32 v221, v52, v56
v_mfma_f32_16x16x32_bf16 v[84:87], v[116:119], a[8:11], 0
v_cvt_pk_bf16_f32 v222, v60, v64
v_cvt_pk_bf16_f32 v223, v68, v72
v_mfma_f32_16x16x32_bf16 v[88:91], v[116:119], a[12:15], 0
v_bfi_b32 v220, 1, s101, v220
v_bfi_b32 v221, 1, s101, v221
v_mfma_f32_16x16x32_bf16 v[92:95], v[116:119], a[16:19], 0
v_bfi_b32 v222, 1, s101, v222
v_bfi_b32 v223, 1, s101, v223
s_add_u32 s40, s39, 0
v_mfma_f32_16x16x32_bf16 v[96:99], v[116:119], a[20:23], 0
buffer_store_dwordx4 v[220:223], v8, s[4:7], s40 offen
v_mfma_f32_16x16x32_bf16 v[100:103], v[116:119], a[24:27], 0
v_mfma_f32_16x16x32_bf16 v[104:107], v[116:119], a[28:31], 0
ds_read_b128 v[116:119], v244 offset:3072
s_waitcnt lgkmcnt(2)
v_mfma_f32_16x16x32_bf16 v[76:79], v[108:111], a[32:35], v[76:79]
v_cvt_pk_bf16_f32 v216, v45, v49
v_cvt_pk_bf16_f32 v217, v53, v57
v_mfma_f32_16x16x32_bf16 v[80:83], v[108:111], a[36:39], v[80:83]
v_cvt_pk_bf16_f32 v218, v61, v65
v_cvt_pk_bf16_f32 v219, v69, v73
v_mfma_f32_16x16x32_bf16 v[84:87], v[108:111], a[40:43], v[84:87]
v_bfi_b32 v216, 1, s101, v216
v_bfi_b32 v217, 1, s101, v217
v_mfma_f32_16x16x32_bf16 v[88:91], v[108:111], a[44:47], v[88:91]
v_bfi_b32 v218, 1, s101, v218
v_bfi_b32 v219, 1, s101, v219
s_add_u32 s40, s39, 32768
v_mfma_f32_16x16x32_bf16 v[92:95], v[108:111], a[48:51], v[92:95]
buffer_store_dwordx4 v[216:219], v8, s[4:7], s40 offen
v_mfma_f32_16x16x32_bf16 v[96:99], v[108:111], a[52:55], v[96:99]
v_mfma_f32_16x16x32_bf16 v[100:103], v[108:111], a[56:59], v[100:103]
v_mfma_f32_16x16x32_bf16 v[104:107], v[108:111], a[60:63], v[104:107]
ds_read_b128 v[108:111], v232 offset:0
s_waitcnt lgkmcnt(2)
v_mfma_f32_16x16x32_bf16 v[76:79], v[112:115], a[64:67], v[76:79]
v_cvt_pk_bf16_f32 v220, v46, v50
v_cvt_pk_bf16_f32 v221, v54, v58
v_mfma_f32_16x16x32_bf16 v[80:83], v[112:115], a[68:71], v[80:83]
v_cvt_pk_bf16_f32 v222, v62, v66
v_cvt_pk_bf16_f32 v223, v70, v74
v_mfma_f32_16x16x32_bf16 v[84:87], v[112:115], a[72:75], v[84:87]
v_bfi_b32 v220, 1, s101, v220
v_bfi_b32 v221, 1, s101, v221
v_mfma_f32_16x16x32_bf16 v[88:91], v[112:115], a[76:79], v[88:91]
v_bfi_b32 v222, 1, s101, v222
v_bfi_b32 v223, 1, s101, v223
s_add_u32 s40, s39, 65536
v_mfma_f32_16x16x32_bf16 v[92:95], v[112:115], a[80:83], v[92:95]
buffer_store_dwordx4 v[220:223], v8, s[4:7], s40 offen
v_mfma_f32_16x16x32_bf16 v[96:99], v[112:115], a[84:87], v[96:99]
v_mfma_f32_16x16x32_bf16 v[100:103], v[112:115], a[88:91], v[100:103]
v_mfma_f32_16x16x32_bf16 v[104:107], v[112:115], a[92:95], v[104:107]
ds_read_b128 v[112:115], v232 offset:1024
s_waitcnt lgkmcnt(2)
v_mfma_f32_16x16x32_bf16 v[76:79], v[116:119], a[96:99], v[76:79]
v_cvt_pk_bf16_f32 v216, v47, v51
v_cvt_pk_bf16_f32 v217, v55, v59
v_mfma_f32_16x16x32_bf16 v[80:83], v[116:119], a[100:103], v[80:83]
v_cvt_pk_bf16_f32 v218, v63, v67
v_cvt_pk_bf16_f32 v219, v71, v75
v_mfma_f32_16x16x32_bf16 v[84:87], v[116:119], a[104:107], v[84:87]
v_bfi_b32 v216, 1, s101, v216
v_bfi_b32 v217, 1, s101, v217
v_mfma_f32_16x16x32_bf16 v[88:91], v[116:119], a[108:111], v[88:91]
v_bfi_b32 v218, 1, s101, v218
v_bfi_b32 v219, 1, s101, v219
s_add_u32 s40, s39, 98304
v_mfma_f32_16x16x32_bf16 v[92:95], v[116:119], a[112:115], v[92:95]
buffer_store_dwordx4 v[216:219], v8, s[4:7], s40 offen
v_mfma_f32_16x16x32_bf16 v[96:99], v[116:119], a[116:119], v[96:99]
v_mfma_f32_16x16x32_bf16 v[100:103], v[116:119], a[120:123], v[100:103]
v_mfma_f32_16x16x32_bf16 v[104:107], v[116:119], a[124:127], v[104:107]
ds_read_b128 v[116:119], v232 offset:2048
s_waitcnt lgkmcnt(2)
v_mfma_f32_16x16x32_bf16 v[76:79], v[108:111], a[128:131], v[76:79]
v_mfma_f32_16x16x32_bf16 v[80:83], v[108:111], a[132:135], v[80:83]
v_mfma_f32_16x16x32_bf16 v[84:87], v[108:111], a[136:139], v[84:87]
v_mfma_f32_16x16x32_bf16 v[88:91], v[108:111], a[140:143], v[88:91]
v_mfma_f32_16x16x32_bf16 v[92:95], v[108:111], a[144:147], v[92:95]
v_mfma_f32_16x16x32_bf16 v[96:99], v[108:111], a[148:151], v[96:99]
v_mfma_f32_16x16x32_bf16 v[100:103], v[108:111], a[152:155], v[100:103]
v_mfma_f32_16x16x32_bf16 v[104:107], v[108:111], a[156:159], v[104:107]
ds_read_b128 v[108:111], v232 offset:3072
s_waitcnt lgkmcnt(2)
v_mfma_f32_16x16x32_bf16 v[76:79], v[112:115], a[160:163], v[76:79]
v_mfma_f32_16x16x32_bf16 v[80:83], v[112:115], a[164:167], v[80:83]
v_mfma_f32_16x16x32_bf16 v[84:87], v[112:115], a[168:171], v[84:87]
v_mfma_f32_16x16x32_bf16 v[88:91], v[112:115], a[172:175], v[88:91]
v_mfma_f32_16x16x32_bf16 v[92:95], v[112:115], a[176:179], v[92:95]
v_mfma_f32_16x16x32_bf16 v[96:99], v[112:115], a[180:183], v[96:99]
v_mfma_f32_16x16x32_bf16 v[100:103], v[112:115], a[184:187], v[100:103]
v_mfma_f32_16x16x32_bf16 v[104:107], v[112:115], a[188:191], v[104:107]
s_waitcnt lgkmcnt(1)
v_mfma_f32_16x16x32_bf16 v[76:79], v[116:119], a[192:195], v[76:79]
v_mfma_f32_16x16x32_bf16 v[80:83], v[116:119], a[196:199], v[80:83]
v_mfma_f32_16x16x32_bf16 v[84:87], v[116:119], a[200:203], v[84:87]
v_mfma_f32_16x16x32_bf16 v[88:91], v[116:119], a[204:207], v[88:91]
v_mfma_f32_16x16x32_bf16 v[92:95], v[116:119], a[208:211], v[92:95]
v_mfma_f32_16x16x32_bf16 v[96:99], v[116:119], a[212:215], v[96:99]
v_mfma_f32_16x16x32_bf16 v[100:103], v[116:119], a[216:219], v[100:103]
v_mfma_f32_16x16x32_bf16 v[104:107], v[116:119], a[220:223], v[104:107]
s_waitcnt lgkmcnt(0)
v_mfma_f32_16x16x32_bf16 v[76:79], v[108:111], a[224:227], v[76:79]
v_mfma_f32_16x16x32_bf16 v[80:83], v[108:111], a[228:231], v[80:83]
v_mfma_f32_16x16x32_bf16 v[84:87], v[108:111], a[232:235], v[84:87]
v_mfma_f32_16x16x32_bf16 v[88:91], v[108:111], a[236:239], v[88:91]
v_mfma_f32_16x16x32_bf16 v[92:95], v[108:111], a[240:243], v[92:95]
v_mfma_f32_16x16x32_bf16 v[96:99], v[108:111], a[244:247], v[96:99]
v_mfma_f32_16x16x32_bf16 v[100:103], v[108:111], a[248:251], v[100:103]
v_mfma_f32_16x16x32_bf16 v[104:107], v[108:111], a[252:255], v[104:107]
s_nop 1
v_cvt_pk_bf16_f32 v216, v76, v80
s_nop 0
v_cvt_pk_bf16_f32 v217, v84, v88
s_nop 0
v_cvt_pk_bf16_f32 v218, v92, v96
s_nop 0
v_cvt_pk_bf16_f32 v219, v100, v104
v_bfi_b32 v216, 1, s101, v216
v_bfi_b32 v217, 1, s101, v217
v_bfi_b32 v218, 1, s101, v218
v_bfi_b32 v219, 1, s101, v219
s_add_u32 s40, s39, 0
buffer_store_dwordx4 v[216:219], v253, s[4:7], s40 offen
v_cvt_pk_bf16_f32 v220, v77, v81
v_cvt_pk_bf16_f32 v221, v85, v89
v_cvt_pk_bf16_f32 v222, v93, v97
v_cvt_pk_bf16_f32 v223, v101, v105
v_bfi_b32 v220, 1, s101, v220
v_bfi_b32 v221, 1, s101, v221
v_bfi_b32 v222, 1, s101, v222
v_bfi_b32 v223, 1, s101, v223
s_add_u32 s40, s39, 32768
buffer_store_dwordx4 v[220:223], v253, s[4:7], s40 offen
v_cvt_pk_bf16_f32 v216, v78, v82
v_cvt_pk_bf16_f32 v217, v86, v90
v_cvt_pk_bf16_f32 v218, v94, v98
v_cvt_pk_bf16_f32 v219, v102, v106
v_bfi_b32 v216, 1, s101, v216
v_bfi_b32 v217, 1, s101, v217
v_bfi_b32 v218, 1, s101, v218
v_bfi_b32 v219, 1, s101, v219
s_add_u32 s40, s39, 65536
buffer_store_dwordx4 v[216:219], v253, s[4:7], s40 offen
v_cvt_pk_bf16_f32 v220, v79, v83
v_cvt_pk_bf16_f32 v221, v87, v91
v_cvt_pk_bf16_f32 v222, v95, v99
v_cvt_pk_bf16_f32 v223, v103, v107
v_bfi_b32 v220, 1, s101, v220
v_bfi_b32 v221, 1, s101, v221
v_bfi_b32 v222, 1, s101, v222
v_bfi_b32 v223, 1, s101, v223
s_add_u32 s40, s39, 98304
buffer_store_dwordx4 v[220:223], v253, s[4:7], s40 offen
s_add_u32 s43, s39, 0
buffer_load_dwordx4 v[192:195], v5, s[4:7], s43 offen sc1
s_add_u32 s43, s39, 4096
buffer_load_dwordx4 v[196:199], v5, s[4:7], s43 offen sc1
s_add_u32 s43, s39, 8192
buffer_load_dwordx4 v[200:203], v5, s[4:7], s43 offen sc1
s_add_u32 s43, s39, 12288
buffer_load_dwordx4 v[204:207], v5, s[4:7], s43 offen sc1
s_waitcnt vmcnt(0)
s_add_u32 s43, s39, 0
buffer_load_dwordx4 v[208:211], v252, s[4:7], s43 offen sc1
s_add_u32 s43, s39, 4096
buffer_load_dwordx4 v[212:215], v252, s[4:7], s43 offen sc1
s_add_u32 s43, s39, 8192
buffer_load_dwordx4 v[216:219], v252, s[4:7], s43 offen sc1
s_add_u32 s43, s39, 12288
buffer_load_dwordx4 v[220:223], v252, s[4:7], s43 offen sc1
L_rea2_71:
v_mov_b32 v232, 0
v_mov_b32 v233, -1
v_mfma_f32_16x16x32_bf16 v[240:243], v[12:15], v[192:195], 0
v_or3_b32 v232, v232, v192, v193
v_bitop3_b32 v233, v233, v192, v193 bitop3:0x80
v_or3_b32 v232, v232, v194, v195
v_bitop3_b32 v233, v233, v194, v195 bitop3:0x80
v_mfma_f32_16x16x32_bf16 v[240:243], v[12:15], v[196:199], v[240:243]
v_or3_b32 v232, v232, v196, v197
v_bitop3_b32 v233, v233, v196, v197 bitop3:0x80
v_or3_b32 v232, v232, v198, v199
v_bitop3_b32 v233, v233, v198, v199 bitop3:0x80
v_mfma_f32_16x16x32_bf16 v[240:243], v[12:15], v[200:203], v[240:243]
v_or3_b32 v232, v232, v200, v201
v_bitop3_b32 v233, v233, v200, v201 bitop3:0x80
v_or3_b32 v232, v232, v202, v203
v_bitop3_b32 v233, v233, v202, v203 bitop3:0x80
v_mfma_f32_16x16x32_bf16 v[240:243], v[12:15], v[204:207], v[240:243]
v_or3_b32 v232, v232, v204, v205
v_bitop3_b32 v233, v233, v204, v205 bitop3:0x80
v_or3_b32 v232, v232, v206, v207
v_bitop3_b32 v233, v233, v206, v207 bitop3:0x80
v_xor_b32 v232, s101, v232
v_bitop3_b32 v232, v232, v233, s101 bitop3:0xf6
v_and_b32 v232, 1, v232
v_cmp_ne_u32 vcc, 0, v232
s_cbranch_vccnz L_rea_70
v_lshlrev_b32 v236, 16, v228
v_and_b32 v237, 0xffff0000, v228
v_lshlrev_b32 v238, 16, v229
v_and_b32 v239, 0xffff0000, v229
L_red2_69:
v_mov_b32 v232, 0
v_mov_b32 v233, -1
s_waitcnt vmcnt(3)
v_mfma_f32_16x16x32_bf16 v[224:227], v[16:19], v[208:211], v[240:243]
v_or3_b32 v232, v232, v208, v209
v_bitop3_b32 v233, v233, v208, v209 bitop3:0x80
v_or3_b32 v232, v232, v210, v211
v_bitop3_b32 v233, v233, v210, v211 bitop3:0x80
s_waitcnt vmcnt(2)
v_mfma_f32_16x16x32_bf16 v[224:227], v[16:19], v[212:215], v[224:227]
v_or3_b32 v232, v232, v212, v213
v_bitop3_b32 v233, v233, v212, v213 bitop3:0x80
v_or3_b32 v232, v232, v214, v215
v_bitop3_b32 v233, v233, v214, v215 bitop3:0x80
s_waitcnt vmcnt(1)
v_mfma_f32_16x16x32_bf16 v[224:227], v[16:19], v[216:219], v[224:227]
v_or3_b32 v232, v232, v216, v217
v_bitop3_b32 v233, v233, v216, v217 bitop3:0x80
v_or3_b32 v232, v232, v218, v219
v_bitop3_b32 v233, v233, v218, v219 bitop3:0x80
s_waitcnt vmcnt(0)
v_mfma_f32_16x16x32_bf16 v[224:227], v[16:19], v[220:223], v[224:227]
v_or3_b32 v232, v232, v220, v221
v_bitop3_b32 v233, v233, v220, v221 bitop3:0x80
v_or3_b32 v232, v232, v222, v223
v_bitop3_b32 v233, v233, v222, v223 bitop3:0x80
v_xor_b32 v232, s101, v232
v_bitop3_b32 v232, v232, v233, s101 bitop3:0xf6
v_and_b32 v232, 1, v232
v_cmp_ne_u32 vcc, 0, v232
s_cbranch_vccnz L_red_68
v_add_f32 v236, v236, v224
v_add_f32 v237, v237, v225
v_add_f32 v238, v238, v226
v_add_f32 v239, v239, v227
v_cvt_pk_bf16_f32 v224, v236, v237
v_cvt_pk_bf16_f32 v225, v238, v239
s_add_u32 s41, s37, 2
s_bfe_u32 s25, s41, 0x10003
s_and_b32 s41, s41, 7
s_lshl_b32 s41, s41, 17
s_add_u32 s78, s41, s24
buffer_load_dword v24, v38, s[4:7], s79 offen sc1
v_lshlrev_b32 v234, 16, v230
v_lshlrev_b32 v236, 16, v224
v_and_b32 v237, 0xffff0000, v224
v_lshlrev_b32 v238, 16, v225
v_and_b32 v239, 0xffff0000, v225
v_sub_f32 v236, v236, v234
v_sub_f32 v237, v237, v234
v_sub_f32 v238, v238, v234
v_sub_f32 v239, v239, v234
v_add_f32 v232, v236, v237
buffer_load_dwordx4 v[92:95], v21, s[4:7], s78 offen offset:0 sc1
v_mul_f32 v233, v236, v236
v_add_f32 v232, v232, v238
v_fmac_f32 v233, v237, v237
v_add_f32 v232, v232, v239
v_fmac_f32 v233, v238, v238
v_fmac_f32 v233, v239, v239
v_add_f32_dpp v232, v232, v232 row_ror:8 row_mask:0xf bank_mask:0xf
s_nop 0
v_add_f32_dpp v233, v233, v233 row_ror:8 row_mask:0xf bank_mask:0xf
v_add_f32_dpp v232, v232, v232 row_ror:4 row_mask:0xf bank_mask:0xf
s_nop 0
v_add_f32_dpp v233, v233, v233 row_ror:4 row_mask:0xf bank_mask:0xf
v_add_f32_dpp v232, v232, v232 row_ror:2 row_mask:0xf bank_mask:0xf
s_nop 0
v_add_f32_dpp v233, v233, v233 row_ror:2 row_mask:0xf bank_mask:0xf
v_add_f32_dpp v232, v232, v232 row_ror:1 row_mask:0xf bank_mask:0xf
s_nop 0
v_add_f32_dpp v233, v233, v233 row_ror:1 row_mask:0xf bank_mask:0xf
s_nop 1
v_permlane16_swap_b32 v232, v233
v_add_f32 v232, v232, v233
ds_write_b32 v10, v232
s_waitcnt lgkmcnt(0)
s_barrier
ds_read_b128 v[192:195], v11
ds_read_b128 v[196:199], v11 offset:16
v_mov_b32 v235, 0x3727c5ac
s_waitcnt lgkmcnt(1)
v_add_f32 v192, v192, v193
buffer_load_dwordx4 v[96:99], v21, s[4:7], s78 offen offset:512 sc1
v_add_f32 v194, v194, v195
v_add_f32 v192, v192, v194
s_waitcnt lgkmcnt(0)
v_add_f32 v196, v196, v197
v_add_f32 v198, v198, v199
v_mul_f32 v192, 0x3b000000, v192
v_add_f32 v196, v196, v198
v_mul_f32 v196, 0x3b000000, v196
v_fma_f32 v196, -v192, v192, v196
v_max_f32 v196, 0, v196
v_add_f32 v235, v235, v196
buffer_load_dwordx4 v[100:103], v21, s[4:7], s78 offen offset:1024 sc1
v_rsq_f32 v235, v235
v_sub_f32 v236, v236, v192
v_sub_f32 v237, v237, v192
v_sub_f32 v238, v238, v192
v_sub_f32 v239, v239, v192
v_mul_f32 v236, v236, v235
v_mul_f32 v237, v237, v235
v_mul_f32 v238, v238, v235
v_mul_f32 v239, v239, v235
v_cvt_pk_bf16_f32 v192, v236, v237
buffer_load_dwordx4 v[104:107], v21, s[4:7], s78 offen offset:1536 sc1
v_cvt_pk_bf16_f32 v193, v238, v239
buffer_store_dwordx2 v[192:193], v7, s[4:7], s30 offen sc1
buffer_store_dwordx2 v[224:225], v6, s[4:7], s29 offen sc1
s_mov_b32 s76, s31
s_xor_b32 s39, s39, 524288
s_add_u32 s28, s28, 65536
s_add_u32 s29, s29, 65536
s_add_u32 s30, s30, 65536
s_add_u32 s31, s31, 1024
s_add_u32 s37, s37, 2
s_bfe_u32 s101, s37, 0x10002
s_cmp_lt_u32 s37, 64
s_cbranch_scc1 L_att_loop_L
s_waitcnt vmcnt(0)
s_cmp_eq_u32 s76, 0
s_cbranch_scc1 L_np_72
s_mov_b64 exec, 3
buffer_store_dword v9, v2, s[4:7], s76 offen sc1
s_mov_b64 exec, -1
s_mov_b32 s76, 0
L_np_72:
s_endpgm
L_sp_51:
s_cmp_ge_u32 s37, 62
s_cbranch_scc1 L_spo_52
s_sub_u32 s36, s36, 1
s_cbranch_scc1 L_end_att_L
buffer_load_dword v24, v38, s[4:7], s79 offen sc1
s_waitcnt vmcnt(0)
v_cmp_eq_u32 vcc, 0, v24
s_nop 0
s_and_b32 s40, vcc_lo, 0x0ff00ff0
s_cbranch_scc1 L_sp_51
s_branch L_spo_52
L_km2_55:
s_sub_u32 s36, s36, 1
s_cbranch_scc1 L_end_att_L
buffer_load_dwordx4 v[92:95], v21, s[4:7], s78 offen offset:0 sc1
buffer_load_dwordx4 v[96:99], v21, s[4:7], s78 offen offset:512 sc1
buffer_load_dwordx4 v[100:103], v21, s[4:7], s78 offen offset:1024 sc1
buffer_load_dwordx4 v[104:107], v21, s[4:7], s78 offen offset:1536 sc1
L_km_53:
s_waitcnt vmcnt(0)
s_cmp_eq_u32 s76, 0
s_cbranch_scc1 L_np_73
s_mov_b64 exec, 3
buffer_store_dword v9, v2, s[4:7], s76 offen sc1
s_mov_b64 exec, -1
s_mov_b32 s76, 0
L_np_73:
s_branch L_kmo_54
L_kv_56:
v_mfma_f32_16x16x32_bf16 v[164:167], v[92:95], v[44:47], 0
v_mfma_f32_16x16x32_bf16 v[164:167], v[96:99], v[48:51], v[164:167]
v_mfma_f32_16x16x32_bf16 v[164:167], v[100:103], v[52:55], v[164:167]
v_mfma_f32_16x16x32_bf16 v[164:167], v[104:107], v[56:59], v[164:167]
s_branch L_kj_57
L_smx_59:
v_mov_b32 v249, v248
s_nop 1
v_permlane16_swap_b32 v248, v249
v_max_f32 v248, v248, v249
v_mov_b32 v249, v248
s_nop 1
v_permlane32_swap_b32 v248, v249
v_max_f32 v248, v248, v249
v_sub_f32 v156, v156, v248
v_sub_f32 v157, v157, v248
v_sub_f32 v158, v158, v248
v_sub_f32 v159, v159, v248
v_sub_f32 v160, v160, v248
v_sub_f32 v161, v161, v248
v_sub_f32 v162, v162, v248
v_sub_f32 v163, v163, v248
v_sub_f32 v164, v164, v248
v_sub_f32 v165, v165, v248
s_branch L_smb_60
L_vm_61:
s_sub_u32 s36, s36, 1
s_cbranch_scc1 L_end_att_L
buffer_load_dwordx2 v[140:141], v22, s[4:7], s78 offen offset:2048 sc1
buffer_load_dwordx2 v[144:145], v22, s[4:7], s78 offen offset:2560 sc1
buffer_load_dwordx2 v[148:149], v22, s[4:7], s78 offen offset:3072 sc1
buffer_load_dwordx2 v[152:153], v22, s[4:7], s78 offen offset:3584 sc1
s_branch L_vmo_62
L_sp_64:
s_cmp_ge_u32 s37, 62
s_cbranch_scc1 L_spo_65
s_sub_u32 s36, s36, 1
s_cbranch_scc1 L_end_att_L
buffer_load_dword v24, v38, s[4:7], s79 offen sc1
s_waitcnt vmcnt(0)
v_cmp_eq_u32 vcc, 0, v24
s_nop 0
s_and_b32 s40, vcc_lo, 0x0ff00ff0
s_cbranch_scc1 L_sp_64
s_branch L_spo_65
L_rea_70:
s_sub_u32 s36, s36, 1
s_cbranch_scc1 L_end_att_L
s_add_u32 s43, s39, 0
buffer_load_dwordx4 v[192:195], v5, s[4:7], s43 offen sc1
s_add_u32 s43, s39, 4096
buffer_load_dwordx4 v[196:199], v5, s[4:7], s43 offen sc1
s_add_u32 s43, s39, 8192
buffer_load_dwordx4 v[200:203], v5, s[4:7], s43 offen sc1
s_add_u32 s43, s39, 12288
buffer_load_dwordx4 v[204:207], v5, s[4:7], s43 offen sc1
s_waitcnt vmcnt(0)
s_branch L_rea2_71
L_red_68:
s_sub_u32 s36, s36, 1
s_cbranch_scc1 L_end_att_L
s_add_u32 s43, s39, 0
buffer_load_dwordx4 v[208:211], v252, s[4:7], s43 offen sc1
s_add_u32 s43, s39, 4096
buffer_load_dwordx4 v[212:215], v252, s[4:7], s43 offen sc1
s_add_u32 s43, s39, 8192
buffer_load_dwordx4 v[216:219], v252, s[4:7], s43 offen sc1
s_add_u32 s43, s39, 12288
buffer_load_dwordx4 v[220:223], v252, s[4:7], s43 offen sc1
s_waitcnt vmcnt(0)
s_branch L_red2_69
L_fb_att:
s_getpc_b64 s[40:41]
L_fb_att_pc:
s_add_u32 s40, s40, L_fallback-L_fb_att_pc
s_addc_u32 s41, s41, -1
s_setpc_b64 s[40:41]
L_end_att_L:
s_endpgm
.p2align 6
R_ffn_L:
s_sub_u32 s38, s35, 5
s_lshr_b32 s38, s38, 1
v_and_b32 v3, 15, v1
v_lshrrev_b32 v4, 4, v1
s_and_b32 s98, s34, 15
s_lshr_b32 s99, s34, 4
s_sub_u32 s40, s35, 4
s_lshl_b32 s40, s40, 1
s_add_u32 s40, s40, s99
s_lshl_b32 s40, s40, 20
s_add_u32 s39, s40, 2097152
s_lshl_b32 s40, s98, 15
s_lshl_b32 s41, s32, 8
s_add_u32 s40, s40, s41
v_lshlrev_b32 v68, 4, v3
v_lshl_add_u32 v69, v4, 10, v68
v_add_u32 v5, s40, v69
s_and_b32 s3, s32, 0
s_lshl_b32 s42, s3, 14
v_add_u32 v5, s42, v5
v_xor_b32 v0, 16384, v5
s_lshl_b32 s40, s98, 10
s_add_u32 s40, s40, s41
v_lshl_add_u32 v69, v4, 17, v68
v_add3_u32 v8, v69, s40, 0
v_add_u32 v8, s42, v8
v_xor_b32 v27, 16384, v8
v_and_b32 v69, 1, v4
v_lshlrev_b32 v69, 3, v69
v_lshrrev_b32 v70, 1, v4
v_lshl_add_u32 v69, v70, 10, v69
s_lshl_b32 s40, s34, 11
s_add_u32 s40, s40, s41
v_add3_u32 v6, v68, v69, s40
v_and_b32 v31, 0xfffffc00, v6
v_xor_b32 v68, s98, v3
v_lshlrev_b32 v68, 4, v68
v_add3_u32 v7, v68, v69, s40
v_mov_b32 v9, 1
v_lshlrev_b32 v70, 6, v70
v_add_u32 v11, 163712, v70
s_lshl_b32 s40, s32, 2
v_and_b32 v70, 1, v4
v_lshlrev_b32 v70, 4, v70
v_add3_u32 v10, v70, v11, s40
s_mov_b32 s37, s99
s_mov_b32 s76, 0
s_mov_b32 s101, 0
s_lshl_b32 s42, s3, 3
v_xor_b32 v70, s42, v3
v_mov_b32 v12, 0
v_cmp_eq_u32 vcc, 0, v70
v_mov_b32 v69, 0x3f80
s_nop 0
v_cndmask_b32 v12, v12, v69, vcc
v_cmp_eq_u32 vcc, 1, v70
v_mov_b32 v69, 0x3f800000
s_nop 0
v_cndmask_b32 v12, v12, v69, vcc
v_mov_b32 v16, 0
v_cmp_eq_u32 vcc, 8, v70
v_mov_b32 v69, 0x3f80
s_nop 0
v_cndmask_b32 v16, v16, v69, vcc
v_cmp_eq_u32 vcc, 9, v70
v_mov_b32 v69, 0x3f800000
s_nop 0
v_cndmask_b32 v16, v16, v69, vcc
v_mov_b32 v13, 0
v_cmp_eq_u32 vcc, 2, v70
v_mov_b32 v69, 0x3f80
s_nop 0
v_cndmask_b32 v13, v13, v69, vcc
v_cmp_eq_u32 vcc, 3, v70
v_mov_b32 v69, 0x3f800000
s_nop 0
v_cndmask_b32 v13, v13, v69, vcc
v_mov_b32 v17, 0
v_cmp_eq_u32 vcc, 10, v70
v_mov_b32 v69, 0x3f80
s_nop 0
v_cndmask_b32 v17, v17, v69, vcc
v_cmp_eq_u32 vcc, 11, v70
v_mov_b32 v69, 0x3f800000
s_nop 0
v_cndmask_b32 v17, v17, v69, vcc
v_mov_b32 v14, 0
v_cmp_eq_u32 vcc, 4, v70
v_mov_b32 v69, 0x3f80
s_nop 0
v_cndmask_b32 v14, v14, v69, vcc
v_cmp_eq_u32 vcc, 5, v70
v_mov_b32 v69, 0x3f800000
s_nop 0
v_cndmask_b32 v14, v14, v69, vcc
v_mov_b32 v18, 0
v_cmp_eq_u32 vcc, 12, v70
v_mov_b32 v69, 0x3f80
s_nop 0
v_cndmask_b32 v18, v18, v69, vcc
v_cmp_eq_u32 vcc, 13, v70
v_mov_b32 v69, 0x3f800000
s_nop 0
v_cndmask_b32 v18, v18, v69, vcc
v_mov_b32 v15, 0
v_cmp_eq_u32 vcc, 6, v70
v_mov_b32 v69, 0x3f80
s_nop 0
v_cndmask_b32 v15, v15, v69, vcc
v_cmp_eq_u32 vcc, 7, v70
v_mov_b32 v69, 0x3f800000
s_nop 0
v_cndmask_b32 v15, v15, v69, vcc
v_mov_b32 v19, 0
v_cmp_eq_u32 vcc, 14, v70
v_mov_b32 v69, 0x3f80
s_nop 0
v_cndmask_b32 v19, v19, v69, vcc
v_cmp_eq_u32 vcc, 15, v70
v_mov_b32 v69, 0x3f800000
s_nop 0
v_cndmask_b32 v19, v19, v69, vcc
s_waitcnt vmcnt(0)
s_barrier
s_cmp_lg_u32 s32, 0
s_cbranch_scc1 L_da_74
v_mov_b32 v72, 1
s_lshl_b32 s40, s33, 5
v_mov_b32 v73, s40
s_mov_b64 exec, 1
buffer_atomic_add v72, v73, s[8:11], 0 offen offset:4
s_mov_b64 exec, -1
L_da_74:
s_sub_u32 s40, s35, 4
s_lshl_b32 s40, s40, 5
s_add_u32 s40, s40, s34
s_lshl_b32 s40, s40, 2
s_add_u32 s40, s40, s32
s_mul_i32 s40, s40, 7168
s_mov_b32 s12, s54
s_mov_b32 s13, s55
s_mov_b32 s14, 4194304
s_mov_b32 s15, 0x20000
s_add_u32 s41, s40, 0
buffer_load_dwordx4 v[76:79], v2, s[12:15], s41 offen offset:0
buffer_load_dwordx4 v[76:79], v2, s[12:15], s41 offen offset:1024
buffer_load_dwordx4 v[76:79], v2, s[12:15], s41 offen offset:2048
buffer_load_dwordx4 v[76:79], v2, s[12:15], s41 offen offset:3072
s_add_u32 s41, s40, 4096
buffer_load_dwordx4 v[76:79], v2, s[12:15], s41 offen offset:0
buffer_load_dwordx4 v[76:79], v2, s[12:15], s41 offen offset:1024
buffer_load_dwordx4 v[76:79], v2, s[12:15], s41 offen offset:2048
s_mov_b32 s12, s56
s_mov_b32 s13, s57
s_mov_b32 s14, 4194304
s_mov_b32 s15, 0x20000
s_add_u32 s41, s40, 0
buffer_load_dwordx4 v[76:79], v2, s[12:15], s41 offen offset:0
buffer_load_dwordx4 v[76:79], v2, s[12:15], s41 offen offset:1024
buffer_load_dwordx4 v[76:79], v2, s[12:15], s41 offen offset:2048
buffer_load_dwordx4 v[76:79], v2, s[12:15], s41 offen offset:3072
s_add_u32 s41, s40, 4096
buffer_load_dwordx4 v[76:79], v2, s[12:15], s41 offen offset:0
buffer_load_dwordx4 v[76:79], v2, s[12:15], s41 offen offset:1024
buffer_load_dwordx4 v[76:79], v2, s[12:15], s41 offen offset:2048
s_mov_b32 s12, s52
s_mov_b32 s13, s53
s_mov_b32 s14, 4194304
s_mov_b32 s15, 0x20000
s_add_u32 s41, s40, 0
buffer_load_dwordx4 v[76:79], v2, s[12:15], s41 offen offset:0
buffer_load_dwordx4 v[76:79], v2, s[12:15], s41 offen offset:1024
buffer_load_dwordx4 v[76:79], v2, s[12:15], s41 offen offset:2048
buffer_load_dwordx4 v[76:79], v2, s[12:15], s41 offen offset:3072
s_add_u32 s41, s40, 4096
buffer_load_dwordx4 v[76:79], v2, s[12:15], s41 offen offset:0
buffer_load_dwordx4 v[76:79], v2, s[12:15], s41 offen offset:1024
buffer_load_dwordx4 v[76:79], v2, s[12:15], s41 offen offset:2048
s_mov_b32 s12, s58
s_mov_b32 s13, s59
s_mov_b32 s14, 4194304
s_mov_b32 s15, 0x20000
s_add_u32 s41, s40, 0
buffer_load_dwordx4 v[76:79], v2, s[12:15], s41 offen offset:0
buffer_load_dwordx4 v[76:79], v2, s[12:15], s41 offen offset:1024
buffer_load_dwordx4 v[76:79], v2, s[12:15], s41 offen offset:2048
buffer_load_dwordx4 v[76:79], v2, s[12:15], s41 offen offset:3072
s_add_u32 s41, s40, 4096
buffer_load_dwordx4 v[76:79], v2, s[12:15], s41 offen offset:0
buffer_load_dwordx4 v[76:79], v2, s[12:15], s41 offen offset:1024
buffer_load_dwordx4 v[76:79], v2, s[12:15], s41 offen offset:2048
v_lshlrev_b32 v74, 5, v1
buffer_load_dwordx2 v[72:73], v74, s[8:11], 0 offen sc1
s_waitcnt vmcnt(0)
L_cen_75:
s_mov_b32 s40, 0
v_readlane_b32 s41, v73, 0
s_nop 0
s_add_u32 s40, s40, s41
v_readlane_b32 s41, v73, 1
s_nop 0
s_add_u32 s40, s40, s41
v_readlane_b32 s41, v73, 2
s_nop 0
s_add_u32 s40, s40, s41
v_readlane_b32 s41, v73, 3
s_nop 0
s_add_u32 s40, s40, s41
v_readlane_b32 s41, v73, 4
s_nop 0
s_add_u32 s40, s40, s41
v_readlane_b32 s41, v73, 5
s_nop 0
s_add_u32 s40, s40, s41
v_readlane_b32 s41, v73, 6
s_nop 0
s_add_u32 s40, s40, s41
v_readlane_b32 s41, v73, 7
s_nop 0
s_add_u32 s40, s40, s41
s_cmp_eq_u32 s40, 256
s_cbranch_scc1 L_cenok_76
s_sub_u32 s36, s36, 1
s_cbranch_scc1 L_end_ffn_L
s_sleep 4
buffer_load_dwordx2 v[72:73], v74, s[8:11], 0 offen sc1
s_waitcnt vmcnt(0)
s_branch L_cen_75
L_cenok_76:
v_cmp_ne_u32 vcc, 32, v72
s_nop 0
s_and_b32 s40, vcc_lo, 0xff
s_cbranch_scc1 L_fb_ffn
v_mov_b32 v68, -1
v_mov_b32 v69, -1
v_mov_b32 v70, -1
v_mov_b32 v71, -1
s_add_u32 s40, s39, 0
buffer_store_dwordx4 v[68:71], v5, s[4:7], s40 offen
s_add_u32 s40, s39, 4096
buffer_store_dwordx4 v[68:71], v5, s[4:7], s40 offen
s_add_u32 s40, s39, 8192
buffer_store_dwordx4 v[68:71], v5, s[4:7], s40 offen
s_add_u32 s40, s39, 12288
buffer_store_dwordx4 v[68:71], v5, s[4:7], s40 offen
s_add_u32 s40, s39, 0
buffer_store_dwordx4 v[68:71], v0, s[4:7], s40 offen
s_add_u32 s40, s39, 4096
buffer_store_dwordx4 v[68:71], v0, s[4:7], s40 offen
s_add_u32 s40, s39, 8192
buffer_store_dwordx4 v[68:71], v0, s[4:7], s40 offen
s_add_u32 s40, s39, 12288
buffer_store_dwordx4 v[68:71], v0, s[4:7], s40 offen
s_add_u32 s40, s39, 524288
buffer_store_dwordx4 v[68:71], v5, s[4:7], s40 offen
s_add_u32 s40, s39, 528384
buffer_store_dwordx4 v[68:71], v5, s[4:7], s40 offen
s_add_u32 s40, s39, 532480
buffer_store_dwordx4 v[68:71], v5, s[4:7], s40 offen
s_add_u32 s40, s39, 536576
buffer_store_dwordx4 v[68:71], v5, s[4:7], s40 offen
s_add_u32 s40, s39, 524288
buffer_store_dwordx4 v[68:71], v0, s[4:7], s40 offen
s_add_u32 s40, s39, 528384
buffer_store_dwordx4 v[68:71], v0, s[4:7], s40 offen
s_add_u32 s40, s39, 532480
buffer_store_dwordx4 v[68:71], v0, s[4:7], s40 offen
s_add_u32 s40, s39, 536576
buffer_store_dwordx4 v[68:71], v0, s[4:7], s40 offen
s_waitcnt vmcnt(0)
s_barrier
s_cmp_lg_u32 s32, 0
s_cbranch_scc1 L_ra_77
v_mov_b32 v72, 1
s_lshl_b32 s40, s35, 5
v_mov_b32 v73, s40
s_mov_b64 exec, 1
buffer_atomic_add v72, v73, s[8:11], 0 offen offset:8
s_mov_b64 exec, -1
L_ra_77:
s_cmp_eq_u32 s38, 0
s_cbranch_scc1 L_go_78
s_mul_i32 s40, s35, 0
s_add_u32 s40, s40, 0
v_mov_b32 v73, s40
L_rw_79:
buffer_load_dword v72, v73, s[8:11], 0 offen offset:8 sc1
s_waitcnt vmcnt(0)
v_cmp_ne_u32 vcc, 32, v72
s_cbranch_vccz L_rwo_80
s_sub_u32 s36, s36, 1
s_cbranch_scc1 L_end_ffn_L
s_sleep 2
s_branch L_rw_79
L_rwo_80:
L_go_78:
s_mov_b32 s12, s64
s_mov_b32 s13, s65
s_mov_b32 s14, 1835008
s_mov_b32 s15, 0x20000
s_mov_b32 s20, s66
s_mov_b32 s21, s67
s_mov_b32 s22, 1835008
s_mov_b32 s23, 0x20000
s_mov_b32 s24, s68
s_mov_b32 s25, s69
s_mov_b32 s26, 1835008
s_mov_b32 s27, 0x20000
s_cmp_ge_u32 s98, 14
s_cbranch_scc1 L_ffn_now_L
s_lshl_b32 s40, s98, 8
s_lshl_b32 s41, s32, 6
s_add_u32 s42, s40, s41
s_mul_i32 s77, s32, 40704
v_lshlrev_b32 v23, 3, v4
v_lshrrev_b32 v24, 2, v1
v_mul_u32_u24 v24, 3584, v24
v_and_b32 v20, 3, v1
v_lshl_add_u32 v20, v20, 4, v24
v_add_u32 v21, 56320, v20
v_and_b32 v24, 15, v1
v_lshlrev_b32 v24, 2, v24
v_lshl_add_u32 v22, v23, 6, v24
v_add_u32 v22, s77, v22
s_add_u32 s45, s42, 0
s_add_u32 m0, s77, 0
s_nop 0
buffer_load_dwordx4 v20, s[12:15], s45 offen offset:0 lds
buffer_load_dwordx4 v21, s[12:15], s45 offen offset:1024 lds
s_add_u32 s45, s42, 0
s_add_u32 m0, s77, 2048
s_nop 0
buffer_load_dwordx4 v20, s[20:23], s45 offen offset:0 lds
buffer_load_dwordx4 v21, s[20:23], s45 offen offset:1024 lds
s_add_u32 s45, s42, 114688
s_add_u32 m0, s77, 4096
s_nop 0
buffer_load_dwordx4 v20, s[12:15], s45 offen offset:0 lds
buffer_load_dwordx4 v21, s[12:15], s45 offen offset:1024 lds
s_add_u32 s45, s42, 114688
s_add_u32 m0, s77, 6144
s_nop 0
buffer_load_dwordx4 v20, s[20:23], s45 offen offset:0 lds
buffer_load_dwordx4 v21, s[20:23], s45 offen offset:1024 lds
s_add_u32 s45, s42, 229376
s_add_u32 m0, s77, 8192
s_nop 0
buffer_load_dwordx4 v20, s[12:15], s45 offen offset:0 lds
buffer_load_dwordx4 v21, s[12:15], s45 offen offset:1024 lds
s_add_u32 s45, s42, 229376
s_add_u32 m0, s77, 10240
s_nop 0
buffer_load_dwordx4 v20, s[20:23], s45 offen offset:0 lds
buffer_load_dwordx4 v21, s[20:23], s45 offen offset:1024 lds
s_add_u32 s45, s42, 344064
s_add_u32 m0, s77, 12288
s_nop 0
buffer_load_dwordx4 v20, s[12:15], s45 offen offset:0 lds
buffer_load_dwordx4 v21, s[12:15], s45 offen offset:1024 lds
s_add_u32 s45, s42, 344064
s_add_u32 m0, s77, 14336
s_nop 0
buffer_load_dwordx4 v20, s[20:23], s45 offen offset:0 lds
buffer_load_dwordx4 v21, s[20:23], s45 offen offset:1024 lds
s_add_u32 s45, s42, 458752
s_add_u32 m0, s77, 16384
s_nop 0
buffer_load_dwordx4 v20, s[12:15], s45 offen offset:0 lds
buffer_load_dwordx4 v21, s[12:15], s45 offen offset:1024 lds
s_add_u32 s45, s42, 458752
s_add_u32 m0, s77, 18432
s_nop 0
buffer_load_dwordx4 v20, s[20:23], s45 offen offset:0 lds
buffer_load_dwordx4 v21, s[20:23], s45 offen offset:1024 lds
s_add_u32 s45, s42, 573440
s_add_u32 m0, s77, 20480
s_nop 0
buffer_load_dwordx4 v20, s[12:15], s45 offen offset:0 lds
buffer_load_dwordx4 v21, s[12:15], s45 offen offset:1024 lds
s_add_u32 s45, s42, 573440
s_add_u32 m0, s77, 22528
s_nop 0
buffer_load_dwordx4 v20, s[20:23], s45 offen offset:0 lds
buffer_load_dwordx4 v21, s[20:23], s45 offen offset:1024 lds
s_add_u32 s45, s42, 688128
s_add_u32 m0, s77, 24576
s_nop 0
buffer_load_dwordx4 v20, s[12:15], s45 offen offset:0 lds
buffer_load_dwordx4 v21, s[12:15], s45 offen offset:1024 lds
s_add_u32 s45, s42, 688128
s_add_u32 m0, s77, 26624
s_nop 0
buffer_load_dwordx4 v20, s[20:23], s45 offen offset:0 lds
buffer_load_dwordx4 v21, s[20:23], s45 offen offset:1024 lds
s_add_u32 s45, s42, 802816
s_add_u32 m0, s77, 28672
s_nop 0
buffer_load_dwordx4 v20, s[12:15], s45 offen offset:0 lds
buffer_load_dwordx4 v21, s[12:15], s45 offen offset:1024 lds
s_add_u32 s45, s42, 802816
s_add_u32 m0, s77, 30720
s_nop 0
buffer_load_dwordx4 v20, s[20:23], s45 offen offset:0 lds
buffer_load_dwordx4 v21, s[20:23], s45 offen offset:1024 lds
s_add_u32 s45, s42, 917504
s_add_u32 m0, s77, 32768
s_nop 0
buffer_load_dwordx4 v20, s[12:15], s45 offen offset:0 lds
buffer_load_dwordx4 v21, s[12:15], s45 offen offset:1024 lds
s_add_u32 s45, s42, 917504
s_add_u32 m0, s77, 34816
s_nop 0
buffer_load_dwordx4 v20, s[20:23], s45 offen offset:0 lds
buffer_load_dwordx4 v21, s[20:23], s45 offen offset:1024 lds
s_add_u32 s45, s42, 1032192
s_add_u32 m0, s77, 36864
s_nop 0
buffer_load_dwordx4 v20, s[12:15], s45 offen offset:0 lds
buffer_load_dwordx4 v21, s[12:15], s45 offen offset:1024 lds
s_waitcnt vmcnt(36)
ds_read_b32 v40, v22 offset:0
ds_read_b32 v41, v22 offset:64
ds_read_b32 v42, v22 offset:128
ds_read_b32 v43, v22 offset:192
ds_read_b32 v44, v22 offset:256
ds_read_b32 v45, v22 offset:320
ds_read_b32 v46, v22 offset:384
ds_read_b32 v47, v22 offset:448
s_waitcnt lgkmcnt(6)
v_perm_b32 v32, v41, v40, s46
v_perm_b32 v36, v41, v40, s47
s_waitcnt lgkmcnt(4)
v_perm_b32 v33, v43, v42, s46
v_perm_b32 v37, v43, v42, s47
s_waitcnt lgkmcnt(2)
v_perm_b32 v34, v45, v44, s46
v_perm_b32 v38, v45, v44, s47
s_waitcnt lgkmcnt(0)
v_perm_b32 v35, v47, v46, s46
v_perm_b32 v39, v47, v46, s47
s_add_u32 s45, s42, 1032192
s_add_u32 m0, s77, 0
s_nop 0
buffer_load_dwordx4 v20, s[20:23], s45 offen offset:0 lds
buffer_load_dwordx4 v21, s[20:23], s45 offen offset:1024 lds
v_accvgpr_write_b32 a0, v32
v_accvgpr_write_b32 a1, v33
v_accvgpr_write_b32 a2, v34
v_accvgpr_write_b32 a3, v35
v_accvgpr_write_b32 a4, v36
v_accvgpr_write_b32 a5, v37
v_accvgpr_write_b32 a6, v38
v_accvgpr_write_b32 a7, v39
s_waitcnt vmcnt(36)
ds_read_b32 v40, v22 offset:2048
ds_read_b32 v41, v22 offset:2112
ds_read_b32 v42, v22 offset:2176
ds_read_b32 v43, v22 offset:2240
ds_read_b32 v44, v22 offset:2304
ds_read_b32 v45, v22 offset:2368
ds_read_b32 v46, v22 offset:2432
ds_read_b32 v47, v22 offset:2496
s_waitcnt lgkmcnt(6)
v_perm_b32 v32, v41, v40, s46
v_perm_b32 v36, v41, v40, s47
s_waitcnt lgkmcnt(4)
v_perm_b32 v33, v43, v42, s46
v_perm_b32 v37, v43, v42, s47
s_waitcnt lgkmcnt(2)
v_perm_b32 v34, v45, v44, s46
v_perm_b32 v38, v45, v44, s47
s_waitcnt lgkmcnt(0)
v_perm_b32 v35, v47, v46, s46
v_perm_b32 v39, v47, v46, s47
s_add_u32 s45, s42, 1146880
s_add_u32 m0, s77, 2048
s_nop 0
buffer_load_dwordx4 v20, s[12:15], s45 offen offset:0 lds
buffer_load_dwordx4 v21, s[12:15], s45 offen offset:1024 lds
v_accvgpr_write_b32 a128, v32
v_accvgpr_write_b32 a129, v33
v_accvgpr_write_b32 a130, v34
v_accvgpr_write_b32 a131, v35
v_accvgpr_write_b32 a132, v36
v_accvgpr_write_b32 a133, v37
v_accvgpr_write_b32 a134, v38
v_accvgpr_write_b32 a135, v39
s_waitcnt vmcnt(36)
ds_read_b32 v40, v22 offset:4096
ds_read_b32 v41, v22 offset:4160
ds_read_b32 v42, v22 offset:4224
ds_read_b32 v43, v22 offset:4288
ds_read_b32 v44, v22 offset:4352
ds_read_b32 v45, v22 offset:4416
ds_read_b32 v46, v22 offset:4480
ds_read_b32 v47, v22 offset:4544
s_waitcnt lgkmcnt(6)
v_perm_b32 v32, v41, v40, s46
v_perm_b32 v36, v41, v40, s47
s_waitcnt lgkmcnt(4)
v_perm_b32 v33, v43, v42, s46
v_perm_b32 v37, v43, v42, s47
s_waitcnt lgkmcnt(2)
v_perm_b32 v34, v45, v44, s46
v_perm_b32 v38, v45, v44, s47
s_waitcnt lgkmcnt(0)
v_perm_b32 v35, v47, v46, s46
v_perm_b32 v39, v47, v46, s47
s_add_u32 s45, s42, 1146880
s_add_u32 m0, s77, 4096
s_nop 0
buffer_load_dwordx4 v20, s[20:23], s45 offen offset:0 lds
buffer_load_dwordx4 v21, s[20:23], s45 offen offset:1024 lds
v_accvgpr_write_b32 a8, v32
v_accvgpr_write_b32 a9, v33
v_accvgpr_write_b32 a10, v34
v_accvgpr_write_b32 a11, v35
v_accvgpr_write_b32 a12, v36
v_accvgpr_write_b32 a13, v37
v_accvgpr_write_b32 a14, v38
v_accvgpr_write_b32 a15, v39
s_waitcnt vmcnt(36)
ds_read_b32 v40, v22 offset:6144
ds_read_b32 v41, v22 offset:6208
ds_read_b32 v42, v22 offset:6272
ds_read_b32 v43, v22 offset:6336
ds_read_b32 v44, v22 offset:6400
ds_read_b32 v45, v22 offset:6464
ds_read_b32 v46, v22 offset:6528
ds_read_b32 v47, v22 offset:6592
s_waitcnt lgkmcnt(6)
v_perm_b32 v32, v41, v40, s46
v_perm_b32 v36, v41, v40, s47
s_waitcnt lgkmcnt(4)
v_perm_b32 v33, v43, v42, s46
v_perm_b32 v37, v43, v42, s47
s_waitcnt lgkmcnt(2)
v_perm_b32 v34, v45, v44, s46
v_perm_b32 v38, v45, v44, s47
s_waitcnt lgkmcnt(0)
v_perm_b32 v35, v47, v46, s46
v_perm_b32 v39, v47, v46, s47
s_add_u32 s45, s42, 1261568
s_add_u32 m0, s77, 6144
s_nop 0
buffer_load_dwordx4 v20, s[12:15], s45 offen offset:0 lds
buffer_load_dwordx4 v21, s[12:15], s45 offen offset:1024 lds
v_accvgpr_write_b32 a136, v32
v_accvgpr_write_b32 a137, v33
v_accvgpr_write_b32 a138, v34
v_accvgpr_write_b32 a139, v35
v_accvgpr_write_b32 a140, v36
v_accvgpr_write_b32 a141, v37
v_accvgpr_write_b32 a142, v38
v_accvgpr_write_b32 a143, v39
s_waitcnt vmcnt(36)
ds_read_b32 v40, v22 offset:8192
ds_read_b32 v41, v22 offset:8256
ds_read_b32 v42, v22 offset:8320
ds_read_b32 v43, v22 offset:8384
ds_read_b32 v44, v22 offset:8448
ds_read_b32 v45, v22 offset:8512
ds_read_b32 v46, v22 offset:8576
ds_read_b32 v47, v22 offset:8640
s_waitcnt lgkmcnt(6)
v_perm_b32 v32, v41, v40, s46
v_perm_b32 v36, v41, v40, s47
s_waitcnt lgkmcnt(4)
v_perm_b32 v33, v43, v42, s46
v_perm_b32 v37, v43, v42, s47
s_waitcnt lgkmcnt(2)
v_perm_b32 v34, v45, v44, s46
v_perm_b32 v38, v45, v44, s47
s_waitcnt lgkmcnt(0)
v_perm_b32 v35, v47, v46, s46
v_perm_b32 v39, v47, v46, s47
s_add_u32 s45, s42, 1261568
s_add_u32 m0, s77, 8192
s_nop 0
buffer_load_dwordx4 v20, s[20:23], s45 offen offset:0 lds
buffer_load_dwordx4 v21, s[20:23], s45 offen offset:1024 lds
v_accvgpr_write_b32 a16, v32
v_accvgpr_write_b32 a17, v33
v_accvgpr_write_b32 a18, v34
v_accvgpr_write_b32 a19, v35
v_accvgpr_write_b32 a20, v36
v_accvgpr_write_b32 a21, v37
v_accvgpr_write_b32 a22, v38
v_accvgpr_write_b32 a23, v39
s_waitcnt vmcnt(36)
ds_read_b32 v40, v22 offset:10240
ds_read_b32 v41, v22 offset:10304
ds_read_b32 v42, v22 offset:10368
ds_read_b32 v43, v22 offset:10432
ds_read_b32 v44, v22 offset:10496
ds_read_b32 v45, v22 offset:10560
ds_read_b32 v46, v22 offset:10624
ds_read_b32 v47, v22 offset:10688
s_waitcnt lgkmcnt(6)
v_perm_b32 v32, v41, v40, s46
v_perm_b32 v36, v41, v40, s47
s_waitcnt lgkmcnt(4)
v_perm_b32 v33, v43, v42, s46
v_perm_b32 v37, v43, v42, s47
s_waitcnt lgkmcnt(2)
v_perm_b32 v34, v45, v44, s46
v_perm_b32 v38, v45, v44, s47
s_waitcnt lgkmcnt(0)
v_perm_b32 v35, v47, v46, s46
v_perm_b32 v39, v47, v46, s47
s_add_u32 s45, s42, 1376256
s_add_u32 m0, s77, 10240
s_nop 0
buffer_load_dwordx4 v20, s[12:15], s45 offen offset:0 lds
buffer_load_dwordx4 v21, s[12:15], s45 offen offset:1024 lds
v_accvgpr_write_b32 a144, v32
v_accvgpr_write_b32 a145, v33
v_accvgpr_write_b32 a146, v34
v_accvgpr_write_b32 a147, v35
v_accvgpr_write_b32 a148, v36
v_accvgpr_write_b32 a149, v37
v_accvgpr_write_b32 a150, v38
v_accvgpr_write_b32 a151, v39
s_waitcnt vmcnt(36)
ds_read_b32 v40, v22 offset:12288
ds_read_b32 v41, v22 offset:12352
ds_read_b32 v42, v22 offset:12416
ds_read_b32 v43, v22 offset:12480
ds_read_b32 v44, v22 offset:12544
ds_read_b32 v45, v22 offset:12608
ds_read_b32 v46, v22 offset:12672
ds_read_b32 v47, v22 offset:12736
s_waitcnt lgkmcnt(6)
v_perm_b32 v32, v41, v40, s46
v_perm_b32 v36, v41, v40, s47
s_waitcnt lgkmcnt(4)
v_perm_b32 v33, v43, v42, s46
v_perm_b32 v37, v43, v42, s47
s_waitcnt lgkmcnt(2)
v_perm_b32 v34, v45, v44, s46
v_perm_b32 v38, v45, v44, s47
s_waitcnt lgkmcnt(0)
v_perm_b32 v35, v47, v46, s46
v_perm_b32 v39, v47, v46, s47
s_add_u32 s45, s42, 1376256
s_add_u32 m0, s77, 12288
s_nop 0
buffer_load_dwordx4 v20, s[20:23], s45 offen offset:0 lds
buffer_load_dwordx4 v21, s[20:23], s45 offen offset:1024 lds
v_accvgpr_write_b32 a24, v32
v_accvgpr_write_b32 a25, v33
v_accvgpr_write_b32 a26, v34
v_accvgpr_write_b32 a27, v35
v_accvgpr_write_b32 a28, v36
v_accvgpr_write_b32 a29, v37
v_accvgpr_write_b32 a30, v38
v_accvgpr_write_b32 a31, v39
s_waitcnt vmcnt(36)
ds_read_b32 v40, v22 offset:14336
ds_read_b32 v41, v22 offset:14400
ds_read_b32 v42, v22 offset:14464
ds_read_b32 v43, v22 offset:14528
ds_read_b32 v44, v22 offset:14592
ds_read_b32 v45, v22 offset:14656
ds_read_b32 v46, v22 offset:14720
ds_read_b32 v47, v22 offset:14784
s_waitcnt lgkmcnt(6)
v_perm_b32 v32, v41, v40, s46
v_perm_b32 v36, v41, v40, s47
s_waitcnt lgkmcnt(4)
v_perm_b32 v33, v43, v42, s46
v_perm_b32 v37, v43, v42, s47
s_waitcnt lgkmcnt(2)
v_perm_b32 v34, v45, v44, s46
v_perm_b32 v38, v45, v44, s47
s_waitcnt lgkmcnt(0)
v_perm_b32 v35, v47, v46, s46
v_perm_b32 v39, v47, v46, s47
s_add_u32 s45, s42, 1490944
s_add_u32 m0, s77, 14336
s_nop 0
buffer_load_dwordx4 v20, s[12:15], s45 offen offset:0 lds
buffer_load_dwordx4 v21, s[12:15], s45 offen offset:1024 lds
v_accvgpr_write_b32 a152, v32
v_accvgpr_write_b32 a153, v33
v_accvgpr_write_b32 a154, v34
v_accvgpr_write_b32 a155, v35
v_accvgpr_write_b32 a156, v36
v_accvgpr_write_b32 a157, v37
v_accvgpr_write_b32 a158, v38
v_accvgpr_write_b32 a159, v39
s_waitcnt vmcnt(36)
ds_read_b32 v40, v22 offset:16384
ds_read_b32 v41, v22 offset:16448
ds_read_b32 v42, v22 offset:16512
ds_read_b32 v43, v22 offset:16576
ds_read_b32 v44, v22 offset:16640
ds_read_b32 v45, v22 offset:16704
ds_read_b32 v46, v22 offset:16768
ds_read_b32 v47, v22 offset:16832
s_waitcnt lgkmcnt(6)
v_perm_b32 v32, v41, v40, s46
v_perm_b32 v36, v41, v40, s47
s_waitcnt lgkmcnt(4)
v_perm_b32 v33, v43, v42, s46
v_perm_b32 v37, v43, v42, s47
s_waitcnt lgkmcnt(2)
v_perm_b32 v34, v45, v44, s46
v_perm_b32 v38, v45, v44, s47
s_waitcnt lgkmcnt(0)
v_perm_b32 v35, v47, v46, s46
v_perm_b32 v39, v47, v46, s47
s_add_u32 s45, s42, 1490944
s_add_u32 m0, s77, 16384
s_nop 0
buffer_load_dwordx4 v20, s[20:23], s45 offen offset:0 lds
buffer_load_dwordx4 v21, s[20:23], s45 offen offset:1024 lds
v_accvgpr_write_b32 a32, v32
v_accvgpr_write_b32 a33, v33
v_accvgpr_write_b32 a34, v34
v_accvgpr_write_b32 a35, v35
v_accvgpr_write_b32 a36, v36
v_accvgpr_write_b32 a37, v37
v_accvgpr_write_b32 a38, v38
v_accvgpr_write_b32 a39, v39
s_waitcnt vmcnt(36)
ds_read_b32 v40, v22 offset:18432
ds_read_b32 v41, v22 offset:18496
ds_read_b32 v42, v22 offset:18560
ds_read_b32 v43, v22 offset:18624
ds_read_b32 v44, v22 offset:18688
ds_read_b32 v45, v22 offset:18752
ds_read_b32 v46, v22 offset:18816
ds_read_b32 v47, v22 offset:18880
s_waitcnt lgkmcnt(6)
v_perm_b32 v32, v41, v40, s46
v_perm_b32 v36, v41, v40, s47
s_waitcnt lgkmcnt(4)
v_perm_b32 v33, v43, v42, s46
v_perm_b32 v37, v43, v42, s47
s_waitcnt lgkmcnt(2)
v_perm_b32 v34, v45, v44, s46
v_perm_b32 v38, v45, v44, s47
s_waitcnt lgkmcnt(0)
v_perm_b32 v35, v47, v46, s46
v_perm_b32 v39, v47, v46, s47
s_add_u32 s45, s42, 1605632
s_add_u32 m0, s77, 18432
s_nop 0
buffer_load_dwordx4 v20, s[12:15], s45 offen offset:0 lds
buffer_load_dwordx4 v21, s[12:15], s45 offen offset:1024 lds
v_accvgpr_write_b32 a160, v32
v_accvgpr_write_b32 a161, v33
v_accvgpr_write_b32 a162, v34
v_accvgpr_write_b32 a163, v35
v_accvgpr_write_b32 a164, v36
v_accvgpr_write_b32 a165, v37
v_accvgpr_write_b32 a166, v38
v_accvgpr_write_b32 a167, v39
s_waitcnt vmcnt(36)
ds_read_b32 v40, v22 offset:20480
ds_read_b32 v41, v22 offset:20544
ds_read_b32 v42, v22 offset:20608
ds_read_b32 v43, v22 offset:20672
ds_read_b32 v44, v22 offset:20736
ds_read_b32 v45, v22 offset:20800
ds_read_b32 v46, v22 offset:20864
ds_read_b32 v47, v22 offset:20928
s_waitcnt lgkmcnt(6)
v_perm_b32 v32, v41, v40, s46
v_perm_b32 v36, v41, v40, s47
s_waitcnt lgkmcnt(4)
v_perm_b32 v33, v43, v42, s46
v_perm_b32 v37, v43, v42, s47
s_waitcnt lgkmcnt(2)
v_perm_b32 v34, v45, v44, s46
v_perm_b32 v38, v45, v44, s47
s_waitcnt lgkmcnt(0)
v_perm_b32 v35, v47, v46, s46
v_perm_b32 v39, v47, v46, s47
s_add_u32 s45, s42, 1605632
s_add_u32 m0, s77, 20480
s_nop 0
buffer_load_dwordx4 v20, s[20:23], s45 offen offset:0 lds
buffer_load_dwordx4 v21, s[20:23], s45 offen offset:1024 lds
v_accvgpr_write_b32 a40, v32
v_accvgpr_write_b32 a41, v33
v_accvgpr_write_b32 a42, v34
v_accvgpr_write_b32 a43, v35
v_accvgpr_write_b32 a44, v36
v_accvgpr_write_b32 a45, v37
v_accvgpr_write_b32 a46, v38
v_accvgpr_write_b32 a47, v39
s_waitcnt vmcnt(36)
ds_read_b32 v40, v22 offset:22528
ds_read_b32 v41, v22 offset:22592
ds_read_b32 v42, v22 offset:22656
ds_read_b32 v43, v22 offset:22720
ds_read_b32 v44, v22 offset:22784
ds_read_b32 v45, v22 offset:22848
ds_read_b32 v46, v22 offset:22912
ds_read_b32 v47, v22 offset:22976
s_waitcnt lgkmcnt(6)
v_perm_b32 v32, v41, v40, s46
v_perm_b32 v36, v41, v40, s47
s_waitcnt lgkmcnt(4)
v_perm_b32 v33, v43, v42, s46
v_perm_b32 v37, v43, v42, s47
s_waitcnt lgkmcnt(2)
v_perm_b32 v34, v45, v44, s46
v_perm_b32 v38, v45, v44, s47
s_waitcnt lgkmcnt(0)
v_perm_b32 v35, v47, v46, s46
v_perm_b32 v39, v47, v46, s47
s_add_u32 s45, s42, 1720320
s_add_u32 m0, s77, 22528
s_nop 0
buffer_load_dwordx4 v20, s[12:15], s45 offen offset:0 lds
buffer_load_dwordx4 v21, s[12:15], s45 offen offset:1024 lds
v_accvgpr_write_b32 a168, v32
v_accvgpr_write_b32 a169, v33
v_accvgpr_write_b32 a170, v34
v_accvgpr_write_b32 a171, v35
v_accvgpr_write_b32 a172, v36
v_accvgpr_write_b32 a173, v37
v_accvgpr_write_b32 a174, v38
v_accvgpr_write_b32 a175, v39
s_waitcnt vmcnt(36)
ds_read_b32 v40, v22 offset:24576
ds_read_b32 v41, v22 offset:24640
ds_read_b32 v42, v22 offset:24704
ds_read_b32 v43, v22 offset:24768
ds_read_b32 v44, v22 offset:24832
ds_read_b32 v45, v22 offset:24896
ds_read_b32 v46, v22 offset:24960
ds_read_b32 v47, v22 offset:25024
s_waitcnt lgkmcnt(6)
v_perm_b32 v32, v41, v40, s46
v_perm_b32 v36, v41, v40, s47
s_waitcnt lgkmcnt(4)
v_perm_b32 v33, v43, v42, s46
v_perm_b32 v37, v43, v42, s47
s_waitcnt lgkmcnt(2)
v_perm_b32 v34, v45, v44, s46
v_perm_b32 v38, v45, v44, s47
s_waitcnt lgkmcnt(0)
v_perm_b32 v35, v47, v46, s46
v_perm_b32 v39, v47, v46, s47
s_add_u32 s45, s42, 1720320
s_add_u32 m0, s77, 24576
s_nop 0
buffer_load_dwordx4 v20, s[20:23], s45 offen offset:0 lds
buffer_load_dwordx4 v21, s[20:23], s45 offen offset:1024 lds
v_accvgpr_write_b32 a48, v32
v_accvgpr_write_b32 a49, v33
v_accvgpr_write_b32 a50, v34
v_accvgpr_write_b32 a51, v35
v_accvgpr_write_b32 a52, v36
v_accvgpr_write_b32 a53, v37
v_accvgpr_write_b32 a54, v38
v_accvgpr_write_b32 a55, v39
s_waitcnt vmcnt(36)
ds_read_b32 v40, v22 offset:26624
ds_read_b32 v41, v22 offset:26688
ds_read_b32 v42, v22 offset:26752
ds_read_b32 v43, v22 offset:26816
ds_read_b32 v44, v22 offset:26880
ds_read_b32 v45, v22 offset:26944
ds_read_b32 v46, v22 offset:27008
ds_read_b32 v47, v22 offset:27072
s_waitcnt lgkmcnt(6)
v_perm_b32 v32, v41, v40, s46
v_perm_b32 v36, v41, v40, s47
s_waitcnt lgkmcnt(4)
v_perm_b32 v33, v43, v42, s46
v_perm_b32 v37, v43, v42, s47
s_waitcnt lgkmcnt(2)
v_perm_b32 v34, v45, v44, s46
v_perm_b32 v38, v45, v44, s47
s_waitcnt lgkmcnt(0)
v_perm_b32 v35, v47, v46, s46
v_perm_b32 v39, v47, v46, s47
v_accvgpr_write_b32 a176, v32
v_accvgpr_write_b32 a177, v33
v_accvgpr_write_b32 a178, v34
v_accvgpr_write_b32 a179, v35
v_accvgpr_write_b32 a180, v36
v_accvgpr_write_b32 a181, v37
v_accvgpr_write_b32 a182, v38
v_accvgpr_write_b32 a183, v39
s_waitcnt vmcnt(34)
ds_read_b32 v40, v22 offset:28672
ds_read_b32 v41, v22 offset:28736
ds_read_b32 v42, v22 offset:28800
ds_read_b32 v43, v22 offset:28864
ds_read_b32 v44, v22 offset:28928
ds_read_b32 v45, v22 offset:28992
ds_read_b32 v46, v22 offset:29056
ds_read_b32 v47, v22 offset:29120
s_waitcnt lgkmcnt(6)
v_perm_b32 v32, v41, v40, s46
v_perm_b32 v36, v41, v40, s47
s_waitcnt lgkmcnt(4)
v_perm_b32 v33, v43, v42, s46
v_perm_b32 v37, v43, v42, s47
s_waitcnt lgkmcnt(2)
v_perm_b32 v34, v45, v44, s46
v_perm_b32 v38, v45, v44, s47
s_waitcnt lgkmcnt(0)
v_perm_b32 v35, v47, v46, s46
v_perm_b32 v39, v47, v46, s47
v_accvgpr_write_b32 a56, v32
v_accvgpr_write_b32 a57, v33
v_accvgpr_write_b32 a58, v34
v_accvgpr_write_b32 a59, v35
v_accvgpr_write_b32 a60, v36
v_accvgpr_write_b32 a61, v37
v_accvgpr_write_b32 a62, v38
v_accvgpr_write_b32 a63, v39
s_waitcnt vmcnt(32)
ds_read_b32 v40, v22 offset:30720
ds_read_b32 v41, v22 offset:30784
ds_read_b32 v42, v22 offset:30848
ds_read_b32 v43, v22 offset:30912
ds_read_b32 v44, v22 offset:30976
ds_read_b32 v45, v22 offset:31040
ds_read_b32 v46, v22 offset:31104
ds_read_b32 v47, v22 offset:31168
s_waitcnt lgkmcnt(6)
v_perm_b32 v32, v41, v40, s46
v_perm_b32 v36, v41, v40, s47
s_waitcnt lgkmcnt(4)
v_perm_b32 v33, v43, v42, s46
v_perm_b32 v37, v43, v42, s47
s_waitcnt lgkmcnt(2)
v_perm_b32 v34, v45, v44, s46
v_perm_b32 v38, v45, v44, s47
s_waitcnt lgkmcnt(0)
v_perm_b32 v35, v47, v46, s46
v_perm_b32 v39, v47, v46, s47
v_accvgpr_write_b32 a184, v32
v_accvgpr_write_b32 a185, v33
v_accvgpr_write_b32 a186, v34
v_accvgpr_write_b32 a187, v35
v_accvgpr_write_b32 a188, v36
v_accvgpr_write_b32 a189, v37
v_accvgpr_write_b32 a190, v38
v_accvgpr_write_b32 a191, v39
s_waitcnt vmcnt(30)
ds_read_b32 v40, v22 offset:32768
ds_read_b32 v41, v22 offset:32832
ds_read_b32 v42, v22 offset:32896
ds_read_b32 v43, v22 offset:32960
ds_read_b32 v44, v22 offset:33024
ds_read_b32 v45, v22 offset:33088
ds_read_b32 v46, v22 offset:33152
ds_read_b32 v47, v22 offset:33216
s_waitcnt lgkmcnt(6)
v_perm_b32 v32, v41, v40, s46
v_perm_b32 v36, v41, v40, s47
s_waitcnt lgkmcnt(4)
v_perm_b32 v33, v43, v42, s46
v_perm_b32 v37, v43, v42, s47
s_waitcnt lgkmcnt(2)
v_perm_b32 v34, v45, v44, s46
v_perm_b32 v38, v45, v44, s47
s_waitcnt lgkmcnt(0)
v_perm_b32 v35, v47, v46, s46
v_perm_b32 v39, v47, v46, s47
v_accvgpr_write_b32 a64, v32
v_accvgpr_write_b32 a65, v33
v_accvgpr_write_b32 a66, v34
v_accvgpr_write_b32 a67, v35
v_accvgpr_write_b32 a68, v36
v_accvgpr_write_b32 a69, v37
v_accvgpr_write_b32 a70, v38
v_accvgpr_write_b32 a71, v39
s_waitcnt vmcnt(28)
ds_read_b32 v40, v22 offset:34816
ds_read_b32 v41, v22 offset:34880
ds_read_b32 v42, v22 offset:34944
ds_read_b32 v43, v22 offset:35008
ds_read_b32 v44, v22 offset:35072
ds_read_b32 v45, v22 offset:35136
ds_read_b32 v46, v22 offset:35200
ds_read_b32 v47, v22 offset:35264
s_waitcnt lgkmcnt(6)
v_perm_b32 v32, v41, v40, s46
v_perm_b32 v36, v41, v40, s47
s_waitcnt lgkmcnt(4)
v_perm_b32 v33, v43, v42, s46
v_perm_b32 v37, v43, v42, s47
s_waitcnt lgkmcnt(2)
v_perm_b32 v34, v45, v44, s46
v_perm_b32 v38, v45, v44, s47
s_waitcnt lgkmcnt(0)
v_perm_b32 v35, v47, v46, s46
v_perm_b32 v39, v47, v46, s47
v_accvgpr_write_b32 a192, v32
v_accvgpr_write_b32 a193, v33
v_accvgpr_write_b32 a194, v34
v_accvgpr_write_b32 a195, v35
v_accvgpr_write_b32 a196, v36
v_accvgpr_write_b32 a197, v37
v_accvgpr_write_b32 a198, v38
v_accvgpr_write_b32 a199, v39
s_waitcnt vmcnt(26)
ds_read_b32 v40, v22 offset:36864
ds_read_b32 v41, v22 offset:36928
ds_read_b32 v42, v22 offset:36992
ds_read_b32 v43, v22 offset:37056
ds_read_b32 v44, v22 offset:37120
ds_read_b32 v45, v22 offset:37184
ds_read_b32 v46, v22 offset:37248
ds_read_b32 v47, v22 offset:37312
s_waitcnt lgkmcnt(6)
v_perm_b32 v32, v41, v40, s46
v_perm_b32 v36, v41, v40, s47
s_waitcnt lgkmcnt(4)
v_perm_b32 v33, v43, v42, s46
v_perm_b32 v37, v43, v42, s47
s_waitcnt lgkmcnt(2)
v_perm_b32 v34, v45, v44, s46
v_perm_b32 v38, v45, v44, s47
s_waitcnt lgkmcnt(0)
v_perm_b32 v35, v47, v46, s46
v_perm_b32 v39, v47, v46, s47
v_accvgpr_write_b32 a72, v32
v_accvgpr_write_b32 a73, v33
v_accvgpr_write_b32 a74, v34
v_accvgpr_write_b32 a75, v35
v_accvgpr_write_b32 a76, v36
v_accvgpr_write_b32 a77, v37
v_accvgpr_write_b32 a78, v38
v_accvgpr_write_b32 a79, v39
s_waitcnt vmcnt(24)
ds_read_b32 v40, v22 offset:0
ds_read_b32 v41, v22 offset:64
ds_read_b32 v42, v22 offset:128
ds_read_b32 v43, v22 offset:192
ds_read_b32 v44, v22 offset:256
ds_read_b32 v45, v22 offset:320
ds_read_b32 v46, v22 offset:384
ds_read_b32 v47, v22 offset:448
s_waitcnt lgkmcnt(6)
v_perm_b32 v32, v41, v40, s46
v_perm_b32 v36, v41, v40, s47
s_waitcnt lgkmcnt(4)
v_perm_b32 v33, v43, v42, s46
v_perm_b32 v37, v43, v42, s47
s_waitcnt lgkmcnt(2)
v_perm_b32 v34, v45, v44, s46
v_perm_b32 v38, v45, v44, s47
s_waitcnt lgkmcnt(0)
v_perm_b32 v35, v47, v46, s46
v_perm_b32 v39, v47, v46, s47
v_accvgpr_write_b32 a200, v32
v_accvgpr_write_b32 a201, v33
v_accvgpr_write_b32 a202, v34
v_accvgpr_write_b32 a203, v35
v_accvgpr_write_b32 a204, v36
v_accvgpr_write_b32 a205, v37
v_accvgpr_write_b32 a206, v38
v_accvgpr_write_b32 a207, v39
s_waitcnt vmcnt(22)
ds_read_b32 v40, v22 offset:2048
ds_read_b32 v41, v22 offset:2112
ds_read_b32 v42, v22 offset:2176
ds_read_b32 v43, v22 offset:2240
ds_read_b32 v44, v22 offset:2304
ds_read_b32 v45, v22 offset:2368
ds_read_b32 v46, v22 offset:2432
ds_read_b32 v47, v22 offset:2496
s_waitcnt lgkmcnt(6)
v_perm_b32 v32, v41, v40, s46
v_perm_b32 v36, v41, v40, s47
s_waitcnt lgkmcnt(4)
v_perm_b32 v33, v43, v42, s46
v_perm_b32 v37, v43, v42, s47
s_waitcnt lgkmcnt(2)
v_perm_b32 v34, v45, v44, s46
v_perm_b32 v38, v45, v44, s47
s_waitcnt lgkmcnt(0)
v_perm_b32 v35, v47, v46, s46
v_perm_b32 v39, v47, v46, s47
v_accvgpr_write_b32 a80, v32
v_accvgpr_write_b32 a81, v33
v_accvgpr_write_b32 a82, v34
v_accvgpr_write_b32 a83, v35
v_accvgpr_write_b32 a84, v36
v_accvgpr_write_b32 a85, v37
v_accvgpr_write_b32 a86, v38
v_accvgpr_write_b32 a87, v39
s_waitcnt vmcnt(20)
ds_read_b32 v40, v22 offset:4096
ds_read_b32 v41, v22 offset:4160
ds_read_b32 v42, v22 offset:4224
ds_read_b32 v43, v22 offset:4288
ds_read_b32 v44, v22 offset:4352
ds_read_b32 v45, v22 offset:4416
ds_read_b32 v46, v22 offset:4480
ds_read_b32 v47, v22 offset:4544
s_waitcnt lgkmcnt(6)
v_perm_b32 v32, v41, v40, s46
v_perm_b32 v36, v41, v40, s47
s_waitcnt lgkmcnt(4)
v_perm_b32 v33, v43, v42, s46
v_perm_b32 v37, v43, v42, s47
s_waitcnt lgkmcnt(2)
v_perm_b32 v34, v45, v44, s46
v_perm_b32 v38, v45, v44, s47
s_waitcnt lgkmcnt(0)
v_perm_b32 v35, v47, v46, s46
v_perm_b32 v39, v47, v46, s47
v_accvgpr_write_b32 a208, v32
v_accvgpr_write_b32 a209, v33
v_accvgpr_write_b32 a210, v34
v_accvgpr_write_b32 a211, v35
v_accvgpr_write_b32 a212, v36
v_accvgpr_write_b32 a213, v37
v_accvgpr_write_b32 a214, v38
v_accvgpr_write_b32 a215, v39
s_waitcnt vmcnt(18)
ds_read_b32 v40, v22 offset:6144
ds_read_b32 v41, v22 offset:6208
ds_read_b32 v42, v22 offset:6272
ds_read_b32 v43, v22 offset:6336
ds_read_b32 v44, v22 offset:6400
ds_read_b32 v45, v22 offset:6464
ds_read_b32 v46, v22 offset:6528
ds_read_b32 v47, v22 offset:6592
s_waitcnt lgkmcnt(6)
v_perm_b32 v32, v41, v40, s46
v_perm_b32 v36, v41, v40, s47
s_waitcnt lgkmcnt(4)
v_perm_b32 v33, v43, v42, s46
v_perm_b32 v37, v43, v42, s47
s_waitcnt lgkmcnt(2)
v_perm_b32 v34, v45, v44, s46
v_perm_b32 v38, v45, v44, s47
s_waitcnt lgkmcnt(0)
v_perm_b32 v35, v47, v46, s46
v_perm_b32 v39, v47, v46, s47
v_accvgpr_write_b32 a88, v32
v_accvgpr_write_b32 a89, v33
v_accvgpr_write_b32 a90, v34
v_accvgpr_write_b32 a91, v35
v_accvgpr_write_b32 a92, v36
v_accvgpr_write_b32 a93, v37
v_accvgpr_write_b32 a94, v38
v_accvgpr_write_b32 a95, v39
s_waitcnt vmcnt(16)
ds_read_b32 v40, v22 offset:8192
ds_read_b32 v41, v22 offset:8256
ds_read_b32 v42, v22 offset:8320
ds_read_b32 v43, v22 offset:8384
ds_read_b32 v44, v22 offset:8448
ds_read_b32 v45, v22 offset:8512
ds_read_b32 v46, v22 offset:8576
ds_read_b32 v47, v22 offset:8640
s_waitcnt lgkmcnt(6)
v_perm_b32 v32, v41, v40, s46
v_perm_b32 v36, v41, v40, s47
s_waitcnt lgkmcnt(4)
v_perm_b32 v33, v43, v42, s46
v_perm_b32 v37, v43, v42, s47
s_waitcnt lgkmcnt(2)
v_perm_b32 v34, v45, v44, s46
v_perm_b32 v38, v45, v44, s47
s_waitcnt lgkmcnt(0)
v_perm_b32 v35, v47, v46, s46
v_perm_b32 v39, v47, v46, s47
v_accvgpr_write_b32 a216, v32
v_accvgpr_write_b32 a217, v33
v_accvgpr_write_b32 a218, v34
v_accvgpr_write_b32 a219, v35
v_accvgpr_write_b32 a220, v36
v_accvgpr_write_b32 a221, v37
v_accvgpr_write_b32 a222, v38
v_accvgpr_write_b32 a223, v39
s_waitcnt vmcnt(14)
ds_read_b32 v40, v22 offset:10240
ds_read_b32 v41, v22 offset:10304
ds_read_b32 v42, v22 offset:10368
ds_read_b32 v43, v22 offset:10432
ds_read_b32 v44, v22 offset:10496
ds_read_b32 v45, v22 offset:10560
ds_read_b32 v46, v22 offset:10624
ds_read_b32 v47, v22 offset:10688
s_waitcnt lgkmcnt(6)
v_perm_b32 v32, v41, v40, s46
v_perm_b32 v36, v41, v40, s47
s_waitcnt lgkmcnt(4)
v_perm_b32 v33, v43, v42, s46
v_perm_b32 v37, v43, v42, s47
s_waitcnt lgkmcnt(2)
v_perm_b32 v34, v45, v44, s46
v_perm_b32 v38, v45, v44, s47
s_waitcnt lgkmcnt(0)
v_perm_b32 v35, v47, v46, s46
v_perm_b32 v39, v47, v46, s47
v_accvgpr_write_b32 a96, v32
v_accvgpr_write_b32 a97, v33
v_accvgpr_write_b32 a98, v34
v_accvgpr_write_b32 a99, v35
v_accvgpr_write_b32 a100, v36
v_accvgpr_write_b32 a101, v37
v_accvgpr_write_b32 a102, v38
v_accvgpr_write_b32 a103, v39
s_waitcnt vmcnt(12)
ds_read_b32 v40, v22 offset:12288
ds_read_b32 v41, v22 offset:12352
ds_read_b32 v42, v22 offset:12416
ds_read_b32 v43, v22 offset:12480
ds_read_b32 v44, v22 offset:12544
ds_read_b32 v45, v22 offset:12608
ds_read_b32 v46, v22 offset:12672
ds_read_b32 v47, v22 offset:12736
s_waitcnt lgkmcnt(6)
v_perm_b32 v32, v41, v40, s46
v_perm_b32 v36, v41, v40, s47
s_waitcnt lgkmcnt(4)
v_perm_b32 v33, v43, v42, s46
v_perm_b32 v37, v43, v42, s47
s_waitcnt lgkmcnt(2)
v_perm_b32 v34, v45, v44, s46
v_perm_b32 v38, v45, v44, s47
s_waitcnt lgkmcnt(0)
v_perm_b32 v35, v47, v46, s46
v_perm_b32 v39, v47, v46, s47
v_accvgpr_write_b32 a224, v32
v_accvgpr_write_b32 a225, v33
v_accvgpr_write_b32 a226, v34
v_accvgpr_write_b32 a227, v35
v_accvgpr_write_b32 a228, v36
v_accvgpr_write_b32 a229, v37
v_accvgpr_write_b32 a230, v38
v_accvgpr_write_b32 a231, v39
s_waitcnt vmcnt(10)
ds_read_b32 v40, v22 offset:14336
ds_read_b32 v41, v22 offset:14400
ds_read_b32 v42, v22 offset:14464
ds_read_b32 v43, v22 offset:14528
ds_read_b32 v44, v22 offset:14592
ds_read_b32 v45, v22 offset:14656
ds_read_b32 v46, v22 offset:14720
ds_read_b32 v47, v22 offset:14784
s_waitcnt lgkmcnt(6)
v_perm_b32 v32, v41, v40, s46
v_perm_b32 v36, v41, v40, s47
s_waitcnt lgkmcnt(4)
v_perm_b32 v33, v43, v42, s46
v_perm_b32 v37, v43, v42, s47
s_waitcnt lgkmcnt(2)
v_perm_b32 v34, v45, v44, s46
v_perm_b32 v38, v45, v44, s47
s_waitcnt lgkmcnt(0)
v_perm_b32 v35, v47, v46, s46
v_perm_b32 v39, v47, v46, s47
v_accvgpr_write_b32 a104, v32
v_accvgpr_write_b32 a105, v33
v_accvgpr_write_b32 a106, v34
v_accvgpr_write_b32 a107, v35
v_accvgpr_write_b32 a108, v36
v_accvgpr_write_b32 a109, v37
v_accvgpr_write_b32 a110, v38
v_accvgpr_write_b32 a111, v39
s_waitcnt vmcnt(8)
ds_read_b32 v40, v22 offset:16384
ds_read_b32 v41, v22 offset:16448
ds_read_b32 v42, v22 offset:16512
ds_read_b32 v43, v22 offset:16576
ds_read_b32 v44, v22 offset:16640
ds_read_b32 v45, v22 offset:16704
ds_read_b32 v46, v22 offset:16768
ds_read_b32 v47, v22 offset:16832
s_waitcnt lgkmcnt(6)
v_perm_b32 v32, v41, v40, s46
v_perm_b32 v36, v41, v40, s47
s_waitcnt lgkmcnt(4)
v_perm_b32 v33, v43, v42, s46
v_perm_b32 v37, v43, v42, s47
s_waitcnt lgkmcnt(2)
v_perm_b32 v34, v45, v44, s46
v_perm_b32 v38, v45, v44, s47
s_waitcnt lgkmcnt(0)
v_perm_b32 v35, v47, v46, s46
v_perm_b32 v39, v47, v46, s47
v_accvgpr_write_b32 a232, v32
v_accvgpr_write_b32 a233, v33
v_accvgpr_write_b32 a234, v34
v_accvgpr_write_b32 a235, v35
v_accvgpr_write_b32 a236, v36
v_accvgpr_write_b32 a237, v37
v_accvgpr_write_b32 a238, v38
v_accvgpr_write_b32 a239, v39
s_waitcnt vmcnt(6)
ds_read_b32 v40, v22 offset:18432
ds_read_b32 v41, v22 offset:18496
ds_read_b32 v42, v22 offset:18560
ds_read_b32 v43, v22 offset:18624
ds_read_b32 v44, v22 offset:18688
ds_read_b32 v45, v22 offset:18752
ds_read_b32 v46, v22 offset:18816
ds_read_b32 v47, v22 offset:18880
s_waitcnt lgkmcnt(6)
v_perm_b32 v32, v41, v40, s46
v_perm_b32 v36, v41, v40, s47
s_waitcnt lgkmcnt(4)
v_perm_b32 v33, v43, v42, s46
v_perm_b32 v37, v43, v42, s47
s_waitcnt lgkmcnt(2)
v_perm_b32 v34, v45, v44, s46
v_perm_b32 v38, v45, v44, s47
s_waitcnt lgkmcnt(0)
v_perm_b32 v35, v47, v46, s46
v_perm_b32 v39, v47, v46, s47
v_accvgpr_write_b32 a112, v32
v_accvgpr_write_b32 a113, v33
v_accvgpr_write_b32 a114, v34
v_accvgpr_write_b32 a115, v35
v_accvgpr_write_b32 a116, v36
v_accvgpr_write_b32 a117, v37
v_accvgpr_write_b32 a118, v38
v_accvgpr_write_b32 a119, v39
s_waitcnt vmcnt(4)
ds_read_b32 v40, v22 offset:20480
ds_read_b32 v41, v22 offset:20544
ds_read_b32 v42, v22 offset:20608
ds_read_b32 v43, v22 offset:20672
ds_read_b32 v44, v22 offset:20736
ds_read_b32 v45, v22 offset:20800
ds_read_b32 v46, v22 offset:20864
ds_read_b32 v47, v22 offset:20928
s_waitcnt lgkmcnt(6)
v_perm_b32 v32, v41, v40, s46
v_perm_b32 v36, v41, v40, s47
s_waitcnt lgkmcnt(4)
v_perm_b32 v33, v43, v42, s46
v_perm_b32 v37, v43, v42, s47
s_waitcnt lgkmcnt(2)
v_perm_b32 v34, v45, v44, s46
v_perm_b32 v38, v45, v44, s47
s_waitcnt lgkmcnt(0)
v_perm_b32 v35, v47, v46, s46
v_perm_b32 v39, v47, v46, s47
v_accvgpr_write_b32 a240, v32
v_accvgpr_write_b32 a241, v33
v_accvgpr_write_b32 a242, v34
v_accvgpr_write_b32 a243, v35
v_accvgpr_write_b32 a244, v36
v_accvgpr_write_b32 a245, v37
v_accvgpr_write_b32 a246, v38
v_accvgpr_write_b32 a247, v39
s_waitcnt vmcnt(2)
ds_read_b32 v40, v22 offset:22528
ds_read_b32 v41, v22 offset:22592
ds_read_b32 v42, v22 offset:22656
ds_read_b32 v43, v22 offset:22720
ds_read_b32 v44, v22 offset:22784
ds_read_b32 v45, v22 offset:22848
ds_read_b32 v46, v22 offset:22912
ds_read_b32 v47, v22 offset:22976
s_waitcnt lgkmcnt(6)
v_perm_b32 v32, v41, v40, s46
v_perm_b32 v36, v41, v40, s47
s_waitcnt lgkmcnt(4)
v_perm_b32 v33, v43, v42, s46
v_perm_b32 v37, v43, v42, s47
s_waitcnt lgkmcnt(2)
v_perm_b32 v34, v45, v44, s46
v_perm_b32 v38, v45, v44, s47
s_waitcnt lgkmcnt(0)
v_perm_b32 v35, v47, v46, s46
v_perm_b32 v39, v47, v46, s47
v_accvgpr_write_b32 a120, v32
v_accvgpr_write_b32 a121, v33
v_accvgpr_write_b32 a122, v34
v_accvgpr_write_b32 a123, v35
v_accvgpr_write_b32 a124, v36
v_accvgpr_write_b32 a125, v37
v_accvgpr_write_b32 a126, v38
v_accvgpr_write_b32 a127, v39
s_waitcnt vmcnt(0)
ds_read_b32 v40, v22 offset:24576
ds_read_b32 v41, v22 offset:24640
ds_read_b32 v42, v22 offset:24704
ds_read_b32 v43, v22 offset:24768
ds_read_b32 v44, v22 offset:24832
ds_read_b32 v45, v22 offset:24896
ds_read_b32 v46, v22 offset:24960
ds_read_b32 v47, v22 offset:25024
s_waitcnt lgkmcnt(6)
v_perm_b32 v32, v41, v40, s46
v_perm_b32 v36, v41, v40, s47
s_waitcnt lgkmcnt(4)
v_perm_b32 v33, v43, v42, s46
v_perm_b32 v37, v43, v42, s47
s_waitcnt lgkmcnt(2)
v_perm_b32 v34, v45, v44, s46
v_perm_b32 v38, v45, v44, s47
s_waitcnt lgkmcnt(0)
v_perm_b32 v35, v47, v46, s46
v_perm_b32 v39, v47, v46, s47
v_accvgpr_write_b32 a248, v32
v_accvgpr_write_b32 a249, v33
v_accvgpr_write_b32 a250, v34
v_accvgpr_write_b32 a251, v35
v_accvgpr_write_b32 a252, v36
v_accvgpr_write_b32 a253, v37
v_accvgpr_write_b32 a254, v38
v_accvgpr_write_b32 a255, v39
s_lshl_b32 s40, s98, 17
s_lshl_b32 s41, s32, 8
s_add_u32 s40, s40, s41
v_lshlrev_b32 v20, 4, v3
v_lshl_add_u32 v20, v4, 13, v20
v_add_u32 v20, s40, v20
v_add_u32 v21, 4096, v20
s_mov_b32 s45, 0
buffer_load_dwordx4 v[32:35], v20, s[24:27], s45 offen
buffer_load_dwordx4 v[36:39], v20, s[24:27], s45 offen offset:1024
buffer_load_dwordx4 v[40:43], v20, s[24:27], s45 offen offset:2048
buffer_load_dwordx4 v[44:47], v20, s[24:27], s45 offen offset:3072
buffer_load_dwordx4 v[48:51], v21, s[24:27], s45 offen
buffer_load_dwordx4 v[52:55], v21, s[24:27], s45 offen offset:1024
buffer_load_dwordx4 v[56:59], v21, s[24:27], s45 offen offset:2048
buffer_load_dwordx4 v[60:63], v21, s[24:27], s45 offen offset:3072
s_mov_b32 s45, 32768
buffer_load_dwordx4 v[64:67], v20, s[24:27], s45 offen
buffer_load_dwordx4 v[68:71], v20, s[24:27], s45 offen offset:1024
buffer_load_dwordx4 v[72:75], v20, s[24:27], s45 offen offset:2048
buffer_load_dwordx4 v[76:79], v20, s[24:27], s45 offen offset:3072
buffer_load_dwordx4 v[80:83], v21, s[24:27], s45 offen
buffer_load_dwordx4 v[84:87], v21, s[24:27], s45 offen offset:1024
buffer_load_dwordx4 v[88:91], v21, s[24:27], s45 offen offset:2048
buffer_load_dwordx4 v[92:95], v21, s[24:27], s45 offen offset:3072
s_mov_b32 s45, 65536
buffer_load_dwordx4 v[96:99], v20, s[24:27], s45 offen
buffer_load_dwordx4 v[100:103], v20, s[24:27], s45 offen offset:1024
buffer_load_dwordx4 v[104:107], v20, s[24:27], s45 offen offset:2048
buffer_load_dwordx4 v[108:111], v20, s[24:27], s45 offen offset:3072
buffer_load_dwordx4 v[112:115], v21, s[24:27], s45 offen
buffer_load_dwordx4 v[116:119], v21, s[24:27], s45 offen offset:1024
buffer_load_dwordx4 v[120:123], v21, s[24:27], s45 offen offset:2048
buffer_load_dwordx4 v[124:127], v21, s[24:27], s45 offen offset:3072
s_waitcnt vmcnt(16)
v_perm_b32 v128, v36, v32, s46
v_perm_b32 v129, v44, v40, s46
v_perm_b32 v130, v52, v48, s46
v_perm_b32 v131, v60, v56, s46
v_perm_b32 v132, v36, v32, s47
v_perm_b32 v133, v44, v40, s47
v_perm_b32 v134, v52, v48, s47
v_perm_b32 v135, v60, v56, s47
v_perm_b32 v136, v37, v33, s46
v_perm_b32 v137, v45, v41, s46
v_perm_b32 v138, v53, v49, s46
v_perm_b32 v139, v61, v57, s46
v_perm_b32 v140, v37, v33, s47
v_perm_b32 v141, v45, v41, s47
v_perm_b32 v142, v53, v49, s47
v_perm_b32 v143, v61, v57, s47
v_perm_b32 v144, v38, v34, s46
v_perm_b32 v145, v46, v42, s46
v_perm_b32 v146, v54, v50, s46
v_perm_b32 v147, v62, v58, s46
v_perm_b32 v148, v38, v34, s47
v_perm_b32 v149, v46, v42, s47
v_perm_b32 v150, v54, v50, s47
v_perm_b32 v151, v62, v58, s47
v_perm_b32 v152, v39, v35, s46
v_perm_b32 v153, v47, v43, s46
v_perm_b32 v154, v55, v51, s46
v_perm_b32 v155, v63, v59, s46
v_perm_b32 v156, v39, v35, s47
v_perm_b32 v157, v47, v43, s47
v_perm_b32 v158, v55, v51, s47
v_perm_b32 v159, v63, v59, s47
s_mov_b32 s45, 98304
buffer_load_dwordx4 v[32:35], v20, s[24:27], s45 offen
buffer_load_dwordx4 v[36:39], v20, s[24:27], s45 offen offset:1024
buffer_load_dwordx4 v[40:43], v20, s[24:27], s45 offen offset:2048
buffer_load_dwordx4 v[44:47], v20, s[24:27], s45 offen offset:3072
buffer_load_dwordx4 v[48:51], v21, s[24:27], s45 offen
buffer_load_dwordx4 v[52:55], v21, s[24:27], s45 offen offset:1024
buffer_load_dwordx4 v[56:59], v21, s[24:27], s45 offen offset:2048
buffer_load_dwordx4 v[60:63], v21, s[24:27], s45 offen offset:3072
s_waitcnt vmcnt(16)
v_perm_b32 v160, v68, v64, s46
v_perm_b32 v161, v76, v72, s46
v_perm_b32 v162, v84, v80, s46
v_perm_b32 v163, v92, v88, s46
v_perm_b32 v164, v68, v64, s47
v_perm_b32 v165, v76, v72, s47
v_perm_b32 v166, v84, v80, s47
v_perm_b32 v167, v92, v88, s47
v_perm_b32 v168, v69, v65, s46
v_perm_b32 v169, v77, v73, s46
v_perm_b32 v170, v85, v81, s46
v_perm_b32 v171, v93, v89, s46
v_perm_b32 v172, v69, v65, s47
v_perm_b32 v173, v77, v73, s47
v_perm_b32 v174, v85, v81, s47
v_perm_b32 v175, v93, v89, s47
v_perm_b32 v176, v70, v66, s46
v_perm_b32 v177, v78, v74, s46
v_perm_b32 v178, v86, v82, s46
v_perm_b32 v179, v94, v90, s46
v_perm_b32 v180, v70, v66, s47
v_perm_b32 v181, v78, v74, s47
v_perm_b32 v182, v86, v82, s47
v_perm_b32 v183, v94, v90, s47
v_perm_b32 v184, v71, v67, s46
v_perm_b32 v185, v79, v75, s46
v_perm_b32 v186, v87, v83, s46
v_perm_b32 v187, v95, v91, s46
v_perm_b32 v188, v71, v67, s47
v_perm_b32 v189, v79, v75, s47
v_perm_b32 v190, v87, v83, s47
v_perm_b32 v191, v95, v91, s47
s_waitcnt vmcnt(8)
v_perm_b32 v192, v100, v96, s46
v_perm_b32 v193, v108, v104, s46
v_perm_b32 v194, v116, v112, s46
v_perm_b32 v195, v124, v120, s46
v_perm_b32 v196, v100, v96, s47
v_perm_b32 v197, v108, v104, s47
v_perm_b32 v198, v116, v112, s47
v_perm_b32 v199, v124, v120, s47
v_perm_b32 v200, v101, v97, s46
v_perm_b32 v201, v109, v105, s46
v_perm_b32 v202, v117, v113, s46
v_perm_b32 v203, v125, v121, s46
v_perm_b32 v204, v101, v97, s47
v_perm_b32 v205, v109, v105, s47
v_perm_b32 v206, v117, v113, s47
v_perm_b32 v207, v125, v121, s47
v_perm_b32 v208, v102, v98, s46
v_perm_b32 v209, v110, v106, s46
v_perm_b32 v210, v118, v114, s46
v_perm_b32 v211, v126, v122, s46
v_perm_b32 v212, v102, v98, s47
v_perm_b32 v213, v110, v106, s47
v_perm_b32 v214, v118, v114, s47
v_perm_b32 v215, v126, v122, s47
v_perm_b32 v216, v103, v99, s46
v_perm_b32 v217, v111, v107, s46
v_perm_b32 v218, v119, v115, s46
v_perm_b32 v219, v127, v123, s46
v_perm_b32 v220, v103, v99, s47
v_perm_b32 v221, v111, v107, s47
v_perm_b32 v222, v119, v115, s47
v_perm_b32 v223, v127, v123, s47
s_waitcnt vmcnt(0)
v_perm_b32 v224, v36, v32, s46
v_perm_b32 v225, v44, v40, s46
v_perm_b32 v226, v52, v48, s46
v_perm_b32 v227, v60, v56, s46
v_perm_b32 v228, v36, v32, s47
v_perm_b32 v229, v44, v40, s47
v_perm_b32 v230, v52, v48, s47
v_perm_b32 v231, v60, v56, s47
v_perm_b32 v232, v37, v33, s46
v_perm_b32 v233, v45, v41, s46
v_perm_b32 v234, v53, v49, s46
v_perm_b32 v235, v61, v57, s46
v_perm_b32 v236, v37, v33, s47
v_perm_b32 v237, v45, v41, s47
v_perm_b32 v238, v53, v49, s47
v_perm_b32 v239, v61, v57, s47
v_perm_b32 v240, v38, v34, s46
v_perm_b32 v241, v46, v42, s46
v_perm_b32 v242, v54, v50, s46
v_perm_b32 v243, v62, v58, s46
v_perm_b32 v244, v38, v34, s47
v_perm_b32 v245, v46, v42, s47
v_perm_b32 v246, v54, v50, s47
v_perm_b32 v247, v62, v58, s47
v_perm_b32 v248, v39, v35, s46
v_perm_b32 v249, v47, v43, s46
v_perm_b32 v250, v55, v51, s46
v_perm_b32 v251, v63, v59, s46
v_perm_b32 v252, v39, v35, s47
v_perm_b32 v253, v47, v43, s47
v_perm_b32 v254, v55, v51, s47
v_perm_b32 v255, v63, v59, s47
L_ffn_now_L:
s_mul_i32 s40, s35, 32
s_add_u32 s40, s40, 0
v_mov_b32 v73, s40
L_rw_81:
buffer_load_dword v72, v73, s[8:11], 0 offen offset:8 sc1
s_waitcnt vmcnt(0)
v_cmp_ne_u32 vcc, 32, v72
s_cbranch_vccz L_rwo_82
s_sub_u32 s36, s36, 1
s_cbranch_scc1 L_end_ffn_L
s_sleep 2
s_branch L_rw_81
L_rwo_82:
s_barrier
s_mov_b32 s16, s70
s_mov_b32 s17, s71
s_mov_b32 s18, 2097152
s_mov_b32 s19, 0x20000
v_add_u32 v68, 0, v4
v_xor_b32 v68, v68, v3
v_lshlrev_b32 v68, 4, v68
v_lshl_add_u32 v20, v3, 11, v68
v_add_u32 v68, 4, v4
v_xor_b32 v68, v68, v3
v_lshlrev_b32 v68, 4, v68
v_lshl_add_u32 v21, v3, 11, v68
v_add_u32 v68, 8, v4
v_xor_b32 v68, v68, v3
v_lshlrev_b32 v68, 4, v68
v_lshl_add_u32 v22, v3, 11, v68
v_add_u32 v68, 12, v4
v_xor_b32 v68, v68, v3
v_lshlrev_b32 v68, 4, v68
v_lshl_add_u32 v23, v3, 11, v68
s_lshl_b32 s80, s32, 13
s_lshl_b32 s40, s38, 22
s_add_u32 s28, s40, 18874368
s_add_u32 s40, s40, s80
s_lshl_b32 s41, s99, 15
s_add_u32 s40, s40, s41
s_add_u32 s77, s40, 12582912
s_cmp_eq_u32 s38, 0
s_cselect_b32 s29, 20971520, 0
s_mov_b32 s30, 14680064
s_lshl_b32 s40, s34, 5
s_lshl_b32 s41, s32, 2
s_add_u32 s40, s40, s41
s_add_u32 s31, s40, 49152
s_lshl_b32 s41, s32, 7
s_lshl_b32 s42, s99, 9
s_add_u32 s41, s41, s42
s_cmp_ge_u32 s98, 14
s_cselect_b32 s41, s40, s41
s_cselect_b32 s43, 4, 2
s_lshl_b32 s42, s38, 16
s_add_u32 s42, s42, 16384
s_add_u32 s78, s42, s41
s_mov_b32 s79, 0xbfb8aa3b
s_cmp_ge_u32 s98, 14
s_cselect_b32 s41, 1, 31
v_and_b32 v24, s41, v1
v_lshlrev_b32 v24, s43, v24
s_mov_b32 s81, 0
s_lshl_b32 s40, s32, 10
s_add_u32 s40, s40, 32768
v_add_u32 v26, s40, v2
buffer_load_dword v25, v24, s[4:7], s78 offen sc1
L_ffn_loop_L:
s_cmp_ge_u32 s98, 14
s_cbranch_scc1 L_ffn_idle_L
s_cmp_eq_u32 s81, 0
s_cbranch_scc1 L_pf_83
s_waitcnt vmcnt(5)
L_pfo_84:
s_add_u32 s77, s77, 65536
s_add_u32 s78, s78, 1024
s_barrier
ds_read_b128 v[32:35], v20 offset:0
ds_read_b128 v[36:39], v21 offset:0
ds_read_b128 v[40:43], v22 offset:0
ds_read_b128 v[44:47], v23 offset:0
s_waitcnt lgkmcnt(3)
v_mfma_f32_16x16x32_bf16 v[48:51], a[0:3], v[32:35], 0
v_mfma_f32_16x16x32_bf16 v[52:55], a[4:7], v[32:35], 0
v_mfma_f32_16x16x32_bf16 v[56:59], a[128:131], v[32:35], 0
v_mfma_f32_16x16x32_bf16 v[60:63], a[132:135], v[32:35], 0
ds_read_b128 v[32:35], v20 offset:256
s_waitcnt lgkmcnt(3)
v_mfma_f32_16x16x32_bf16 v[48:51], a[8:11], v[36:39], v[48:51]
v_mfma_f32_16x16x32_bf16 v[52:55], a[12:15], v[36:39], v[52:55]
v_mfma_f32_16x16x32_bf16 v[56:59], a[136:139], v[36:39], v[56:59]
v_mfma_f32_16x16x32_bf16 v[60:63], a[140:143], v[36:39], v[60:63]
ds_read_b128 v[36:39], v21 offset:256
s_waitcnt lgkmcnt(3)
v_mfma_f32_16x16x32_bf16 v[48:51], a[16:19], v[40:43], v[48:51]
v_mfma_f32_16x16x32_bf16 v[52:55], a[20:23], v[40:43], v[52:55]
v_mfma_f32_16x16x32_bf16 v[56:59], a[144:147], v[40:43], v[56:59]
v_mfma_f32_16x16x32_bf16 v[60:63], a[148:151], v[40:43], v[60:63]
ds_read_b128 v[40:43], v22 offset:256
s_waitcnt lgkmcnt(3)
v_mfma_f32_16x16x32_bf16 v[48:51], a[24:27], v[44:47], v[48:51]
v_mfma_f32_16x16x32_bf16 v[52:55], a[28:31], v[44:47], v[52:55]
v_mfma_f32_16x16x32_bf16 v[56:59], a[152:155], v[44:47], v[56:59]
v_mfma_f32_16x16x32_bf16 v[60:63], a[156:159], v[44:47], v[60:63]
ds_read_b128 v[44:47], v23 offset:256
s_waitcnt lgkmcnt(3)
v_mfma_f32_16x16x32_bf16 v[48:51], a[32:35], v[32:35], v[48:51]
v_mfma_f32_16x16x32_bf16 v[52:55], a[36:39], v[32:35], v[52:55]
v_mfma_f32_16x16x32_bf16 v[56:59], a[160:163], v[32:35], v[56:59]
v_mfma_f32_16x16x32_bf16 v[60:63], a[164:167], v[32:35], v[60:63]
ds_read_b128 v[32:35], v20 offset:512
s_waitcnt lgkmcnt(3)
v_mfma_f32_16x16x32_bf16 v[48:51], a[40:43], v[36:39], v[48:51]
v_mfma_f32_16x16x32_bf16 v[52:55], a[44:47], v[36:39], v[52:55]
v_mfma_f32_16x16x32_bf16 v[56:59], a[168:171], v[36:39], v[56:59]
v_mfma_f32_16x16x32_bf16 v[60:63], a[172:175], v[36:39], v[60:63]
ds_read_b128 v[36:39], v21 offset:512
s_waitcnt lgkmcnt(3)
v_mfma_f32_16x16x32_bf16 v[48:51], a[48:51], v[40:43], v[48:51]
v_mfma_f32_16x16x32_bf16 v[52:55], a[52:55], v[40:43], v[52:55]
v_mfma_f32_16x16x32_bf16 v[56:59], a[176:179], v[40:43], v[56:59]
v_mfma_f32_16x16x32_bf16 v[60:63], a[180:183], v[40:43], v[60:63]
ds_read_b128 v[40:43], v22 offset:512
s_waitcnt lgkmcnt(3)
v_mfma_f32_16x16x32_bf16 v[48:51], a[56:59], v[44:47], v[48:51]
v_mfma_f32_16x16x32_bf16 v[52:55], a[60:63], v[44:47], v[52:55]
v_mfma_f32_16x16x32_bf16 v[56:59], a[184:187], v[44:47], v[56:59]
v_mfma_f32_16x16x32_bf16 v[60:63], a[188:191], v[44:47], v[60:63]
ds_read_b128 v[44:47], v23 offset:512
s_waitcnt lgkmcnt(3)
v_mfma_f32_16x16x32_bf16 v[48:51], a[64:67], v[32:35], v[48:51]
v_mfma_f32_16x16x32_bf16 v[52:55], a[68:71], v[32:35], v[52:55]
v_mfma_f32_16x16x32_bf16 v[56:59], a[192:195], v[32:35], v[56:59]
v_mfma_f32_16x16x32_bf16 v[60:63], a[196:199], v[32:35], v[60:63]
ds_read_b128 v[32:35], v20 offset:768
s_waitcnt lgkmcnt(3)
v_mfma_f32_16x16x32_bf16 v[48:51], a[72:75], v[36:39], v[48:51]
v_mfma_f32_16x16x32_bf16 v[52:55], a[76:79], v[36:39], v[52:55]
v_mfma_f32_16x16x32_bf16 v[56:59], a[200:203], v[36:39], v[56:59]
v_mfma_f32_16x16x32_bf16 v[60:63], a[204:207], v[36:39], v[60:63]
ds_read_b128 v[36:39], v21 offset:768
s_waitcnt lgkmcnt(3)
v_mfma_f32_16x16x32_bf16 v[48:51], a[80:83], v[40:43], v[48:51]
v_mfma_f32_16x16x32_bf16 v[52:55], a[84:87], v[40:43], v[52:55]
v_mfma_f32_16x16x32_bf16 v[56:59], a[208:211], v[40:43], v[56:59]
v_mfma_f32_16x16x32_bf16 v[60:63], a[212:215], v[40:43], v[60:63]
ds_read_b128 v[40:43], v22 offset:768
s_waitcnt lgkmcnt(3)
v_mfma_f32_16x16x32_bf16 v[48:51], a[88:91], v[44:47], v[48:51]
v_mfma_f32_16x16x32_bf16 v[52:55], a[92:95], v[44:47], v[52:55]
v_mfma_f32_16x16x32_bf16 v[56:59], a[216:219], v[44:47], v[56:59]
v_mfma_f32_16x16x32_bf16 v[60:63], a[220:223], v[44:47], v[60:63]
ds_read_b128 v[44:47], v23 offset:768
s_waitcnt lgkmcnt(3)
v_mfma_f32_16x16x32_bf16 v[48:51], a[96:99], v[32:35], v[48:51]
v_mfma_f32_16x16x32_bf16 v[52:55], a[100:103], v[32:35], v[52:55]
v_mfma_f32_16x16x32_bf16 v[56:59], a[224:227], v[32:35], v[56:59]
v_mfma_f32_16x16x32_bf16 v[60:63], a[228:231], v[32:35], v[60:63]
s_waitcnt vmcnt(0)
s_barrier
s_cmp_eq_u32 s76, 0
s_cbranch_scc1 L_np_85
s_mov_b64 exec, 3
buffer_store_dword v9, v2, s[4:7], s76 offen sc1
s_mov_b64 exec, -1
s_mov_b32 s76, 0
L_np_85:
buffer_load_dwordx2 v[28:29], v6, s[4:7], s28 offen sc1
buffer_load_ushort v30, v31, s[4:7], s28 offen sc1
ds_read_b128 v[32:35], v20 offset:1024
s_waitcnt lgkmcnt(3)
v_mfma_f32_16x16x32_bf16 v[48:51], a[104:107], v[36:39], v[48:51]
v_mfma_f32_16x16x32_bf16 v[52:55], a[108:111], v[36:39], v[52:55]
v_mfma_f32_16x16x32_bf16 v[56:59], a[232:235], v[36:39], v[56:59]
v_mfma_f32_16x16x32_bf16 v[60:63], a[236:239], v[36:39], v[60:63]
ds_read_b128 v[36:39], v21 offset:1024
s_waitcnt lgkmcnt(3)
v_mfma_f32_16x16x32_bf16 v[48:51], a[112:115], v[40:43], v[48:51]
v_mfma_f32_16x16x32_bf16 v[52:55], a[116:119], v[40:43], v[52:55]
v_mfma_f32_16x16x32_bf16 v[56:59], a[240:243], v[40:43], v[56:59]
v_mfma_f32_16x16x32_bf16 v[60:63], a[244:247], v[40:43], v[60:63]
ds_read_b128 v[40:43], v22 offset:1024
s_waitcnt lgkmcnt(3)
v_mfma_f32_16x16x32_bf16 v[48:51], a[120:123], v[44:47], v[48:51]
v_mfma_f32_16x16x32_bf16 v[52:55], a[124:127], v[44:47], v[52:55]
v_mfma_f32_16x16x32_bf16 v[56:59], a[248:251], v[44:47], v[56:59]
v_mfma_f32_16x16x32_bf16 v[60:63], a[252:255], v[44:47], v[60:63]
ds_read_b128 v[44:47], v23 offset:1024
s_waitcnt lgkmcnt(3)
v_mfma_f32_16x16x32_bf16 v[64:67], a[0:3], v[32:35], 0
v_mfma_f32_16x16x32_bf16 v[68:71], a[4:7], v[32:35], 0
v_mfma_f32_16x16x32_bf16 v[72:75], a[128:131], v[32:35], 0
v_mfma_f32_16x16x32_bf16 v[76:79], a[132:135], v[32:35], 0
ds_read_b128 v[32:35], v20 offset:1280
s_waitcnt lgkmcnt(3)
v_mfma_f32_16x16x32_bf16 v[64:67], a[8:11], v[36:39], v[64:67]
v_mfma_f32_16x16x32_bf16 v[68:71], a[12:15], v[36:39], v[68:71]
v_mfma_f32_16x16x32_bf16 v[72:75], a[136:139], v[36:39], v[72:75]
v_mfma_f32_16x16x32_bf16 v[76:79], a[140:143], v[36:39], v[76:79]
ds_read_b128 v[36:39], v21 offset:1280
s_waitcnt lgkmcnt(3)
v_mfma_f32_16x16x32_bf16 v[64:67], a[16:19], v[40:43], v[64:67]
v_mul_f32 v80, s79, v48
v_mfma_f32_16x16x32_bf16 v[68:71], a[20:23], v[40:43], v[68:71]
v_mul_f32 v81, s79, v49
v_mfma_f32_16x16x32_bf16 v[72:75], a[144:147], v[40:43], v[72:75]
v_mul_f32 v82, s79, v50
v_mfma_f32_16x16x32_bf16 v[76:79], a[148:151], v[40:43], v[76:79]
v_mul_f32 v83, s79, v51
ds_read_b128 v[40:43], v22 offset:1280
s_waitcnt lgkmcnt(3)
v_mfma_f32_16x16x32_bf16 v[64:67], a[24:27], v[44:47], v[64:67]
v_mul_f32 v84, s79, v52
v_mfma_f32_16x16x32_bf16 v[68:71], a[28:31], v[44:47], v[68:71]
v_mul_f32 v85, s79, v53
v_mfma_f32_16x16x32_bf16 v[72:75], a[152:155], v[44:47], v[72:75]
v_mul_f32 v86, s79, v54
v_mfma_f32_16x16x32_bf16 v[76:79], a[156:159], v[44:47], v[76:79]
v_mul_f32 v87, s79, v55
ds_read_b128 v[44:47], v23 offset:1280
s_waitcnt lgkmcnt(3)
v_mfma_f32_16x16x32_bf16 v[64:67], a[32:35], v[32:35], v[64:67]
v_exp_f32 v80, v80
v_mfma_f32_16x16x32_bf16 v[68:71], a[36:39], v[32:35], v[68:71]
v_mul_f32 v48, v48, v56
v_mfma_f32_16x16x32_bf16 v[72:75], a[160:163], v[32:35], v[72:75]
v_exp_f32 v81, v81
v_mfma_f32_16x16x32_bf16 v[76:79], a[164:167], v[32:35], v[76:79]
v_mul_f32 v49, v49, v57
ds_read_b128 v[32:35], v20 offset:1536
s_waitcnt lgkmcnt(3)
v_mfma_f32_16x16x32_bf16 v[64:67], a[40:43], v[36:39], v[64:67]
v_exp_f32 v82, v82
v_mfma_f32_16x16x32_bf16 v[68:71], a[44:47], v[36:39], v[68:71]
v_mul_f32 v50, v50, v58
v_mfma_f32_16x16x32_bf16 v[72:75], a[168:171], v[36:39], v[72:75]
v_exp_f32 v83, v83
v_mfma_f32_16x16x32_bf16 v[76:79], a[172:175], v[36:39], v[76:79]
v_mul_f32 v51, v51, v59
ds_read_b128 v[36:39], v21 offset:1536
s_waitcnt lgkmcnt(3)
v_mfma_f32_16x16x32_bf16 v[64:67], a[48:51], v[40:43], v[64:67]
v_exp_f32 v84, v84
v_mfma_f32_16x16x32_bf16 v[68:71], a[52:55], v[40:43], v[68:71]
v_mul_f32 v52, v52, v60
v_mfma_f32_16x16x32_bf16 v[72:75], a[176:179], v[40:43], v[72:75]
v_exp_f32 v85, v85
v_mfma_f32_16x16x32_bf16 v[76:79], a[180:183], v[40:43], v[76:79]
v_mul_f32 v53, v53, v61
ds_read_b128 v[40:43], v22 offset:1536
s_waitcnt lgkmcnt(3)
v_mfma_f32_16x16x32_bf16 v[64:67], a[56:59], v[44:47], v[64:67]
v_exp_f32 v86, v86
v_mfma_f32_16x16x32_bf16 v[68:71], a[60:63], v[44:47], v[68:71]
v_mul_f32 v54, v54, v62
v_mfma_f32_16x16x32_bf16 v[72:75], a[184:187], v[44:47], v[72:75]
v_exp_f32 v87, v87
v_mfma_f32_16x16x32_bf16 v[76:79], a[188:191], v[44:47], v[76:79]
v_mul_f32 v55, v55, v63
ds_read_b128 v[44:47], v23 offset:1536
s_waitcnt lgkmcnt(3)
v_mfma_f32_16x16x32_bf16 v[64:67], a[64:67], v[32:35], v[64:67]
v_add_f32 v80, 1.0, v80
v_mfma_f32_16x16x32_bf16 v[68:71], a[68:71], v[32:35], v[68:71]
v_add_f32 v81, 1.0, v81
v_mfma_f32_16x16x32_bf16 v[72:75], a[192:195], v[32:35], v[72:75]
v_add_f32 v82, 1.0, v82
v_mfma_f32_16x16x32_bf16 v[76:79], a[196:199], v[32:35], v[76:79]
v_add_f32 v83, 1.0, v83
ds_read_b128 v[32:35], v20 offset:1792
s_waitcnt lgkmcnt(3)
v_mfma_f32_16x16x32_bf16 v[64:67], a[72:75], v[36:39], v[64:67]
v_add_f32 v84, 1.0, v84
v_mfma_f32_16x16x32_bf16 v[68:71], a[76:79], v[36:39], v[68:71]
v_add_f32 v85, 1.0, v85
v_mfma_f32_16x16x32_bf16 v[72:75], a[200:203], v[36:39], v[72:75]
v_add_f32 v86, 1.0, v86
v_mfma_f32_16x16x32_bf16 v[76:79], a[204:207], v[36:39], v[76:79]
v_add_f32 v87, 1.0, v87
ds_read_b128 v[36:39], v21 offset:1792
s_waitcnt lgkmcnt(3)
v_mfma_f32_16x16x32_bf16 v[64:67], a[80:83], v[40:43], v[64:67]
v_rcp_f32 v80, v80
v_mfma_f32_16x16x32_bf16 v[68:71], a[84:87], v[40:43], v[68:71]
v_rcp_f32 v81, v81
v_mfma_f32_16x16x32_bf16 v[72:75], a[208:211], v[40:43], v[72:75]
v_rcp_f32 v82, v82
v_mfma_f32_16x16x32_bf16 v[76:79], a[212:215], v[40:43], v[76:79]
v_rcp_f32 v83, v83
ds_read_b128 v[40:43], v22 offset:1792
s_waitcnt lgkmcnt(3)
v_mfma_f32_16x16x32_bf16 v[64:67], a[88:91], v[44:47], v[64:67]
v_rcp_f32 v84, v84
v_mfma_f32_16x16x32_bf16 v[68:71], a[92:95], v[44:47], v[68:71]
v_rcp_f32 v85, v85
v_mfma_f32_16x16x32_bf16 v[72:75], a[216:219], v[44:47], v[72:75]
v_rcp_f32 v86, v86
v_mfma_f32_16x16x32_bf16 v[76:79], a[220:223], v[44:47], v[76:79]
v_rcp_f32 v87, v87
ds_read_b128 v[44:47], v23 offset:1792
s_waitcnt lgkmcnt(3)
v_mfma_f32_16x16x32_bf16 v[64:67], a[96:99], v[32:35], v[64:67]
v_mul_f32 v80, v80, v48
v_mfma_f32_16x16x32_bf16 v[68:71], a[100:103], v[32:35], v[68:71]
v_mul_f32 v81, v81, v49
v_mfma_f32_16x16x32_bf16 v[72:75], a[224:227], v[32:35], v[72:75]
v_mul_f32 v82, v82, v50
v_mfma_f32_16x16x32_bf16 v[76:79], a[228:231], v[32:35], v[76:79]
v_mul_f32 v83, v83, v51
s_waitcnt lgkmcnt(2)
v_mfma_f32_16x16x32_bf16 v[64:67], a[104:107], v[36:39], v[64:67]
v_mul_f32 v84, v84, v52
v_mfma_f32_16x16x32_bf16 v[68:71], a[108:111], v[36:39], v[68:71]
v_mul_f32 v85, v85, v53
v_mfma_f32_16x16x32_bf16 v[72:75], a[232:235], v[36:39], v[72:75]
v_mul_f32 v86, v86, v54
v_mfma_f32_16x16x32_bf16 v[76:79], a[236:239], v[36:39], v[76:79]
v_mul_f32 v87, v87, v55
s_waitcnt lgkmcnt(1)
v_mfma_f32_16x16x32_bf16 v[64:67], a[112:115], v[40:43], v[64:67]
v_cvt_pk_bf16_f32 v56, v80, v84
v_mfma_f32_16x16x32_bf16 v[68:71], a[116:119], v[40:43], v[68:71]
v_cvt_pk_bf16_f32 v57, v81, v85
v_mfma_f32_16x16x32_bf16 v[72:75], a[240:243], v[40:43], v[72:75]
v_cvt_pk_bf16_f32 v58, v82, v86
v_mfma_f32_16x16x32_bf16 v[76:79], a[244:247], v[40:43], v[76:79]
v_cvt_pk_bf16_f32 v59, v83, v87
s_waitcnt lgkmcnt(0)
v_mfma_f32_16x16x32_bf16 v[64:67], a[120:123], v[44:47], v[64:67]
ds_write_b128 v26, v[56:59] offset:0
v_mfma_f32_16x16x32_bf16 v[68:71], a[124:127], v[44:47], v[68:71]
v_mfma_f32_16x16x32_bf16 v[72:75], a[248:251], v[44:47], v[72:75]
v_mfma_f32_16x16x32_bf16 v[76:79], a[252:255], v[44:47], v[76:79]
s_waitcnt lgkmcnt(0)
s_barrier
ds_read_b128 v[32:35], v2 offset:32768
ds_read_b128 v[36:39], v2 offset:33792
ds_read_b128 v[40:43], v2 offset:34816
ds_read_b128 v[44:47], v2 offset:35840
v_mul_f32 v80, s79, v64
v_mul_f32 v81, s79, v65
v_mul_f32 v82, s79, v66
v_mul_f32 v83, s79, v67
v_mul_f32 v84, s79, v68
v_mul_f32 v85, s79, v69
v_mul_f32 v86, s79, v70
v_mul_f32 v87, s79, v71
v_exp_f32 v80, v80
v_mul_f32 v64, v64, v72
v_exp_f32 v81, v81
s_waitcnt lgkmcnt(3)
v_mfma_f32_16x16x32_bf16 v[88:91], v[32:35], v[128:131], 0
v_mul_f32 v65, v65, v73
v_exp_f32 v82, v82
v_mfma_f32_16x16x32_bf16 v[92:95], v[32:35], v[132:135], 0
v_mul_f32 v66, v66, v74
v_exp_f32 v83, v83
v_mfma_f32_16x16x32_bf16 v[96:99], v[32:35], v[136:139], 0
v_mul_f32 v67, v67, v75
v_exp_f32 v84, v84
v_mfma_f32_16x16x32_bf16 v[100:103], v[32:35], v[140:143], 0
v_mul_f32 v68, v68, v76
v_exp_f32 v85, v85
v_mfma_f32_16x16x32_bf16 v[104:107], v[32:35], v[144:147], 0
v_mul_f32 v69, v69, v77
v_exp_f32 v86, v86
v_mfma_f32_16x16x32_bf16 v[108:111], v[32:35], v[148:151], 0
v_mul_f32 v70, v70, v78
v_exp_f32 v87, v87
v_mfma_f32_16x16x32_bf16 v[112:115], v[32:35], v[152:155], 0
v_mul_f32 v71, v71, v79
v_add_f32 v80, 1.0, v80
v_mfma_f32_16x16x32_bf16 v[116:119], v[32:35], v[156:159], 0
v_add_f32 v81, 1.0, v81
v_add_f32 v82, 1.0, v82
s_waitcnt lgkmcnt(2)
v_mfma_f32_16x16x32_bf16 v[88:91], v[36:39], v[160:163], v[88:91]
v_add_f32 v83, 1.0, v83
v_add_f32 v84, 1.0, v84
v_mfma_f32_16x16x32_bf16 v[92:95], v[36:39], v[164:167], v[92:95]
v_add_f32 v85, 1.0, v85
v_add_f32 v86, 1.0, v86
v_mfma_f32_16x16x32_bf16 v[96:99], v[36:39], v[168:171], v[96:99]
v_add_f32 v87, 1.0, v87
v_rcp_f32 v80, v80
v_mfma_f32_16x16x32_bf16 v[100:103], v[36:39], v[172:175], v[100:103]
v_rcp_f32 v81, v81
v_mfma_f32_16x16x32_bf16 v[104:107], v[36:39], v[176:179], v[104:107]
v_rcp_f32 v82, v82
v_mfma_f32_16x16x32_bf16 v[108:111], v[36:39], v[180:183], v[108:111]
v_rcp_f32 v83, v83
v_mfma_f32_16x16x32_bf16 v[112:115], v[36:39], v[184:187], v[112:115]
v_rcp_f32 v84, v84
v_mfma_f32_16x16x32_bf16 v[116:119], v[36:39], v[188:191], v[116:119]
v_rcp_f32 v85, v85
s_waitcnt lgkmcnt(1)
v_mfma_f32_16x16x32_bf16 v[88:91], v[40:43], v[192:195], v[88:91]
v_rcp_f32 v86, v86
v_mfma_f32_16x16x32_bf16 v[92:95], v[40:43], v[196:199], v[92:95]
v_rcp_f32 v87, v87
v_mfma_f32_16x16x32_bf16 v[96:99], v[40:43], v[200:203], v[96:99]
v_mul_f32 v80, v80, v64
v_mul_f32 v81, v81, v65
v_mfma_f32_16x16x32_bf16 v[100:103], v[40:43], v[204:207], v[100:103]
v_mul_f32 v82, v82, v66
v_mul_f32 v83, v83, v67
v_mfma_f32_16x16x32_bf16 v[104:107], v[40:43], v[208:211], v[104:107]
v_mul_f32 v84, v84, v68
v_mul_f32 v85, v85, v69
v_mfma_f32_16x16x32_bf16 v[108:111], v[40:43], v[212:215], v[108:111]
v_mul_f32 v86, v86, v70
v_mul_f32 v87, v87, v71
v_mfma_f32_16x16x32_bf16 v[112:115], v[40:43], v[216:219], v[112:115]
v_cvt_pk_bf16_f32 v72, v80, v84
v_cvt_pk_bf16_f32 v73, v81, v85
v_mfma_f32_16x16x32_bf16 v[116:119], v[40:43], v[220:223], v[116:119]
v_cvt_pk_bf16_f32 v74, v82, v86
v_cvt_pk_bf16_f32 v75, v83, v87
s_waitcnt lgkmcnt(0)
v_mfma_f32_16x16x32_bf16 v[88:91], v[44:47], v[224:227], v[88:91]
ds_write_b128 v26, v[72:75] offset:4096
v_mfma_f32_16x16x32_bf16 v[92:95], v[44:47], v[228:231], v[92:95]
v_mfma_f32_16x16x32_bf16 v[96:99], v[44:47], v[232:235], v[96:99]
v_mfma_f32_16x16x32_bf16 v[100:103], v[44:47], v[236:239], v[100:103]
v_mfma_f32_16x16x32_bf16 v[104:107], v[44:47], v[240:243], v[104:107]
v_mfma_f32_16x16x32_bf16 v[108:111], v[44:47], v[244:247], v[108:111]
v_mfma_f32_16x16x32_bf16 v[112:115], v[44:47], v[248:251], v[112:115]
v_mfma_f32_16x16x32_bf16 v[116:119], v[44:47], v[252:255], v[116:119]
s_waitcnt lgkmcnt(0)
s_barrier
ds_read_b128 v[32:35], v2 offset:36864
ds_read_b128 v[36:39], v2 offset:37888
ds_read_b128 v[40:43], v2 offset:38912
ds_read_b128 v[44:47], v2 offset:39936
s_waitcnt lgkmcnt(3)
v_mfma_f32_16x16x32_bf16 v[48:51], v[32:35], v[128:131], 0
v_cvt_pk_bf16_f32 v120, v88, v92
v_cvt_pk_bf16_f32 v121, v96, v100
v_mfma_f32_16x16x32_bf16 v[52:55], v[32:35], v[132:135], 0
v_cvt_pk_bf16_f32 v122, v104, v108
v_cvt_pk_bf16_f32 v123, v112, v116
v_mfma_f32_16x16x32_bf16 v[56:59], v[32:35], v[136:139], 0
v_bfi_b32 v120, 1, s101, v120
v_bfi_b32 v121, 1, s101, v121
v_mfma_f32_16x16x32_bf16 v[60:63], v[32:35], v[140:143], 0
v_bfi_b32 v122, 1, s101, v122
v_bfi_b32 v123, 1, s101, v123
s_add_u32 s40, s39, 0
v_mfma_f32_16x16x32_bf16 v[64:67], v[32:35], v[144:147], 0
buffer_store_dwordx4 v[120:123], v8, s[4:7], s40 offen
v_mfma_f32_16x16x32_bf16 v[68:71], v[32:35], v[148:151], 0
v_cvt_pk_bf16_f32 v124, v89, v93
v_cvt_pk_bf16_f32 v125, v97, v101
v_mfma_f32_16x16x32_bf16 v[72:75], v[32:35], v[152:155], 0
v_cvt_pk_bf16_f32 v126, v105, v109
v_cvt_pk_bf16_f32 v127, v113, v117
v_mfma_f32_16x16x32_bf16 v[76:79], v[32:35], v[156:159], 0
v_bfi_b32 v124, 1, s101, v124
v_bfi_b32 v125, 1, s101, v125
s_waitcnt lgkmcnt(2)
v_mfma_f32_16x16x32_bf16 v[48:51], v[36:39], v[160:163], v[48:51]
v_bfi_b32 v126, 1, s101, v126
v_bfi_b32 v127, 1, s101, v127
s_add_u32 s40, s39, 32768
v_mfma_f32_16x16x32_bf16 v[52:55], v[36:39], v[164:167], v[52:55]
buffer_store_dwordx4 v[124:127], v8, s[4:7], s40 offen
v_mfma_f32_16x16x32_bf16 v[56:59], v[36:39], v[168:171], v[56:59]
v_cvt_pk_bf16_f32 v120, v90, v94
v_cvt_pk_bf16_f32 v121, v98, v102
v_mfma_f32_16x16x32_bf16 v[60:63], v[36:39], v[172:175], v[60:63]
v_cvt_pk_bf16_f32 v122, v106, v110
v_cvt_pk_bf16_f32 v123, v114, v118
v_mfma_f32_16x16x32_bf16 v[64:67], v[36:39], v[176:179], v[64:67]
v_bfi_b32 v120, 1, s101, v120
v_bfi_b32 v121, 1, s101, v121
v_mfma_f32_16x16x32_bf16 v[68:71], v[36:39], v[180:183], v[68:71]
v_bfi_b32 v122, 1, s101, v122
v_bfi_b32 v123, 1, s101, v123
s_add_u32 s40, s39, 65536
v_mfma_f32_16x16x32_bf16 v[72:75], v[36:39], v[184:187], v[72:75]
buffer_store_dwordx4 v[120:123], v8, s[4:7], s40 offen
v_mfma_f32_16x16x32_bf16 v[76:79], v[36:39], v[188:191], v[76:79]
v_cvt_pk_bf16_f32 v124, v91, v95
v_cvt_pk_bf16_f32 v125, v99, v103
s_waitcnt lgkmcnt(1)
v_mfma_f32_16x16x32_bf16 v[48:51], v[40:43], v[192:195], v[48:51]
v_cvt_pk_bf16_f32 v126, v107, v111
v_cvt_pk_bf16_f32 v127, v115, v119
v_mfma_f32_16x16x32_bf16 v[52:55], v[40:43], v[196:199], v[52:55]
v_bfi_b32 v124, 1, s101, v124
v_bfi_b32 v125, 1, s101, v125
v_mfma_f32_16x16x32_bf16 v[56:59], v[40:43], v[200:203], v[56:59]
v_bfi_b32 v126, 1, s101, v126
v_bfi_b32 v127, 1, s101, v127
s_add_u32 s40, s39, 98304
v_mfma_f32_16x16x32_bf16 v[60:63], v[40:43], v[204:207], v[60:63]
buffer_store_dwordx4 v[124:127], v8, s[4:7], s40 offen
v_mfma_f32_16x16x32_bf16 v[64:67], v[40:43], v[208:211], v[64:67]
v_mfma_f32_16x16x32_bf16 v[68:71], v[40:43], v[212:215], v[68:71]
v_mfma_f32_16x16x32_bf16 v[72:75], v[40:43], v[216:219], v[72:75]
v_mfma_f32_16x16x32_bf16 v[76:79], v[40:43], v[220:223], v[76:79]
s_waitcnt lgkmcnt(0)
v_mfma_f32_16x16x32_bf16 v[48:51], v[44:47], v[224:227], v[48:51]
v_mfma_f32_16x16x32_bf16 v[52:55], v[44:47], v[228:231], v[52:55]
v_mfma_f32_16x16x32_bf16 v[56:59], v[44:47], v[232:235], v[56:59]
v_mfma_f32_16x16x32_bf16 v[60:63], v[44:47], v[236:239], v[60:63]
v_mfma_f32_16x16x32_bf16 v[64:67], v[44:47], v[240:243], v[64:67]
v_mfma_f32_16x16x32_bf16 v[68:71], v[44:47], v[244:247], v[68:71]
v_mfma_f32_16x16x32_bf16 v[72:75], v[44:47], v[248:251], v[72:75]
v_mfma_f32_16x16x32_bf16 v[76:79], v[44:47], v[252:255], v[76:79]
s_nop 1
v_cvt_pk_bf16_f32 v120, v48, v52
s_nop 0
v_cvt_pk_bf16_f32 v121, v56, v60
s_nop 0
v_cvt_pk_bf16_f32 v122, v64, v68
s_nop 0
v_cvt_pk_bf16_f32 v123, v72, v76
v_bfi_b32 v120, 1, s101, v120
v_bfi_b32 v121, 1, s101, v121
v_bfi_b32 v122, 1, s101, v122
v_bfi_b32 v123, 1, s101, v123
s_add_u32 s40, s39, 0
buffer_store_dwordx4 v[120:123], v27, s[4:7], s40 offen
v_cvt_pk_bf16_f32 v124, v49, v53
v_cvt_pk_bf16_f32 v125, v57, v61
v_cvt_pk_bf16_f32 v126, v65, v69
v_cvt_pk_bf16_f32 v127, v73, v77
v_bfi_b32 v124, 1, s101, v124
v_bfi_b32 v125, 1, s101, v125
v_bfi_b32 v126, 1, s101, v126
v_bfi_b32 v127, 1, s101, v127
s_add_u32 s40, s39, 32768
buffer_store_dwordx4 v[124:127], v27, s[4:7], s40 offen
v_cvt_pk_bf16_f32 v120, v50, v54
v_cvt_pk_bf16_f32 v121, v58, v62
v_cvt_pk_bf16_f32 v122, v66, v70
v_cvt_pk_bf16_f32 v123, v74, v78
v_bfi_b32 v120, 1, s101, v120
v_bfi_b32 v121, 1, s101, v121
v_bfi_b32 v122, 1, s101, v122
v_bfi_b32 v123, 1, s101, v123
s_add_u32 s40, s39, 65536
buffer_store_dwordx4 v[120:123], v27, s[4:7], s40 offen
v_cvt_pk_bf16_f32 v124, v51, v55
v_cvt_pk_bf16_f32 v125, v59, v63
v_cvt_pk_bf16_f32 v126, v67, v71
v_cvt_pk_bf16_f32 v127, v75, v79
v_bfi_b32 v124, 1, s101, v124
v_bfi_b32 v125, 1, s101, v125
v_bfi_b32 v126, 1, s101, v126
v_bfi_b32 v127, 1, s101, v127
s_add_u32 s40, s39, 98304
buffer_store_dwordx4 v[124:127], v27, s[4:7], s40 offen
s_add_u32 s43, s39, 0
buffer_load_dwordx4 v[88:91], v5, s[4:7], s43 offen sc1
s_add_u32 s43, s39, 4096
buffer_load_dwordx4 v[92:95], v5, s[4:7], s43 offen sc1
s_add_u32 s43, s39, 8192
buffer_load_dwordx4 v[96:99], v5, s[4:7], s43 offen sc1
s_add_u32 s43, s39, 12288
buffer_load_dwordx4 v[100:103], v5, s[4:7], s43 offen sc1
s_branch L_ffn_red_L
L_ffn_idle_L:
s_waitcnt vmcnt(0)
s_cmp_eq_u32 s76, 0
s_cbranch_scc1 L_np_88
s_mov_b64 exec, 3
buffer_store_dword v9, v2, s[4:7], s76 offen sc1
s_mov_b64 exec, -1
s_mov_b32 s76, 0
L_np_88:
L_sp_86:
v_cmp_eq_u32 vcc, 0, v25
s_cbranch_vccz L_spo_87
s_sub_u32 s36, s36, 1
s_cbranch_scc1 L_end_ffn_L
buffer_load_dword v25, v24, s[4:7], s78 offen sc1
s_waitcnt vmcnt(0)
s_branch L_sp_86
L_spo_87:
s_add_u32 s78, s78, 1024
s_barrier
buffer_load_dwordx2 v[28:29], v6, s[4:7], s28 offen sc1
buffer_load_ushort v30, v31, s[4:7], s28 offen sc1
v_mov_b32 v120, s101
v_mov_b32 v121, s101
v_mov_b32 v122, s101
v_mov_b32 v123, s101
s_add_u32 s40, s39, 0
buffer_store_dwordx4 v[120:123], v8, s[4:7], s40 offen
s_add_u32 s40, s39, 16384
buffer_store_dwordx4 v[120:123], v8, s[4:7], s40 offen
s_add_u32 s40, s39, 32768
buffer_store_dwordx4 v[120:123], v8, s[4:7], s40 offen
s_add_u32 s40, s39, 49152
buffer_store_dwordx4 v[120:123], v8, s[4:7], s40 offen
s_add_u32 s40, s39, 65536
buffer_store_dwordx4 v[120:123], v8, s[4:7], s40 offen
s_add_u32 s40, s39, 81920
buffer_store_dwordx4 v[120:123], v8, s[4:7], s40 offen
s_add_u32 s40, s39, 98304
buffer_store_dwordx4 v[120:123], v8, s[4:7], s40 offen
s_add_u32 s40, s39, 114688
buffer_store_dwordx4 v[120:123], v8, s[4:7], s40 offen
s_add_u32 s43, s39, 0
buffer_load_dwordx4 v[88:91], v5, s[4:7], s43 offen sc1
s_add_u32 s43, s39, 4096
buffer_load_dwordx4 v[92:95], v5, s[4:7], s43 offen sc1
s_add_u32 s43, s39, 8192
buffer_load_dwordx4 v[96:99], v5, s[4:7], s43 offen sc1
s_add_u32 s43, s39, 12288
buffer_load_dwordx4 v[100:103], v5, s[4:7], s43 offen sc1
L_ffn_red_L:
s_waitcnt vmcnt(0)
s_add_u32 s43, s39, 0
buffer_load_dwordx4 v[104:107], v0, s[4:7], s43 offen sc1
s_add_u32 s43, s39, 4096
buffer_load_dwordx4 v[108:111], v0, s[4:7], s43 offen sc1
s_add_u32 s43, s39, 8192
buffer_load_dwordx4 v[112:115], v0, s[4:7], s43 offen sc1
s_add_u32 s43, s39, 12288
buffer_load_dwordx4 v[116:119], v0, s[4:7], s43 offen sc1
buffer_load_dword v25, v24, s[4:7], s78 offen sc1
L_rea2_100:
v_mov_b32 v68, 0
v_mov_b32 v69, -1
v_mfma_f32_16x16x32_bf16 v[76:79], v[12:15], v[88:91], 0
v_or3_b32 v68, v68, v88, v89
v_bitop3_b32 v69, v69, v88, v89 bitop3:0x80
v_or3_b32 v68, v68, v90, v91
v_bitop3_b32 v69, v69, v90, v91 bitop3:0x80
v_mfma_f32_16x16x32_bf16 v[76:79], v[12:15], v[92:95], v[76:79]
v_or3_b32 v68, v68, v92, v93
v_bitop3_b32 v69, v69, v92, v93 bitop3:0x80
v_or3_b32 v68, v68, v94, v95
v_bitop3_b32 v69, v69, v94, v95 bitop3:0x80
v_mfma_f32_16x16x32_bf16 v[76:79], v[12:15], v[96:99], v[76:79]
v_or3_b32 v68, v68, v96, v97
v_bitop3_b32 v69, v69, v96, v97 bitop3:0x80
v_or3_b32 v68, v68, v98, v99
v_bitop3_b32 v69, v69, v98, v99 bitop3:0x80
v_mfma_f32_16x16x32_bf16 v[76:79], v[12:15], v[100:103], v[76:79]
v_or3_b32 v68, v68, v100, v101
v_bitop3_b32 v69, v69, v100, v101 bitop3:0x80
v_or3_b32 v68, v68, v102, v103
v_bitop3_b32 v69, v69, v102, v103 bitop3:0x80
v_xor_b32 v68, s101, v68
v_bitop3_b32 v68, v68, v69, s101 bitop3:0xf6
v_and_b32 v68, 1, v68
v_cmp_ne_u32 vcc, 0, v68
s_cbranch_vccnz L_rea_99
v_lshlrev_b32 v72, 16, v28
v_and_b32 v73, 0xffff0000, v28
v_lshlrev_b32 v74, 16, v29
v_and_b32 v75, 0xffff0000, v29
L_red2_98:
v_mov_b32 v68, 0
v_mov_b32 v69, -1
s_waitcnt vmcnt(4)
v_mfma_f32_16x16x32_bf16 v[64:67], v[16:19], v[104:107], v[76:79]
v_or3_b32 v68, v68, v104, v105
v_bitop3_b32 v69, v69, v104, v105 bitop3:0x80
v_or3_b32 v68, v68, v106, v107
v_bitop3_b32 v69, v69, v106, v107 bitop3:0x80
s_waitcnt vmcnt(3)
v_mfma_f32_16x16x32_bf16 v[64:67], v[16:19], v[108:111], v[64:67]
v_or3_b32 v68, v68, v108, v109
v_bitop3_b32 v69, v69, v108, v109 bitop3:0x80
v_or3_b32 v68, v68, v110, v111
v_bitop3_b32 v69, v69, v110, v111 bitop3:0x80
s_waitcnt vmcnt(2)
v_mfma_f32_16x16x32_bf16 v[64:67], v[16:19], v[112:115], v[64:67]
v_or3_b32 v68, v68, v112, v113
v_bitop3_b32 v69, v69, v112, v113 bitop3:0x80
v_or3_b32 v68, v68, v114, v115
v_bitop3_b32 v69, v69, v114, v115 bitop3:0x80
s_waitcnt vmcnt(1)
v_mfma_f32_16x16x32_bf16 v[64:67], v[16:19], v[116:119], v[64:67]
v_or3_b32 v68, v68, v116, v117
v_bitop3_b32 v69, v69, v116, v117 bitop3:0x80
v_or3_b32 v68, v68, v118, v119
v_bitop3_b32 v69, v69, v118, v119 bitop3:0x80
v_xor_b32 v68, s101, v68
v_bitop3_b32 v68, v68, v69, s101 bitop3:0xf6
v_and_b32 v68, 1, v68
v_cmp_ne_u32 vcc, 0, v68
s_cbranch_vccnz L_red_97
v_add_f32 v72, v72, v64
v_add_f32 v73, v73, v65
v_add_f32 v74, v74, v66
v_add_f32 v75, v75, v67
v_cvt_pk_bf16_f32 v64, v72, v73
v_cvt_pk_bf16_f32 v65, v74, v75
s_waitcnt vmcnt(0)
v_cmp_eq_u32 vcc, 0, v25
s_cmp_ge_u32 s98, 14
s_cselect_b64 vcc, -1, vcc
s_cmp_eq_u64 vcc, 0
s_cselect_b32 s81, 1, 0
s_cselect_b64 vcc, -1, 0
s_cbranch_scc1 L_nx_101
buffer_load_dword v25, v24, s[4:7], s78 offen sc1
L_nx_101:
s_cmp_eq_u32 s38, 1
s_cbranch_scc1 L_ffn_fin_L
v_lshlrev_b32 v70, 16, v30
v_lshlrev_b32 v72, 16, v64
v_and_b32 v73, 0xffff0000, v64
v_lshlrev_b32 v74, 16, v65
v_and_b32 v75, 0xffff0000, v65
s_cbranch_vccz L_gd_89
s_add_u32 m0, s80, 0
s_add_u32 s44, s77, 0
buffer_load_dwordx4 v2, s[4:7], s44 offen offset:0 sc1 lds
L_gd_89:
v_sub_f32 v72, v72, v70
v_sub_f32 v73, v73, v70
v_sub_f32 v74, v74, v70
v_sub_f32 v75, v75, v70
v_add_f32 v68, v72, v73
s_cbranch_vccz L_gd_90
s_add_u32 m0, s80, 0
s_add_u32 s44, s77, 0
buffer_load_dwordx4 v2, s[4:7], s44 offen offset:2048 sc1 lds
L_gd_90:
v_mul_f32 v69, v72, v72
v_add_f32 v68, v68, v74
v_fmac_f32 v69, v73, v73
v_add_f32 v68, v68, v75
v_fmac_f32 v69, v74, v74
s_cbranch_vccz L_gd_91
s_add_u32 m0, s80, 4096
s_add_u32 s44, s77, 4096
buffer_load_dwordx4 v2, s[4:7], s44 offen offset:0 sc1 lds
L_gd_91:
v_fmac_f32 v69, v75, v75
v_add_f32_dpp v68, v68, v68 row_ror:8 row_mask:0xf bank_mask:0xf
s_nop 0
v_add_f32_dpp v69, v69, v69 row_ror:8 row_mask:0xf bank_mask:0xf
v_add_f32_dpp v68, v68, v68 row_ror:4 row_mask:0xf bank_mask:0xf
s_nop 0
v_add_f32_dpp v69, v69, v69 row_ror:4 row_mask:0xf bank_mask:0xf
v_add_f32_dpp v68, v68, v68 row_ror:2 row_mask:0xf bank_mask:0xf
s_nop 0
v_add_f32_dpp v69, v69, v69 row_ror:2 row_mask:0xf bank_mask:0xf
v_add_f32_dpp v68, v68, v68 row_ror:1 row_mask:0xf bank_mask:0xf
s_nop 0
v_add_f32_dpp v69, v69, v69 row_ror:1 row_mask:0xf bank_mask:0xf
s_nop 1
v_permlane16_swap_b32 v68, v69
v_add_f32 v68, v68, v69
ds_write_b32 v10, v68
s_waitcnt lgkmcnt(0)
s_barrier
ds_read_b128 v[88:91], v11
ds_read_b128 v[92:95], v11 offset:16
v_mov_b32 v71, 0x3727c5ac
s_waitcnt lgkmcnt(1)
v_add_f32 v88, v88, v89
s_cbranch_vccz L_gd_92
s_add_u32 m0, s80, 4096
s_add_u32 s44, s77, 4096
buffer_load_dwordx4 v2, s[4:7], s44 offen offset:2048 sc1 lds
L_gd_92:
v_add_f32 v90, v90, v91
v_add_f32 v88, v88, v90
s_waitcnt lgkmcnt(0)
v_add_f32 v92, v92, v93
v_add_f32 v94, v94, v95
v_mul_f32 v88, 0x3b000000, v88
s_cbranch_vccz L_gd_93
s_add_u32 m0, s80, 0
s_add_u32 s44, s77, 0
buffer_load_dwordx4 v2, s[4:7], s44 offen offset:1024 sc1 lds
L_gd_93:
v_add_f32 v92, v92, v94
v_mul_f32 v92, 0x3b000000, v92
v_fma_f32 v92, -v88, v88, v92
v_max_f32 v92, 0, v92
v_add_f32 v71, v71, v92
s_cbranch_vccz L_gd_94
s_add_u32 m0, s80, 0
s_add_u32 s44, s77, 0
buffer_load_dwordx4 v2, s[4:7], s44 offen offset:3072 sc1 lds
L_gd_94:
v_rsq_f32 v71, v71
v_sub_f32 v72, v72, v88
v_sub_f32 v73, v73, v88
v_sub_f32 v74, v74, v88
v_sub_f32 v75, v75, v88
s_cbranch_vccz L_gd_95
s_add_u32 m0, s80, 4096
s_add_u32 s44, s77, 4096
buffer_load_dwordx4 v2, s[4:7], s44 offen offset:1024 sc1 lds
L_gd_95:
v_mul_f32 v72, v72, v71
v_mul_f32 v73, v73, v71
v_mul_f32 v74, v74, v71
v_mul_f32 v75, v75, v71
v_cvt_pk_bf16_f32 v88, v72, v73
s_cbranch_vccz L_gd_96
s_add_u32 m0, s80, 4096
s_add_u32 s44, s77, 4096
buffer_load_dwordx4 v2, s[4:7], s44 offen offset:3072 sc1 lds
L_gd_96:
v_cvt_pk_bf16_f32 v89, v74, v75
buffer_store_dwordx2 v[88:89], v7, s[4:7], s30 offen sc1
buffer_store_dwordx2 v[64:65], v6, s[4:7], s29 offen sc1
s_mov_b32 s76, s31
s_branch L_ffn_adv_L
L_ffn_fin_L:
s_cbranch_vccz L_gd_102
s_add_u32 m0, s80, 0
s_add_u32 s44, s77, 0
buffer_load_dwordx4 v2, s[4:7], s44 offen offset:0 sc1 lds
s_add_u32 m0, s80, 0
s_add_u32 s44, s77, 0
buffer_load_dwordx4 v2, s[4:7], s44 offen offset:2048 sc1 lds
s_add_u32 m0, s80, 4096
s_add_u32 s44, s77, 4096
buffer_load_dwordx4 v2, s[4:7], s44 offen offset:0 sc1 lds
s_add_u32 m0, s80, 4096
s_add_u32 s44, s77, 4096
buffer_load_dwordx4 v2, s[4:7], s44 offen offset:2048 sc1 lds
s_add_u32 m0, s80, 0
s_add_u32 s44, s77, 0
buffer_load_dwordx4 v2, s[4:7], s44 offen offset:1024 sc1 lds
s_add_u32 m0, s80, 0
s_add_u32 s44, s77, 0
buffer_load_dwordx4 v2, s[4:7], s44 offen offset:3072 sc1 lds
s_add_u32 m0, s80, 4096
s_add_u32 s44, s77, 4096
buffer_load_dwordx4 v2, s[4:7], s44 offen offset:1024 sc1 lds
s_add_u32 m0, s80, 4096
s_add_u32 s44, s77, 4096
buffer_load_dwordx4 v2, s[4:7], s44 offen offset:3072 sc1 lds
L_gd_102:
buffer_store_dwordx2 v[64:65], v6, s[16:19], s29 offen
L_ffn_adv_L:
s_xor_b32 s39, s39, 524288
s_add_u32 s28, s28, 65536
s_add_u32 s29, s29, 65536
s_add_u32 s30, s30, 65536
s_add_u32 s31, s31, 1024
s_add_u32 s37, s37, 2
s_bfe_u32 s101, s37, 0x10002
s_cmp_lt_u32 s37, 64
s_cbranch_scc1 L_ffn_loop_L
s_waitcnt vmcnt(0)
s_cmp_eq_u32 s76, 0
s_cbranch_scc1 L_np_103
s_mov_b64 exec, 3
buffer_store_dword v9, v2, s[4:7], s76 offen sc1
s_mov_b64 exec, -1
s_mov_b32 s76, 0
L_np_103:
s_endpgm
L_pf_83:
s_waitcnt vmcnt(2)
s_cmp_eq_u32 s38, 0
s_cbranch_scc1 L_pz_104w
s_waitcnt vmcnt(1)
L_pz_104w:
v_cmp_eq_u32 vcc, 0, v25
s_cmp_lt_u32 s37, 2
s_cselect_b64 vcc, -1, vcc
s_cbranch_vccz L_pz_104
s_waitcnt vmcnt(0)
s_cmp_eq_u32 s76, 0
s_cbranch_scc1 L_np_107
s_mov_b64 exec, 3
buffer_store_dword v9, v2, s[4:7], s76 offen sc1
s_mov_b64 exec, -1
s_mov_b32 s76, 0
L_np_107:
L_sp_105:
v_cmp_eq_u32 vcc, 0, v25
s_cbranch_vccz L_spo_106
s_sub_u32 s36, s36, 1
s_cbranch_scc1 L_end_ffn_L
buffer_load_dword v25, v24, s[4:7], s78 offen sc1
s_waitcnt vmcnt(0)
s_branch L_sp_105
L_spo_106:
L_pz_104:
s_add_u32 m0, s80, 0
s_add_u32 s44, s77, 0
buffer_load_dwordx4 v2, s[4:7], s44 offen offset:0 sc1 lds
s_add_u32 m0, s80, 0
s_add_u32 s44, s77, 0
buffer_load_dwordx4 v2, s[4:7], s44 offen offset:2048 sc1 lds
s_add_u32 m0, s80, 4096
s_add_u32 s44, s77, 4096
buffer_load_dwordx4 v2, s[4:7], s44 offen offset:0 sc1 lds
s_add_u32 m0, s80, 4096
s_add_u32 s44, s77, 4096
buffer_load_dwordx4 v2, s[4:7], s44 offen offset:2048 sc1 lds
s_add_u32 m0, s80, 0
s_add_u32 s44, s77, 0
buffer_load_dwordx4 v2, s[4:7], s44 offen offset:1024 sc1 lds
s_add_u32 m0, s80, 0
s_add_u32 s44, s77, 0
buffer_load_dwordx4 v2, s[4:7], s44 offen offset:3072 sc1 lds
s_add_u32 m0, s80, 4096
s_add_u32 s44, s77, 4096
buffer_load_dwordx4 v2, s[4:7], s44 offen offset:1024 sc1 lds
s_add_u32 m0, s80, 4096
s_add_u32 s44, s77, 4096
buffer_load_dwordx4 v2, s[4:7], s44 offen offset:3072 sc1 lds
s_waitcnt vmcnt(4)
s_branch L_pfo_84
L_rea_99:
s_sub_u32 s36, s36, 1
s_cbranch_scc1 L_end_ffn_L
s_add_u32 s43, s39, 0
buffer_load_dwordx4 v[88:91], v5, s[4:7], s43 offen sc1
s_add_u32 s43, s39, 4096
buffer_load_dwordx4 v[92:95], v5, s[4:7], s43 offen sc1
s_add_u32 s43, s39, 8192
buffer_load_dwordx4 v[96:99], v5, s[4:7], s43 offen sc1
s_add_u32 s43, s39, 12288
buffer_load_dwordx4 v[100:103], v5, s[4:7], s43 offen sc1
s_waitcnt vmcnt(0)
s_branch L_rea2_100
L_red_97:
s_sub_u32 s36, s36, 1
s_cbranch_scc1 L_end_ffn_L
s_add_u32 s43, s39, 0
buffer_load_dwordx4 v[104:107], v0, s[4:7], s43 offen sc1
s_add_u32 s43, s39, 4096
buffer_load_dwordx4 v[108:111], v0, s[4:7], s43 offen sc1
s_add_u32 s43, s39, 8192
buffer_load_dwordx4 v[112:115], v0, s[4:7], s43 offen sc1
s_add_u32 s43, s39, 12288
buffer_load_dwordx4 v[116:119], v0, s[4:7], s43 offen sc1
s_waitcnt vmcnt(0)
s_branch L_red2_98
L_fb_ffn:
s_getpc_b64 s[40:41]
L_fb_ffn_pc:
s_add_u32 s40, s40, L_fallback-L_fb_ffn_pc
s_addc_u32 s41, s41, -1
s_setpc_b64 s[40:41]
L_end_ffn_L:
s_endpgm
.p2align 6
R_chain_G:
s_mov_b32 s12, s52
s_mov_b32 s13, s53
s_mov_b32 s14, 4194304
s_mov_b32 s15, 0x20000
s_mov_b32 s16, s54
s_mov_b32 s17, s55
s_mov_b32 s18, 4194304
s_mov_b32 s19, 0x20000
s_mov_b32 s20, s56
s_mov_b32 s21, s57
s_mov_b32 s22, 4194304
s_mov_b32 s23, 0x20000
s_mov_b32 s24, s58
s_mov_b32 s25, s59
s_mov_b32 s26, 4194304
s_mov_b32 s27, 0x20000
v_and_b32 v90, 15, v1
v_lshrrev_b32 v91, 4, v1
v_lshrrev_b32 v94, 1, v91
v_and_b32 v95, 1, v91
v_lshlrev_b32 v95, 2, v95
v_lshl_add_u32 v95, v94, 4, v95
s_lshl_b32 s40, s34, 8
s_lshl_b32 s41, s32, 6
s_add_u32 s88, s40, s41
s_lshl_b32 s40, s34, 17
s_lshl_b32 s41, s32, 8
s_add_u32 s40, s40, s41
v_lshlrev_b32 v92, 4, v90
v_lshl_add_u32 v93, v95, 10, v92
v_add_u32 v88, s40, v93
v_add_u32 v89, 8192, v88
s_lshl_b32 s86, s32, 15
s_lshl_b32 s87, s32, 13
s_add_u32 s87, s87, 131072
v_add_u32 v3, s86, v2
v_lshlrev_b32 v95, 3, v91
v_lshrrev_b32 v84, 2, v1
v_mul_u32_u24 v84, 8192, v84
v_and_b32 v80, 3, v1
v_lshl_add_u32 v80, v80, 4, v84
v_add_u32 v81, 130048, v80
v_and_b32 v84, 15, v1
v_lshlrev_b32 v84, 2, v84
v_lshl_add_u32 v82, v95, 6, v84
v_add_u32 v83, s87, v82
v_add_u32 v82, s86, v82
s_lshl_b32 s42, s35, 19
s_add_u32 s76, s42, 1048576
s_and_b32 s43, s32, 1
s_lshl_b32 s40, s43, 17
s_lshl_b32 s41, s34, 12
s_add_u32 s40, s40, s41
s_add_u32 s77, s40, s76
s_lshl_b32 s42, s35, 14
s_add_u32 s42, s42, 532480
s_lshl_b32 s40, s32, 11
s_add_u32 s78, s40, s42
s_and_b32 s40, s34, 0
s_mul_i32 s40, s40, 32768
s_add_u32 s78, s78, s40
s_lshr_b32 s40, s34, 3
s_lshl_b32 s40, s40, 11
s_lshl_b32 s41, s43, 9
s_add_u32 s40, s40, s41
s_and_b32 s41, s34, 1
s_lshl_b32 s41, s41, 10
s_add_u32 s40, s40, s41
s_bfe_u32 s41, s34, 0x20001
s_lshl_b32 s41, s41, 7
s_add_u32 s40, s40, s41
s_add_u32 s79, s40, s42
v_bfe_u32 v93, v90, 1, 2
v_lshlrev_b32 v93, 5, v93
v_and_b32 v95, 1, v91
v_lshl_add_u32 v93, v95, 4, v93
v_and_b32 v95, 1, v90
v_lshl_add_u32 v93, v95, 3, v93
v_lshl_add_u32 v11, v94, 2, v93
v_and_b32 v93, 7, v90
v_lshlrev_b32 v93, 4, v93
s_waitcnt vmcnt(0)
s_barrier
s_cmp_lg_u32 s32, 0
s_cbranch_scc1 L_da_109
v_mov_b32 v96, 1
s_lshl_b32 s40, s33, 5
v_mov_b32 v97, s40
s_mov_b64 exec, 1
buffer_atomic_add v96, v97, s[8:11], 0 offen offset:12
s_mov_b64 exec, -1
L_da_109:
s_cmp_eq_u32 s35, 0
s_cbranch_scc1 L_go_108
s_add_u32 s40, s34, 128
s_lshl_b32 s40, s40, 2
s_add_u32 s40, s40, s32
s_mul_i32 s40, s40, 7168
s_mov_b32 s12, s54
s_mov_b32 s13, s55
s_mov_b32 s14, 4194304
s_mov_b32 s15, 0x20000
s_add_u32 s41, s40, 0
buffer_load_dwordx4 v[104:107], v2, s[12:15], s41 offen offset:0
buffer_load_dwordx4 v[104:107], v2, s[12:15], s41 offen offset:1024
buffer_load_dwordx4 v[104:107], v2, s[12:15], s41 offen offset:2048
buffer_load_dwordx4 v[104:107], v2, s[12:15], s41 offen offset:3072
s_add_u32 s41, s40, 4096
buffer_load_dwordx4 v[104:107], v2, s[12:15], s41 offen offset:0
buffer_load_dwordx4 v[104:107], v2, s[12:15], s41 offen offset:1024
buffer_load_dwordx4 v[104:107], v2, s[12:15], s41 offen offset:2048
s_mov_b32 s12, s56
s_mov_b32 s13, s57
s_mov_b32 s14, 4194304
s_mov_b32 s15, 0x20000
s_add_u32 s41, s40, 0
buffer_load_dwordx4 v[104:107], v2, s[12:15], s41 offen offset:0
buffer_load_dwordx4 v[104:107], v2, s[12:15], s41 offen offset:1024
buffer_load_dwordx4 v[104:107], v2, s[12:15], s41 offen offset:2048
buffer_load_dwordx4 v[104:107], v2, s[12:15], s41 offen offset:3072
s_add_u32 s41, s40, 4096
buffer_load_dwordx4 v[104:107], v2, s[12:15], s41 offen offset:0
buffer_load_dwordx4 v[104:107], v2, s[12:15], s41 offen offset:1024
buffer_load_dwordx4 v[104:107], v2, s[12:15], s41 offen offset:2048
s_mov_b32 s12, s52
s_mov_b32 s13, s53
s_mov_b32 s14, 4194304
s_mov_b32 s15, 0x20000
s_add_u32 s41, s40, 0
buffer_load_dwordx4 v[104:107], v2, s[12:15], s41 offen offset:0
buffer_load_dwordx4 v[104:107], v2, s[12:15], s41 offen offset:1024
buffer_load_dwordx4 v[104:107], v2, s[12:15], s41 offen offset:2048
buffer_load_dwordx4 v[104:107], v2, s[12:15], s41 offen offset:3072
s_add_u32 s41, s40, 4096
buffer_load_dwordx4 v[104:107], v2, s[12:15], s41 offen offset:0
buffer_load_dwordx4 v[104:107], v2, s[12:15], s41 offen offset:1024
buffer_load_dwordx4 v[104:107], v2, s[12:15], s41 offen offset:2048
s_mov_b32 s12, s58
s_mov_b32 s13, s59
s_mov_b32 s14, 4194304
s_mov_b32 s15, 0x20000
s_add_u32 s41, s40, 0
buffer_load_dwordx4 v[104:107], v2, s[12:15], s41 offen offset:0
buffer_load_dwordx4 v[104:107], v2, s[12:15], s41 offen offset:1024
buffer_load_dwordx4 v[104:107], v2, s[12:15], s41 offen offset:2048
buffer_load_dwordx4 v[104:107], v2, s[12:15], s41 offen offset:3072
s_add_u32 s41, s40, 4096
buffer_load_dwordx4 v[104:107], v2, s[12:15], s41 offen offset:0
buffer_load_dwordx4 v[104:107], v2, s[12:15], s41 offen offset:1024
buffer_load_dwordx4 v[104:107], v2, s[12:15], s41 offen offset:2048
s_mov_b32 s12, s52
s_mov_b32 s13, s53
s_mov_b32 s14, 4194304
s_mov_b32 s15, 0x20000
v_lshlrev_b32 v98, 5, v1
buffer_load_dword v97, v98, s[8:11], 0 offen offset:12 sc1
s_waitcnt vmcnt(0)
L_cen_110:
s_mov_b32 s40, 0
v_readlane_b32 s41, v97, 0
s_nop 0
s_add_u32 s40, s40, s41
v_readlane_b32 s41, v97, 1
s_nop 0
s_add_u32 s40, s40, s41
v_readlane_b32 s41, v97, 2
s_nop 0
s_add_u32 s40, s40, s41
v_readlane_b32 s41, v97, 3
s_nop 0
s_add_u32 s40, s40, s41
v_readlane_b32 s41, v97, 4
s_nop 0
s_add_u32 s40, s40, s41
v_readlane_b32 s41, v97, 5
s_nop 0
s_add_u32 s40, s40, s41
v_readlane_b32 s41, v97, 6
s_nop 0
s_add_u32 s40, s40, s41
v_readlane_b32 s41, v97, 7
s_nop 0
s_add_u32 s40, s40, s41
s_cmp_eq_u32 s40, 256
s_cbranch_scc1 L_cenok_111
s_sub_u32 s36, s36, 1
s_cbranch_scc1 L_end_chain_G
s_sleep 4
buffer_load_dword v97, v98, s[8:11], 0 offen offset:12 sc1
s_waitcnt vmcnt(0)
s_branch L_cen_110
L_cenok_111:
s_mul_i32 s40, s35, 0
s_add_u32 s40, s40, 0
v_mov_b32 v97, s40
L_rw_112:
buffer_load_dword v96, v97, s[8:11], 0 offen offset:8 sc1
s_waitcnt vmcnt(0)
v_cmp_ne_u32 vcc, 32, v96
s_cbranch_vccz L_rwo_113
s_sub_u32 s36, s36, 1
s_cbranch_scc1 L_end_chain_G
s_sleep 2
s_branch L_rw_112
L_rwo_113:
L_go_108:
s_add_u32 s45, s88, 0
s_add_u32 m0, s86, 16384
s_nop 0
buffer_load_dwordx4 v80, s[16:19], s45 offen offset:0 lds
buffer_load_dwordx4 v81, s[16:19], s45 offen offset:1024 lds
s_add_u32 s45, s88, 262144
s_add_u32 m0, s86, 18432
s_nop 0
buffer_load_dwordx4 v80, s[16:19], s45 offen offset:0 lds
buffer_load_dwordx4 v81, s[16:19], s45 offen offset:1024 lds
s_add_u32 s45, s88, 524288
s_add_u32 m0, s86, 20480
s_nop 0
buffer_load_dwordx4 v80, s[16:19], s45 offen offset:0 lds
buffer_load_dwordx4 v81, s[16:19], s45 offen offset:1024 lds
s_add_u32 s45, s88, 786432
s_add_u32 m0, s86, 22528
s_nop 0
buffer_load_dwordx4 v80, s[16:19], s45 offen offset:0 lds
buffer_load_dwordx4 v81, s[16:19], s45 offen offset:1024 lds
s_add_u32 s45, s88, 1048576
s_add_u32 m0, s86, 24576
s_nop 0
buffer_load_dwordx4 v80, s[16:19], s45 offen offset:0 lds
buffer_load_dwordx4 v81, s[16:19], s45 offen offset:1024 lds
s_add_u32 s45, s88, 1310720
s_add_u32 m0, s86, 26624
s_nop 0
buffer_load_dwordx4 v80, s[16:19], s45 offen offset:0 lds
buffer_load_dwordx4 v81, s[16:19], s45 offen offset:1024 lds
s_add_u32 s45, s88, 1572864
s_add_u32 m0, s86, 28672
s_nop 0
buffer_load_dwordx4 v80, s[16:19], s45 offen offset:0 lds
buffer_load_dwordx4 v81, s[16:19], s45 offen offset:1024 lds
s_add_u32 s45, s88, 1835008
s_add_u32 m0, s86, 30720
s_nop 0
buffer_load_dwordx4 v80, s[16:19], s45 offen offset:0 lds
buffer_load_dwordx4 v81, s[16:19], s45 offen offset:1024 lds
s_add_u32 s45, s88, 2097152
s_add_u32 m0, s87, 0
s_nop 0
buffer_load_dwordx4 v80, s[16:19], s45 offen offset:0 lds
buffer_load_dwordx4 v81, s[16:19], s45 offen offset:1024 lds
s_add_u32 s45, s88, 2359296
s_add_u32 m0, s87, 2048
s_nop 0
buffer_load_dwordx4 v80, s[16:19], s45 offen offset:0 lds
buffer_load_dwordx4 v81, s[16:19], s45 offen offset:1024 lds
s_add_u32 s45, s88, 2621440
s_add_u32 m0, s87, 4096
s_nop 0
buffer_load_dwordx4 v80, s[16:19], s45 offen offset:0 lds
buffer_load_dwordx4 v81, s[16:19], s45 offen offset:1024 lds
s_add_u32 s45, s88, 2883584
s_add_u32 m0, s87, 6144
s_nop 0
buffer_load_dwordx4 v80, s[16:19], s45 offen offset:0 lds
buffer_load_dwordx4 v81, s[16:19], s45 offen offset:1024 lds
s_waitcnt vmcnt(22)
ds_read_b32 v112, v82 offset:16384
ds_read_b32 v113, v82 offset:16448
ds_read_b32 v114, v82 offset:16640
ds_read_b32 v115, v82 offset:16704
ds_read_b32 v116, v82 offset:16512
ds_read_b32 v117, v82 offset:16576
ds_read_b32 v118, v82 offset:16768
ds_read_b32 v119, v82 offset:16832
s_waitcnt lgkmcnt(6)
v_perm_b32 v104, v113, v112, s46
v_perm_b32 v108, v113, v112, s47
s_waitcnt lgkmcnt(4)
v_perm_b32 v105, v115, v114, s46
v_perm_b32 v109, v115, v114, s47
s_waitcnt lgkmcnt(2)
v_perm_b32 v106, v117, v116, s46
v_perm_b32 v110, v117, v116, s47
s_waitcnt lgkmcnt(0)
v_perm_b32 v107, v119, v118, s46
v_perm_b32 v111, v119, v118, s47
s_add_u32 s45, s88, 3145728
s_add_u32 m0, s86, 16384
s_nop 0
buffer_load_dwordx4 v80, s[16:19], s45 offen offset:0 lds
buffer_load_dwordx4 v81, s[16:19], s45 offen offset:1024 lds
v_accvgpr_write_b32 a0, v104
v_accvgpr_write_b32 a1, v105
v_accvgpr_write_b32 a2, v106
v_accvgpr_write_b32 a3, v107
v_accvgpr_write_b32 a8, v108
v_accvgpr_write_b32 a9, v109
v_accvgpr_write_b32 a10, v110
v_accvgpr_write_b32 a11, v111
s_waitcnt vmcnt(22)
ds_read_b32 v112, v82 offset:18432
ds_read_b32 v113, v82 offset:18496
ds_read_b32 v114, v82 offset:18688
ds_read_b32 v115, v82 offset:18752
ds_read_b32 v116, v82 offset:18560
ds_read_b32 v117, v82 offset:18624
ds_read_b32 v118, v82 offset:18816
ds_read_b32 v119, v82 offset:18880
s_waitcnt lgkmcnt(6)
v_perm_b32 v104, v113, v112, s46
v_perm_b32 v108, v113, v112, s47
s_waitcnt lgkmcnt(4)
v_perm_b32 v105, v115, v114, s46
v_perm_b32 v109, v115, v114, s47
s_waitcnt lgkmcnt(2)
v_perm_b32 v106, v117, v116, s46
v_perm_b32 v110, v117, v116, s47
s_waitcnt lgkmcnt(0)
v_perm_b32 v107, v119, v118, s46
v_perm_b32 v111, v119, v118, s47
s_add_u32 s45, s88, 3407872
s_add_u32 m0, s86, 18432
s_nop 0
buffer_load_dwordx4 v80, s[16:19], s45 offen offset:0 lds
buffer_load_dwordx4 v81, s[16:19], s45 offen offset:1024 lds
v_accvgpr_write_b32 a4, v104
v_accvgpr_write_b32 a5, v105
v_accvgpr_write_b32 a6, v106
v_accvgpr_write_b32 a7, v107
v_accvgpr_write_b32 a12, v108
v_accvgpr_write_b32 a13, v109
v_accvgpr_write_b32 a14, v110
v_accvgpr_write_b32 a15, v111
s_waitcnt vmcnt(22)
ds_read_b32 v112, v82 offset:20480
ds_read_b32 v113, v82 offset:20544
ds_read_b32 v114, v82 offset:20736
ds_read_b32 v115, v82 offset:20800
ds_read_b32 v116, v82 offset:20608
ds_read_b32 v117, v82 offset:20672
ds_read_b32 v118, v82 offset:20864
ds_read_b32 v119, v82 offset:20928
s_waitcnt lgkmcnt(6)
v_perm_b32 v104, v113, v112, s46
v_perm_b32 v108, v113, v112, s47
s_waitcnt lgkmcnt(4)
v_perm_b32 v105, v115, v114, s46
v_perm_b32 v109, v115, v114, s47
s_waitcnt lgkmcnt(2)
v_perm_b32 v106, v117, v116, s46
v_perm_b32 v110, v117, v116, s47
s_waitcnt lgkmcnt(0)
v_perm_b32 v107, v119, v118, s46
v_perm_b32 v111, v119, v118, s47
s_add_u32 s45, s88, 3670016
s_add_u32 m0, s86, 20480
s_nop 0
buffer_load_dwordx4 v80, s[16:19], s45 offen offset:0 lds
buffer_load_dwordx4 v81, s[16:19], s45 offen offset:1024 lds
v_accvgpr_write_b32 a16, v104
v_accvgpr_write_b32 a17, v105
v_accvgpr_write_b32 a18, v106
v_accvgpr_write_b32 a19, v107
v_accvgpr_write_b32 a24, v108
v_accvgpr_write_b32 a25, v109
v_accvgpr_write_b32 a26, v110
v_accvgpr_write_b32 a27, v111
s_waitcnt vmcnt(22)
ds_read_b32 v112, v82 offset:22528
ds_read_b32 v113, v82 offset:22592
ds_read_b32 v114, v82 offset:22784
ds_read_b32 v115, v82 offset:22848
ds_read_b32 v116, v82 offset:22656
ds_read_b32 v117, v82 offset:22720
ds_read_b32 v118, v82 offset:22912
ds_read_b32 v119, v82 offset:22976
s_waitcnt lgkmcnt(6)
v_perm_b32 v104, v113, v112, s46
v_perm_b32 v108, v113, v112, s47
s_waitcnt lgkmcnt(4)
v_perm_b32 v105, v115, v114, s46
v_perm_b32 v109, v115, v114, s47
s_waitcnt lgkmcnt(2)
v_perm_b32 v106, v117, v116, s46
v_perm_b32 v110, v117, v116, s47
s_waitcnt lgkmcnt(0)
v_perm_b32 v107, v119, v118, s46
v_perm_b32 v111, v119, v118, s47
s_add_u32 s45, s88, 3932160
s_add_u32 m0, s86, 22528
s_nop 0
buffer_load_dwordx4 v80, s[16:19], s45 offen offset:0 lds
buffer_load_dwordx4 v81, s[16:19], s45 offen offset:1024 lds
v_accvgpr_write_b32 a20, v104
v_accvgpr_write_b32 a21, v105
v_accvgpr_write_b32 a22, v106
v_accvgpr_write_b32 a23, v107
v_accvgpr_write_b32 a28, v108
v_accvgpr_write_b32 a29, v109
v_accvgpr_write_b32 a30, v110
v_accvgpr_write_b32 a31, v111
s_waitcnt vmcnt(22)
ds_read_b32 v112, v82 offset:24576
ds_read_b32 v113, v82 offset:24640
ds_read_b32 v114, v82 offset:24832
ds_read_b32 v115, v82 offset:24896
ds_read_b32 v116, v82 offset:24704
ds_read_b32 v117, v82 offset:24768
ds_read_b32 v118, v82 offset:24960
ds_read_b32 v119, v82 offset:25024
s_waitcnt lgkmcnt(6)
v_perm_b32 v104, v113, v112, s46
v_perm_b32 v108, v113, v112, s47
s_waitcnt lgkmcnt(4)
v_perm_b32 v105, v115, v114, s46
v_perm_b32 v109, v115, v114, s47
s_waitcnt lgkmcnt(2)
v_perm_b32 v106, v117, v116, s46
v_perm_b32 v110, v117, v116, s47
s_waitcnt lgkmcnt(0)
v_perm_b32 v107, v119, v118, s46
v_perm_b32 v111, v119, v118, s47
s_add_u32 s45, s88, 0
s_add_u32 m0, s86, 24576
s_nop 0
buffer_load_dwordx4 v80, s[20:23], s45 offen offset:0 lds
buffer_load_dwordx4 v81, s[20:23], s45 offen offset:1024 lds
v_accvgpr_write_b32 a32, v104
v_accvgpr_write_b32 a33, v105
v_accvgpr_write_b32 a34, v106
v_accvgpr_write_b32 a35, v107
v_accvgpr_write_b32 a40, v108
v_accvgpr_write_b32 a41, v109
v_accvgpr_write_b32 a42, v110
v_accvgpr_write_b32 a43, v111
s_waitcnt vmcnt(22)
ds_read_b32 v112, v82 offset:26624
ds_read_b32 v113, v82 offset:26688
ds_read_b32 v114, v82 offset:26880
ds_read_b32 v115, v82 offset:26944
ds_read_b32 v116, v82 offset:26752
ds_read_b32 v117, v82 offset:26816
ds_read_b32 v118, v82 offset:27008
ds_read_b32 v119, v82 offset:27072
s_waitcnt lgkmcnt(6)
v_perm_b32 v104, v113, v112, s46
v_perm_b32 v108, v113, v112, s47
s_waitcnt lgkmcnt(4)
v_perm_b32 v105, v115, v114, s46
v_perm_b32 v109, v115, v114, s47
s_waitcnt lgkmcnt(2)
v_perm_b32 v106, v117, v116, s46
v_perm_b32 v110, v117, v116, s47
s_waitcnt lgkmcnt(0)
v_perm_b32 v107, v119, v118, s46
v_perm_b32 v111, v119, v118, s47
s_add_u32 s45, s88, 262144
s_add_u32 m0, s86, 26624
s_nop 0
buffer_load_dwordx4 v80, s[20:23], s45 offen offset:0 lds
buffer_load_dwordx4 v81, s[20:23], s45 offen offset:1024 lds
v_accvgpr_write_b32 a36, v104
v_accvgpr_write_b32 a37, v105
v_accvgpr_write_b32 a38, v106
v_accvgpr_write_b32 a39, v107
v_accvgpr_write_b32 a44, v108
v_accvgpr_write_b32 a45, v109
v_accvgpr_write_b32 a46, v110
v_accvgpr_write_b32 a47, v111
s_waitcnt vmcnt(22)
ds_read_b32 v112, v82 offset:28672
ds_read_b32 v113, v82 offset:28736
ds_read_b32 v114, v82 offset:28928
ds_read_b32 v115, v82 offset:28992
ds_read_b32 v116, v82 offset:28800
ds_read_b32 v117, v82 offset:28864
ds_read_b32 v118, v82 offset:29056
ds_read_b32 v119, v82 offset:29120
s_waitcnt lgkmcnt(6)
v_perm_b32 v104, v113, v112, s46
v_perm_b32 v108, v113, v112, s47
s_waitcnt lgkmcnt(4)
v_perm_b32 v105, v115, v114, s46
v_perm_b32 v109, v115, v114, s47
s_waitcnt lgkmcnt(2)
v_perm_b32 v106, v117, v116, s46
v_perm_b32 v110, v117, v116, s47
s_waitcnt lgkmcnt(0)
v_perm_b32 v107, v119, v118, s46
v_perm_b32 v111, v119, v118, s47
s_add_u32 s45, s88, 524288
s_add_u32 m0, s86, 28672
s_nop 0
buffer_load_dwordx4 v80, s[20:23], s45 offen offset:0 lds
buffer_load_dwordx4 v81, s[20:23], s45 offen offset:1024 lds
v_accvgpr_write_b32 a48, v104
v_accvgpr_write_b32 a49, v105
v_accvgpr_write_b32 a50, v106
v_accvgpr_write_b32 a51, v107
v_accvgpr_write_b32 a56, v108
v_accvgpr_write_b32 a57, v109
v_accvgpr_write_b32 a58, v110
v_accvgpr_write_b32 a59, v111
s_waitcnt vmcnt(22)
ds_read_b32 v112, v82 offset:30720
ds_read_b32 v113, v82 offset:30784
ds_read_b32 v114, v82 offset:30976
ds_read_b32 v115, v82 offset:31040
ds_read_b32 v116, v82 offset:30848
ds_read_b32 v117, v82 offset:30912
ds_read_b32 v118, v82 offset:31104
ds_read_b32 v119, v82 offset:31168
s_waitcnt lgkmcnt(6)
v_perm_b32 v104, v113, v112, s46
v_perm_b32 v108, v113, v112, s47
s_waitcnt lgkmcnt(4)
v_perm_b32 v105, v115, v114, s46
v_perm_b32 v109, v115, v114, s47
s_waitcnt lgkmcnt(2)
v_perm_b32 v106, v117, v116, s46
v_perm_b32 v110, v117, v116, s47
s_waitcnt lgkmcnt(0)
v_perm_b32 v107, v119, v118, s46
v_perm_b32 v111, v119, v118, s47
s_add_u32 s45, s88, 786432
s_add_u32 m0, s86, 30720
s_nop 0
buffer_load_dwordx4 v80, s[20:23], s45 offen offset:0 lds
buffer_load_dwordx4 v81, s[20:23], s45 offen offset:1024 lds
v_accvgpr_write_b32 a52, v104
v_accvgpr_write_b32 a53, v105
v_accvgpr_write_b32 a54, v106
v_accvgpr_write_b32 a55, v107
v_accvgpr_write_b32 a60, v108
v_accvgpr_write_b32 a61, v109
v_accvgpr_write_b32 a62, v110
v_accvgpr_write_b32 a63, v111
v_lshlrev_b32 v98, 5, v1
buffer_load_dword v97, v98, s[8:11], 0 offen offset:12 sc1
s_waitcnt vmcnt(22)
ds_read_b32 v112, v83 offset:0
ds_read_b32 v113, v83 offset:64
ds_read_b32 v114, v83 offset:256
ds_read_b32 v115, v83 offset:320
ds_read_b32 v116, v83 offset:128
ds_read_b32 v117, v83 offset:192
ds_read_b32 v118, v83 offset:384
ds_read_b32 v119, v83 offset:448
s_waitcnt lgkmcnt(6)
v_perm_b32 v104, v113, v112, s46
v_perm_b32 v108, v113, v112, s47
s_waitcnt lgkmcnt(4)
v_perm_b32 v105, v115, v114, s46
v_perm_b32 v109, v115, v114, s47
s_waitcnt lgkmcnt(2)
v_perm_b32 v106, v117, v116, s46
v_perm_b32 v110, v117, v116, s47
s_waitcnt lgkmcnt(0)
v_perm_b32 v107, v119, v118, s46
v_perm_b32 v111, v119, v118, s47
s_add_u32 s45, s88, 1048576
s_add_u32 m0, s87, 0
s_nop 0
buffer_load_dwordx4 v80, s[20:23], s45 offen offset:0 lds
buffer_load_dwordx4 v81, s[20:23], s45 offen offset:1024 lds
v_accvgpr_write_b32 a64, v104
v_accvgpr_write_b32 a65, v105
v_accvgpr_write_b32 a66, v106
v_accvgpr_write_b32 a67, v107
v_accvgpr_write_b32 a72, v108
v_accvgpr_write_b32 a73, v109
v_accvgpr_write_b32 a74, v110
v_accvgpr_write_b32 a75, v111
s_waitcnt vmcnt(22)
ds_read_b32 v112, v83 offset:2048
ds_read_b32 v113, v83 offset:2112
ds_read_b32 v114, v83 offset:2304
ds_read_b32 v115, v83 offset:2368
ds_read_b32 v116, v83 offset:2176
ds_read_b32 v117, v83 offset:2240
ds_read_b32 v118, v83 offset:2432
ds_read_b32 v119, v83 offset:2496
s_waitcnt lgkmcnt(6)
v_perm_b32 v104, v113, v112, s46
v_perm_b32 v108, v113, v112, s47
s_waitcnt lgkmcnt(4)
v_perm_b32 v105, v115, v114, s46
v_perm_b32 v109, v115, v114, s47
s_waitcnt lgkmcnt(2)
v_perm_b32 v106, v117, v116, s46
v_perm_b32 v110, v117, v116, s47
s_waitcnt lgkmcnt(0)
v_perm_b32 v107, v119, v118, s46
v_perm_b32 v111, v119, v118, s47
s_add_u32 s45, s88, 1310720
s_add_u32 m0, s87, 2048
s_nop 0
buffer_load_dwordx4 v80, s[20:23], s45 offen offset:0 lds
buffer_load_dwordx4 v81, s[20:23], s45 offen offset:1024 lds
v_accvgpr_write_b32 a68, v104
v_accvgpr_write_b32 a69, v105
v_accvgpr_write_b32 a70, v106
v_accvgpr_write_b32 a71, v107
v_accvgpr_write_b32 a76, v108
v_accvgpr_write_b32 a77, v109
v_accvgpr_write_b32 a78, v110
v_accvgpr_write_b32 a79, v111
s_waitcnt vmcnt(22)
ds_read_b32 v112, v83 offset:4096
ds_read_b32 v113, v83 offset:4160
ds_read_b32 v114, v83 offset:4352
ds_read_b32 v115, v83 offset:4416
ds_read_b32 v116, v83 offset:4224
ds_read_b32 v117, v83 offset:4288
ds_read_b32 v118, v83 offset:4480
ds_read_b32 v119, v83 offset:4544
s_waitcnt lgkmcnt(6)
v_perm_b32 v104, v113, v112, s46
v_perm_b32 v108, v113, v112, s47
s_waitcnt lgkmcnt(4)
v_perm_b32 v105, v115, v114, s46
v_perm_b32 v109, v115, v114, s47
s_waitcnt lgkmcnt(2)
v_perm_b32 v106, v117, v116, s46
v_perm_b32 v110, v117, v116, s47
s_waitcnt lgkmcnt(0)
v_perm_b32 v107, v119, v118, s46
v_perm_b32 v111, v119, v118, s47
s_add_u32 s45, s88, 1572864
s_add_u32 m0, s87, 4096
s_nop 0
buffer_load_dwordx4 v80, s[20:23], s45 offen offset:0 lds
buffer_load_dwordx4 v81, s[20:23], s45 offen offset:1024 lds
v_accvgpr_write_b32 a80, v104
v_accvgpr_write_b32 a81, v105
v_accvgpr_write_b32 a82, v106
v_accvgpr_write_b32 a83, v107
v_accvgpr_write_b32 a88, v108
v_accvgpr_write_b32 a89, v109
v_accvgpr_write_b32 a90, v110
v_accvgpr_write_b32 a91, v111
s_waitcnt vmcnt(22)
ds_read_b32 v112, v83 offset:6144
ds_read_b32 v113, v83 offset:6208
ds_read_b32 v114, v83 offset:6400
ds_read_b32 v115, v83 offset:6464
ds_read_b32 v116, v83 offset:6272
ds_read_b32 v117, v83 offset:6336
ds_read_b32 v118, v83 offset:6528
ds_read_b32 v119, v83 offset:6592
s_waitcnt lgkmcnt(6)
v_perm_b32 v104, v113, v112, s46
v_perm_b32 v108, v113, v112, s47
s_waitcnt lgkmcnt(4)
v_perm_b32 v105, v115, v114, s46
v_perm_b32 v109, v115, v114, s47
s_waitcnt lgkmcnt(2)
v_perm_b32 v106, v117, v116, s46
v_perm_b32 v110, v117, v116, s47
s_waitcnt lgkmcnt(0)
v_perm_b32 v107, v119, v118, s46
v_perm_b32 v111, v119, v118, s47
s_add_u32 s45, s88, 1835008
s_add_u32 m0, s87, 6144
s_nop 0
buffer_load_dwordx4 v80, s[20:23], s45 offen offset:0 lds
buffer_load_dwordx4 v81, s[20:23], s45 offen offset:1024 lds
v_accvgpr_write_b32 a84, v104
v_accvgpr_write_b32 a85, v105
v_accvgpr_write_b32 a86, v106
v_accvgpr_write_b32 a87, v107
v_accvgpr_write_b32 a92, v108
v_accvgpr_write_b32 a93, v109
v_accvgpr_write_b32 a94, v110
v_accvgpr_write_b32 a95, v111
s_waitcnt vmcnt(22)
ds_read_b32 v112, v82 offset:16384
ds_read_b32 v113, v82 offset:16448
ds_read_b32 v114, v82 offset:16640
ds_read_b32 v115, v82 offset:16704
ds_read_b32 v116, v82 offset:16512
ds_read_b32 v117, v82 offset:16576
ds_read_b32 v118, v82 offset:16768
ds_read_b32 v119, v82 offset:16832
s_waitcnt lgkmcnt(6)
v_perm_b32 v104, v113, v112, s46
v_perm_b32 v108, v113, v112, s47
s_waitcnt lgkmcnt(4)
v_perm_b32 v105, v115, v114, s46
v_perm_b32 v109, v115, v114, s47
s_waitcnt lgkmcnt(2)
v_perm_b32 v106, v117, v116, s46
v_perm_b32 v110, v117, v116, s47
s_waitcnt lgkmcnt(0)
v_perm_b32 v107, v119, v118, s46
v_perm_b32 v111, v119, v118, s47
s_add_u32 s45, s88, 2097152
s_add_u32 m0, s86, 16384
s_nop 0
buffer_load_dwordx4 v80, s[20:23], s45 offen offset:0 lds
buffer_load_dwordx4 v81, s[20:23], s45 offen offset:1024 lds
v_accvgpr_write_b32 a96, v104
v_accvgpr_write_b32 a97, v105
v_accvgpr_write_b32 a98, v106
v_accvgpr_write_b32 a99, v107
v_accvgpr_write_b32 a104, v108
v_accvgpr_write_b32 a105, v109
v_accvgpr_write_b32 a106, v110
v_accvgpr_write_b32 a107, v111
s_waitcnt vmcnt(22)
ds_read_b32 v112, v82 offset:18432
ds_read_b32 v113, v82 offset:18496
ds_read_b32 v114, v82 offset:18688
ds_read_b32 v115, v82 offset:18752
ds_read_b32 v116, v82 offset:18560
ds_read_b32 v117, v82 offset:18624
ds_read_b32 v118, v82 offset:18816
ds_read_b32 v119, v82 offset:18880
s_waitcnt lgkmcnt(6)
v_perm_b32 v104, v113, v112, s46
v_perm_b32 v108, v113, v112, s47
s_waitcnt lgkmcnt(4)
v_perm_b32 v105, v115, v114, s46
v_perm_b32 v109, v115, v114, s47
s_waitcnt lgkmcnt(2)
v_perm_b32 v106, v117, v116, s46
v_perm_b32 v110, v117, v116, s47
s_waitcnt lgkmcnt(0)
v_perm_b32 v107, v119, v118, s46
v_perm_b32 v111, v119, v118, s47
s_add_u32 s45, s88, 2359296
s_add_u32 m0, s86, 18432
s_nop 0
buffer_load_dwordx4 v80, s[20:23], s45 offen offset:0 lds
buffer_load_dwordx4 v81, s[20:23], s45 offen offset:1024 lds
v_accvgpr_write_b32 a100, v104
v_accvgpr_write_b32 a101, v105
v_accvgpr_write_b32 a102, v106
v_accvgpr_write_b32 a103, v107
v_accvgpr_write_b32 a108, v108
v_accvgpr_write_b32 a109, v109
v_accvgpr_write_b32 a110, v110
v_accvgpr_write_b32 a111, v111
s_waitcnt vmcnt(22)
ds_read_b32 v112, v82 offset:20480
ds_read_b32 v113, v82 offset:20544
ds_read_b32 v114, v82 offset:20736
ds_read_b32 v115, v82 offset:20800
ds_read_b32 v116, v82 offset:20608
ds_read_b32 v117, v82 offset:20672
ds_read_b32 v118, v82 offset:20864
ds_read_b32 v119, v82 offset:20928
s_waitcnt lgkmcnt(6)
v_perm_b32 v104, v113, v112, s46
v_perm_b32 v108, v113, v112, s47
s_waitcnt lgkmcnt(4)
v_perm_b32 v105, v115, v114, s46
v_perm_b32 v109, v115, v114, s47
s_waitcnt lgkmcnt(2)
v_perm_b32 v106, v117, v116, s46
v_perm_b32 v110, v117, v116, s47
s_waitcnt lgkmcnt(0)
v_perm_b32 v107, v119, v118, s46
v_perm_b32 v111, v119, v118, s47
s_add_u32 s45, s88, 2621440
s_add_u32 m0, s86, 20480
s_nop 0
buffer_load_dwordx4 v80, s[20:23], s45 offen offset:0 lds
buffer_load_dwordx4 v81, s[20:23], s45 offen offset:1024 lds
v_accvgpr_write_b32 a112, v104
v_accvgpr_write_b32 a113, v105
v_accvgpr_write_b32 a114, v106
v_accvgpr_write_b32 a115, v107
v_accvgpr_write_b32 a120, v108
v_accvgpr_write_b32 a121, v109
v_accvgpr_write_b32 a122, v110
v_accvgpr_write_b32 a123, v111
s_waitcnt vmcnt(22)
ds_read_b32 v112, v82 offset:22528
ds_read_b32 v113, v82 offset:22592
ds_read_b32 v114, v82 offset:22784
ds_read_b32 v115, v82 offset:22848
ds_read_b32 v116, v82 offset:22656
ds_read_b32 v117, v82 offset:22720
ds_read_b32 v118, v82 offset:22912
ds_read_b32 v119, v82 offset:22976
s_waitcnt lgkmcnt(6)
v_perm_b32 v104, v113, v112, s46
v_perm_b32 v108, v113, v112, s47
s_waitcnt lgkmcnt(4)
v_perm_b32 v105, v115, v114, s46
v_perm_b32 v109, v115, v114, s47
s_waitcnt lgkmcnt(2)
v_perm_b32 v106, v117, v116, s46
v_perm_b32 v110, v117, v116, s47
s_waitcnt lgkmcnt(0)
v_perm_b32 v107, v119, v118, s46
v_perm_b32 v111, v119, v118, s47
s_add_u32 s45, s88, 2883584
s_add_u32 m0, s86, 22528
s_nop 0
buffer_load_dwordx4 v80, s[20:23], s45 offen offset:0 lds
buffer_load_dwordx4 v81, s[20:23], s45 offen offset:1024 lds
v_accvgpr_write_b32 a116, v104
v_accvgpr_write_b32 a117, v105
v_accvgpr_write_b32 a118, v106
v_accvgpr_write_b32 a119, v107
v_accvgpr_write_b32 a124, v108
v_accvgpr_write_b32 a125, v109
v_accvgpr_write_b32 a126, v110
v_accvgpr_write_b32 a127, v111
s_waitcnt vmcnt(22)
ds_read_b32 v112, v82 offset:24576
ds_read_b32 v113, v82 offset:24640
ds_read_b32 v114, v82 offset:24832
ds_read_b32 v115, v82 offset:24896
ds_read_b32 v116, v82 offset:24704
ds_read_b32 v117, v82 offset:24768
ds_read_b32 v118, v82 offset:24960
ds_read_b32 v119, v82 offset:25024
s_waitcnt lgkmcnt(6)
v_perm_b32 v104, v113, v112, s46
v_perm_b32 v108, v113, v112, s47
s_waitcnt lgkmcnt(4)
v_perm_b32 v105, v115, v114, s46
v_perm_b32 v109, v115, v114, s47
s_waitcnt lgkmcnt(2)
v_perm_b32 v106, v117, v116, s46
v_perm_b32 v110, v117, v116, s47
s_waitcnt lgkmcnt(0)
v_perm_b32 v107, v119, v118, s46
v_perm_b32 v111, v119, v118, s47
s_add_u32 s45, s88, 3145728
s_add_u32 m0, s86, 24576
s_nop 0
buffer_load_dwordx4 v80, s[20:23], s45 offen offset:0 lds
buffer_load_dwordx4 v81, s[20:23], s45 offen offset:1024 lds
v_accvgpr_write_b32 a128, v104
v_accvgpr_write_b32 a129, v105
v_accvgpr_write_b32 a130, v106
v_accvgpr_write_b32 a131, v107
v_accvgpr_write_b32 a136, v108
v_accvgpr_write_b32 a137, v109
v_accvgpr_write_b32 a138, v110
v_accvgpr_write_b32 a139, v111
s_waitcnt vmcnt(22)
ds_read_b32 v112, v82 offset:26624
ds_read_b32 v113, v82 offset:26688
ds_read_b32 v114, v82 offset:26880
ds_read_b32 v115, v82 offset:26944
ds_read_b32 v116, v82 offset:26752
ds_read_b32 v117, v82 offset:26816
ds_read_b32 v118, v82 offset:27008
ds_read_b32 v119, v82 offset:27072
s_waitcnt lgkmcnt(6)
v_perm_b32 v104, v113, v112, s46
v_perm_b32 v108, v113, v112, s47
s_waitcnt lgkmcnt(4)
v_perm_b32 v105, v115, v114, s46
v_perm_b32 v109, v115, v114, s47
s_waitcnt lgkmcnt(2)
v_perm_b32 v106, v117, v116, s46
v_perm_b32 v110, v117, v116, s47
s_waitcnt lgkmcnt(0)
v_perm_b32 v107, v119, v118, s46
v_perm_b32 v111, v119, v118, s47
s_add_u32 s45, s88, 3407872
s_add_u32 m0, s86, 26624
s_nop 0
buffer_load_dwordx4 v80, s[20:23], s45 offen offset:0 lds
buffer_load_dwordx4 v81, s[20:23], s45 offen offset:1024 lds
v_accvgpr_write_b32 a132, v104
v_accvgpr_write_b32 a133, v105
v_accvgpr_write_b32 a134, v106
v_accvgpr_write_b32 a135, v107
v_accvgpr_write_b32 a140, v108
v_accvgpr_write_b32 a141, v109
v_accvgpr_write_b32 a142, v110
v_accvgpr_write_b32 a143, v111
s_waitcnt vmcnt(22)
ds_read_b32 v112, v82 offset:28672
ds_read_b32 v113, v82 offset:28736
ds_read_b32 v114, v82 offset:28928
ds_read_b32 v115, v82 offset:28992
ds_read_b32 v116, v82 offset:28800
ds_read_b32 v117, v82 offset:28864
ds_read_b32 v118, v82 offset:29056
ds_read_b32 v119, v82 offset:29120
s_waitcnt lgkmcnt(6)
v_perm_b32 v104, v113, v112, s46
v_perm_b32 v108, v113, v112, s47
s_waitcnt lgkmcnt(4)
v_perm_b32 v105, v115, v114, s46
v_perm_b32 v109, v115, v114, s47
s_waitcnt lgkmcnt(2)
v_perm_b32 v106, v117, v116, s46
v_perm_b32 v110, v117, v116, s47
s_waitcnt lgkmcnt(0)
v_perm_b32 v107, v119, v118, s46
v_perm_b32 v111, v119, v118, s47
s_add_u32 s45, s88, 3670016
s_add_u32 m0, s86, 28672
s_nop 0
buffer_load_dwordx4 v80, s[20:23], s45 offen offset:0 lds
buffer_load_dwordx4 v81, s[20:23], s45 offen offset:1024 lds
v_accvgpr_write_b32 a144, v104
v_accvgpr_write_b32 a145, v105
v_accvgpr_write_b32 a146, v106
v_accvgpr_write_b32 a147, v107
v_accvgpr_write_b32 a152, v108
v_accvgpr_write_b32 a153, v109
v_accvgpr_write_b32 a154, v110
v_accvgpr_write_b32 a155, v111
s_waitcnt vmcnt(22)
ds_read_b32 v112, v82 offset:30720
ds_read_b32 v113, v82 offset:30784
ds_read_b32 v114, v82 offset:30976
ds_read_b32 v115, v82 offset:31040
ds_read_b32 v116, v82 offset:30848
ds_read_b32 v117, v82 offset:30912
ds_read_b32 v118, v82 offset:31104
ds_read_b32 v119, v82 offset:31168
s_waitcnt lgkmcnt(6)
v_perm_b32 v104, v113, v112, s46
v_perm_b32 v108, v113, v112, s47
s_waitcnt lgkmcnt(4)
v_perm_b32 v105, v115, v114, s46
v_perm_b32 v109, v115, v114, s47
s_waitcnt lgkmcnt(2)
v_perm_b32 v106, v117, v116, s46
v_perm_b32 v110, v117, v116, s47
s_waitcnt lgkmcnt(0)
v_perm_b32 v107, v119, v118, s46
v_perm_b32 v111, v119, v118, s47
s_add_u32 s45, s88, 3932160
s_add_u32 m0, s86, 30720
s_nop 0
buffer_load_dwordx4 v80, s[20:23], s45 offen offset:0 lds
buffer_load_dwordx4 v81, s[20:23], s45 offen offset:1024 lds
v_accvgpr_write_b32 a148, v104
v_accvgpr_write_b32 a149, v105
v_accvgpr_write_b32 a150, v106
v_accvgpr_write_b32 a151, v107
v_accvgpr_write_b32 a156, v108
v_accvgpr_write_b32 a157, v109
v_accvgpr_write_b32 a158, v110
v_accvgpr_write_b32 a159, v111
s_waitcnt vmcnt(22)
ds_read_b32 v112, v83 offset:0
ds_read_b32 v113, v83 offset:64
ds_read_b32 v114, v83 offset:256
ds_read_b32 v115, v83 offset:320
ds_read_b32 v116, v83 offset:128
ds_read_b32 v117, v83 offset:192
ds_read_b32 v118, v83 offset:384
ds_read_b32 v119, v83 offset:448
s_waitcnt lgkmcnt(6)
v_perm_b32 v104, v113, v112, s46
v_perm_b32 v108, v113, v112, s47
s_waitcnt lgkmcnt(4)
v_perm_b32 v105, v115, v114, s46
v_perm_b32 v109, v115, v114, s47
s_waitcnt lgkmcnt(2)
v_perm_b32 v106, v117, v116, s46
v_perm_b32 v110, v117, v116, s47
s_waitcnt lgkmcnt(0)
v_perm_b32 v107, v119, v118, s46
v_perm_b32 v111, v119, v118, s47
s_add_u32 s45, s88, 0
s_add_u32 m0, s87, 0
s_nop 0
buffer_load_dwordx4 v80, s[12:15], s45 offen offset:0 lds
buffer_load_dwordx4 v81, s[12:15], s45 offen offset:1024 lds
v_accvgpr_write_b32 a160, v104
v_accvgpr_write_b32 a161, v105
v_accvgpr_write_b32 a162, v106
v_accvgpr_write_b32 a163, v107
v_accvgpr_write_b32 a168, v108
v_accvgpr_write_b32 a169, v109
v_accvgpr_write_b32 a170, v110
v_accvgpr_write_b32 a171, v111
L_cen_114:
s_mov_b32 s40, 0
v_readlane_b32 s41, v97, 0
s_nop 0
s_add_u32 s40, s40, s41
v_readlane_b32 s41, v97, 1
s_nop 0
s_add_u32 s40, s40, s41
v_readlane_b32 s41, v97, 2
s_nop 0
s_add_u32 s40, s40, s41
v_readlane_b32 s41, v97, 3
s_nop 0
s_add_u32 s40, s40, s41
v_readlane_b32 s41, v97, 4
s_nop 0
s_add_u32 s40, s40, s41
v_readlane_b32 s41, v97, 5
s_nop 0
s_add_u32 s40, s40, s41
v_readlane_b32 s41, v97, 6
s_nop 0
s_add_u32 s40, s40, s41
v_readlane_b32 s41, v97, 7
s_nop 0
s_add_u32 s40, s40, s41
s_cmp_eq_u32 s40, 256
s_cbranch_scc1 L_cenok_115
s_sub_u32 s36, s36, 1
s_cbranch_scc1 L_end_chain_G
s_sleep 4
buffer_load_dword v97, v98, s[8:11], 0 offen offset:12 sc1
s_waitcnt vmcnt(0)
s_branch L_cen_114
L_cenok_115:
v_mov_b32 v100, -1
v_mov_b32 v101, -1
v_mov_b32 v102, -1
v_mov_b32 v103, -1
s_lshr_b32 s41, s32, 1
s_lshl_b32 s40, s41, 18
s_xor_b32 s40, s40, s77
buffer_store_dwordx4 v[100:103], v2, s[4:7], s40 offen offset:0 sc1
buffer_store_dwordx4 v[100:103], v2, s[4:7], s40 offen offset:1024 sc1
buffer_store_dwordx4 v[100:103], v2, s[4:7], s40 offen offset:2048 sc1
buffer_store_dwordx4 v[100:103], v2, s[4:7], s40 offen offset:3072 sc1
s_lshl_b32 s40, s41, 13
s_xor_b32 s40, s40, s79
buffer_store_dword v100, v11, s[4:7], s40 offen sc1
s_add_u32 s40, s40, 32768
s_waitcnt vmcnt(22)
ds_read_b32 v112, v83 offset:2048
ds_read_b32 v113, v83 offset:2112
ds_read_b32 v114, v83 offset:2304
ds_read_b32 v115, v83 offset:2368
ds_read_b32 v116, v83 offset:2176
ds_read_b32 v117, v83 offset:2240
ds_read_b32 v118, v83 offset:2432
ds_read_b32 v119, v83 offset:2496
s_waitcnt lgkmcnt(6)
v_perm_b32 v104, v113, v112, s46
v_perm_b32 v108, v113, v112, s47
s_waitcnt lgkmcnt(4)
v_perm_b32 v105, v115, v114, s46
v_perm_b32 v109, v115, v114, s47
s_waitcnt lgkmcnt(2)
v_perm_b32 v106, v117, v116, s46
v_perm_b32 v110, v117, v116, s47
s_waitcnt lgkmcnt(0)
v_perm_b32 v107, v119, v118, s46
v_perm_b32 v111, v119, v118, s47
s_add_u32 s45, s88, 262144
s_add_u32 m0, s87, 2048
s_nop 0
buffer_load_dwordx4 v80, s[12:15], s45 offen offset:0 lds
buffer_load_dwordx4 v81, s[12:15], s45 offen offset:1024 lds
v_accvgpr_write_b32 a164, v104
v_accvgpr_write_b32 a165, v105
v_accvgpr_write_b32 a166, v106
v_accvgpr_write_b32 a167, v107
v_accvgpr_write_b32 a172, v108
v_accvgpr_write_b32 a173, v109
v_accvgpr_write_b32 a174, v110
v_accvgpr_write_b32 a175, v111
s_waitcnt vmcnt(22)
ds_read_b32 v112, v83 offset:4096
ds_read_b32 v113, v83 offset:4160
ds_read_b32 v114, v83 offset:4352
ds_read_b32 v115, v83 offset:4416
ds_read_b32 v116, v83 offset:4224
ds_read_b32 v117, v83 offset:4288
ds_read_b32 v118, v83 offset:4480
ds_read_b32 v119, v83 offset:4544
s_waitcnt lgkmcnt(6)
v_perm_b32 v104, v113, v112, s46
v_perm_b32 v108, v113, v112, s47
s_waitcnt lgkmcnt(4)
v_perm_b32 v105, v115, v114, s46
v_perm_b32 v109, v115, v114, s47
s_waitcnt lgkmcnt(2)
v_perm_b32 v106, v117, v116, s46
v_perm_b32 v110, v117, v116, s47
s_waitcnt lgkmcnt(0)
v_perm_b32 v107, v119, v118, s46
v_perm_b32 v111, v119, v118, s47
s_add_u32 s45, s88, 524288
s_add_u32 m0, s87, 4096
s_nop 0
buffer_load_dwordx4 v80, s[12:15], s45 offen offset:0 lds
buffer_load_dwordx4 v81, s[12:15], s45 offen offset:1024 lds
v_accvgpr_write_b32 a176, v104
v_accvgpr_write_b32 a177, v105
v_accvgpr_write_b32 a178, v106
v_accvgpr_write_b32 a179, v107
v_accvgpr_write_b32 a184, v108
v_accvgpr_write_b32 a185, v109
v_accvgpr_write_b32 a186, v110
v_accvgpr_write_b32 a187, v111
s_waitcnt vmcnt(22)
ds_read_b32 v112, v83 offset:6144
ds_read_b32 v113, v83 offset:6208
ds_read_b32 v114, v83 offset:6400
ds_read_b32 v115, v83 offset:6464
ds_read_b32 v116, v83 offset:6272
ds_read_b32 v117, v83 offset:6336
ds_read_b32 v118, v83 offset:6528
ds_read_b32 v119, v83 offset:6592
s_waitcnt lgkmcnt(6)
v_perm_b32 v104, v113, v112, s46
v_perm_b32 v108, v113, v112, s47
s_waitcnt lgkmcnt(4)
v_perm_b32 v105, v115, v114, s46
v_perm_b32 v109, v115, v114, s47
s_waitcnt lgkmcnt(2)
v_perm_b32 v106, v117, v116, s46
v_perm_b32 v110, v117, v116, s47
s_waitcnt lgkmcnt(0)
v_perm_b32 v107, v119, v118, s46
v_perm_b32 v111, v119, v118, s47
s_add_u32 s45, s88, 786432
s_add_u32 m0, s87, 6144
s_nop 0
buffer_load_dwordx4 v80, s[12:15], s45 offen offset:0 lds
buffer_load_dwordx4 v81, s[12:15], s45 offen offset:1024 lds
v_accvgpr_write_b32 a180, v104
v_accvgpr_write_b32 a181, v105
v_accvgpr_write_b32 a182, v106
v_accvgpr_write_b32 a183, v107
v_accvgpr_write_b32 a188, v108
v_accvgpr_write_b32 a189, v109
v_accvgpr_write_b32 a190, v110
v_accvgpr_write_b32 a191, v111
s_waitcnt vmcnt(22)
ds_read_b32 v112, v82 offset:16384
ds_read_b32 v113, v82 offset:16448
ds_read_b32 v114, v82 offset:16640
ds_read_b32 v115, v82 offset:16704
ds_read_b32 v116, v82 offset:16512
ds_read_b32 v117, v82 offset:16576
ds_read_b32 v118, v82 offset:16768
ds_read_b32 v119, v82 offset:16832
s_waitcnt lgkmcnt(6)
v_perm_b32 v104, v113, v112, s46
v_perm_b32 v108, v113, v112, s47
s_waitcnt lgkmcnt(4)
v_perm_b32 v105, v115, v114, s46
v_perm_b32 v109, v115, v114, s47
s_waitcnt lgkmcnt(2)
v_perm_b32 v106, v117, v116, s46
v_perm_b32 v110, v117, v116, s47
s_waitcnt lgkmcnt(0)
v_perm_b32 v107, v119, v118, s46
v_perm_b32 v111, v119, v118, s47
s_add_u32 s45, s88, 1048576
s_add_u32 m0, s86, 16384
s_nop 0
buffer_load_dwordx4 v80, s[12:15], s45 offen offset:0 lds
buffer_load_dwordx4 v81, s[12:15], s45 offen offset:1024 lds
v_accvgpr_write_b32 a192, v104
v_accvgpr_write_b32 a193, v105
v_accvgpr_write_b32 a194, v106
v_accvgpr_write_b32 a195, v107
v_accvgpr_write_b32 a200, v108
v_accvgpr_write_b32 a201, v109
v_accvgpr_write_b32 a202, v110
v_accvgpr_write_b32 a203, v111
s_waitcnt vmcnt(22)
ds_read_b32 v112, v82 offset:18432
ds_read_b32 v113, v82 offset:18496
ds_read_b32 v114, v82 offset:18688
ds_read_b32 v115, v82 offset:18752
ds_read_b32 v116, v82 offset:18560
ds_read_b32 v117, v82 offset:18624
ds_read_b32 v118, v82 offset:18816
ds_read_b32 v119, v82 offset:18880
s_waitcnt lgkmcnt(6)
v_perm_b32 v104, v113, v112, s46
v_perm_b32 v108, v113, v112, s47
s_waitcnt lgkmcnt(4)
v_perm_b32 v105, v115, v114, s46
v_perm_b32 v109, v115, v114, s47
s_waitcnt lgkmcnt(2)
v_perm_b32 v106, v117, v116, s46
v_perm_b32 v110, v117, v116, s47
s_waitcnt lgkmcnt(0)
v_perm_b32 v107, v119, v118, s46
v_perm_b32 v111, v119, v118, s47
s_add_u32 s45, s88, 1310720
s_add_u32 m0, s86, 18432
s_nop 0
buffer_load_dwordx4 v80, s[12:15], s45 offen offset:0 lds
buffer_load_dwordx4 v81, s[12:15], s45 offen offset:1024 lds
v_accvgpr_write_b32 a196, v104
v_accvgpr_write_b32 a197, v105
v_accvgpr_write_b32 a198, v106
v_accvgpr_write_b32 a199, v107
v_accvgpr_write_b32 a204, v108
v_accvgpr_write_b32 a205, v109
v_accvgpr_write_b32 a206, v110
v_accvgpr_write_b32 a207, v111
s_waitcnt vmcnt(22)
ds_read_b32 v112, v82 offset:20480
ds_read_b32 v113, v82 offset:20544
ds_read_b32 v114, v82 offset:20736
ds_read_b32 v115, v82 offset:20800
ds_read_b32 v116, v82 offset:20608
ds_read_b32 v117, v82 offset:20672
ds_read_b32 v118, v82 offset:20864
ds_read_b32 v119, v82 offset:20928
s_waitcnt lgkmcnt(6)
v_perm_b32 v104, v113, v112, s46
v_perm_b32 v108, v113, v112, s47
s_waitcnt lgkmcnt(4)
v_perm_b32 v105, v115, v114, s46
v_perm_b32 v109, v115, v114, s47
s_waitcnt lgkmcnt(2)
v_perm_b32 v106, v117, v116, s46
v_perm_b32 v110, v117, v116, s47
s_waitcnt lgkmcnt(0)
v_perm_b32 v107, v119, v118, s46
v_perm_b32 v111, v119, v118, s47
s_add_u32 s45, s88, 1572864
s_add_u32 m0, s86, 20480
s_nop 0
buffer_load_dwordx4 v80, s[12:15], s45 offen offset:0 lds
buffer_load_dwordx4 v81, s[12:15], s45 offen offset:1024 lds
v_accvgpr_write_b32 a208, v104
v_accvgpr_write_b32 a209, v105
v_accvgpr_write_b32 a210, v106
v_accvgpr_write_b32 a211, v107
v_accvgpr_write_b32 a216, v108
v_accvgpr_write_b32 a217, v109
v_accvgpr_write_b32 a218, v110
v_accvgpr_write_b32 a219, v111
s_waitcnt vmcnt(22)
ds_read_b32 v112, v82 offset:22528
ds_read_b32 v113, v82 offset:22592
ds_read_b32 v114, v82 offset:22784
ds_read_b32 v115, v82 offset:22848
ds_read_b32 v116, v82 offset:22656
ds_read_b32 v117, v82 offset:22720
ds_read_b32 v118, v82 offset:22912
ds_read_b32 v119, v82 offset:22976
s_waitcnt lgkmcnt(6)
v_perm_b32 v104, v113, v112, s46
v_perm_b32 v108, v113, v112, s47
s_waitcnt lgkmcnt(4)
v_perm_b32 v105, v115, v114, s46
v_perm_b32 v109, v115, v114, s47
s_waitcnt lgkmcnt(2)
v_perm_b32 v106, v117, v116, s46
v_perm_b32 v110, v117, v116, s47
s_waitcnt lgkmcnt(0)
v_perm_b32 v107, v119, v118, s46
v_perm_b32 v111, v119, v118, s47
s_add_u32 s45, s88, 1835008
s_add_u32 m0, s86, 22528
s_nop 0
buffer_load_dwordx4 v80, s[12:15], s45 offen offset:0 lds
buffer_load_dwordx4 v81, s[12:15], s45 offen offset:1024 lds
v_accvgpr_write_b32 a212, v104
v_accvgpr_write_b32 a213, v105
v_accvgpr_write_b32 a214, v106
v_accvgpr_write_b32 a215, v107
v_accvgpr_write_b32 a220, v108
v_accvgpr_write_b32 a221, v109
v_accvgpr_write_b32 a222, v110
v_accvgpr_write_b32 a223, v111
s_waitcnt vmcnt(22)
ds_read_b32 v112, v82 offset:24576
ds_read_b32 v113, v82 offset:24640
ds_read_b32 v114, v82 offset:24832
ds_read_b32 v115, v82 offset:24896
ds_read_b32 v116, v82 offset:24704
ds_read_b32 v117, v82 offset:24768
ds_read_b32 v118, v82 offset:24960
ds_read_b32 v119, v82 offset:25024
s_waitcnt lgkmcnt(6)
v_perm_b32 v104, v113, v112, s46
v_perm_b32 v108, v113, v112, s47
s_waitcnt lgkmcnt(4)
v_perm_b32 v105, v115, v114, s46
v_perm_b32 v109, v115, v114, s47
s_waitcnt lgkmcnt(2)
v_perm_b32 v106, v117, v116, s46
v_perm_b32 v110, v117, v116, s47
s_waitcnt lgkmcnt(0)
v_perm_b32 v107, v119, v118, s46
v_perm_b32 v111, v119, v118, s47
s_add_u32 s45, s88, 2097152
s_add_u32 m0, s86, 24576
s_nop 0
buffer_load_dwordx4 v80, s[12:15], s45 offen offset:0 lds
buffer_load_dwordx4 v81, s[12:15], s45 offen offset:1024 lds
v_accvgpr_write_b32 a224, v104
v_accvgpr_write_b32 a225, v105
v_accvgpr_write_b32 a226, v106
v_accvgpr_write_b32 a227, v107
v_accvgpr_write_b32 a232, v108
v_accvgpr_write_b32 a233, v109
v_accvgpr_write_b32 a234, v110
v_accvgpr_write_b32 a235, v111
s_waitcnt vmcnt(22)
ds_read_b32 v112, v82 offset:26624
ds_read_b32 v113, v82 offset:26688
ds_read_b32 v114, v82 offset:26880
ds_read_b32 v115, v82 offset:26944
ds_read_b32 v116, v82 offset:26752
ds_read_b32 v117, v82 offset:26816
ds_read_b32 v118, v82 offset:27008
ds_read_b32 v119, v82 offset:27072
s_waitcnt lgkmcnt(6)
v_perm_b32 v104, v113, v112, s46
v_perm_b32 v108, v113, v112, s47
s_waitcnt lgkmcnt(4)
v_perm_b32 v105, v115, v114, s46
v_perm_b32 v109, v115, v114, s47
s_waitcnt lgkmcnt(2)
v_perm_b32 v106, v117, v116, s46
v_perm_b32 v110, v117, v116, s47
s_waitcnt lgkmcnt(0)
v_perm_b32 v107, v119, v118, s46
v_perm_b32 v111, v119, v118, s47
s_add_u32 s45, s88, 2359296
s_add_u32 m0, s86, 26624
s_nop 0
buffer_load_dwordx4 v80, s[12:15], s45 offen offset:0 lds
buffer_load_dwordx4 v81, s[12:15], s45 offen offset:1024 lds
v_accvgpr_write_b32 a228, v104
v_accvgpr_write_b32 a229, v105
v_accvgpr_write_b32 a230, v106
v_accvgpr_write_b32 a231, v107
v_accvgpr_write_b32 a236, v108
v_accvgpr_write_b32 a237, v109
v_accvgpr_write_b32 a238, v110
v_accvgpr_write_b32 a239, v111
s_waitcnt vmcnt(22)
ds_read_b32 v112, v82 offset:28672
ds_read_b32 v113, v82 offset:28736
ds_read_b32 v114, v82 offset:28928
ds_read_b32 v115, v82 offset:28992
ds_read_b32 v116, v82 offset:28800
ds_read_b32 v117, v82 offset:28864
ds_read_b32 v118, v82 offset:29056
ds_read_b32 v119, v82 offset:29120
s_waitcnt lgkmcnt(6)
v_perm_b32 v104, v113, v112, s46
v_perm_b32 v108, v113, v112, s47
s_waitcnt lgkmcnt(4)
v_perm_b32 v105, v115, v114, s46
v_perm_b32 v109, v115, v114, s47
s_waitcnt lgkmcnt(2)
v_perm_b32 v106, v117, v116, s46
v_perm_b32 v110, v117, v116, s47
s_waitcnt lgkmcnt(0)
v_perm_b32 v107, v119, v118, s46
v_perm_b32 v111, v119, v118, s47
s_add_u32 s45, s88, 2621440
s_add_u32 m0, s86, 28672
s_nop 0
buffer_load_dwordx4 v80, s[12:15], s45 offen offset:0 lds
buffer_load_dwordx4 v81, s[12:15], s45 offen offset:1024 lds
v_accvgpr_write_b32 a240, v104
v_accvgpr_write_b32 a241, v105
v_accvgpr_write_b32 a242, v106
v_accvgpr_write_b32 a243, v107
v_accvgpr_write_b32 a248, v108
v_accvgpr_write_b32 a249, v109
v_accvgpr_write_b32 a250, v110
v_accvgpr_write_b32 a251, v111
s_waitcnt vmcnt(22)
ds_read_b32 v112, v82 offset:30720
ds_read_b32 v113, v82 offset:30784
ds_read_b32 v114, v82 offset:30976
ds_read_b32 v115, v82 offset:31040
ds_read_b32 v116, v82 offset:30848
ds_read_b32 v117, v82 offset:30912
ds_read_b32 v118, v82 offset:31104
ds_read_b32 v119, v82 offset:31168
s_waitcnt lgkmcnt(6)
v_perm_b32 v104, v113, v112, s46
v_perm_b32 v108, v113, v112, s47
s_waitcnt lgkmcnt(4)
v_perm_b32 v105, v115, v114, s46
v_perm_b32 v109, v115, v114, s47
s_waitcnt lgkmcnt(2)
v_perm_b32 v106, v117, v116, s46
v_perm_b32 v110, v117, v116, s47
s_waitcnt lgkmcnt(0)
v_perm_b32 v107, v119, v118, s46
v_perm_b32 v111, v119, v118, s47
s_add_u32 s45, s88, 2883584
s_add_u32 m0, s86, 30720
s_nop 0
buffer_load_dwordx4 v80, s[12:15], s45 offen offset:0 lds
buffer_load_dwordx4 v81, s[12:15], s45 offen offset:1024 lds
v_accvgpr_write_b32 a244, v104
v_accvgpr_write_b32 a245, v105
v_accvgpr_write_b32 a246, v106
v_accvgpr_write_b32 a247, v107
v_accvgpr_write_b32 a252, v108
v_accvgpr_write_b32 a253, v109
v_accvgpr_write_b32 a254, v110
v_accvgpr_write_b32 a255, v111
s_waitcnt vmcnt(22)
ds_read_b32 v112, v83 offset:0
ds_read_b32 v113, v83 offset:64
ds_read_b32 v114, v83 offset:256
ds_read_b32 v115, v83 offset:320
ds_read_b32 v116, v83 offset:128
ds_read_b32 v117, v83 offset:192
ds_read_b32 v118, v83 offset:384
ds_read_b32 v119, v83 offset:448
s_waitcnt lgkmcnt(6)
v_perm_b32 v104, v113, v112, s46
v_perm_b32 v108, v113, v112, s47
s_waitcnt lgkmcnt(4)
v_perm_b32 v105, v115, v114, s46
v_perm_b32 v109, v115, v114, s47
s_waitcnt lgkmcnt(2)
v_perm_b32 v106, v117, v116, s46
v_perm_b32 v110, v117, v116, s47
s_waitcnt lgkmcnt(0)
v_perm_b32 v107, v119, v118, s46
v_perm_b32 v111, v119, v118, s47
s_add_u32 s45, s88, 3145728
s_add_u32 m0, s87, 0
s_nop 0
buffer_load_dwordx4 v80, s[12:15], s45 offen offset:0 lds
buffer_load_dwordx4 v81, s[12:15], s45 offen offset:1024 lds
v_mov_b32 v128, v104
v_mov_b32 v129, v105
v_mov_b32 v130, v106
v_mov_b32 v131, v107
ds_write_b128 v3, v[108:111] offset:0
s_waitcnt vmcnt(22)
ds_read_b32 v112, v83 offset:2048
ds_read_b32 v113, v83 offset:2112
ds_read_b32 v114, v83 offset:2304
ds_read_b32 v115, v83 offset:2368
ds_read_b32 v116, v83 offset:2176
ds_read_b32 v117, v83 offset:2240
ds_read_b32 v118, v83 offset:2432
ds_read_b32 v119, v83 offset:2496
s_waitcnt lgkmcnt(6)
v_perm_b32 v104, v113, v112, s46
v_perm_b32 v108, v113, v112, s47
s_waitcnt lgkmcnt(4)
v_perm_b32 v105, v115, v114, s46
v_perm_b32 v109, v115, v114, s47
s_waitcnt lgkmcnt(2)
v_perm_b32 v106, v117, v116, s46
v_perm_b32 v110, v117, v116, s47
s_waitcnt lgkmcnt(0)
v_perm_b32 v107, v119, v118, s46
v_perm_b32 v111, v119, v118, s47
s_add_u32 s45, s88, 3407872
s_add_u32 m0, s87, 2048
s_nop 0
buffer_load_dwordx4 v80, s[12:15], s45 offen offset:0 lds
buffer_load_dwordx4 v81, s[12:15], s45 offen offset:1024 lds
v_mov_b32 v132, v104
v_mov_b32 v133, v105
v_mov_b32 v134, v106
v_mov_b32 v135, v107
ds_write_b128 v3, v[108:111] offset:1024
s_barrier
s_cmp_lg_u32 s32, 0
s_cbranch_scc1 L_ra_116
v_mov_b32 v100, 1
s_lshl_b32 s40, s35, 5
v_mov_b32 v101, s40
s_mov_b64 exec, 1
buffer_atomic_add v100, v101, s[8:11], 0 offen offset:8
s_mov_b64 exec, -1
L_ra_116:
s_waitcnt vmcnt(22)
ds_read_b32 v112, v83 offset:4096
ds_read_b32 v113, v83 offset:4160
ds_read_b32 v114, v83 offset:4352
ds_read_b32 v115, v83 offset:4416
ds_read_b32 v116, v83 offset:4224
ds_read_b32 v117, v83 offset:4288
ds_read_b32 v118, v83 offset:4480
ds_read_b32 v119, v83 offset:4544
s_waitcnt lgkmcnt(6)
v_perm_b32 v104, v113, v112, s46
v_perm_b32 v108, v113, v112, s47
s_waitcnt lgkmcnt(4)
v_perm_b32 v105, v115, v114, s46
v_perm_b32 v109, v115, v114, s47
s_waitcnt lgkmcnt(2)
v_perm_b32 v106, v117, v116, s46
v_perm_b32 v110, v117, v116, s47
s_waitcnt lgkmcnt(0)
v_perm_b32 v107, v119, v118, s46
v_perm_b32 v111, v119, v118, s47
s_add_u32 s45, s88, 3670016
s_add_u32 m0, s87, 4096
s_nop 0
buffer_load_dwordx4 v80, s[12:15], s45 offen offset:0 lds
buffer_load_dwordx4 v81, s[12:15], s45 offen offset:1024 lds
v_mov_b32 v136, v104
v_mov_b32 v137, v105
v_mov_b32 v138, v106
v_mov_b32 v139, v107
ds_write_b128 v3, v[108:111] offset:2048
s_mov_b32 s12, s50
s_mov_b32 s13, s51
s_mov_b32 s14, 8192
s_mov_b32 s15, 0x20000
v_bfe_u32 v86, v1, 3, 2
v_and_b32 v85, 1, v1
v_lshl_add_u32 v86, v86, 1, v85
v_lshlrev_b32 v86, 10, v86
v_bfe_u32 v85, v1, 1, 2
v_lshl_add_u32 v86, v85, 5, v86
v_lshrrev_b32 v85, 5, v1
v_lshl_add_u32 v85, v85, 3, v86
s_lshl_b32 s40, s32, 8
buffer_load_dwordx2 v[120:121], v85, s[12:15], s40 offen
buffer_load_dwordx2 v[122:123], v85, s[12:15], s40 offen offset:16
buffer_load_dwordx2 v[124:125], v85, s[12:15], s40 offen offset:128
buffer_load_dwordx2 v[126:127], v85, s[12:15], s40 offen offset:144
s_lshl_b32 s42, s35, 11
s_add_u32 s42, s42, s34
s_lshl_b32 s40, s42, 6
s_lshl_b32 s41, s32, 2
s_add_u32 s40, s40, s41
s_add_u32 s30, s40, 131072
v_and_b32 v85, 1, v1
v_lshlrev_b32 v86, 4, v85
v_add_u32 v86, 16, v86
v_lshlrev_b32 v85, 2, v85
v_subrev_u32 v85, s41, v85
v_add_u32 v85, 48, v85
v_and_b32 v87, 2, v1
v_cmp_eq_u32 vcc, 0, v87
s_nop 1
v_cndmask_b32 v102, v85, v86, vcc
buffer_load_dword v0, v102, s[4:7], s30 offen sc1
s_lshl_b32 s40, s42, 13
s_lshl_b32 s41, s32, 11
s_add_u32 s40, s40, s41
s_add_u32 s38, s40, 75497472
s_add_u32 s31, s41, 147456
s_waitcnt vmcnt(22)
ds_read_b32 v112, v83 offset:6144
ds_read_b32 v113, v83 offset:6208
ds_read_b32 v114, v83 offset:6400
ds_read_b32 v115, v83 offset:6464
ds_read_b32 v116, v83 offset:6272
ds_read_b32 v117, v83 offset:6336
ds_read_b32 v118, v83 offset:6528
ds_read_b32 v119, v83 offset:6592
s_waitcnt lgkmcnt(6)
v_perm_b32 v104, v113, v112, s46
v_perm_b32 v108, v113, v112, s47
s_waitcnt lgkmcnt(4)
v_perm_b32 v105, v115, v114, s46
v_perm_b32 v109, v115, v114, s47
s_waitcnt lgkmcnt(2)
v_perm_b32 v106, v117, v116, s46
v_perm_b32 v110, v117, v116, s47
s_waitcnt lgkmcnt(0)
v_perm_b32 v107, v119, v118, s46
v_perm_b32 v111, v119, v118, s47
s_add_u32 s45, s88, 3932160
s_add_u32 m0, s87, 6144
s_nop 0
buffer_load_dwordx4 v80, s[12:15], s45 offen offset:0 lds
buffer_load_dwordx4 v81, s[12:15], s45 offen offset:1024 lds
v_mov_b32 v140, v104
v_mov_b32 v141, v105
v_mov_b32 v142, v106
v_mov_b32 v143, v107
ds_write_b128 v3, v[108:111] offset:3072
s_waitcnt vmcnt(22)
ds_read_b32 v112, v82 offset:16384
ds_read_b32 v113, v82 offset:16448
ds_read_b32 v114, v82 offset:16640
ds_read_b32 v115, v82 offset:16704
ds_read_b32 v116, v82 offset:16512
ds_read_b32 v117, v82 offset:16576
ds_read_b32 v118, v82 offset:16768
ds_read_b32 v119, v82 offset:16832
s_waitcnt lgkmcnt(6)
v_perm_b32 v104, v113, v112, s46
v_perm_b32 v108, v113, v112, s47
s_waitcnt lgkmcnt(4)
v_perm_b32 v105, v115, v114, s46
v_perm_b32 v109, v115, v114, s47
s_waitcnt lgkmcnt(2)
v_perm_b32 v106, v117, v116, s46
v_perm_b32 v110, v117, v116, s47
s_waitcnt lgkmcnt(0)
v_perm_b32 v107, v119, v118, s46
v_perm_b32 v111, v119, v118, s47
s_mov_b32 s45, 0
buffer_load_dwordx4 v[16:19], v88, s[24:27], s45 offen offset:0
buffer_load_dwordx4 v[20:23], v88, s[24:27], s45 offen offset:1024
buffer_load_dwordx4 v[24:27], v89, s[24:27], s45 offen offset:0
buffer_load_dwordx4 v[28:31], v89, s[24:27], s45 offen offset:1024
buffer_load_dwordx4 v[32:35], v88, s[24:27], s45 offen offset:2048
buffer_load_dwordx4 v[36:39], v88, s[24:27], s45 offen offset:3072
buffer_load_dwordx4 v[40:43], v89, s[24:27], s45 offen offset:2048
buffer_load_dwordx4 v[44:47], v89, s[24:27], s45 offen offset:3072
v_mov_b32 v144, v104
v_mov_b32 v145, v105
v_mov_b32 v146, v106
v_mov_b32 v147, v107
ds_write_b128 v3, v[108:111] offset:4096
s_waitcnt vmcnt(28)
ds_read_b32 v112, v82 offset:18432
ds_read_b32 v113, v82 offset:18496
ds_read_b32 v114, v82 offset:18688
ds_read_b32 v115, v82 offset:18752
ds_read_b32 v116, v82 offset:18560
ds_read_b32 v117, v82 offset:18624
ds_read_b32 v118, v82 offset:18816
ds_read_b32 v119, v82 offset:18880
s_waitcnt lgkmcnt(6)
v_perm_b32 v104, v113, v112, s46
v_perm_b32 v108, v113, v112, s47
s_waitcnt lgkmcnt(4)
v_perm_b32 v105, v115, v114, s46
v_perm_b32 v109, v115, v114, s47
s_waitcnt lgkmcnt(2)
v_perm_b32 v106, v117, v116, s46
v_perm_b32 v110, v117, v116, s47
s_waitcnt lgkmcnt(0)
v_perm_b32 v107, v119, v118, s46
v_perm_b32 v111, v119, v118, s47
v_mov_b32 v148, v104
v_mov_b32 v149, v105
v_mov_b32 v150, v106
v_mov_b32 v151, v107
ds_write_b128 v3, v[108:111] offset:5120
s_waitcnt vmcnt(26)
ds_read_b32 v112, v82 offset:20480
ds_read_b32 v113, v82 offset:20544
ds_read_b32 v114, v82 offset:20736
ds_read_b32 v115, v82 offset:20800
ds_read_b32 v116, v82 offset:20608
ds_read_b32 v117, v82 offset:20672
ds_read_b32 v118, v82 offset:20864
ds_read_b32 v119, v82 offset:20928
s_waitcnt lgkmcnt(6)
v_perm_b32 v104, v113, v112, s46
v_perm_b32 v108, v113, v112, s47
s_waitcnt lgkmcnt(4)
v_perm_b32 v105, v115, v114, s46
v_perm_b32 v109, v115, v114, s47
s_waitcnt lgkmcnt(2)
v_perm_b32 v106, v117, v116, s46
v_perm_b32 v110, v117, v116, s47
s_waitcnt lgkmcnt(0)
v_perm_b32 v107, v119, v118, s46
v_perm_b32 v111, v119, v118, s47
v_mov_b32 v152, v104
v_mov_b32 v153, v105
v_mov_b32 v154, v106
v_mov_b32 v155, v107
ds_write_b128 v3, v[108:111] offset:6144
s_waitcnt vmcnt(24)
ds_read_b32 v112, v82 offset:22528
ds_read_b32 v113, v82 offset:22592
ds_read_b32 v114, v82 offset:22784
ds_read_b32 v115, v82 offset:22848
ds_read_b32 v116, v82 offset:22656
ds_read_b32 v117, v82 offset:22720
ds_read_b32 v118, v82 offset:22912
ds_read_b32 v119, v82 offset:22976
s_waitcnt lgkmcnt(6)
v_perm_b32 v104, v113, v112, s46
v_perm_b32 v108, v113, v112, s47
s_waitcnt lgkmcnt(4)
v_perm_b32 v105, v115, v114, s46
v_perm_b32 v109, v115, v114, s47
s_waitcnt lgkmcnt(2)
v_perm_b32 v106, v117, v116, s46
v_perm_b32 v110, v117, v116, s47
s_waitcnt lgkmcnt(0)
v_perm_b32 v107, v119, v118, s46
v_perm_b32 v111, v119, v118, s47
v_mov_b32 v156, v104
v_mov_b32 v157, v105
v_mov_b32 v158, v106
v_mov_b32 v159, v107
ds_write_b128 v3, v[108:111] offset:7168
s_waitcnt vmcnt(22)
ds_read_b32 v112, v82 offset:24576
ds_read_b32 v113, v82 offset:24640
ds_read_b32 v114, v82 offset:24832
ds_read_b32 v115, v82 offset:24896
ds_read_b32 v116, v82 offset:24704
ds_read_b32 v117, v82 offset:24768
ds_read_b32 v118, v82 offset:24960
ds_read_b32 v119, v82 offset:25024
s_waitcnt lgkmcnt(6)
v_perm_b32 v104, v113, v112, s46
v_perm_b32 v108, v113, v112, s47
s_waitcnt lgkmcnt(4)
v_perm_b32 v105, v115, v114, s46
v_perm_b32 v109, v115, v114, s47
s_waitcnt lgkmcnt(2)
v_perm_b32 v106, v117, v116, s46
v_perm_b32 v110, v117, v116, s47
s_waitcnt lgkmcnt(0)
v_perm_b32 v107, v119, v118, s46
v_perm_b32 v111, v119, v118, s47
s_mov_b32 s45, 32768
buffer_load_dwordx4 v[48:51], v88, s[24:27], s45 offen offset:0
buffer_load_dwordx4 v[52:55], v88, s[24:27], s45 offen offset:1024
buffer_load_dwordx4 v[56:59], v89, s[24:27], s45 offen offset:0
buffer_load_dwordx4 v[60:63], v89, s[24:27], s45 offen offset:1024
buffer_load_dwordx4 v[64:67], v88, s[24:27], s45 offen offset:2048
buffer_load_dwordx4 v[68:71], v88, s[24:27], s45 offen offset:3072
buffer_load_dwordx4 v[72:75], v89, s[24:27], s45 offen offset:2048
buffer_load_dwordx4 v[76:79], v89, s[24:27], s45 offen offset:3072
v_mov_b32 v160, v104
v_mov_b32 v161, v105
v_mov_b32 v162, v106
v_mov_b32 v163, v107
ds_write_b128 v3, v[108:111] offset:8192
s_waitcnt vmcnt(28)
ds_read_b32 v112, v82 offset:26624
ds_read_b32 v113, v82 offset:26688
ds_read_b32 v114, v82 offset:26880
ds_read_b32 v115, v82 offset:26944
ds_read_b32 v116, v82 offset:26752
ds_read_b32 v117, v82 offset:26816
ds_read_b32 v118, v82 offset:27008
ds_read_b32 v119, v82 offset:27072
s_waitcnt lgkmcnt(6)
v_perm_b32 v104, v113, v112, s46
v_perm_b32 v108, v113, v112, s47
s_waitcnt lgkmcnt(4)
v_perm_b32 v105, v115, v114, s46
v_perm_b32 v109, v115, v114, s47
s_waitcnt lgkmcnt(2)
v_perm_b32 v106, v117, v116, s46
v_perm_b32 v110, v117, v116, s47
s_waitcnt lgkmcnt(0)
v_perm_b32 v107, v119, v118, s46
v_perm_b32 v111, v119, v118, s47
v_mov_b32 v164, v104
v_mov_b32 v165, v105
v_mov_b32 v166, v106
v_mov_b32 v167, v107
ds_write_b128 v3, v[108:111] offset:9216
s_waitcnt vmcnt(26)
ds_read_b32 v112, v82 offset:28672
ds_read_b32 v113, v82 offset:28736
ds_read_b32 v114, v82 offset:28928
ds_read_b32 v115, v82 offset:28992
ds_read_b32 v116, v82 offset:28800
ds_read_b32 v117, v82 offset:28864
ds_read_b32 v118, v82 offset:29056
ds_read_b32 v119, v82 offset:29120
s_waitcnt lgkmcnt(6)
v_perm_b32 v104, v113, v112, s46
v_perm_b32 v108, v113, v112, s47
s_waitcnt lgkmcnt(4)
v_perm_b32 v105, v115, v114, s46
v_perm_b32 v109, v115, v114, s47
s_waitcnt lgkmcnt(2)
v_perm_b32 v106, v117, v116, s46
v_perm_b32 v110, v117, v116, s47
s_waitcnt lgkmcnt(0)
v_perm_b32 v107, v119, v118, s46
v_perm_b32 v111, v119, v118, s47
v_mov_b32 v168, v104
v_mov_b32 v169, v105
v_mov_b32 v170, v106
v_mov_b32 v171, v107
ds_write_b128 v3, v[108:111] offset:10240
s_waitcnt vmcnt(24)
ds_read_b32 v112, v82 offset:30720
ds_read_b32 v113, v82 offset:30784
ds_read_b32 v114, v82 offset:30976
ds_read_b32 v115, v82 offset:31040
ds_read_b32 v116, v82 offset:30848
ds_read_b32 v117, v82 offset:30912
ds_read_b32 v118, v82 offset:31104
ds_read_b32 v119, v82 offset:31168
s_waitcnt lgkmcnt(6)
v_perm_b32 v104, v113, v112, s46
v_perm_b32 v108, v113, v112, s47
s_waitcnt lgkmcnt(4)
v_perm_b32 v105, v115, v114, s46
v_perm_b32 v109, v115, v114, s47
s_waitcnt lgkmcnt(2)
v_perm_b32 v106, v117, v116, s46
v_perm_b32 v110, v117, v116, s47
s_waitcnt lgkmcnt(0)
v_perm_b32 v107, v119, v118, s46
v_perm_b32 v111, v119, v118, s47
v_mov_b32 v172, v104
v_mov_b32 v173, v105
v_mov_b32 v174, v106
v_mov_b32 v175, v107
ds_write_b128 v3, v[108:111] offset:11264
s_waitcnt vmcnt(22)
ds_read_b32 v112, v83 offset:0
ds_read_b32 v113, v83 offset:64
ds_read_b32 v114, v83 offset:256
ds_read_b32 v115, v83 offset:320
ds_read_b32 v116, v83 offset:128
ds_read_b32 v117, v83 offset:192
ds_read_b32 v118, v83 offset:384
ds_read_b32 v119, v83 offset:448
s_waitcnt lgkmcnt(6)
v_perm_b32 v104, v113, v112, s46
v_perm_b32 v108, v113, v112, s47
s_waitcnt lgkmcnt(4)
v_perm_b32 v105, v115, v114, s46
v_perm_b32 v109, v115, v114, s47
s_waitcnt lgkmcnt(2)
v_perm_b32 v106, v117, v116, s46
v_perm_b32 v110, v117, v116, s47
s_waitcnt lgkmcnt(0)
v_perm_b32 v107, v119, v118, s46
v_perm_b32 v111, v119, v118, s47
v_mov_b32 v176, v104
v_mov_b32 v177, v105
v_mov_b32 v178, v106
v_mov_b32 v179, v107
ds_write_b128 v3, v[108:111] offset:12288
s_waitcnt vmcnt(20)
ds_read_b32 v112, v83 offset:2048
ds_read_b32 v113, v83 offset:2112
ds_read_b32 v114, v83 offset:2304
ds_read_b32 v115, v83 offset:2368
ds_read_b32 v116, v83 offset:2176
ds_read_b32 v117, v83 offset:2240
ds_read_b32 v118, v83 offset:2432
ds_read_b32 v119, v83 offset:2496
s_waitcnt lgkmcnt(6)
v_perm_b32 v104, v113, v112, s46
v_perm_b32 v108, v113, v112, s47
s_waitcnt lgkmcnt(4)
v_perm_b32 v105, v115, v114, s46
v_perm_b32 v109, v115, v114, s47
s_waitcnt lgkmcnt(2)
v_perm_b32 v106, v117, v116, s46
v_perm_b32 v110, v117, v116, s47
s_waitcnt lgkmcnt(0)
v_perm_b32 v107, v119, v118, s46
v_perm_b32 v111, v119, v118, s47
v_mov_b32 v180, v104
v_mov_b32 v181, v105
v_mov_b32 v182, v106
v_mov_b32 v183, v107
ds_write_b128 v3, v[108:111] offset:13312
s_waitcnt vmcnt(18)
ds_read_b32 v112, v83 offset:4096
ds_read_b32 v113, v83 offset:4160
ds_read_b32 v114, v83 offset:4352
ds_read_b32 v115, v83 offset:4416
ds_read_b32 v116, v83 offset:4224
ds_read_b32 v117, v83 offset:4288
ds_read_b32 v118, v83 offset:4480
ds_read_b32 v119, v83 offset:4544
s_waitcnt lgkmcnt(6)
v_perm_b32 v104, v113, v112, s46
v_perm_b32 v108, v113, v112, s47
s_waitcnt lgkmcnt(4)
v_perm_b32 v105, v115, v114, s46
v_perm_b32 v109, v115, v114, s47
s_waitcnt lgkmcnt(2)
v_perm_b32 v106, v117, v116, s46
v_perm_b32 v110, v117, v116, s47
s_waitcnt lgkmcnt(0)
v_perm_b32 v107, v119, v118, s46
v_perm_b32 v111, v119, v118, s47
v_mov_b32 v184, v104
v_mov_b32 v185, v105
v_mov_b32 v186, v106
v_mov_b32 v187, v107
ds_write_b128 v3, v[108:111] offset:14336
s_waitcnt vmcnt(16)
ds_read_b32 v112, v83 offset:6144
ds_read_b32 v113, v83 offset:6208
ds_read_b32 v114, v83 offset:6400
ds_read_b32 v115, v83 offset:6464
ds_read_b32 v116, v83 offset:6272
ds_read_b32 v117, v83 offset:6336
ds_read_b32 v118, v83 offset:6528
ds_read_b32 v119, v83 offset:6592
s_waitcnt lgkmcnt(6)
v_perm_b32 v104, v113, v112, s46
v_perm_b32 v108, v113, v112, s47
s_waitcnt lgkmcnt(4)
v_perm_b32 v105, v115, v114, s46
v_perm_b32 v109, v115, v114, s47
s_waitcnt lgkmcnt(2)
v_perm_b32 v106, v117, v116, s46
v_perm_b32 v110, v117, v116, s47
s_waitcnt lgkmcnt(0)
v_perm_b32 v107, v119, v118, s46
v_perm_b32 v111, v119, v118, s47
v_mov_b32 v188, v104
v_mov_b32 v189, v105
v_mov_b32 v190, v106
v_mov_b32 v191, v107
ds_write_b128 v3, v[108:111] offset:15360
s_waitcnt vmcnt(8)
v_perm_b32 v192, v20, v16, s46
v_perm_b32 v193, v28, v24, s46
v_perm_b32 v194, v36, v32, s46
v_perm_b32 v195, v44, v40, s46
v_perm_b32 v104, v20, v16, s47
v_perm_b32 v105, v28, v24, s47
v_perm_b32 v106, v36, v32, s47
v_perm_b32 v107, v44, v40, s47
ds_write_b128 v3, v[104:107] offset:16384
v_perm_b32 v208, v21, v17, s46
v_perm_b32 v209, v29, v25, s46
v_perm_b32 v210, v37, v33, s46
v_perm_b32 v211, v45, v41, s46
v_perm_b32 v108, v21, v17, s47
v_perm_b32 v109, v29, v25, s47
v_perm_b32 v110, v37, v33, s47
v_perm_b32 v111, v45, v41, s47
ds_write_b128 v3, v[108:111] offset:20480
v_perm_b32 v224, v22, v18, s46
v_perm_b32 v225, v30, v26, s46
v_perm_b32 v226, v38, v34, s46
v_perm_b32 v227, v46, v42, s46
v_perm_b32 v104, v22, v18, s47
v_perm_b32 v105, v30, v26, s47
v_perm_b32 v106, v38, v34, s47
v_perm_b32 v107, v46, v42, s47
ds_write_b128 v3, v[104:107] offset:24576
v_perm_b32 v240, v23, v19, s46
v_perm_b32 v241, v31, v27, s46
v_perm_b32 v242, v39, v35, s46
v_perm_b32 v243, v47, v43, s46
v_perm_b32 v108, v23, v19, s47
v_perm_b32 v109, v31, v27, s47
v_perm_b32 v110, v39, v35, s47
v_perm_b32 v111, v47, v43, s47
ds_write_b128 v3, v[108:111] offset:28672
s_mov_b32 s45, 65536
buffer_load_dwordx4 v[16:19], v88, s[24:27], s45 offen offset:0
buffer_load_dwordx4 v[20:23], v88, s[24:27], s45 offen offset:1024
buffer_load_dwordx4 v[24:27], v89, s[24:27], s45 offen offset:0
buffer_load_dwordx4 v[28:31], v89, s[24:27], s45 offen offset:1024
buffer_load_dwordx4 v[32:35], v88, s[24:27], s45 offen offset:2048
buffer_load_dwordx4 v[36:39], v88, s[24:27], s45 offen offset:3072
buffer_load_dwordx4 v[40:43], v89, s[24:27], s45 offen offset:2048
buffer_load_dwordx4 v[44:47], v89, s[24:27], s45 offen offset:3072
s_waitcnt vmcnt(8)
v_perm_b32 v196, v52, v48, s46
v_perm_b32 v197, v60, v56, s46
v_perm_b32 v198, v68, v64, s46
v_perm_b32 v199, v76, v72, s46
v_perm_b32 v104, v52, v48, s47
v_perm_b32 v105, v60, v56, s47
v_perm_b32 v106, v68, v64, s47
v_perm_b32 v107, v76, v72, s47
ds_write_b128 v3, v[104:107] offset:17408
v_perm_b32 v212, v53, v49, s46
v_perm_b32 v213, v61, v57, s46
v_perm_b32 v214, v69, v65, s46
v_perm_b32 v215, v77, v73, s46
v_perm_b32 v108, v53, v49, s47
v_perm_b32 v109, v61, v57, s47
v_perm_b32 v110, v69, v65, s47
v_perm_b32 v111, v77, v73, s47
ds_write_b128 v3, v[108:111] offset:21504
v_perm_b32 v228, v54, v50, s46
v_perm_b32 v229, v62, v58, s46
v_perm_b32 v230, v70, v66, s46
v_perm_b32 v231, v78, v74, s46
v_perm_b32 v104, v54, v50, s47
v_perm_b32 v105, v62, v58, s47
v_perm_b32 v106, v70, v66, s47
v_perm_b32 v107, v78, v74, s47
ds_write_b128 v3, v[104:107] offset:25600
v_perm_b32 v244, v55, v51, s46
v_perm_b32 v245, v63, v59, s46
v_perm_b32 v246, v71, v67, s46
v_perm_b32 v247, v79, v75, s46
v_perm_b32 v108, v55, v51, s47
v_perm_b32 v109, v63, v59, s47
v_perm_b32 v110, v71, v67, s47
v_perm_b32 v111, v79, v75, s47
ds_write_b128 v3, v[108:111] offset:29696
s_mov_b32 s45, 98304
buffer_load_dwordx4 v[48:51], v88, s[24:27], s45 offen offset:0
buffer_load_dwordx4 v[52:55], v88, s[24:27], s45 offen offset:1024
buffer_load_dwordx4 v[56:59], v89, s[24:27], s45 offen offset:0
buffer_load_dwordx4 v[60:63], v89, s[24:27], s45 offen offset:1024
buffer_load_dwordx4 v[64:67], v88, s[24:27], s45 offen offset:2048
buffer_load_dwordx4 v[68:71], v88, s[24:27], s45 offen offset:3072
buffer_load_dwordx4 v[72:75], v89, s[24:27], s45 offen offset:2048
buffer_load_dwordx4 v[76:79], v89, s[24:27], s45 offen offset:3072
s_barrier
L_f0_117:
v_cmp_eq_u32 vcc, 0, v0
s_cbranch_vccz L_f0o_118
s_sub_u32 s36, s36, 1
s_cbranch_scc1 L_end_chain_G
buffer_load_dword v0, v102, s[4:7], s30 offen sc1
s_waitcnt vmcnt(0)
s_branch L_f0_117
L_f0o_118:
s_mov_b32 m0, s31
s_xor_b32 s31, s31, 8192
buffer_load_dwordx4 v2, s[4:7], s38 offen offset:0 sc1 lds
buffer_load_dwordx4 v2, s[4:7], s38 offen offset:1024 sc1 lds
s_lshl_b32 s40, s35, 5
v_mov_b32 v99, s40
buffer_load_dword v103, v99, s[8:11], 0 offen offset:8 sc1
s_waitcnt vmcnt(11)
v_perm_b32 v200, v20, v16, s46
v_perm_b32 v201, v28, v24, s46
v_perm_b32 v202, v36, v32, s46
v_perm_b32 v203, v44, v40, s46
v_perm_b32 v104, v20, v16, s47
v_perm_b32 v105, v28, v24, s47
v_perm_b32 v106, v36, v32, s47
v_perm_b32 v107, v44, v40, s47
ds_write_b128 v3, v[104:107] offset:18432
v_perm_b32 v216, v21, v17, s46
v_perm_b32 v217, v29, v25, s46
v_perm_b32 v218, v37, v33, s46
v_perm_b32 v219, v45, v41, s46
v_perm_b32 v108, v21, v17, s47
v_perm_b32 v109, v29, v25, s47
v_perm_b32 v110, v37, v33, s47
v_perm_b32 v111, v45, v41, s47
ds_write_b128 v3, v[108:111] offset:22528
v_perm_b32 v232, v22, v18, s46
v_perm_b32 v233, v30, v26, s46
v_perm_b32 v234, v38, v34, s46
v_perm_b32 v235, v46, v42, s46
v_perm_b32 v104, v22, v18, s47
v_perm_b32 v105, v30, v26, s47
v_perm_b32 v106, v38, v34, s47
v_perm_b32 v107, v46, v42, s47
ds_write_b128 v3, v[104:107] offset:26624
v_perm_b32 v248, v23, v19, s46
v_perm_b32 v249, v31, v27, s46
v_perm_b32 v250, v39, v35, s46
v_perm_b32 v251, v47, v43, s46
v_perm_b32 v108, v23, v19, s47
v_perm_b32 v109, v31, v27, s47
v_perm_b32 v110, v39, v35, s47
v_perm_b32 v111, v47, v43, s47
ds_write_b128 v3, v[108:111] offset:30720
s_waitcnt vmcnt(3)
v_perm_b32 v204, v52, v48, s46
v_perm_b32 v205, v60, v56, s46
v_perm_b32 v206, v68, v64, s46
v_perm_b32 v207, v76, v72, s46
v_perm_b32 v104, v52, v48, s47
v_perm_b32 v105, v60, v56, s47
v_perm_b32 v106, v68, v64, s47
v_perm_b32 v107, v76, v72, s47
ds_write_b128 v3, v[104:107] offset:19456
v_perm_b32 v220, v53, v49, s46
v_perm_b32 v221, v61, v57, s46
v_perm_b32 v222, v69, v65, s46
v_perm_b32 v223, v77, v73, s46
v_perm_b32 v108, v53, v49, s47
v_perm_b32 v109, v61, v57, s47
v_perm_b32 v110, v69, v65, s47
v_perm_b32 v111, v77, v73, s47
ds_write_b128 v3, v[108:111] offset:23552
v_perm_b32 v236, v54, v50, s46
v_perm_b32 v237, v62, v58, s46
v_perm_b32 v238, v70, v66, s46
v_perm_b32 v239, v78, v74, s46
v_perm_b32 v104, v54, v50, s47
v_perm_b32 v105, v62, v58, s47
v_perm_b32 v106, v70, v66, s47
v_perm_b32 v107, v78, v74, s47
ds_write_b128 v3, v[104:107] offset:27648
v_perm_b32 v252, v55, v51, s46
v_perm_b32 v253, v63, v59, s46
v_perm_b32 v254, v71, v67, s46
v_perm_b32 v255, v79, v75, s46
v_perm_b32 v108, v55, v51, s47
v_perm_b32 v109, v63, v59, s47
v_perm_b32 v110, v71, v67, s47
v_perm_b32 v111, v79, v75, s47
ds_write_b128 v3, v[108:111] offset:31744
s_waitcnt vmcnt(0)
s_lshl_b32 s40, s34, 12
s_lshl_b32 s41, s35, 20
s_add_u32 s40, s40, s41
s_lshl_b32 s41, s32, 9
s_add_u32 s40, s40, s41
s_add_u32 s84, s40, 25165824
v_and_b32 v104, 1, v90
v_bfe_u32 v105, v90, 1, 2
v_and_b32 v106, 1, v91
s_and_b32 s40, s32, 1
s_lshl_b32 s40, s40, 1
v_add_u32 v107, s40, v94
v_and_b32 v108, 2, v105
v_xor_b32 v108, v108, v107
v_lshl_add_u32 v108, v108, 1, v104
v_lshl_add_u32 v108, v106, 3, v108
v_lshl_add_u32 v108, v105, 4, v108
v_lshlrev_b32 v96, 4, v108
s_lshr_b32 s40, s32, 1
s_lshl_b32 s40, s40, 10
s_add_u32 s40, s40, 131072
v_add_u32 v9, s40, v96
v_lshrrev_b32 v97, 2, v90
v_and_b32 v98, 1, v90
v_lshl_add_u32 v96, v97, 1, v98
v_lshlrev_b32 v96, 4, v96
v_lshl_add_u32 v14, v91, 7, v96
v_bfe_u32 v101, v90, 1, 1
v_lshl_add_u32 v14, v101, 30, v14
v_lshlrev_b32 v15, 3, v1
v_and_b32 v108, 2, v97
v_xor_b32 v108, v108, v91
v_lshl_add_u32 v108, v108, 1, v98
v_lshl_add_u32 v108, v101, 3, v108
v_lshl_add_u32 v108, v97, 4, v108
v_lshlrev_b32 v96, 4, v108
v_add_u32 v4, 131072, v96
v_add_u32 v18, 147456, v2
v_and_b32 v104, 1, v1
v_bfe_u32 v105, v1, 1, 2
v_lshrrev_b32 v106, 5, v1
v_bfe_u32 v107, v1, 3, 2
v_and_b32 v108, 2, v107
v_xor_b32 v108, v108, v105
v_lshl_add_u32 v108, v108, 1, v104
v_lshl_add_u32 v108, v106, 3, v108
v_lshl_add_u32 v108, v107, 4, v108
v_lshlrev_b32 v96, 4, v108
s_lshl_b32 s40, s32, 11
s_add_u32 s40, s40, 131072
v_add_u32 v5, s40, v96
v_and_b32 v95, 1, v91
v_lshlrev_b32 v96, 3, v90
v_lshl_add_u32 v96, v95, 2, v96
v_mul_u32_u24 v99, 1088, v94
s_lshl_b32 s40, s32, 8
s_add_u32 s40, s40, 139264
v_add3_u32 v6, v96, v99, s40
v_mul_u32_u24 v96, 192, v91
v_lshl_add_u32 v96, v90, 3, v96
s_mul_i32 s40, s32, 1488
s_add_u32 s40, s40, 141376
v_add_u32 v19, s40, v96
v_lshrrev_b32 v96, 1, v97
v_lshl_add_u32 v96, v91, 2, v96
v_lshlrev_b32 v96, 3, v96
v_and_b32 v95, 1, v97
v_lshl_add_u32 v99, v95, 7, v96
v_mul_u32_u24 v100, 1088, v98
v_add_u32 v99, v99, v100
v_add_u32 v7, 139264, v99
v_mul_u32_u24 v99, 784, v95
v_and_b32 v95, 3, v90
v_mul_u32_u24 v95, 192, v95
v_add3_u32 v96, v96, v99, v95
v_add_u32 v8, 141376, v96
v_add_u32 v26, s40, v96
v_lshrrev_b32 v95, 3, v90
v_lshl_add_u32 v96, v91, 1, v95
v_lshlrev_b32 v96, 12, v96
s_lshl_b32 s40, s32, 15
s_lshl_b32 s41, s34, 7
s_add_u32 s40, s40, s41
v_add3_u32 v10, v96, v93, s40
v_mul_u32_u24 v95, 0xaaaa, v101
v_add_u32 v17, 0x4444, v95
s_mov_b32 s80, 0x3e0293ee
s_mov_b64 s[90:91], -1
s_mov_b32 s89, 1568669696
v_mov_b32 v27, 0x2b800000
s_mov_b32 s82, 0
s_mov_b32 s83, -1
s_mov_b32 s37, 0
v_and_b32 v94, 7, v90
v_mov_b32 v32, 0
v_cmp_eq_u32 vcc, 0, v94
v_mov_b32 v95, 0x3f80
s_nop 0
v_cndmask_b32 v32, v32, v95, vcc
v_cmp_eq_u32 vcc, 1, v94
v_mov_b32 v95, 0x3f800000
s_nop 0
v_cndmask_b32 v32, v32, v95, vcc
v_mov_b32 v36, 0x3f803f80
v_mov_b32 v33, 0
v_cmp_eq_u32 vcc, 2, v94
v_mov_b32 v95, 0x3f80
s_nop 0
v_cndmask_b32 v33, v33, v95, vcc
v_cmp_eq_u32 vcc, 3, v94
v_mov_b32 v95, 0x3f800000
s_nop 0
v_cndmask_b32 v33, v33, v95, vcc
v_mov_b32 v37, 0x3f803f80
v_mov_b32 v34, 0
v_cmp_eq_u32 vcc, 4, v94
v_mov_b32 v95, 0x3f80
s_nop 0
v_cndmask_b32 v34, v34, v95, vcc
v_cmp_eq_u32 vcc, 5, v94
v_mov_b32 v95, 0x3f800000
s_nop 0
v_cndmask_b32 v34, v34, v95, vcc
v_mov_b32 v38, 0x3f803f80
v_mov_b32 v35, 0
v_cmp_eq_u32 vcc, 6, v94
v_mov_b32 v95, 0x3f80
s_nop 0
v_cndmask_b32 v35, v35, v95, vcc
v_cmp_eq_u32 vcc, 7, v94
v_mov_b32 v95, 0x3f800000
s_nop 0
v_cndmask_b32 v35, v35, v95, vcc
v_mov_b32 v39, 0x3f803f80
v_mov_b32 v12, 0
v_mov_b32 v13, 0
v_mov_b32 v30, 0
v_mov_b32 v31, 0
v_mov_b32 v20, 0
v_mov_b32 v21, 0
v_mov_b32 v22, 0
v_mov_b32 v23, 0
v_mov_b32 v24, 0
v_mov_b32 v25, 0
v_mov_b32 v72, 0
v_mov_b32 v73, 0
v_mov_b32 v74, 0
v_mov_b32 v75, 0
ds_write_b128 v5, v[72:75] offset:8192
ds_write_b128 v5, v[72:75] offset:9216
v_mov_b32 v16, v102
ds_write_b128 v5, v[120:123] offset:0
ds_write_b128 v5, v[124:127] offset:1024
v_cmp_ne_u32 vcc, 32, v103
s_cbranch_vccz L_rdy_119
s_mul_i32 s40, s35, 32
s_add_u32 s40, s40, 0
v_mov_b32 v101, s40
L_rw_120:
buffer_load_dword v100, v101, s[8:11], 0 offen offset:8 sc1
s_waitcnt vmcnt(0)
v_cmp_ne_u32 vcc, 32, v100
s_cbranch_vccz L_rwo_121
s_sub_u32 s36, s36, 1
s_cbranch_scc1 L_end_chain_G
s_sleep 2
s_branch L_rw_120
L_rwo_121:
L_rdy_119:
s_and_b32 s29, s37, 7
s_lshl_b32 s29, s29, 17
s_add_u32 s29, s29, s84
s_bfe_u32 s85, s37, 0x10003
s_add_u32 s30, s30, 2048
s_add_u32 s39, s38, 33554432
s_add_u32 s38, s38, 262144
v_mov_b32 v40, -1
v_mov_b32 v104, 0
v_mov_b32 v105, 0
v_mov_b32 v106, 0
v_mov_b32 v107, 0
v_mov_b32 v108, 0
v_mov_b32 v109, 0
v_mov_b32 v110, 0
v_mov_b32 v111, 0
v_mov_b32 v112, 0
v_mov_b32 v113, 0
v_mov_b32 v114, 0
v_mov_b32 v115, 0
v_mov_b32 v116, 0
v_mov_b32 v117, 0
v_mov_b32 v118, 0
v_mov_b32 v119, 0
v_mov_b32 v120, 0
v_mov_b32 v121, 0
v_mov_b32 v122, 0
v_mov_b32 v123, 0
v_mov_b32 v124, 0
v_mov_b32 v125, 0
v_mov_b32 v126, 0
v_mov_b32 v127, 0
ds_read_b128 v[80:83], v3 offset:0
ds_read_b128 v[84:87], v3 offset:1024
ds_read_b128 v[88:91], v3 offset:2048
ds_read_b128 v[92:95], v3 offset:3072
ds_read_b128 v[96:99], v3 offset:4096
ds_read_b128 v[100:103], v3 offset:5120
s_waitcnt lgkmcnt(0)
s_barrier
.p2align 5
L_ch_loop_G:
ds_read_b128 v[48:51], v4 offset:0
ds_read_b128 v[52:55], v4 offset:1024
ds_read_b128 v[56:59], v4 offset:2048
ds_read_b128 v[60:63], v4 offset:3072
ds_read_b128 v[64:67], v4 offset:4096
ds_read_b128 v[68:71], v4 offset:5120
ds_read_b128 v[72:75], v4 offset:6144
ds_read_b128 v[76:79], v4 offset:7168
s_waitcnt lgkmcnt(7)
v_smfmac_f32_16x16x64_bf16 v[112:115], v[48:51], v[128:135], v17
v_smfmac_f32_16x16x64_bf16 v[116:119], v[48:51], v[80:87], v17
ds_read_b128 v[80:83], v3 offset:6144
v_smfmac_f32_16x16x64_bf16 v[120:123], v[48:51], a[0:7], v17
ds_read_b128 v[84:87], v3 offset:7168
v_smfmac_f32_16x16x64_bf16 v[124:127], v[48:51], a[8:15], v17
buffer_load_dword v0, v16, s[4:7], s30 offen sc1
s_waitcnt lgkmcnt(8)
v_smfmac_f32_16x16x64_bf16 v[112:115], v[52:55], v[136:143], v17
v_smfmac_f32_16x16x64_bf16 v[116:119], v[52:55], v[88:95], v17
ds_read_b128 v[88:91], v3 offset:8192
v_smfmac_f32_16x16x64_bf16 v[120:123], v[52:55], a[16:23], v17
ds_read_b128 v[92:95], v3 offset:9216
v_smfmac_f32_16x16x64_bf16 v[124:127], v[52:55], a[24:31], v17
buffer_load_dwordx4 v[40:43], v2, s[4:7], s39 offen offset:0 sc1
s_waitcnt lgkmcnt(4)
v_smfmac_f32_16x16x64_bf16 v[112:115], v[56:59], v[144:151], v17
v_smfmac_f32_16x16x64_bf16 v[116:119], v[56:59], v[96:103], v17
ds_read_b128 v[96:99], v3 offset:10240
v_smfmac_f32_16x16x64_bf16 v[120:123], v[56:59], a[32:39], v17
ds_read_b128 v[100:103], v3 offset:11264
v_smfmac_f32_16x16x64_bf16 v[124:127], v[56:59], a[40:47], v17
buffer_load_dwordx4 v[44:47], v2, s[4:7], s39 offen offset:1024 sc1
v_smfmac_f32_16x16x64_bf16 v[112:115], v[60:63], v[152:159], v17
s_waitcnt lgkmcnt(4)
v_smfmac_f32_16x16x64_bf16 v[116:119], v[60:63], v[80:87], v17
ds_read_b128 v[80:83], v3 offset:12288
v_smfmac_f32_16x16x64_bf16 v[120:123], v[60:63], a[48:55], v17
ds_read_b128 v[84:87], v3 offset:13312
v_smfmac_f32_16x16x64_bf16 v[124:127], v[60:63], a[56:63], v17
v_smfmac_f32_16x16x64_bf16 v[112:115], v[64:67], v[160:167], v17
s_waitcnt lgkmcnt(4)
v_smfmac_f32_16x16x64_bf16 v[116:119], v[64:67], v[88:95], v17
ds_read_b128 v[88:91], v3 offset:14336
ds_read_b128 v[92:95], v3 offset:15360
v_smfmac_f32_16x16x64_bf16 v[112:115], v[68:71], v[168:175], v17
s_waitcnt lgkmcnt(4)
v_smfmac_f32_16x16x64_bf16 v[116:119], v[68:71], v[96:103], v17
v_smfmac_f32_16x16x64_bf16 v[112:115], v[72:75], v[176:183], v17
s_waitcnt lgkmcnt(2)
v_smfmac_f32_16x16x64_bf16 v[116:119], v[72:75], v[80:87], v17
v_smfmac_f32_16x16x64_bf16 v[112:115], v[76:79], v[184:191], v17
s_waitcnt lgkmcnt(0)
v_smfmac_f32_16x16x64_bf16 v[116:119], v[76:79], v[88:95], v17
v_smfmac_f32_16x16x64_bf16 v[120:123], v[64:67], a[64:71], v17
ds_read_b128 v[80:83], v18 offset:0
v_smfmac_f32_16x16x64_bf16 v[124:127], v[64:67], a[72:79], v17
ds_read_b128 v[84:87], v18 offset:1024
s_nop 1
v_smfmac_f32_16x16x64_bf16 v[120:123], v[68:71], a[80:87], v17
v_add_f32 v112, v112, v114
v_smfmac_f32_16x16x64_bf16 v[124:127], v[68:71], a[88:95], v17
v_add_f32 v113, v113, v115
v_smfmac_f32_16x16x64_bf16 v[120:123], v[72:75], a[96:103], v17
v_add_f32 v116, v116, v118
v_smfmac_f32_16x16x64_bf16 v[124:127], v[72:75], a[104:111], v17
v_add_f32 v117, v117, v119
v_smfmac_f32_16x16x64_bf16 v[120:123], v[76:79], a[112:119], v17
v_mul_f32 v112, s80, v112
v_smfmac_f32_16x16x64_bf16 v[124:127], v[76:79], a[120:127], v17
v_mul_f32 v113, s80, v113
v_smfmac_f32_16x16x64_bf16 v[104:107], v[48:51], a[128:135], v17
v_mul_f32 v116, s80, v116
v_mul_f32 v117, s80, v117
v_smfmac_f32_16x16x64_bf16 v[108:111], v[48:51], a[136:143], v17
v_cvt_pk_bf16_f32 v112, v112, v113
v_cvt_pk_bf16_f32 v113, v116, v117
ds_write2_b32 v6, v112, v113 offset0:0 offset1:32
v_add_f32 v120, v120, v122
v_add_f32 v121, v121, v123
v_add_f32 v124, v124, v126
v_add_f32 v125, v125, v127
v_cvt_pk_bf16_f32 v120, v120, v121
v_cvt_pk_bf16_f32 v121, v124, v125
ds_write2_b32 v19, v120, v121 offset0:0 offset1:196
v_smfmac_f32_16x16x64_bf16 v[104:107], v[52:55], a[144:151], v17
ds_read_b128 v[88:91], v18 offset:2048
v_smfmac_f32_16x16x64_bf16 v[108:111], v[52:55], a[152:159], v17
ds_read_b128 v[92:95], v18 offset:3072
v_smfmac_f32_16x16x64_bf16 v[104:107], v[56:59], a[160:167], v17
ds_read_b128 v[96:99], v18 offset:4096
v_smfmac_f32_16x16x64_bf16 v[108:111], v[56:59], a[168:175], v17
ds_read_b128 v[100:103], v18 offset:5120
s_waitcnt lgkmcnt(4)
s_barrier
ds_read_b64_tr_b16 v[112:113], v7 offset:0
ds_read_b64_tr_b16 v[114:115], v7 offset:16
ds_read_b64_tr_b16 v[116:117], v8 offset:0
ds_read_b64_tr_b16 v[118:119], v8 offset:16
ds_read_b64_tr_b16 v[120:121], v7 offset:256
ds_read_b64_tr_b16 v[122:123], v7 offset:272
ds_read_b64_tr_b16 v[124:125], v8 offset:1488
ds_read_b64_tr_b16 v[126:127], v8 offset:1504
v_smfmac_f32_16x16x64_bf16 v[104:107], v[60:63], a[176:183], v17
v_smfmac_f32_16x16x64_bf16 v[108:111], v[60:63], a[184:191], v17
v_smfmac_f32_16x16x64_bf16 v[104:107], v[64:67], a[192:199], v17
v_smfmac_f32_16x16x64_bf16 v[108:111], v[64:67], a[200:207], v17
ds_read_b128 v[60:63], v18 offset:6144
ds_read_b128 v[64:67], v18 offset:7168
s_waitcnt lgkmcnt(8)
v_mfma_f32_16x16x32_bf16 v[48:51], v[80:83], v[112:115], 0
v_mfma_f32_16x16x32_bf16 v[52:55], v[84:87], v[112:115], 0
s_waitcnt lgkmcnt(6)
v_mfma_f32_16x16x32_bf16 v[56:59], v[116:119], v[112:115], 0
ds_read_b64_tr_b16 v[112:113], v7 offset:512
ds_read_b64_tr_b16 v[114:115], v7 offset:528
ds_read_b64_tr_b16 v[116:117], v8 offset:2976
ds_read_b64_tr_b16 v[118:119], v8 offset:2992
s_waitcnt lgkmcnt(8)
v_mfma_f32_16x16x32_bf16 v[48:51], v[88:91], v[120:123], v[48:51]
v_mfma_f32_16x16x32_bf16 v[52:55], v[92:95], v[120:123], v[52:55]
ds_read_b64_tr_b16 v[80:81], v26 offset:0
ds_read_b64_tr_b16 v[82:83], v26 offset:16
s_waitcnt lgkmcnt(8)
v_mfma_f32_16x16x32_bf16 v[56:59], v[124:127], v[120:123], v[56:59]
ds_read_b64_tr_b16 v[120:121], v7 offset:768
ds_read_b64_tr_b16 v[122:123], v7 offset:784
ds_read_b64_tr_b16 v[124:125], v8 offset:4464
ds_read_b64_tr_b16 v[126:127], v8 offset:4480
v_smfmac_f32_16x16x64_bf16 v[104:107], v[68:71], a[208:215], v17
s_waitcnt lgkmcnt(8)
v_mfma_f32_16x16x32_bf16 v[48:51], v[96:99], v[112:115], v[48:51]
s_waitcnt vmcnt(2)
v_cmp_eq_u32 vcc, 0, v0
s_cbranch_vccnz L_fl_122
L_flo_123:
v_mfma_f32_16x16x32_bf16 v[52:55], v[100:103], v[112:115], v[52:55]
s_mov_b32 m0, s31
s_xor_b32 s31, s31, 8192
s_waitcnt lgkmcnt(6)
v_mfma_f32_16x16x32_bf16 v[56:59], v[116:119], v[112:115], v[56:59]
buffer_load_dwordx4 v2, s[4:7], s38 offen offset:0 sc1 lds
v_smfmac_f32_16x16x64_bf16 v[108:111], v[68:71], a[216:223], v17
s_waitcnt lgkmcnt(2)
v_mfma_f32_16x16x32_bf16 v[48:51], v[60:63], v[120:123], v[48:51]
v_bfi_b32 v80, 1, s85, v80
v_bfi_b32 v81, 1, s85, v81
v_mfma_f32_16x16x32_bf16 v[52:55], v[64:67], v[120:123], v[52:55]
v_bfi_b32 v82, 1, s85, v82
v_bfi_b32 v83, 1, s85, v83
s_waitcnt lgkmcnt(0)
v_mfma_f32_16x16x32_bf16 v[56:59], v[124:127], v[120:123], v[56:59]
v_smfmac_f32_16x16x64_bf16 v[104:107], v[72:75], a[224:231], v17
buffer_store_dwordx4 v[80:83], v14, s[4:7], s29 offen sc1
s_bfe_u32 s28, s37, 0x10001
v_smfmac_f32_16x16x64_bf16 v[108:111], v[72:75], a[232:239], v17
ds_read_b128 v[88:91], v3 offset:18432
ds_read_b128 v[92:95], v3 offset:19456
s_nop 0
v_exp_f32 v112, v48
v_smfmac_f32_16x16x64_bf16 v[104:107], v[76:79], a[240:247], v17
v_exp_f32 v113, v52
v_smfmac_f32_16x16x64_bf16 v[108:111], v[76:79], a[248:255], v17
v_exp_f32 v114, v49
v_exp_f32 v115, v53
buffer_load_dwordx4 v2, s[4:7], s38 offen offset:1024 sc1 lds
v_exp_f32 v116, v50
v_exp_f32 v117, v54
v_exp_f32 v118, v51
v_exp_f32 v119, v55
v_exp_f32 v120, v56
v_exp_f32 v121, v57
L_smb_125:
v_cvt_pk_bf16_f32 v76, v112, v113
v_cvt_pk_bf16_f32 v77, v114, v115
v_cvt_pk_bf16_f32 v78, v116, v117
v_cvt_pk_bf16_f32 v79, v118, v119
v_cvt_pk_bf16_f32 v23, v120, v121
v_cvt_pk_bf16_f32 v20, v120, v121
s_waitcnt vmcnt(3)
v_mfma_f32_16x16x32_bf16 v[120:123], v[36:39], v[76:79], 0
v_add_f32 v124, v104, v106
v_add_f32 v125, v105, v107
v_mfma_f32_16x16x32_bf16 v[120:123], v[36:39], v[22:25], v[120:123]
v_add_f32 v126, v108, v110
v_add_f32 v127, v109, v111
v_mfma_f32_16x16x32_bf16 v[112:115], v[40:43], v[76:79], 0
v_cvt_pk_bf16_f32 v28, v124, v125
v_cvt_pk_bf16_f32 v29, v126, v127
v_mfma_f32_16x16x32_bf16 v[116:119], v[44:47], v[76:79], 0
v_bfi_b32 v58, 1, s85, v28
v_bfi_b32 v59, 1, s85, v29
v_mfma_f32_16x16x32_bf16 v[112:115], v[28:31], v[20:23], v[112:115]
buffer_store_dwordx2 v[58:59], v15, s[4:7], s29 offen offset:2048 sc1
v_med3_f32 v121, v120, v27, s89
v_mfma_f32_16x16x32_bf16 v[116:119], v[28:31], v[22:25], v[116:119]
v_cmp_lg_f32 vcc, v121, v120
v_rcp_f32 v120, v120
s_cmp_eq_u32 s37, 63
s_cbranch_scc1 L_ch_last_G
s_and_b64 vcc, vcc, s[90:91]
s_cbranch_vccnz L_smx_124
v_mfma_f32_16x16x16_bf16 v[60:63], v[24:25], v[24:25], 0
ds_read_b128 v[80:83], v3 offset:16384
ds_read_b128 v[84:87], v3 offset:17408
v_mul_f32 v112, v112, v120
v_mul_f32 v113, v113, v120
v_mul_f32 v114, v114, v120
v_mul_f32 v115, v115, v120
v_mul_f32 v116, v116, v120
v_cvt_pk_bf16_f32 v124, v112, v116
v_mul_f32 v117, v117, v120
v_cvt_pk_bf16_f32 v125, v113, v117
v_mul_f32 v118, v118, v120
v_cvt_pk_bf16_f32 v126, v114, v118
v_mul_f32 v119, v119, v120
v_cvt_pk_bf16_f32 v127, v115, v119
ds_write_b128 v9, v[124:127]
v_mfma_f32_16x16x16_bf16 v[64:67], v[24:25], v[24:25], 0
ds_read_b128 v[96:99], v3 offset:20480
ds_read_b128 v[100:103], v3 offset:21504
v_mfma_f32_16x16x16_bf16 v[68:71], v[24:25], v[24:25], 0
ds_read_b128 v[104:107], v3 offset:22528
ds_read_b128 v[108:111], v3 offset:23552
v_mfma_f32_16x16x16_bf16 v[72:75], v[24:25], v[24:25], 0
s_mov_b64 s[90:91], -1
s_waitcnt lgkmcnt(4)
s_barrier
ds_read_b128 v[112:115], v4 offset:0
ds_read_b128 v[116:119], v4 offset:1024
v_mfma_f32_16x16x16_bf16 v[48:51], v[24:25], v[24:25], 0
v_mfma_f32_16x16x16_bf16 v[52:55], v[24:25], v[24:25], 0
v_mfma_f32_16x16x16_bf16 v[56:59], v[24:25], v[24:25], 0
s_waitcnt lgkmcnt(1)
v_smfmac_f32_16x16x64_bf16 v[60:63], v[112:115], v[192:199], v17
v_mov_b32 v76, 0
v_smfmac_f32_16x16x64_bf16 v[68:71], v[112:115], v[80:87], v17
ds_read_b128 v[80:83], v3 offset:24576
ds_read_b128 v[84:87], v3 offset:25600
v_mov_b32 v77, 0
v_smfmac_f32_16x16x64_bf16 v[64:67], v[112:115], v[208:215], v17
v_mov_b32 v78, 0
v_smfmac_f32_16x16x64_bf16 v[72:75], v[112:115], v[96:103], v17
ds_read_b128 v[96:99], v3 offset:28672
ds_read_b128 v[100:103], v3 offset:29696
v_mov_b32 v79, 0
s_waitcnt lgkmcnt(4)
v_smfmac_f32_16x16x64_bf16 v[60:63], v[116:119], v[200:207], v17
v_smfmac_f32_16x16x64_bf16 v[68:71], v[116:119], v[88:95], v17
ds_read_b128 v[88:91], v3 offset:26624
ds_read_b128 v[92:95], v3 offset:27648
v_smfmac_f32_16x16x64_bf16 v[64:67], v[116:119], v[216:223], v17
v_smfmac_f32_16x16x64_bf16 v[72:75], v[116:119], v[104:111], v17
ds_read_b128 v[104:107], v3 offset:30720
ds_read_b128 v[108:111], v3 offset:31744
v_smfmac_f32_16x16x64_bf16 v[48:51], v[112:115], v[224:231], v17
s_waitcnt lgkmcnt(6)
v_smfmac_f32_16x16x64_bf16 v[56:59], v[112:115], v[80:87], v17
v_smfmac_f32_16x16x64_bf16 v[52:55], v[112:115], v[240:247], v17
v_add_f32 v60, v60, v62
v_add_f32 v61, v61, v63
s_waitcnt lgkmcnt(4)
v_smfmac_f32_16x16x64_bf16 v[76:79], v[112:115], v[96:103], v17
v_add_f32 v64, v64, v66
v_add_f32 v65, v65, v67
v_smfmac_f32_16x16x64_bf16 v[48:51], v[116:119], v[232:239], v17
v_add_f32 v68, v68, v70
v_add_f32 v69, v69, v71
s_waitcnt lgkmcnt(2)
v_smfmac_f32_16x16x64_bf16 v[56:59], v[116:119], v[88:95], v17
v_add_f32 v72, v72, v74
v_add_f32 v73, v73, v75
v_smfmac_f32_16x16x64_bf16 v[52:55], v[116:119], v[248:255], v17
v_cvt_pk_bf16_f32 v124, v60, v68
v_cvt_pk_bf16_f32 v125, v64, v72
s_waitcnt lgkmcnt(0)
v_smfmac_f32_16x16x64_bf16 v[76:79], v[116:119], v[104:111], v17
v_cvt_pk_bf16_f32 v126, v61, v69
v_cvt_pk_bf16_f32 v127, v65, v73
s_add_u32 s40, s76, 0
v_bfi_b32 v124, 1, s28, v124
v_bfi_b32 v125, 1, s28, v125
v_bfi_b32 v126, 1, s28, v126
v_bfi_b32 v127, 1, s28, v127
buffer_store_dwordx4 v[124:127], v10, s[4:7], s40 offen sc1
v_pk_add_f32 v[48:49], v[48:49], v[50:51]
v_pk_add_f32 v[52:53], v[52:53], v[54:55]
v_pk_add_f32 v[56:57], v[56:57], v[58:59]
v_pk_add_f32 v[76:77], v[76:77], v[78:79]
v_cvt_pk_bf16_f32 v124, v48, v56
v_cvt_pk_bf16_f32 v125, v52, v76
v_cvt_pk_bf16_f32 v126, v49, v57
v_cvt_pk_bf16_f32 v127, v53, v77
s_add_u32 s40, s76, 131072
v_bfi_b32 v124, 1, s28, v124
v_bfi_b32 v125, 1, s28, v125
v_bfi_b32 v126, 1, s28, v126
v_bfi_b32 v127, 1, s28, v127
buffer_store_dwordx4 v[124:127], v10, s[4:7], s40 offen sc1
s_add_u32 s37, s37, 1
s_and_b32 s29, s37, 7
s_lshl_b32 s29, s29, 17
s_add_u32 s29, s29, s84
s_bfe_u32 s85, s37, 0x10003
s_add_u32 s30, s30, 2048
s_add_u32 s39, s38, 33554432
s_add_u32 s38, s38, 262144
v_xor_b32 v18, 8192, v18
v_mov_b32 v40, -1
ds_read_b128 v[80:83], v3 offset:0
ds_read_b128 v[84:87], v3 offset:1024
ds_read_b128 v[88:91], v3 offset:2048
ds_read_b128 v[92:95], v3 offset:3072
ds_read_b128 v[96:99], v3 offset:4096
ds_read_b128 v[100:103], v3 offset:5120
v_mov_b32 v104, 0
v_mov_b32 v105, 0
v_mov_b32 v106, 0
v_mov_b32 v107, 0
s_cmp_ge_u32 s32, 2
s_cbranch_scc1 L_nored_126
v_mov_b32 v118, -1
s_waitcnt vmcnt(0)
s_cmp_eq_u32 s28, 1
s_cbranch_scc1 L_and_128
L_or_129:
buffer_load_dwordx4 v[48:51], v2, s[4:7], s77 offen offset:0 sc1
buffer_load_dwordx4 v[52:55], v2, s[4:7], s77 offen offset:1024 sc1
buffer_load_dwordx4 v[56:59], v2, s[4:7], s77 offen offset:2048 sc1
buffer_load_dwordx4 v[60:63], v2, s[4:7], s77 offen offset:3072 sc1
s_waitcnt vmcnt(3)
v_mfma_f32_16x16x32_bf16 v[112:115], v[32:35], v[48:51], 0
v_or3_b32 v116, v48, v49, v50
v_or3_b32 v117, v51, v51, v51
s_waitcnt vmcnt(2)
v_mfma_f32_16x16x32_bf16 v[112:115], v[32:35], v[52:55], v[112:115]
v_or3_b32 v116, v116, v52, v53
v_or3_b32 v117, v117, v54, v55
s_waitcnt vmcnt(1)
v_mfma_f32_16x16x32_bf16 v[112:115], v[32:35], v[56:59], v[112:115]
v_or3_b32 v116, v116, v56, v57
v_or3_b32 v117, v117, v58, v59
s_waitcnt vmcnt(0)
v_mfma_f32_16x16x32_bf16 v[112:115], v[32:35], v[60:63], v[112:115]
v_or3_b32 v116, v116, v60, v61
v_or3_b32 v117, v117, v62, v63
v_or3_b32 v116, v116, v117, v117
v_and_b32 v116, 1, v116
v_cmp_ne_u32 vcc, 0, v116
s_cbranch_vccz L_redd_127
s_sub_u32 s36, s36, 1
s_cbranch_scc1 L_end_chain_G
s_branch L_or_129
L_and_128:
buffer_load_dwordx4 v[48:51], v2, s[4:7], s77 offen offset:0 sc1
buffer_load_dwordx4 v[52:55], v2, s[4:7], s77 offen offset:1024 sc1
buffer_load_dwordx4 v[56:59], v2, s[4:7], s77 offen offset:2048 sc1
buffer_load_dwordx4 v[60:63], v2, s[4:7], s77 offen offset:3072 sc1
s_waitcnt vmcnt(3)
v_mfma_f32_16x16x32_bf16 v[112:115], v[32:35], v[48:51], 0
v_bitop3_b32 v116, v48, v49, v50 bitop3:0x80
v_bitop3_b32 v117, v51, v51, v51 bitop3:0x80
s_waitcnt vmcnt(2)
v_mfma_f32_16x16x32_bf16 v[112:115], v[32:35], v[52:55], v[112:115]
v_bitop3_b32 v116, v116, v52, v53 bitop3:0x80
v_bitop3_b32 v117, v117, v54, v55 bitop3:0x80
s_waitcnt vmcnt(1)
v_mfma_f32_16x16x32_bf16 v[112:115], v[32:35], v[56:59], v[112:115]
v_bitop3_b32 v116, v116, v56, v57 bitop3:0x80
v_bitop3_b32 v117, v117, v58, v59 bitop3:0x80
s_waitcnt vmcnt(0)
v_mfma_f32_16x16x32_bf16 v[112:115], v[32:35], v[60:63], v[112:115]
v_bitop3_b32 v116, v116, v60, v61 bitop3:0x80
v_bitop3_b32 v117, v117, v62, v63 bitop3:0x80
v_bitop3_b32 v116, v116, v117, v117 bitop3:0x80
v_and_b32 v116, 1, v116
v_cmp_eq_u32 vcc, 0, v116
s_cbranch_vccz L_redd_127
s_sub_u32 s36, s36, 1
s_cbranch_scc1 L_end_chain_G
s_branch L_and_128
L_redd_127:
s_nop 1
v_cndmask_b32 v112, v112, v114, s[82:83]
v_cndmask_b32 v113, v113, v115, s[82:83]
s_nop 0
v_add_f32_dpp v112, v112, v112 row_ror:8 row_mask:0xf bank_mask:0xf
v_add_f32_dpp v113, v113, v113 row_ror:8 row_mask:0xf bank_mask:0xf
v_cvt_pk_bf16_f32 v116, v112, v113
v_min_u32 v116, -2, v116
buffer_store_dword v116, v11, s[4:7], s79 offen sc1
s_xor_b32 s79, s79, 0x2000
s_add_u32 s40, s79, 0
buffer_store_dword v118, v11, s[4:7], s40 offen sc1
L_nored_126:
s_xor_b32 s77, s77, 0x40000
s_xor_b32 s76, s76, 0x40000
s_barrier
v_mov_b32 v108, 0
v_mov_b32 v109, 0
v_mov_b32 v110, 0
v_mov_b32 v111, 0
v_mov_b32 v120, 0
v_mov_b32 v121, 0
v_mov_b32 v122, 0
v_mov_b32 v123, 0
v_mov_b32 v124, 0
v_mov_b32 v125, 0
v_mov_b32 v126, 0
v_mov_b32 v127, 0
v_mov_b32 v112, 0
v_mov_b32 v113, 0
v_mov_b32 v114, 0
v_mov_b32 v115, 0
v_mov_b32 v116, 0
v_mov_b32 v117, 0
v_mov_b32 v118, 0
v_mov_b32 v119, 0
L_g0_130:
buffer_load_dwordx4 v[64:67], v2, s[4:7], s78 offen offset:0 sc1
buffer_load_dwordx4 v[68:71], v2, s[4:7], s78 offen offset:1024 sc1
s_waitcnt vmcnt(1)
v_max3_u32 v48, v64, v65, v66
s_waitcnt vmcnt(0)
v_max3_u32 v49, v67, v68, v69
v_max3_u32 v48, v48, v70, v71
v_max_u32 v48, v48, v49
v_cmp_eq_u32 vcc, -1, v48
s_cbranch_vccz L_st_131
s_sub_u32 s36, s36, 1
s_cbranch_scc1 L_end_chain_G
s_branch L_g0_130
L_st_131:
ds_write_b128 v5, v[64:67] offset:0
ds_write_b128 v5, v[68:71] offset:1024
L_ste_132:
s_xor_b32 s78, s78, 0x2000
s_waitcnt lgkmcnt(0)
s_barrier
s_branch L_ch_loop_G
L_fl_122:
s_cmp_eq_u32 s37, 63
s_cbranch_scc1 L_flo_123
s_sub_u32 s36, s36, 1
s_cbranch_scc1 L_end_chain_G
buffer_load_dword v0, v16, s[4:7], s30 offen sc1
s_waitcnt vmcnt(0)
v_cmp_eq_u32 vcc, 0, v0
s_cbranch_vccnz L_fl_122
s_branch L_flo_123
L_smx_124:
v_max3_f32 v58, v48, v49, v50
v_max3_f32 v58, v58, v51, v52
v_max3_f32 v58, v58, v53, v54
v_max3_f32 v58, v58, v55, v56
v_max_f32 v58, v58, v57
v_mov_b32 v59, v58
s_nop 1
v_permlane16_swap_b32 v58, v59
v_max_f32 v58, v58, v59
v_mov_b32 v59, v58
s_nop 1
v_permlane32_swap_b32 v58, v59
v_max_f32 v58, v58, v59
v_sub_f32 v48, v48, v58
v_sub_f32 v52, v52, v58
v_sub_f32 v49, v49, v58
v_sub_f32 v53, v53, v58
v_sub_f32 v50, v50, v58
v_sub_f32 v54, v54, v58
v_sub_f32 v51, v51, v58
v_sub_f32 v55, v55, v58
v_sub_f32 v56, v56, v58
v_sub_f32 v57, v57, v58
v_exp_f32 v112, v48
v_exp_f32 v113, v52
v_exp_f32 v114, v49
v_exp_f32 v115, v53
v_exp_f32 v116, v50
v_exp_f32 v117, v54
v_exp_f32 v118, v51
v_exp_f32 v119, v55
v_exp_f32 v120, v56
v_exp_f32 v121, v57
s_mov_b32 s90, 0
s_mov_b32 s91, 0
s_branch L_smb_125
L_ch_last_G:
s_endpgm
L_end_chain_G:
s_endpgm
.p2align 6
R_qkv_G:
s_mov_b32 s12, s52
s_mov_b32 s13, s53
s_mov_b32 s14, 4194304
s_mov_b32 s15, 0x20000
s_sub_u32 s37, s35, 1
s_cmp_eq_u32 s37, 1
s_cselect_b32 s16, s54, s56
s_cselect_b32 s17, s55, s57
s_mov_b32 s18, 4194304
s_mov_b32 s19, 0x20000
v_and_b32 v20, 15, v1
v_lshrrev_b32 v21, 4, v1
v_lshlrev_b32 v22, 3, v21
s_lshl_b32 s40, s34, 8
s_lshl_b32 s42, s32, 6
s_add_u32 s42, s42, s40
s_lshr_b32 s43, s32, 1
s_lshl_b32 s41, s37, 1
s_add_u32 s43, s43, s41
s_sub_u32 s43, s43, 2
s_lshl_b32 s44, s43, 6
s_add_u32 s44, s44, s40
s_mul_i32 s38, s32, 40960
s_waitcnt vmcnt(0)
s_barrier
s_cmp_lg_u32 s32, 0
s_cbranch_scc1 L_da_133
v_mov_b32 v100, 1
s_lshl_b32 s40, s33, 5
v_mov_b32 v101, s40
s_mov_b64 exec, 1
buffer_atomic_add v100, v101, s[8:11], 0 offen offset:12
s_mov_b64 exec, -1
L_da_133:
v_lshrrev_b32 v23, 2, v1
v_mul_u32_u24 v23, 8192, v23
v_and_b32 v12, 3, v1
v_lshl_add_u32 v12, v12, 4, v23
v_add_u32 v13, 130048, v12
v_and_b32 v23, 15, v1
v_lshlrev_b32 v23, 2, v23
v_lshl_add_u32 v14, v22, 6, v23
v_add_u32 v14, s38, v14
s_add_u32 s45, s42, 0
s_add_u32 m0, s38, 0
s_nop 0
buffer_load_dwordx4 v12, s[16:19], s45 offen offset:0 lds
buffer_load_dwordx4 v13, s[16:19], s45 offen offset:1024 lds
s_add_u32 s45, s42, 262144
s_add_u32 m0, s38, 2048
s_nop 0
buffer_load_dwordx4 v12, s[16:19], s45 offen offset:0 lds
buffer_load_dwordx4 v13, s[16:19], s45 offen offset:1024 lds
s_add_u32 s45, s42, 524288
s_add_u32 m0, s38, 4096
s_nop 0
buffer_load_dwordx4 v12, s[16:19], s45 offen offset:0 lds
buffer_load_dwordx4 v13, s[16:19], s45 offen offset:1024 lds
s_add_u32 s45, s42, 786432
s_add_u32 m0, s38, 6144
s_nop 0
buffer_load_dwordx4 v12, s[16:19], s45 offen offset:0 lds
buffer_load_dwordx4 v13, s[16:19], s45 offen offset:1024 lds
s_add_u32 s45, s42, 1048576
s_add_u32 m0, s38, 8192
s_nop 0
buffer_load_dwordx4 v12, s[16:19], s45 offen offset:0 lds
buffer_load_dwordx4 v13, s[16:19], s45 offen offset:1024 lds
s_add_u32 s45, s42, 1310720
s_add_u32 m0, s38, 10240
s_nop 0
buffer_load_dwordx4 v12, s[16:19], s45 offen offset:0 lds
buffer_load_dwordx4 v13, s[16:19], s45 offen offset:1024 lds
s_add_u32 s45, s42, 1572864
s_add_u32 m0, s38, 12288
s_nop 0
buffer_load_dwordx4 v12, s[16:19], s45 offen offset:0 lds
buffer_load_dwordx4 v13, s[16:19], s45 offen offset:1024 lds
s_add_u32 s45, s42, 1835008
s_add_u32 m0, s38, 14336
s_nop 0
buffer_load_dwordx4 v12, s[16:19], s45 offen offset:0 lds
buffer_load_dwordx4 v13, s[16:19], s45 offen offset:1024 lds
s_add_u32 s45, s42, 2097152
s_add_u32 m0, s38, 16384
s_nop 0
buffer_load_dwordx4 v12, s[16:19], s45 offen offset:0 lds
buffer_load_dwordx4 v13, s[16:19], s45 offen offset:1024 lds
s_add_u32 s45, s42, 2359296
s_add_u32 m0, s38, 18432
s_nop 0
buffer_load_dwordx4 v12, s[16:19], s45 offen offset:0 lds
buffer_load_dwordx4 v13, s[16:19], s45 offen offset:1024 lds
s_add_u32 s45, s42, 2621440
s_add_u32 m0, s38, 20480
s_nop 0
buffer_load_dwordx4 v12, s[16:19], s45 offen offset:0 lds
buffer_load_dwordx4 v13, s[16:19], s45 offen offset:1024 lds
s_add_u32 s45, s42, 2883584
s_add_u32 m0, s38, 22528
s_nop 0
buffer_load_dwordx4 v12, s[16:19], s45 offen offset:0 lds
buffer_load_dwordx4 v13, s[16:19], s45 offen offset:1024 lds
s_add_u32 s45, s42, 3145728
s_add_u32 m0, s38, 24576
s_nop 0
buffer_load_dwordx4 v12, s[16:19], s45 offen offset:0 lds
buffer_load_dwordx4 v13, s[16:19], s45 offen offset:1024 lds
s_add_u32 s45, s42, 3407872
s_add_u32 m0, s38, 26624
s_nop 0
buffer_load_dwordx4 v12, s[16:19], s45 offen offset:0 lds
buffer_load_dwordx4 v13, s[16:19], s45 offen offset:1024 lds
s_add_u32 s45, s42, 3670016
s_add_u32 m0, s38, 28672
s_nop 0
buffer_load_dwordx4 v12, s[16:19], s45 offen offset:0 lds
buffer_load_dwordx4 v13, s[16:19], s45 offen offset:1024 lds
s_add_u32 s45, s42, 3932160
s_add_u32 m0, s38, 30720
s_nop 0
buffer_load_dwordx4 v12, s[16:19], s45 offen offset:0 lds
buffer_load_dwordx4 v13, s[16:19], s45 offen offset:1024 lds
s_add_u32 s45, s44, 0
s_add_u32 m0, s38, 32768
s_nop 0
buffer_load_dwordx4 v12, s[12:15], s45 offen offset:0 lds
buffer_load_dwordx4 v13, s[12:15], s45 offen offset:1024 lds
s_add_u32 s45, s44, 262144
s_add_u32 m0, s38, 34816
s_nop 0
buffer_load_dwordx4 v12, s[12:15], s45 offen offset:0 lds
buffer_load_dwordx4 v13, s[12:15], s45 offen offset:1024 lds
s_add_u32 s45, s44, 524288
s_add_u32 m0, s38, 36864
s_nop 0
buffer_load_dwordx4 v12, s[12:15], s45 offen offset:0 lds
buffer_load_dwordx4 v13, s[12:15], s45 offen offset:1024 lds
s_add_u32 s45, s44, 786432
s_add_u32 m0, s38, 38912
s_nop 0
buffer_load_dwordx4 v12, s[12:15], s45 offen offset:0 lds
buffer_load_dwordx4 v13, s[12:15], s45 offen offset:1024 lds
s_waitcnt vmcnt(38)
ds_read_b32 v40, v14 offset:0
ds_read_b32 v41, v14 offset:64
ds_read_b32 v42, v14 offset:128
ds_read_b32 v43, v14 offset:192
ds_read_b32 v44, v14 offset:256
ds_read_b32 v45, v14 offset:320
ds_read_b32 v46, v14 offset:384
ds_read_b32 v47, v14 offset:448
s_waitcnt lgkmcnt(6)
v_perm_b32 v32, v41, v40, s46
v_perm_b32 v36, v41, v40, s47
s_waitcnt lgkmcnt(4)
v_perm_b32 v33, v43, v42, s46
v_perm_b32 v37, v43, v42, s47
s_waitcnt lgkmcnt(2)
v_perm_b32 v34, v45, v44, s46
v_perm_b32 v38, v45, v44, s47
s_waitcnt lgkmcnt(0)
v_perm_b32 v35, v47, v46, s46
v_perm_b32 v39, v47, v46, s47
s_add_u32 s45, s44, 1048576
s_add_u32 m0, s38, 0
s_nop 0
buffer_load_dwordx4 v12, s[12:15], s45 offen offset:0 lds
buffer_load_dwordx4 v13, s[12:15], s45 offen offset:1024 lds
v_accvgpr_write_b32 a0, v32
v_accvgpr_write_b32 a1, v33
v_accvgpr_write_b32 a2, v34
v_accvgpr_write_b32 a3, v35
v_accvgpr_write_b32 a4, v36
v_accvgpr_write_b32 a5, v37
v_accvgpr_write_b32 a6, v38
v_accvgpr_write_b32 a7, v39
s_waitcnt vmcnt(38)
ds_read_b32 v40, v14 offset:2048
ds_read_b32 v41, v14 offset:2112
ds_read_b32 v42, v14 offset:2176
ds_read_b32 v43, v14 offset:2240
ds_read_b32 v44, v14 offset:2304
ds_read_b32 v45, v14 offset:2368
ds_read_b32 v46, v14 offset:2432
ds_read_b32 v47, v14 offset:2496
s_waitcnt lgkmcnt(6)
v_perm_b32 v32, v41, v40, s46
v_perm_b32 v36, v41, v40, s47
s_waitcnt lgkmcnt(4)
v_perm_b32 v33, v43, v42, s46
v_perm_b32 v37, v43, v42, s47
s_waitcnt lgkmcnt(2)
v_perm_b32 v34, v45, v44, s46
v_perm_b32 v38, v45, v44, s47
s_waitcnt lgkmcnt(0)
v_perm_b32 v35, v47, v46, s46
v_perm_b32 v39, v47, v46, s47
s_add_u32 s45, s44, 1310720
s_add_u32 m0, s38, 2048
s_nop 0
buffer_load_dwordx4 v12, s[12:15], s45 offen offset:0 lds
buffer_load_dwordx4 v13, s[12:15], s45 offen offset:1024 lds
v_accvgpr_write_b32 a8, v32
v_accvgpr_write_b32 a9, v33
v_accvgpr_write_b32 a10, v34
v_accvgpr_write_b32 a11, v35
v_accvgpr_write_b32 a12, v36
v_accvgpr_write_b32 a13, v37
v_accvgpr_write_b32 a14, v38
v_accvgpr_write_b32 a15, v39
s_waitcnt vmcnt(38)
ds_read_b32 v40, v14 offset:4096
ds_read_b32 v41, v14 offset:4160
ds_read_b32 v42, v14 offset:4224
ds_read_b32 v43, v14 offset:4288
ds_read_b32 v44, v14 offset:4352
ds_read_b32 v45, v14 offset:4416
ds_read_b32 v46, v14 offset:4480
ds_read_b32 v47, v14 offset:4544
s_waitcnt lgkmcnt(6)
v_perm_b32 v32, v41, v40, s46
v_perm_b32 v36, v41, v40, s47
s_waitcnt lgkmcnt(4)
v_perm_b32 v33, v43, v42, s46
v_perm_b32 v37, v43, v42, s47
s_waitcnt lgkmcnt(2)
v_perm_b32 v34, v45, v44, s46
v_perm_b32 v38, v45, v44, s47
s_waitcnt lgkmcnt(0)
v_perm_b32 v35, v47, v46, s46
v_perm_b32 v39, v47, v46, s47
s_add_u32 s45, s44, 1572864
s_add_u32 m0, s38, 4096
s_nop 0
buffer_load_dwordx4 v12, s[12:15], s45 offen offset:0 lds
buffer_load_dwordx4 v13, s[12:15], s45 offen offset:1024 lds
v_accvgpr_write_b32 a16, v32
v_accvgpr_write_b32 a17, v33
v_accvgpr_write_b32 a18, v34
v_accvgpr_write_b32 a19, v35
v_accvgpr_write_b32 a20, v36
v_accvgpr_write_b32 a21, v37
v_accvgpr_write_b32 a22, v38
v_accvgpr_write_b32 a23, v39
s_waitcnt vmcnt(38)
ds_read_b32 v40, v14 offset:6144
ds_read_b32 v41, v14 offset:6208
ds_read_b32 v42, v14 offset:6272
ds_read_b32 v43, v14 offset:6336
ds_read_b32 v44, v14 offset:6400
ds_read_b32 v45, v14 offset:6464
ds_read_b32 v46, v14 offset:6528
ds_read_b32 v47, v14 offset:6592
s_waitcnt lgkmcnt(6)
v_perm_b32 v32, v41, v40, s46
v_perm_b32 v36, v41, v40, s47
s_waitcnt lgkmcnt(4)
v_perm_b32 v33, v43, v42, s46
v_perm_b32 v37, v43, v42, s47
s_waitcnt lgkmcnt(2)
v_perm_b32 v34, v45, v44, s46
v_perm_b32 v38, v45, v44, s47
s_waitcnt lgkmcnt(0)
v_perm_b32 v35, v47, v46, s46
v_perm_b32 v39, v47, v46, s47
s_add_u32 s45, s44, 1835008
s_add_u32 m0, s38, 6144
s_nop 0
buffer_load_dwordx4 v12, s[12:15], s45 offen offset:0 lds
buffer_load_dwordx4 v13, s[12:15], s45 offen offset:1024 lds
v_accvgpr_write_b32 a24, v32
v_accvgpr_write_b32 a25, v33
v_accvgpr_write_b32 a26, v34
v_accvgpr_write_b32 a27, v35
v_accvgpr_write_b32 a28, v36
v_accvgpr_write_b32 a29, v37
v_accvgpr_write_b32 a30, v38
v_accvgpr_write_b32 a31, v39
s_waitcnt vmcnt(38)
ds_read_b32 v40, v14 offset:8192
ds_read_b32 v41, v14 offset:8256
ds_read_b32 v42, v14 offset:8320
ds_read_b32 v43, v14 offset:8384
ds_read_b32 v44, v14 offset:8448
ds_read_b32 v45, v14 offset:8512
ds_read_b32 v46, v14 offset:8576
ds_read_b32 v47, v14 offset:8640
s_waitcnt lgkmcnt(6)
v_perm_b32 v32, v41, v40, s46
v_perm_b32 v36, v41, v40, s47
s_waitcnt lgkmcnt(4)
v_perm_b32 v33, v43, v42, s46
v_perm_b32 v37, v43, v42, s47
s_waitcnt lgkmcnt(2)
v_perm_b32 v34, v45, v44, s46
v_perm_b32 v38, v45, v44, s47
s_waitcnt lgkmcnt(0)
v_perm_b32 v35, v47, v46, s46
v_perm_b32 v39, v47, v46, s47
s_add_u32 s45, s44, 2097152
s_add_u32 m0, s38, 8192
s_nop 0
buffer_load_dwordx4 v12, s[12:15], s45 offen offset:0 lds
buffer_load_dwordx4 v13, s[12:15], s45 offen offset:1024 lds
v_accvgpr_write_b32 a32, v32
v_accvgpr_write_b32 a33, v33
v_accvgpr_write_b32 a34, v34
v_accvgpr_write_b32 a35, v35
v_accvgpr_write_b32 a36, v36
v_accvgpr_write_b32 a37, v37
v_accvgpr_write_b32 a38, v38
v_accvgpr_write_b32 a39, v39
s_waitcnt vmcnt(38)
ds_read_b32 v40, v14 offset:10240
ds_read_b32 v41, v14 offset:10304
ds_read_b32 v42, v14 offset:10368
ds_read_b32 v43, v14 offset:10432
ds_read_b32 v44, v14 offset:10496
ds_read_b32 v45, v14 offset:10560
ds_read_b32 v46, v14 offset:10624
ds_read_b32 v47, v14 offset:10688
s_waitcnt lgkmcnt(6)
v_perm_b32 v32, v41, v40, s46
v_perm_b32 v36, v41, v40, s47
s_waitcnt lgkmcnt(4)
v_perm_b32 v33, v43, v42, s46
v_perm_b32 v37, v43, v42, s47
s_waitcnt lgkmcnt(2)
v_perm_b32 v34, v45, v44, s46
v_perm_b32 v38, v45, v44, s47
s_waitcnt lgkmcnt(0)
v_perm_b32 v35, v47, v46, s46
v_perm_b32 v39, v47, v46, s47
s_add_u32 s45, s44, 2359296
s_add_u32 m0, s38, 10240
s_nop 0
buffer_load_dwordx4 v12, s[12:15], s45 offen offset:0 lds
buffer_load_dwordx4 v13, s[12:15], s45 offen offset:1024 lds
v_accvgpr_write_b32 a40, v32
v_accvgpr_write_b32 a41, v33
v_accvgpr_write_b32 a42, v34
v_accvgpr_write_b32 a43, v35
v_accvgpr_write_b32 a44, v36
v_accvgpr_write_b32 a45, v37
v_accvgpr_write_b32 a46, v38
v_accvgpr_write_b32 a47, v39
s_waitcnt vmcnt(38)
ds_read_b32 v40, v14 offset:12288
ds_read_b32 v41, v14 offset:12352
ds_read_b32 v42, v14 offset:12416
ds_read_b32 v43, v14 offset:12480
ds_read_b32 v44, v14 offset:12544
ds_read_b32 v45, v14 offset:12608
ds_read_b32 v46, v14 offset:12672
ds_read_b32 v47, v14 offset:12736
s_waitcnt lgkmcnt(6)
v_perm_b32 v32, v41, v40, s46
v_perm_b32 v36, v41, v40, s47
s_waitcnt lgkmcnt(4)
v_perm_b32 v33, v43, v42, s46
v_perm_b32 v37, v43, v42, s47
s_waitcnt lgkmcnt(2)
v_perm_b32 v34, v45, v44, s46
v_perm_b32 v38, v45, v44, s47
s_waitcnt lgkmcnt(0)
v_perm_b32 v35, v47, v46, s46
v_perm_b32 v39, v47, v46, s47
s_add_u32 s45, s44, 2621440
s_add_u32 m0, s38, 12288
s_nop 0
buffer_load_dwordx4 v12, s[12:15], s45 offen offset:0 lds
buffer_load_dwordx4 v13, s[12:15], s45 offen offset:1024 lds
v_accvgpr_write_b32 a48, v32
v_accvgpr_write_b32 a49, v33
v_accvgpr_write_b32 a50, v34
v_accvgpr_write_b32 a51, v35
v_accvgpr_write_b32 a52, v36
v_accvgpr_write_b32 a53, v37
v_accvgpr_write_b32 a54, v38
v_accvgpr_write_b32 a55, v39
s_waitcnt vmcnt(38)
ds_read_b32 v40, v14 offset:14336
ds_read_b32 v41, v14 offset:14400
ds_read_b32 v42, v14 offset:14464
ds_read_b32 v43, v14 offset:14528
ds_read_b32 v44, v14 offset:14592
ds_read_b32 v45, v14 offset:14656
ds_read_b32 v46, v14 offset:14720
ds_read_b32 v47, v14 offset:14784
s_waitcnt lgkmcnt(6)
v_perm_b32 v32, v41, v40, s46
v_perm_b32 v36, v41, v40, s47
s_waitcnt lgkmcnt(4)
v_perm_b32 v33, v43, v42, s46
v_perm_b32 v37, v43, v42, s47
s_waitcnt lgkmcnt(2)
v_perm_b32 v34, v45, v44, s46
v_perm_b32 v38, v45, v44, s47
s_waitcnt lgkmcnt(0)
v_perm_b32 v35, v47, v46, s46
v_perm_b32 v39, v47, v46, s47
s_add_u32 s45, s44, 2883584
s_add_u32 m0, s38, 14336
s_nop 0
buffer_load_dwordx4 v12, s[12:15], s45 offen offset:0 lds
buffer_load_dwordx4 v13, s[12:15], s45 offen offset:1024 lds
v_accvgpr_write_b32 a56, v32
v_accvgpr_write_b32 a57, v33
v_accvgpr_write_b32 a58, v34
v_accvgpr_write_b32 a59, v35
v_accvgpr_write_b32 a60, v36
v_accvgpr_write_b32 a61, v37
v_accvgpr_write_b32 a62, v38
v_accvgpr_write_b32 a63, v39
s_waitcnt vmcnt(38)
ds_read_b32 v40, v14 offset:16384
ds_read_b32 v41, v14 offset:16448
ds_read_b32 v42, v14 offset:16512
ds_read_b32 v43, v14 offset:16576
ds_read_b32 v44, v14 offset:16640
ds_read_b32 v45, v14 offset:16704
ds_read_b32 v46, v14 offset:16768
ds_read_b32 v47, v14 offset:16832
s_waitcnt lgkmcnt(6)
v_perm_b32 v32, v41, v40, s46
v_perm_b32 v36, v41, v40, s47
s_waitcnt lgkmcnt(4)
v_perm_b32 v33, v43, v42, s46
v_perm_b32 v37, v43, v42, s47
s_waitcnt lgkmcnt(2)
v_perm_b32 v34, v45, v44, s46
v_perm_b32 v38, v45, v44, s47
s_waitcnt lgkmcnt(0)
v_perm_b32 v35, v47, v46, s46
v_perm_b32 v39, v47, v46, s47
s_add_u32 s45, s44, 3145728
s_add_u32 m0, s38, 16384
s_nop 0
buffer_load_dwordx4 v12, s[12:15], s45 offen offset:0 lds
buffer_load_dwordx4 v13, s[12:15], s45 offen offset:1024 lds
v_accvgpr_write_b32 a64, v32
v_accvgpr_write_b32 a65, v33
v_accvgpr_write_b32 a66, v34
v_accvgpr_write_b32 a67, v35
v_accvgpr_write_b32 a68, v36
v_accvgpr_write_b32 a69, v37
v_accvgpr_write_b32 a70, v38
v_accvgpr_write_b32 a71, v39
s_waitcnt vmcnt(38)
ds_read_b32 v40, v14 offset:18432
ds_read_b32 v41, v14 offset:18496
ds_read_b32 v42, v14 offset:18560
ds_read_b32 v43, v14 offset:18624
ds_read_b32 v44, v14 offset:18688
ds_read_b32 v45, v14 offset:18752
ds_read_b32 v46, v14 offset:18816
ds_read_b32 v47, v14 offset:18880
s_waitcnt lgkmcnt(6)
v_perm_b32 v32, v41, v40, s46
v_perm_b32 v36, v41, v40, s47
s_waitcnt lgkmcnt(4)
v_perm_b32 v33, v43, v42, s46
v_perm_b32 v37, v43, v42, s47
s_waitcnt lgkmcnt(2)
v_perm_b32 v34, v45, v44, s46
v_perm_b32 v38, v45, v44, s47
s_waitcnt lgkmcnt(0)
v_perm_b32 v35, v47, v46, s46
v_perm_b32 v39, v47, v46, s47
s_add_u32 s45, s44, 3407872
s_add_u32 m0, s38, 18432
s_nop 0
buffer_load_dwordx4 v12, s[12:15], s45 offen offset:0 lds
buffer_load_dwordx4 v13, s[12:15], s45 offen offset:1024 lds
v_accvgpr_write_b32 a72, v32
v_accvgpr_write_b32 a73, v33
v_accvgpr_write_b32 a74, v34
v_accvgpr_write_b32 a75, v35
v_accvgpr_write_b32 a76, v36
v_accvgpr_write_b32 a77, v37
v_accvgpr_write_b32 a78, v38
v_accvgpr_write_b32 a79, v39
s_waitcnt vmcnt(38)
ds_read_b32 v40, v14 offset:20480
ds_read_b32 v41, v14 offset:20544
ds_read_b32 v42, v14 offset:20608
ds_read_b32 v43, v14 offset:20672
ds_read_b32 v44, v14 offset:20736
ds_read_b32 v45, v14 offset:20800
ds_read_b32 v46, v14 offset:20864
ds_read_b32 v47, v14 offset:20928
s_waitcnt lgkmcnt(6)
v_perm_b32 v32, v41, v40, s46
v_perm_b32 v36, v41, v40, s47
s_waitcnt lgkmcnt(4)
v_perm_b32 v33, v43, v42, s46
v_perm_b32 v37, v43, v42, s47
s_waitcnt lgkmcnt(2)
v_perm_b32 v34, v45, v44, s46
v_perm_b32 v38, v45, v44, s47
s_waitcnt lgkmcnt(0)
v_perm_b32 v35, v47, v46, s46
v_perm_b32 v39, v47, v46, s47
s_add_u32 s45, s44, 3670016
s_add_u32 m0, s38, 20480
s_nop 0
buffer_load_dwordx4 v12, s[12:15], s45 offen offset:0 lds
buffer_load_dwordx4 v13, s[12:15], s45 offen offset:1024 lds
v_accvgpr_write_b32 a80, v32
v_accvgpr_write_b32 a81, v33
v_accvgpr_write_b32 a82, v34
v_accvgpr_write_b32 a83, v35
v_accvgpr_write_b32 a84, v36
v_accvgpr_write_b32 a85, v37
v_accvgpr_write_b32 a86, v38
v_accvgpr_write_b32 a87, v39
s_waitcnt vmcnt(38)
ds_read_b32 v40, v14 offset:22528
ds_read_b32 v41, v14 offset:22592
ds_read_b32 v42, v14 offset:22656
ds_read_b32 v43, v14 offset:22720
ds_read_b32 v44, v14 offset:22784
ds_read_b32 v45, v14 offset:22848
ds_read_b32 v46, v14 offset:22912
ds_read_b32 v47, v14 offset:22976
s_waitcnt lgkmcnt(6)
v_perm_b32 v32, v41, v40, s46
v_perm_b32 v36, v41, v40, s47
s_waitcnt lgkmcnt(4)
v_perm_b32 v33, v43, v42, s46
v_perm_b32 v37, v43, v42, s47
s_waitcnt lgkmcnt(2)
v_perm_b32 v34, v45, v44, s46
v_perm_b32 v38, v45, v44, s47
s_waitcnt lgkmcnt(0)
v_perm_b32 v35, v47, v46, s46
v_perm_b32 v39, v47, v46, s47
s_add_u32 s45, s44, 3932160
s_add_u32 m0, s38, 22528
s_nop 0
buffer_load_dwordx4 v12, s[12:15], s45 offen offset:0 lds
buffer_load_dwordx4 v13, s[12:15], s45 offen offset:1024 lds
v_accvgpr_write_b32 a88, v32
v_accvgpr_write_b32 a89, v33
v_accvgpr_write_b32 a90, v34
v_accvgpr_write_b32 a91, v35
v_accvgpr_write_b32 a92, v36
v_accvgpr_write_b32 a93, v37
v_accvgpr_write_b32 a94, v38
v_accvgpr_write_b32 a95, v39
s_waitcnt vmcnt(38)
ds_read_b32 v40, v14 offset:24576
ds_read_b32 v41, v14 offset:24640
ds_read_b32 v42, v14 offset:24704
ds_read_b32 v43, v14 offset:24768
ds_read_b32 v44, v14 offset:24832
ds_read_b32 v45, v14 offset:24896
ds_read_b32 v46, v14 offset:24960
ds_read_b32 v47, v14 offset:25024
s_waitcnt lgkmcnt(6)
v_perm_b32 v32, v41, v40, s46
v_perm_b32 v36, v41, v40, s47
s_waitcnt lgkmcnt(4)
v_perm_b32 v33, v43, v42, s46
v_perm_b32 v37, v43, v42, s47
s_waitcnt lgkmcnt(2)
v_perm_b32 v34, v45, v44, s46
v_perm_b32 v38, v45, v44, s47
s_waitcnt lgkmcnt(0)
v_perm_b32 v35, v47, v46, s46
v_perm_b32 v39, v47, v46, s47
v_accvgpr_write_b32 a96, v32
v_accvgpr_write_b32 a97, v33
v_accvgpr_write_b32 a98, v34
v_accvgpr_write_b32 a99, v35
v_accvgpr_write_b32 a100, v36
v_accvgpr_write_b32 a101, v37
v_accvgpr_write_b32 a102, v38
v_accvgpr_write_b32 a103, v39
s_waitcnt vmcnt(36)
ds_read_b32 v40, v14 offset:26624
ds_read_b32 v41, v14 offset:26688
ds_read_b32 v42, v14 offset:26752
ds_read_b32 v43, v14 offset:26816
ds_read_b32 v44, v14 offset:26880
ds_read_b32 v45, v14 offset:26944
ds_read_b32 v46, v14 offset:27008
ds_read_b32 v47, v14 offset:27072
s_waitcnt lgkmcnt(6)
v_perm_b32 v32, v41, v40, s46
v_perm_b32 v36, v41, v40, s47
s_waitcnt lgkmcnt(4)
v_perm_b32 v33, v43, v42, s46
v_perm_b32 v37, v43, v42, s47
s_waitcnt lgkmcnt(2)
v_perm_b32 v34, v45, v44, s46
v_perm_b32 v38, v45, v44, s47
s_waitcnt lgkmcnt(0)
v_perm_b32 v35, v47, v46, s46
v_perm_b32 v39, v47, v46, s47
v_accvgpr_write_b32 a104, v32
v_accvgpr_write_b32 a105, v33
v_accvgpr_write_b32 a106, v34
v_accvgpr_write_b32 a107, v35
v_accvgpr_write_b32 a108, v36
v_accvgpr_write_b32 a109, v37
v_accvgpr_write_b32 a110, v38
v_accvgpr_write_b32 a111, v39
s_waitcnt vmcnt(34)
ds_read_b32 v40, v14 offset:28672
ds_read_b32 v41, v14 offset:28736
ds_read_b32 v42, v14 offset:28800
ds_read_b32 v43, v14 offset:28864
ds_read_b32 v44, v14 offset:28928
ds_read_b32 v45, v14 offset:28992
ds_read_b32 v46, v14 offset:29056
ds_read_b32 v47, v14 offset:29120
s_waitcnt lgkmcnt(6)
v_perm_b32 v32, v41, v40, s46
v_perm_b32 v36, v41, v40, s47
s_waitcnt lgkmcnt(4)
v_perm_b32 v33, v43, v42, s46
v_perm_b32 v37, v43, v42, s47
s_waitcnt lgkmcnt(2)
v_perm_b32 v34, v45, v44, s46
v_perm_b32 v38, v45, v44, s47
s_waitcnt lgkmcnt(0)
v_perm_b32 v35, v47, v46, s46
v_perm_b32 v39, v47, v46, s47
v_accvgpr_write_b32 a112, v32
v_accvgpr_write_b32 a113, v33
v_accvgpr_write_b32 a114, v34
v_accvgpr_write_b32 a115, v35
v_accvgpr_write_b32 a116, v36
v_accvgpr_write_b32 a117, v37
v_accvgpr_write_b32 a118, v38
v_accvgpr_write_b32 a119, v39
s_waitcnt vmcnt(32)
ds_read_b32 v40, v14 offset:30720
ds_read_b32 v41, v14 offset:30784
ds_read_b32 v42, v14 offset:30848
ds_read_b32 v43, v14 offset:30912
ds_read_b32 v44, v14 offset:30976
ds_read_b32 v45, v14 offset:31040
ds_read_b32 v46, v14 offset:31104
ds_read_b32 v47, v14 offset:31168
s_waitcnt lgkmcnt(6)
v_perm_b32 v32, v41, v40, s46
v_perm_b32 v36, v41, v40, s47
s_waitcnt lgkmcnt(4)
v_perm_b32 v33, v43, v42, s46
v_perm_b32 v37, v43, v42, s47
s_waitcnt lgkmcnt(2)
v_perm_b32 v34, v45, v44, s46
v_perm_b32 v38, v45, v44, s47
s_waitcnt lgkmcnt(0)
v_perm_b32 v35, v47, v46, s46
v_perm_b32 v39, v47, v46, s47
v_accvgpr_write_b32 a120, v32
v_accvgpr_write_b32 a121, v33
v_accvgpr_write_b32 a122, v34
v_accvgpr_write_b32 a123, v35
v_accvgpr_write_b32 a124, v36
v_accvgpr_write_b32 a125, v37
v_accvgpr_write_b32 a126, v38
v_accvgpr_write_b32 a127, v39
s_waitcnt vmcnt(30)
ds_read_b32 v40, v14 offset:32768
ds_read_b32 v41, v14 offset:32832
ds_read_b32 v42, v14 offset:32896
ds_read_b32 v43, v14 offset:32960
ds_read_b32 v44, v14 offset:33024
ds_read_b32 v45, v14 offset:33088
ds_read_b32 v46, v14 offset:33152
ds_read_b32 v47, v14 offset:33216
s_waitcnt lgkmcnt(6)
v_perm_b32 v32, v41, v40, s46
v_perm_b32 v36, v41, v40, s47
s_waitcnt lgkmcnt(4)
v_perm_b32 v33, v43, v42, s46
v_perm_b32 v37, v43, v42, s47
s_waitcnt lgkmcnt(2)
v_perm_b32 v34, v45, v44, s46
v_perm_b32 v38, v45, v44, s47
s_waitcnt lgkmcnt(0)
v_perm_b32 v35, v47, v46, s46
v_perm_b32 v39, v47, v46, s47
v_accvgpr_write_b32 a128, v32
v_accvgpr_write_b32 a129, v33
v_accvgpr_write_b32 a130, v34
v_accvgpr_write_b32 a131, v35
v_accvgpr_write_b32 a132, v36
v_accvgpr_write_b32 a133, v37
v_accvgpr_write_b32 a134, v38
v_accvgpr_write_b32 a135, v39
s_waitcnt vmcnt(28)
ds_read_b32 v40, v14 offset:34816
ds_read_b32 v41, v14 offset:34880
ds_read_b32 v42, v14 offset:34944
ds_read_b32 v43, v14 offset:35008
ds_read_b32 v44, v14 offset:35072
ds_read_b32 v45, v14 offset:35136
ds_read_b32 v46, v14 offset:35200
ds_read_b32 v47, v14 offset:35264
s_waitcnt lgkmcnt(6)
v_perm_b32 v32, v41, v40, s46
v_perm_b32 v36, v41, v40, s47
s_waitcnt lgkmcnt(4)
v_perm_b32 v33, v43, v42, s46
v_perm_b32 v37, v43, v42, s47
s_waitcnt lgkmcnt(2)
v_perm_b32 v34, v45, v44, s46
v_perm_b32 v38, v45, v44, s47
s_waitcnt lgkmcnt(0)
v_perm_b32 v35, v47, v46, s46
v_perm_b32 v39, v47, v46, s47
v_accvgpr_write_b32 a136, v32
v_accvgpr_write_b32 a137, v33
v_accvgpr_write_b32 a138, v34
v_accvgpr_write_b32 a139, v35
v_accvgpr_write_b32 a140, v36
v_accvgpr_write_b32 a141, v37
v_accvgpr_write_b32 a142, v38
v_accvgpr_write_b32 a143, v39
s_waitcnt vmcnt(26)
ds_read_b32 v40, v14 offset:36864
ds_read_b32 v41, v14 offset:36928
ds_read_b32 v42, v14 offset:36992
ds_read_b32 v43, v14 offset:37056
ds_read_b32 v44, v14 offset:37120
ds_read_b32 v45, v14 offset:37184
ds_read_b32 v46, v14 offset:37248
ds_read_b32 v47, v14 offset:37312
s_waitcnt lgkmcnt(6)
v_perm_b32 v32, v41, v40, s46
v_perm_b32 v36, v41, v40, s47
s_waitcnt lgkmcnt(4)
v_perm_b32 v33, v43, v42, s46
v_perm_b32 v37, v43, v42, s47
s_waitcnt lgkmcnt(2)
v_perm_b32 v34, v45, v44, s46
v_perm_b32 v38, v45, v44, s47
s_waitcnt lgkmcnt(0)
v_perm_b32 v35, v47, v46, s46
v_perm_b32 v39, v47, v46, s47
v_accvgpr_write_b32 a144, v32
v_accvgpr_write_b32 a145, v33
v_accvgpr_write_b32 a146, v34
v_accvgpr_write_b32 a147, v35
v_accvgpr_write_b32 a148, v36
v_accvgpr_write_b32 a149, v37
v_accvgpr_write_b32 a150, v38
v_accvgpr_write_b32 a151, v39
s_waitcnt vmcnt(24)
ds_read_b32 v40, v14 offset:38912
ds_read_b32 v41, v14 offset:38976
ds_read_b32 v42, v14 offset:39040
ds_read_b32 v43, v14 offset:39104
ds_read_b32 v44, v14 offset:39168
ds_read_b32 v45, v14 offset:39232
ds_read_b32 v46, v14 offset:39296
ds_read_b32 v47, v14 offset:39360
s_waitcnt lgkmcnt(6)
v_perm_b32 v32, v41, v40, s46
v_perm_b32 v36, v41, v40, s47
s_waitcnt lgkmcnt(4)
v_perm_b32 v33, v43, v42, s46
v_perm_b32 v37, v43, v42, s47
s_waitcnt lgkmcnt(2)
v_perm_b32 v34, v45, v44, s46
v_perm_b32 v38, v45, v44, s47
s_waitcnt lgkmcnt(0)
v_perm_b32 v35, v47, v46, s46
v_perm_b32 v39, v47, v46, s47
v_accvgpr_write_b32 a152, v32
v_accvgpr_write_b32 a153, v33
v_accvgpr_write_b32 a154, v34
v_accvgpr_write_b32 a155, v35
v_accvgpr_write_b32 a156, v36
v_accvgpr_write_b32 a157, v37
v_accvgpr_write_b32 a158, v38
v_accvgpr_write_b32 a159, v39
s_waitcnt vmcnt(22)
ds_read_b32 v40, v14 offset:0
ds_read_b32 v41, v14 offset:64
ds_read_b32 v42, v14 offset:128
ds_read_b32 v43, v14 offset:192
ds_read_b32 v44, v14 offset:256
ds_read_b32 v45, v14 offset:320
ds_read_b32 v46, v14 offset:384
ds_read_b32 v47, v14 offset:448
s_waitcnt lgkmcnt(6)
v_perm_b32 v32, v41, v40, s46
v_perm_b32 v36, v41, v40, s47
s_waitcnt lgkmcnt(4)
v_perm_b32 v33, v43, v42, s46
v_perm_b32 v37, v43, v42, s47
s_waitcnt lgkmcnt(2)
v_perm_b32 v34, v45, v44, s46
v_perm_b32 v38, v45, v44, s47
s_waitcnt lgkmcnt(0)
v_perm_b32 v35, v47, v46, s46
v_perm_b32 v39, v47, v46, s47
v_accvgpr_write_b32 a160, v32
v_accvgpr_write_b32 a161, v33
v_accvgpr_write_b32 a162, v34
v_accvgpr_write_b32 a163, v35
v_accvgpr_write_b32 a164, v36
v_accvgpr_write_b32 a165, v37
v_accvgpr_write_b32 a166, v38
v_accvgpr_write_b32 a167, v39
s_waitcnt vmcnt(20)
ds_read_b32 v40, v14 offset:2048
ds_read_b32 v41, v14 offset:2112
ds_read_b32 v42, v14 offset:2176
ds_read_b32 v43, v14 offset:2240
ds_read_b32 v44, v14 offset:2304
ds_read_b32 v45, v14 offset:2368
ds_read_b32 v46, v14 offset:2432
ds_read_b32 v47, v14 offset:2496
s_waitcnt lgkmcnt(6)
v_perm_b32 v32, v41, v40, s46
v_perm_b32 v36, v41, v40, s47
s_waitcnt lgkmcnt(4)
v_perm_b32 v33, v43, v42, s46
v_perm_b32 v37, v43, v42, s47
s_waitcnt lgkmcnt(2)
v_perm_b32 v34, v45, v44, s46
v_perm_b32 v38, v45, v44, s47
s_waitcnt lgkmcnt(0)
v_perm_b32 v35, v47, v46, s46
v_perm_b32 v39, v47, v46, s47
v_accvgpr_write_b32 a168, v32
v_accvgpr_write_b32 a169, v33
v_accvgpr_write_b32 a170, v34
v_accvgpr_write_b32 a171, v35
v_accvgpr_write_b32 a172, v36
v_accvgpr_write_b32 a173, v37
v_accvgpr_write_b32 a174, v38
v_accvgpr_write_b32 a175, v39
s_waitcnt vmcnt(18)
ds_read_b32 v40, v14 offset:4096
ds_read_b32 v41, v14 offset:4160
ds_read_b32 v42, v14 offset:4224
ds_read_b32 v43, v14 offset:4288
ds_read_b32 v44, v14 offset:4352
ds_read_b32 v45, v14 offset:4416
ds_read_b32 v46, v14 offset:4480
ds_read_b32 v47, v14 offset:4544
s_waitcnt lgkmcnt(6)
v_perm_b32 v32, v41, v40, s46
v_perm_b32 v36, v41, v40, s47
s_waitcnt lgkmcnt(4)
v_perm_b32 v33, v43, v42, s46
v_perm_b32 v37, v43, v42, s47
s_waitcnt lgkmcnt(2)
v_perm_b32 v34, v45, v44, s46
v_perm_b32 v38, v45, v44, s47
s_waitcnt lgkmcnt(0)
v_perm_b32 v35, v47, v46, s46
v_perm_b32 v39, v47, v46, s47
v_accvgpr_write_b32 a176, v32
v_accvgpr_write_b32 a177, v33
v_accvgpr_write_b32 a178, v34
v_accvgpr_write_b32 a179, v35
v_accvgpr_write_b32 a180, v36
v_accvgpr_write_b32 a181, v37
v_accvgpr_write_b32 a182, v38
v_accvgpr_write_b32 a183, v39
s_waitcnt vmcnt(16)
ds_read_b32 v40, v14 offset:6144
ds_read_b32 v41, v14 offset:6208
ds_read_b32 v42, v14 offset:6272
ds_read_b32 v43, v14 offset:6336
ds_read_b32 v44, v14 offset:6400
ds_read_b32 v45, v14 offset:6464
ds_read_b32 v46, v14 offset:6528
ds_read_b32 v47, v14 offset:6592
s_waitcnt lgkmcnt(6)
v_perm_b32 v32, v41, v40, s46
v_perm_b32 v36, v41, v40, s47
s_waitcnt lgkmcnt(4)
v_perm_b32 v33, v43, v42, s46
v_perm_b32 v37, v43, v42, s47
s_waitcnt lgkmcnt(2)
v_perm_b32 v34, v45, v44, s46
v_perm_b32 v38, v45, v44, s47
s_waitcnt lgkmcnt(0)
v_perm_b32 v35, v47, v46, s46
v_perm_b32 v39, v47, v46, s47
v_accvgpr_write_b32 a184, v32
v_accvgpr_write_b32 a185, v33
v_accvgpr_write_b32 a186, v34
v_accvgpr_write_b32 a187, v35
v_accvgpr_write_b32 a188, v36
v_accvgpr_write_b32 a189, v37
v_accvgpr_write_b32 a190, v38
v_accvgpr_write_b32 a191, v39
s_waitcnt vmcnt(14)
ds_read_b32 v40, v14 offset:8192
ds_read_b32 v41, v14 offset:8256
ds_read_b32 v42, v14 offset:8320
ds_read_b32 v43, v14 offset:8384
ds_read_b32 v44, v14 offset:8448
ds_read_b32 v45, v14 offset:8512
ds_read_b32 v46, v14 offset:8576
ds_read_b32 v47, v14 offset:8640
s_waitcnt lgkmcnt(6)
v_perm_b32 v32, v41, v40, s46
v_perm_b32 v36, v41, v40, s47
s_waitcnt lgkmcnt(4)
v_perm_b32 v33, v43, v42, s46
v_perm_b32 v37, v43, v42, s47
s_waitcnt lgkmcnt(2)
v_perm_b32 v34, v45, v44, s46
v_perm_b32 v38, v45, v44, s47
s_waitcnt lgkmcnt(0)
v_perm_b32 v35, v47, v46, s46
v_perm_b32 v39, v47, v46, s47
v_accvgpr_write_b32 a192, v32
v_accvgpr_write_b32 a193, v33
v_accvgpr_write_b32 a194, v34
v_accvgpr_write_b32 a195, v35
v_accvgpr_write_b32 a196, v36
v_accvgpr_write_b32 a197, v37
v_accvgpr_write_b32 a198, v38
v_accvgpr_write_b32 a199, v39
s_waitcnt vmcnt(12)
ds_read_b32 v40, v14 offset:10240
ds_read_b32 v41, v14 offset:10304
ds_read_b32 v42, v14 offset:10368
ds_read_b32 v43, v14 offset:10432
ds_read_b32 v44, v14 offset:10496
ds_read_b32 v45, v14 offset:10560
ds_read_b32 v46, v14 offset:10624
ds_read_b32 v47, v14 offset:10688
s_waitcnt lgkmcnt(6)
v_perm_b32 v32, v41, v40, s46
v_perm_b32 v36, v41, v40, s47
s_waitcnt lgkmcnt(4)
v_perm_b32 v33, v43, v42, s46
v_perm_b32 v37, v43, v42, s47
s_waitcnt lgkmcnt(2)
v_perm_b32 v34, v45, v44, s46
v_perm_b32 v38, v45, v44, s47
s_waitcnt lgkmcnt(0)
v_perm_b32 v35, v47, v46, s46
v_perm_b32 v39, v47, v46, s47
v_accvgpr_write_b32 a200, v32
v_accvgpr_write_b32 a201, v33
v_accvgpr_write_b32 a202, v34
v_accvgpr_write_b32 a203, v35
v_accvgpr_write_b32 a204, v36
v_accvgpr_write_b32 a205, v37
v_accvgpr_write_b32 a206, v38
v_accvgpr_write_b32 a207, v39
s_waitcnt vmcnt(10)
ds_read_b32 v40, v14 offset:12288
ds_read_b32 v41, v14 offset:12352
ds_read_b32 v42, v14 offset:12416
ds_read_b32 v43, v14 offset:12480
ds_read_b32 v44, v14 offset:12544
ds_read_b32 v45, v14 offset:12608
ds_read_b32 v46, v14 offset:12672
ds_read_b32 v47, v14 offset:12736
s_waitcnt lgkmcnt(6)
v_perm_b32 v32, v41, v40, s46
v_perm_b32 v36, v41, v40, s47
s_waitcnt lgkmcnt(4)
v_perm_b32 v33, v43, v42, s46
v_perm_b32 v37, v43, v42, s47
s_waitcnt lgkmcnt(2)
v_perm_b32 v34, v45, v44, s46
v_perm_b32 v38, v45, v44, s47
s_waitcnt lgkmcnt(0)
v_perm_b32 v35, v47, v46, s46
v_perm_b32 v39, v47, v46, s47
v_accvgpr_write_b32 a208, v32
v_accvgpr_write_b32 a209, v33
v_accvgpr_write_b32 a210, v34
v_accvgpr_write_b32 a211, v35
v_accvgpr_write_b32 a212, v36
v_accvgpr_write_b32 a213, v37
v_accvgpr_write_b32 a214, v38
v_accvgpr_write_b32 a215, v39
s_waitcnt vmcnt(8)
ds_read_b32 v40, v14 offset:14336
ds_read_b32 v41, v14 offset:14400
ds_read_b32 v42, v14 offset:14464
ds_read_b32 v43, v14 offset:14528
ds_read_b32 v44, v14 offset:14592
ds_read_b32 v45, v14 offset:14656
ds_read_b32 v46, v14 offset:14720
ds_read_b32 v47, v14 offset:14784
s_waitcnt lgkmcnt(6)
v_perm_b32 v32, v41, v40, s46
v_perm_b32 v36, v41, v40, s47
s_waitcnt lgkmcnt(4)
v_perm_b32 v33, v43, v42, s46
v_perm_b32 v37, v43, v42, s47
s_waitcnt lgkmcnt(2)
v_perm_b32 v34, v45, v44, s46
v_perm_b32 v38, v45, v44, s47
s_waitcnt lgkmcnt(0)
v_perm_b32 v35, v47, v46, s46
v_perm_b32 v39, v47, v46, s47
v_accvgpr_write_b32 a216, v32
v_accvgpr_write_b32 a217, v33
v_accvgpr_write_b32 a218, v34
v_accvgpr_write_b32 a219, v35
v_accvgpr_write_b32 a220, v36
v_accvgpr_write_b32 a221, v37
v_accvgpr_write_b32 a222, v38
v_accvgpr_write_b32 a223, v39
s_waitcnt vmcnt(6)
ds_read_b32 v40, v14 offset:16384
ds_read_b32 v41, v14 offset:16448
ds_read_b32 v42, v14 offset:16512
ds_read_b32 v43, v14 offset:16576
ds_read_b32 v44, v14 offset:16640
ds_read_b32 v45, v14 offset:16704
ds_read_b32 v46, v14 offset:16768
ds_read_b32 v47, v14 offset:16832
s_waitcnt lgkmcnt(6)
v_perm_b32 v32, v41, v40, s46
v_perm_b32 v36, v41, v40, s47
s_waitcnt lgkmcnt(4)
v_perm_b32 v33, v43, v42, s46
v_perm_b32 v37, v43, v42, s47
s_waitcnt lgkmcnt(2)
v_perm_b32 v34, v45, v44, s46
v_perm_b32 v38, v45, v44, s47
s_waitcnt lgkmcnt(0)
v_perm_b32 v35, v47, v46, s46
v_perm_b32 v39, v47, v46, s47
v_accvgpr_write_b32 a224, v32
v_accvgpr_write_b32 a225, v33
v_accvgpr_write_b32 a226, v34
v_accvgpr_write_b32 a227, v35
v_accvgpr_write_b32 a228, v36
v_accvgpr_write_b32 a229, v37
v_accvgpr_write_b32 a230, v38
v_accvgpr_write_b32 a231, v39
s_waitcnt vmcnt(4)
ds_read_b32 v40, v14 offset:18432
ds_read_b32 v41, v14 offset:18496
ds_read_b32 v42, v14 offset:18560
ds_read_b32 v43, v14 offset:18624
ds_read_b32 v44, v14 offset:18688
ds_read_b32 v45, v14 offset:18752
ds_read_b32 v46, v14 offset:18816
ds_read_b32 v47, v14 offset:18880
s_waitcnt lgkmcnt(6)
v_perm_b32 v32, v41, v40, s46
v_perm_b32 v36, v41, v40, s47
s_waitcnt lgkmcnt(4)
v_perm_b32 v33, v43, v42, s46
v_perm_b32 v37, v43, v42, s47
s_waitcnt lgkmcnt(2)
v_perm_b32 v34, v45, v44, s46
v_perm_b32 v38, v45, v44, s47
s_waitcnt lgkmcnt(0)
v_perm_b32 v35, v47, v46, s46
v_perm_b32 v39, v47, v46, s47
v_accvgpr_write_b32 a232, v32
v_accvgpr_write_b32 a233, v33
v_accvgpr_write_b32 a234, v34
v_accvgpr_write_b32 a235, v35
v_accvgpr_write_b32 a236, v36
v_accvgpr_write_b32 a237, v37
v_accvgpr_write_b32 a238, v38
v_accvgpr_write_b32 a239, v39
s_waitcnt vmcnt(2)
ds_read_b32 v40, v14 offset:20480
ds_read_b32 v41, v14 offset:20544
ds_read_b32 v42, v14 offset:20608
ds_read_b32 v43, v14 offset:20672
ds_read_b32 v44, v14 offset:20736
ds_read_b32 v45, v14 offset:20800
ds_read_b32 v46, v14 offset:20864
ds_read_b32 v47, v14 offset:20928
s_waitcnt lgkmcnt(6)
v_perm_b32 v32, v41, v40, s46
v_perm_b32 v36, v41, v40, s47
s_waitcnt lgkmcnt(4)
v_perm_b32 v33, v43, v42, s46
v_perm_b32 v37, v43, v42, s47
s_waitcnt lgkmcnt(2)
v_perm_b32 v34, v45, v44, s46
v_perm_b32 v38, v45, v44, s47
s_waitcnt lgkmcnt(0)
v_perm_b32 v35, v47, v46, s46
v_perm_b32 v39, v47, v46, s47
v_accvgpr_write_b32 a240, v32
v_accvgpr_write_b32 a241, v33
v_accvgpr_write_b32 a242, v34
v_accvgpr_write_b32 a243, v35
v_accvgpr_write_b32 a244, v36
v_accvgpr_write_b32 a245, v37
v_accvgpr_write_b32 a246, v38
v_accvgpr_write_b32 a247, v39
s_waitcnt vmcnt(0)
ds_read_b32 v40, v14 offset:22528
ds_read_b32 v41, v14 offset:22592
ds_read_b32 v42, v14 offset:22656
ds_read_b32 v43, v14 offset:22720
ds_read_b32 v44, v14 offset:22784
ds_read_b32 v45, v14 offset:22848
ds_read_b32 v46, v14 offset:22912
ds_read_b32 v47, v14 offset:22976
s_waitcnt lgkmcnt(6)
v_perm_b32 v32, v41, v40, s46
v_perm_b32 v36, v41, v40, s47
s_waitcnt lgkmcnt(4)
v_perm_b32 v33, v43, v42, s46
v_perm_b32 v37, v43, v42, s47
s_waitcnt lgkmcnt(2)
v_perm_b32 v34, v45, v44, s46
v_perm_b32 v38, v45, v44, s47
s_waitcnt lgkmcnt(0)
v_perm_b32 v35, v47, v46, s46
v_perm_b32 v39, v47, v46, s47
v_accvgpr_write_b32 a248, v32
v_accvgpr_write_b32 a249, v33
v_accvgpr_write_b32 a250, v34
v_accvgpr_write_b32 a251, v35
v_accvgpr_write_b32 a252, v36
v_accvgpr_write_b32 a253, v37
v_accvgpr_write_b32 a254, v38
v_accvgpr_write_b32 a255, v39
s_lshl_b32 s40, s43, 11
s_lshl_b32 s41, s32, 11
s_sub_u32 s40, s40, s41
s_lshl_b32 s41, s37, 25
s_sub_u32 s81, s40, s41
v_lshlrev_b32 v34, 5, v1
buffer_load_dword v33, v34, s[8:11], 0 offen offset:12 sc1
s_waitcnt vmcnt(0)
L_cen_134:
s_mov_b32 s40, 0
v_readlane_b32 s41, v33, 0
s_nop 0
s_add_u32 s40, s40, s41
v_readlane_b32 s41, v33, 1
s_nop 0
s_add_u32 s40, s40, s41
v_readlane_b32 s41, v33, 2
s_nop 0
s_add_u32 s40, s40, s41
v_readlane_b32 s41, v33, 3
s_nop 0
s_add_u32 s40, s40, s41
v_readlane_b32 s41, v33, 4
s_nop 0
s_add_u32 s40, s40, s41
v_readlane_b32 s41, v33, 5
s_nop 0
s_add_u32 s40, s40, s41
v_readlane_b32 s41, v33, 6
s_nop 0
s_add_u32 s40, s40, s41
v_readlane_b32 s41, v33, 7
s_nop 0
s_add_u32 s40, s40, s41
s_cmp_eq_u32 s40, 256
s_cbranch_scc1 L_cenok_135
s_sub_u32 s36, s36, 1
s_cbranch_scc1 L_end_qkv_G
s_sleep 4
buffer_load_dword v33, v34, s[8:11], 0 offen offset:12 sc1
s_waitcnt vmcnt(0)
s_branch L_cen_134
L_cenok_135:
s_barrier
s_and_b32 s42, s32, 1
s_lshl_b32 s43, s42, 10
v_add_u32 v28, s43, v2
v_xor_b32 v29, 1024, v28
s_lshl_b32 s42, s42, 8
v_add_u32 v23, 0, v21
v_xor_b32 v23, v23, v20
v_lshlrev_b32 v23, 4, v23
v_lshl_add_u32 v23, v20, 9, v23
v_add_u32 v4, s42, v23
v_xor_b32 v8, 256, v4
v_add_u32 v100, 65536, v4
v_add_u32 v104, 65536, v8
v_add_u32 v23, 4, v21
v_xor_b32 v23, v23, v20
v_lshlrev_b32 v23, 4, v23
v_lshl_add_u32 v23, v20, 9, v23
v_add_u32 v5, s42, v23
v_xor_b32 v9, 256, v5
v_add_u32 v101, 65536, v5
v_add_u32 v105, 65536, v9
v_add_u32 v23, 8, v21
v_xor_b32 v23, v23, v20
v_lshlrev_b32 v23, 4, v23
v_lshl_add_u32 v23, v20, 9, v23
v_add_u32 v6, s42, v23
v_xor_b32 v10, 256, v6
v_add_u32 v102, 65536, v6
v_add_u32 v106, 65536, v10
v_add_u32 v23, 12, v21
v_xor_b32 v23, v23, v20
v_lshlrev_b32 v23, 4, v23
v_lshl_add_u32 v23, v20, 9, v23
v_add_u32 v7, s42, v23
v_xor_b32 v11, 256, v7
v_add_u32 v103, 65536, v7
v_add_u32 v107, 65536, v11
v_mov_b32 v25, 1
v_mov_b32 v24, 0
v_and_b32 v23, 31, v1
v_lshlrev_b32 v27, 2, v23
v_lshlrev_b32 v23, 4, v20
v_lshl_add_u32 v30, v21, 10, v23
v_add_u32 v31, 3072, v30
s_lshl_b32 s40, s32, 13
s_add_u32 s39, s40, 10485760
s_add_u32 s90, s40, 12550144
s_add_u32 s28, s40, 14680064
s_lshl_b32 s40, s37, 25
s_lshl_b32 s41, s34, 13
s_add_u32 s40, s40, s41
s_lshl_b32 s78, s32, 11
s_add_u32 s40, s40, s78
s_add_u32 s29, s40, 41943040
s_add_u32 s30, s40, 58720256
s_add_u32 s84, s40, 143654912
s_lshl_b32 s40, s34, 6
s_lshl_b32 s41, s37, 4
s_add_u32 s40, s40, s41
s_lshl_b32 s41, s32, 2
s_add_u32 s40, s40, s41
s_add_u32 s31, s40, 131072
s_add_u32 s76, s40, 262144
s_add_u32 s82, s40, 393216
s_mov_b32 s83, s82
s_lshl_b32 s40, s32, 7
s_add_u32 s77, s40, 49152
s_add_u32 s79, s78, 65536
s_mov_b32 s38, 0
s_and_b32 s85, s32, 1
s_lshl_b32 s85, s85, 4
s_cmp_eq_u32 s37, 2
s_cbranch_scc1 L_qkv_v_G
s_add_u32 m0, s79, 0
s_add_u32 s41, s39, 0
buffer_load_dwordx4 v30, s[4:7], s41 offen offset:0 sc1 lds
buffer_load_dwordx4 v31, s[4:7], s41 offen offset:1024 sc1 lds
s_add_u32 m0, s79, 8192
s_add_u32 s41, s39, 256
buffer_load_dwordx4 v30, s[4:7], s41 offen offset:0 sc1 lds
buffer_load_dwordx4 v31, s[4:7], s41 offen offset:1024 sc1 lds
s_add_u32 m0, s79, 16384
s_add_u32 s41, s39, 512
buffer_load_dwordx4 v30, s[4:7], s41 offen offset:0 sc1 lds
buffer_load_dwordx4 v31, s[4:7], s41 offen offset:1024 sc1 lds
s_add_u32 m0, s79, 24576
s_add_u32 s41, s39, 768
buffer_load_dwordx4 v30, s[4:7], s41 offen offset:0 sc1 lds
buffer_load_dwordx4 v31, s[4:7], s41 offen offset:1024 sc1 lds
s_add_u32 s39, s39, 32768
s_min_u32 s39, s39, s90
s_xor_b32 s79, s79, 32768
L_qkv_p1_k_G:
s_waitcnt vmcnt(0)
buffer_store_dword v25, v24, s[4:7], s82 offen sc1
s_barrier
ds_read_b128 v[32:35], v100 offset:0
ds_read_b128 v[36:39], v104 offset:0
ds_read_b128 v[40:43], v101 offset:0
ds_read_b128 v[44:47], v105 offset:0
ds_read_b128 v[48:51], v102 offset:0
ds_read_b128 v[52:55], v106 offset:0
s_waitcnt lgkmcnt(5)
v_mfma_f32_16x16x32_bf16 v[64:67], a[0:3], v[32:35], 0
s_add_u32 m0, s79, 0
s_add_u32 s41, s39, 0
v_mfma_f32_16x16x32_bf16 v[68:71], a[4:7], v[32:35], 0
buffer_load_dwordx4 v30, s[4:7], s41 offen offset:0 sc1 lds
v_mfma_f32_16x16x32_bf16 v[80:83], a[128:131], v[32:35], 0
v_mfma_f32_16x16x32_bf16 v[84:87], a[132:135], v[32:35], 0
s_waitcnt lgkmcnt(4)
v_mfma_f32_16x16x32_bf16 v[72:75], a[0:3], v[36:39], 0
v_mfma_f32_16x16x32_bf16 v[76:79], a[4:7], v[36:39], 0
ds_read_b128 v[56:59], v103 offset:0
ds_read_b128 v[60:63], v107 offset:0
s_waitcnt lgkmcnt(5)
v_mfma_f32_16x16x32_bf16 v[64:67], a[8:11], v[40:43], v[64:67]
buffer_load_dwordx4 v31, s[4:7], s41 offen offset:1024 sc1 lds
s_add_u32 m0, s79, 8192
v_mfma_f32_16x16x32_bf16 v[68:71], a[12:15], v[40:43], v[68:71]
s_add_u32 s41, s39, 256
v_mfma_f32_16x16x32_bf16 v[80:83], a[136:139], v[40:43], v[80:83]
v_mfma_f32_16x16x32_bf16 v[84:87], a[140:143], v[40:43], v[84:87]
s_waitcnt lgkmcnt(4)
v_mfma_f32_16x16x32_bf16 v[72:75], a[8:11], v[44:47], v[72:75]
buffer_load_dwordx4 v30, s[4:7], s41 offen offset:0 sc1 lds
v_mfma_f32_16x16x32_bf16 v[76:79], a[12:15], v[44:47], v[76:79]
ds_read_b128 v[32:35], v100 offset:8192
ds_read_b128 v[36:39], v104 offset:8192
s_waitcnt lgkmcnt(5)
v_mfma_f32_16x16x32_bf16 v[64:67], a[16:19], v[48:51], v[64:67]
v_mfma_f32_16x16x32_bf16 v[68:71], a[20:23], v[48:51], v[68:71]
v_mfma_f32_16x16x32_bf16 v[80:83], a[144:147], v[48:51], v[80:83]
buffer_load_dwordx4 v31, s[4:7], s41 offen offset:1024 sc1 lds
s_add_u32 m0, s79, 16384
v_mfma_f32_16x16x32_bf16 v[84:87], a[148:151], v[48:51], v[84:87]
s_add_u32 s41, s39, 512
s_waitcnt lgkmcnt(4)
v_mfma_f32_16x16x32_bf16 v[72:75], a[16:19], v[52:55], v[72:75]
v_mfma_f32_16x16x32_bf16 v[76:79], a[20:23], v[52:55], v[76:79]
ds_read_b128 v[40:43], v101 offset:8192
ds_read_b128 v[44:47], v105 offset:8192
s_waitcnt lgkmcnt(5)
v_mfma_f32_16x16x32_bf16 v[64:67], a[24:27], v[56:59], v[64:67]
buffer_load_dwordx4 v30, s[4:7], s41 offen offset:0 sc1 lds
v_mfma_f32_16x16x32_bf16 v[68:71], a[28:31], v[56:59], v[68:71]
v_mfma_f32_16x16x32_bf16 v[80:83], a[152:155], v[56:59], v[80:83]
v_mfma_f32_16x16x32_bf16 v[84:87], a[156:159], v[56:59], v[84:87]
s_waitcnt lgkmcnt(4)
v_mfma_f32_16x16x32_bf16 v[72:75], a[24:27], v[60:63], v[72:75]
buffer_load_dwordx4 v31, s[4:7], s41 offen offset:1024 sc1 lds
s_add_u32 m0, s79, 24576
v_mfma_f32_16x16x32_bf16 v[76:79], a[28:31], v[60:63], v[76:79]
ds_read_b128 v[48:51], v102 offset:8192
ds_read_b128 v[52:55], v106 offset:8192
s_waitcnt lgkmcnt(5)
v_mfma_f32_16x16x32_bf16 v[64:67], a[32:35], v[32:35], v[64:67]
s_add_u32 s41, s39, 768
v_mfma_f32_16x16x32_bf16 v[68:71], a[36:39], v[32:35], v[68:71]
v_mfma_f32_16x16x32_bf16 v[80:83], a[160:163], v[32:35], v[80:83]
buffer_load_dwordx4 v30, s[4:7], s41 offen offset:0 sc1 lds
v_mfma_f32_16x16x32_bf16 v[84:87], a[164:167], v[32:35], v[84:87]
s_waitcnt lgkmcnt(4)
v_mfma_f32_16x16x32_bf16 v[72:75], a[32:35], v[36:39], v[72:75]
v_mfma_f32_16x16x32_bf16 v[76:79], a[36:39], v[36:39], v[76:79]
ds_read_b128 v[56:59], v103 offset:8192
ds_read_b128 v[60:63], v107 offset:8192
s_waitcnt lgkmcnt(5)
v_mfma_f32_16x16x32_bf16 v[64:67], a[40:43], v[40:43], v[64:67]
buffer_load_dwordx4 v31, s[4:7], s41 offen offset:1024 sc1 lds
s_add_u32 s39, s39, 32768
v_mfma_f32_16x16x32_bf16 v[68:71], a[44:47], v[40:43], v[68:71]
s_min_u32 s39, s39, s90
s_xor_b32 s79, s79, 32768
v_mfma_f32_16x16x32_bf16 v[80:83], a[168:171], v[40:43], v[80:83]
v_mfma_f32_16x16x32_bf16 v[84:87], a[172:175], v[40:43], v[84:87]
s_waitcnt lgkmcnt(4)
v_mfma_f32_16x16x32_bf16 v[72:75], a[40:43], v[44:47], v[72:75]
v_mfma_f32_16x16x32_bf16 v[76:79], a[44:47], v[44:47], v[76:79]
ds_read_b128 v[32:35], v100 offset:16384
ds_read_b128 v[36:39], v104 offset:16384
s_waitcnt lgkmcnt(5)
v_mfma_f32_16x16x32_bf16 v[64:67], a[48:51], v[48:51], v[64:67]
v_mfma_f32_16x16x32_bf16 v[68:71], a[52:55], v[48:51], v[68:71]
v_mfma_f32_16x16x32_bf16 v[80:83], a[176:179], v[48:51], v[80:83]
v_mfma_f32_16x16x32_bf16 v[84:87], a[180:183], v[48:51], v[84:87]
s_waitcnt lgkmcnt(4)
v_mfma_f32_16x16x32_bf16 v[72:75], a[48:51], v[52:55], v[72:75]
v_mfma_f32_16x16x32_bf16 v[76:79], a[52:55], v[52:55], v[76:79]
ds_read_b128 v[40:43], v101 offset:16384
ds_read_b128 v[44:47], v105 offset:16384
s_waitcnt lgkmcnt(5)
v_mfma_f32_16x16x32_bf16 v[64:67], a[56:59], v[56:59], v[64:67]
v_mfma_f32_16x16x32_bf16 v[68:71], a[60:63], v[56:59], v[68:71]
v_mfma_f32_16x16x32_bf16 v[80:83], a[184:187], v[56:59], v[80:83]
v_mfma_f32_16x16x32_bf16 v[84:87], a[188:191], v[56:59], v[84:87]
s_waitcnt lgkmcnt(4)
v_mfma_f32_16x16x32_bf16 v[72:75], a[56:59], v[60:63], v[72:75]
v_mfma_f32_16x16x32_bf16 v[76:79], a[60:63], v[60:63], v[76:79]
ds_read_b128 v[48:51], v102 offset:16384
ds_read_b128 v[52:55], v106 offset:16384
s_waitcnt lgkmcnt(5)
v_mfma_f32_16x16x32_bf16 v[64:67], a[64:67], v[32:35], v[64:67]
v_mfma_f32_16x16x32_bf16 v[68:71], a[68:71], v[32:35], v[68:71]
v_mfma_f32_16x16x32_bf16 v[80:83], a[192:195], v[32:35], v[80:83]
v_mfma_f32_16x16x32_bf16 v[84:87], a[196:199], v[32:35], v[84:87]
s_waitcnt lgkmcnt(4)
v_mfma_f32_16x16x32_bf16 v[72:75], a[64:67], v[36:39], v[72:75]
v_mfma_f32_16x16x32_bf16 v[76:79], a[68:71], v[36:39], v[76:79]
ds_read_b128 v[56:59], v103 offset:16384
ds_read_b128 v[60:63], v107 offset:16384
s_waitcnt lgkmcnt(5)
v_mfma_f32_16x16x32_bf16 v[64:67], a[72:75], v[40:43], v[64:67]
v_mfma_f32_16x16x32_bf16 v[68:71], a[76:79], v[40:43], v[68:71]
v_mfma_f32_16x16x32_bf16 v[80:83], a[200:203], v[40:43], v[80:83]
v_mfma_f32_16x16x32_bf16 v[84:87], a[204:207], v[40:43], v[84:87]
s_waitcnt lgkmcnt(4)
v_mfma_f32_16x16x32_bf16 v[72:75], a[72:75], v[44:47], v[72:75]
v_mfma_f32_16x16x32_bf16 v[76:79], a[76:79], v[44:47], v[76:79]
ds_read_b128 v[32:35], v100 offset:24576
ds_read_b128 v[36:39], v104 offset:24576
s_waitcnt lgkmcnt(5)
v_mfma_f32_16x16x32_bf16 v[64:67], a[80:83], v[48:51], v[64:67]
v_mfma_f32_16x16x32_bf16 v[68:71], a[84:87], v[48:51], v[68:71]
v_mfma_f32_16x16x32_bf16 v[80:83], a[208:211], v[48:51], v[80:83]
v_mfma_f32_16x16x32_bf16 v[84:87], a[212:215], v[48:51], v[84:87]
s_waitcnt lgkmcnt(4)
v_mfma_f32_16x16x32_bf16 v[72:75], a[80:83], v[52:55], v[72:75]
v_mfma_f32_16x16x32_bf16 v[76:79], a[84:87], v[52:55], v[76:79]
ds_read_b128 v[40:43], v101 offset:24576
ds_read_b128 v[44:47], v105 offset:24576
s_waitcnt lgkmcnt(5)
v_mfma_f32_16x16x32_bf16 v[64:67], a[88:91], v[56:59], v[64:67]
v_mfma_f32_16x16x32_bf16 v[68:71], a[92:95], v[56:59], v[68:71]
v_mfma_f32_16x16x32_bf16 v[80:83], a[216:219], v[56:59], v[80:83]
v_mfma_f32_16x16x32_bf16 v[84:87], a[220:223], v[56:59], v[84:87]
s_waitcnt lgkmcnt(4)
v_mfma_f32_16x16x32_bf16 v[72:75], a[88:91], v[60:63], v[72:75]
v_mfma_f32_16x16x32_bf16 v[76:79], a[92:95], v[60:63], v[76:79]
ds_read_b128 v[48:51], v102 offset:24576
ds_read_b128 v[52:55], v106 offset:24576
s_waitcnt lgkmcnt(5)
v_mfma_f32_16x16x32_bf16 v[64:67], a[96:99], v[32:35], v[64:67]
v_mfma_f32_16x16x32_bf16 v[68:71], a[100:103], v[32:35], v[68:71]
v_mfma_f32_16x16x32_bf16 v[80:83], a[224:227], v[32:35], v[80:83]
v_mfma_f32_16x16x32_bf16 v[84:87], a[228:231], v[32:35], v[84:87]
s_waitcnt lgkmcnt(4)
v_mfma_f32_16x16x32_bf16 v[72:75], a[96:99], v[36:39], v[72:75]
v_mfma_f32_16x16x32_bf16 v[76:79], a[100:103], v[36:39], v[76:79]
ds_read_b128 v[56:59], v103 offset:24576
ds_read_b128 v[60:63], v107 offset:24576
s_waitcnt lgkmcnt(5)
v_mfma_f32_16x16x32_bf16 v[64:67], a[104:107], v[40:43], v[64:67]
v_mfma_f32_16x16x32_bf16 v[68:71], a[108:111], v[40:43], v[68:71]
v_mfma_f32_16x16x32_bf16 v[80:83], a[232:235], v[40:43], v[80:83]
v_mfma_f32_16x16x32_bf16 v[84:87], a[236:239], v[40:43], v[84:87]
s_waitcnt lgkmcnt(4)
v_mfma_f32_16x16x32_bf16 v[72:75], a[104:107], v[44:47], v[72:75]
v_mfma_f32_16x16x32_bf16 v[76:79], a[108:111], v[44:47], v[76:79]
s_waitcnt lgkmcnt(3)
v_mfma_f32_16x16x32_bf16 v[64:67], a[112:115], v[48:51], v[64:67]
v_mfma_f32_16x16x32_bf16 v[68:71], a[116:119], v[48:51], v[68:71]
v_mfma_f32_16x16x32_bf16 v[80:83], a[240:243], v[48:51], v[80:83]
v_mfma_f32_16x16x32_bf16 v[84:87], a[244:247], v[48:51], v[84:87]
s_waitcnt lgkmcnt(2)
v_mfma_f32_16x16x32_bf16 v[72:75], a[112:115], v[52:55], v[72:75]
v_mfma_f32_16x16x32_bf16 v[76:79], a[116:119], v[52:55], v[76:79]
s_waitcnt lgkmcnt(1)
v_mfma_f32_16x16x32_bf16 v[64:67], a[120:123], v[56:59], v[64:67]
v_mfma_f32_16x16x32_bf16 v[68:71], a[124:127], v[56:59], v[68:71]
v_mfma_f32_16x16x32_bf16 v[80:83], a[248:251], v[56:59], v[80:83]
v_mfma_f32_16x16x32_bf16 v[84:87], a[252:255], v[56:59], v[84:87]
s_waitcnt lgkmcnt(0)
v_mfma_f32_16x16x32_bf16 v[72:75], a[120:123], v[60:63], v[72:75]
v_mfma_f32_16x16x32_bf16 v[76:79], a[124:127], v[60:63], v[76:79]
s_nop 4
v_cvt_pk_bf16_f32 v96, v80, v84
v_cvt_pk_bf16_f32 v97, v81, v85
v_cvt_pk_bf16_f32 v98, v82, v86
v_cvt_pk_bf16_f32 v99, v83, v87
v_cvt_pk_bf16_f32 v88, v64, v68
v_cvt_pk_bf16_f32 v89, v65, v69
v_cvt_pk_bf16_f32 v90, v66, v70
v_cvt_pk_bf16_f32 v91, v67, v71
v_cvt_pk_bf16_f32 v92, v72, v76
v_cvt_pk_bf16_f32 v93, v73, v77
v_cvt_pk_bf16_f32 v94, v74, v78
v_cvt_pk_bf16_f32 v95, v75, v79
s_add_u32 s40, s29, s81
buffer_store_dwordx4 v[96:99], v28, s[4:7], s40 offen sc1
buffer_store_dwordx4 v[88:91], v28, s[4:7], s29 offen sc1
buffer_store_dwordx4 v[92:95], v29, s[4:7], s29 offen sc1
v_xor_b32 v100, 32768, v100
v_xor_b32 v101, 32768, v101
v_xor_b32 v102, 32768, v102
v_xor_b32 v103, 32768, v103
v_xor_b32 v104, 32768, v104
v_xor_b32 v105, 32768, v105
v_xor_b32 v106, 32768, v106
v_xor_b32 v107, 32768, v107
s_mov_b32 s82, s31
s_add_u32 s29, s29, 262144
s_add_u32 s31, s31, 2048
s_add_u32 s38, s38, 1
s_cmp_lt_u32 s38, 14
s_cbranch_scc1 L_qkv_p1_k_G
buffer_load_dword v26, v27, s[4:7], s77 offen sc1
s_waitcnt vmcnt(0)
buffer_store_dword v25, v24, s[4:7], s82 offen sc1
s_barrier
s_add_u32 m0, s79, 0
s_add_u32 s41, s39, 0
buffer_load_dwordx4 v30, s[4:7], s41 offen offset:0 sc1 lds
buffer_load_dwordx4 v31, s[4:7], s41 offen offset:1024 sc1 lds
s_add_u32 m0, s79, 8192
s_add_u32 s41, s39, 256
buffer_load_dwordx4 v30, s[4:7], s41 offen offset:0 sc1 lds
buffer_load_dwordx4 v31, s[4:7], s41 offen offset:1024 sc1 lds
s_add_u32 m0, s79, 16384
s_add_u32 s41, s39, 512
buffer_load_dwordx4 v30, s[4:7], s41 offen offset:0 sc1 lds
buffer_load_dwordx4 v31, s[4:7], s41 offen offset:1024 sc1 lds
s_add_u32 m0, s79, 24576
s_add_u32 s41, s39, 768
buffer_load_dwordx4 v30, s[4:7], s41 offen offset:0 sc1 lds
buffer_load_dwordx4 v31, s[4:7], s41 offen offset:1024 sc1 lds
s_add_u32 s39, s39, 32768
s_min_u32 s39, s39, s90
s_xor_b32 s79, s79, 32768
s_mov_b32 s88, s84
s_mov_b32 s89, s83
ds_read_b128 v[32:35], v100 offset:0
ds_read_b128 v[36:39], v104 offset:0
ds_read_b128 v[40:43], v101 offset:0
ds_read_b128 v[44:47], v105 offset:0
L_qkv_loop_k_G:
s_waitcnt vmcnt(8)
v_cmp_eq_u32 s[86:87], 0, v26
ds_read_b128 v[48:51], v102 offset:0
ds_read_b128 v[52:55], v106 offset:0
s_waitcnt lgkmcnt(5)
v_mfma_f32_16x16x32_bf16 v[64:67], a[0:3], v[32:35], 0
s_add_u32 m0, s78, 0
s_add_u32 s41, s28, 0
v_cvt_pk_bf16_f32 v144, v128, v132
v_mfma_f32_16x16x32_bf16 v[68:71], a[4:7], v[32:35], 0
buffer_load_dwordx4 v30, s[4:7], s41 offen offset:0 sc1 lds
v_cvt_pk_bf16_f32 v145, v129, v133
v_mfma_f32_16x16x32_bf16 v[80:83], a[128:131], v[32:35], 0
v_cvt_pk_bf16_f32 v146, v130, v134
v_cvt_pk_bf16_f32 v147, v131, v135
v_mfma_f32_16x16x32_bf16 v[84:87], a[132:135], v[32:35], 0
v_cvt_pk_bf16_f32 v136, v112, v116
v_cvt_pk_bf16_f32 v137, v113, v117
s_waitcnt lgkmcnt(4)
v_mfma_f32_16x16x32_bf16 v[72:75], a[0:3], v[36:39], 0
v_cvt_pk_bf16_f32 v138, v114, v118
v_cvt_pk_bf16_f32 v139, v115, v119
v_mfma_f32_16x16x32_bf16 v[76:79], a[4:7], v[36:39], 0
ds_read_b128 v[56:59], v103 offset:0
ds_read_b128 v[60:63], v107 offset:0
s_waitcnt lgkmcnt(5)
v_mfma_f32_16x16x32_bf16 v[64:67], a[8:11], v[40:43], v[64:67]
buffer_load_dwordx4 v31, s[4:7], s41 offen offset:1024 sc1 lds
s_add_u32 m0, s78, 8192
v_mfma_f32_16x16x32_bf16 v[68:71], a[12:15], v[40:43], v[68:71]
s_add_u32 s41, s28, 256
v_cvt_pk_bf16_f32 v140, v120, v124
v_cvt_pk_bf16_f32 v141, v121, v125
v_mfma_f32_16x16x32_bf16 v[80:83], a[136:139], v[40:43], v[80:83]
v_cvt_pk_bf16_f32 v142, v122, v126
v_cvt_pk_bf16_f32 v143, v123, v127
v_mfma_f32_16x16x32_bf16 v[84:87], a[140:143], v[40:43], v[84:87]
s_waitcnt lgkmcnt(4)
v_mfma_f32_16x16x32_bf16 v[72:75], a[8:11], v[44:47], v[72:75]
buffer_load_dwordx4 v30, s[4:7], s41 offen offset:0 sc1 lds
v_mfma_f32_16x16x32_bf16 v[76:79], a[12:15], v[44:47], v[76:79]
ds_read_b128 v[32:35], v100 offset:8192
ds_read_b128 v[36:39], v104 offset:8192
s_waitcnt lgkmcnt(5)
v_mfma_f32_16x16x32_bf16 v[64:67], a[16:19], v[48:51], v[64:67]
v_mfma_f32_16x16x32_bf16 v[68:71], a[20:23], v[48:51], v[68:71]
v_mfma_f32_16x16x32_bf16 v[80:83], a[144:147], v[48:51], v[80:83]
buffer_load_dwordx4 v31, s[4:7], s41 offen offset:1024 sc1 lds
v_mfma_f32_16x16x32_bf16 v[84:87], a[148:151], v[48:51], v[84:87]
s_waitcnt lgkmcnt(4)
v_mfma_f32_16x16x32_bf16 v[72:75], a[16:19], v[52:55], v[72:75]
v_mfma_f32_16x16x32_bf16 v[76:79], a[20:23], v[52:55], v[76:79]
s_barrier
ds_read_b128 v[40:43], v101 offset:8192
ds_read_b128 v[44:47], v105 offset:8192
s_waitcnt lgkmcnt(5)
v_mfma_f32_16x16x32_bf16 v[64:67], a[24:27], v[56:59], v[64:67]
s_add_u32 s40, s84, s81
v_mfma_f32_16x16x32_bf16 v[68:71], a[28:31], v[56:59], v[68:71]
buffer_store_dwordx4 v[144:147], v28, s[4:7], s40 offen sc1
v_mfma_f32_16x16x32_bf16 v[80:83], a[152:155], v[56:59], v[80:83]
v_mfma_f32_16x16x32_bf16 v[84:87], a[156:159], v[56:59], v[84:87]
s_waitcnt lgkmcnt(4)
v_mfma_f32_16x16x32_bf16 v[72:75], a[24:27], v[60:63], v[72:75]
v_mfma_f32_16x16x32_bf16 v[76:79], a[28:31], v[60:63], v[76:79]
ds_read_b128 v[48:51], v102 offset:8192
ds_read_b128 v[52:55], v106 offset:8192
s_waitcnt lgkmcnt(5)
v_mfma_f32_16x16x32_bf16 v[64:67], a[32:35], v[32:35], v[64:67]
buffer_store_dwordx4 v[136:139], v28, s[4:7], s84 offen sc1
v_mfma_f32_16x16x32_bf16 v[68:71], a[36:39], v[32:35], v[68:71]
v_mfma_f32_16x16x32_bf16 v[80:83], a[160:163], v[32:35], v[80:83]
v_mfma_f32_16x16x32_bf16 v[84:87], a[164:167], v[32:35], v[84:87]
s_waitcnt lgkmcnt(4)
v_mfma_f32_16x16x32_bf16 v[72:75], a[32:35], v[36:39], v[72:75]
v_mfma_f32_16x16x32_bf16 v[76:79], a[36:39], v[36:39], v[76:79]
ds_read_b128 v[56:59], v103 offset:8192
ds_read_b128 v[60:63], v107 offset:8192
s_waitcnt lgkmcnt(5)
v_mfma_f32_16x16x32_bf16 v[64:67], a[40:43], v[40:43], v[64:67]
buffer_store_dwordx4 v[140:143], v29, s[4:7], s84 offen sc1
v_mfma_f32_16x16x32_bf16 v[68:71], a[44:47], v[40:43], v[68:71]
s_add_u32 m0, s78, 16384
s_add_u32 s41, s28, 512
v_mfma_f32_16x16x32_bf16 v[80:83], a[168:171], v[40:43], v[80:83]
v_mfma_f32_16x16x32_bf16 v[84:87], a[172:175], v[40:43], v[84:87]
s_waitcnt lgkmcnt(4)
v_mfma_f32_16x16x32_bf16 v[72:75], a[40:43], v[44:47], v[72:75]
v_mfma_f32_16x16x32_bf16 v[76:79], a[44:47], v[44:47], v[76:79]
ds_read_b128 v[32:35], v100 offset:16384
ds_read_b128 v[36:39], v104 offset:16384
s_waitcnt lgkmcnt(5)
v_mfma_f32_16x16x32_bf16 v[64:67], a[48:51], v[48:51], v[64:67]
buffer_load_dwordx4 v30, s[4:7], s41 offen offset:0 sc1 lds
v_mfma_f32_16x16x32_bf16 v[68:71], a[52:55], v[48:51], v[68:71]
v_mfma_f32_16x16x32_bf16 v[80:83], a[176:179], v[48:51], v[80:83]
v_mfma_f32_16x16x32_bf16 v[84:87], a[180:183], v[48:51], v[84:87]
s_waitcnt lgkmcnt(4)
v_mfma_f32_16x16x32_bf16 v[72:75], a[48:51], v[52:55], v[72:75]
v_mfma_f32_16x16x32_bf16 v[76:79], a[52:55], v[52:55], v[76:79]
ds_read_b128 v[40:43], v101 offset:16384
ds_read_b128 v[44:47], v105 offset:16384
s_waitcnt lgkmcnt(5)
v_mfma_f32_16x16x32_bf16 v[64:67], a[56:59], v[56:59], v[64:67]
buffer_load_dwordx4 v31, s[4:7], s41 offen offset:1024 sc1 lds
s_add_u32 m0, s78, 24576
v_mfma_f32_16x16x32_bf16 v[68:71], a[60:63], v[56:59], v[68:71]
s_add_u32 s41, s28, 768
v_mfma_f32_16x16x32_bf16 v[80:83], a[184:187], v[56:59], v[80:83]
v_mfma_f32_16x16x32_bf16 v[84:87], a[188:191], v[56:59], v[84:87]
s_waitcnt lgkmcnt(4)
v_mfma_f32_16x16x32_bf16 v[72:75], a[56:59], v[60:63], v[72:75]
v_mfma_f32_16x16x32_bf16 v[76:79], a[60:63], v[60:63], v[76:79]
ds_read_b128 v[48:51], v102 offset:16384
ds_read_b128 v[52:55], v106 offset:16384
s_waitcnt lgkmcnt(5)
v_mfma_f32_16x16x32_bf16 v[64:67], a[64:67], v[32:35], v[64:67]
buffer_load_dwordx4 v30, s[4:7], s41 offen offset:0 sc1 lds
v_mfma_f32_16x16x32_bf16 v[68:71], a[68:71], v[32:35], v[68:71]
v_mfma_f32_16x16x32_bf16 v[80:83], a[192:195], v[32:35], v[80:83]
v_mfma_f32_16x16x32_bf16 v[84:87], a[196:199], v[32:35], v[84:87]
s_waitcnt lgkmcnt(4)
v_mfma_f32_16x16x32_bf16 v[72:75], a[64:67], v[36:39], v[72:75]
v_mfma_f32_16x16x32_bf16 v[76:79], a[68:71], v[36:39], v[76:79]
ds_read_b128 v[56:59], v103 offset:16384
ds_read_b128 v[60:63], v107 offset:16384
s_waitcnt lgkmcnt(5)
v_mfma_f32_16x16x32_bf16 v[64:67], a[72:75], v[40:43], v[64:67]
buffer_load_dwordx4 v31, s[4:7], s41 offen offset:1024 sc1 lds
s_add_u32 s40, s88, s81
v_mfma_f32_16x16x32_bf16 v[68:71], a[76:79], v[40:43], v[68:71]
v_mfma_f32_16x16x32_bf16 v[80:83], a[200:203], v[40:43], v[80:83]
v_mfma_f32_16x16x32_bf16 v[84:87], a[204:207], v[40:43], v[84:87]
s_waitcnt lgkmcnt(4)
v_mfma_f32_16x16x32_bf16 v[72:75], a[72:75], v[44:47], v[72:75]
v_mfma_f32_16x16x32_bf16 v[76:79], a[76:79], v[44:47], v[76:79]
ds_read_b128 v[32:35], v100 offset:24576
ds_read_b128 v[36:39], v104 offset:24576
s_waitcnt lgkmcnt(5)
v_mfma_f32_16x16x32_bf16 v[64:67], a[80:83], v[48:51], v[64:67]
buffer_store_dwordx4 v[96:99], v28, s[4:7], s40 offen sc1
v_mfma_f32_16x16x32_bf16 v[68:71], a[84:87], v[48:51], v[68:71]
v_mfma_f32_16x16x32_bf16 v[80:83], a[208:211], v[48:51], v[80:83]
v_mfma_f32_16x16x32_bf16 v[84:87], a[212:215], v[48:51], v[84:87]
s_waitcnt lgkmcnt(4)
v_mfma_f32_16x16x32_bf16 v[72:75], a[80:83], v[52:55], v[72:75]
v_mfma_f32_16x16x32_bf16 v[76:79], a[84:87], v[52:55], v[76:79]
ds_read_b128 v[40:43], v101 offset:24576
ds_read_b128 v[44:47], v105 offset:24576
s_waitcnt lgkmcnt(5)
v_mfma_f32_16x16x32_bf16 v[64:67], a[88:91], v[56:59], v[64:67]
buffer_store_dwordx4 v[88:91], v28, s[4:7], s88 offen sc1
v_mfma_f32_16x16x32_bf16 v[68:71], a[92:95], v[56:59], v[68:71]
v_mfma_f32_16x16x32_bf16 v[80:83], a[216:219], v[56:59], v[80:83]
v_mfma_f32_16x16x32_bf16 v[84:87], a[220:223], v[56:59], v[84:87]
s_waitcnt lgkmcnt(4)
v_mfma_f32_16x16x32_bf16 v[72:75], a[88:91], v[60:63], v[72:75]
v_mfma_f32_16x16x32_bf16 v[76:79], a[92:95], v[60:63], v[76:79]
ds_read_b128 v[48:51], v102 offset:24576
ds_read_b128 v[52:55], v106 offset:24576
s_waitcnt lgkmcnt(5)
v_mfma_f32_16x16x32_bf16 v[64:67], a[96:99], v[32:35], v[64:67]
buffer_store_dwordx4 v[92:95], v29, s[4:7], s88 offen sc1
v_mfma_f32_16x16x32_bf16 v[68:71], a[100:103], v[32:35], v[68:71]
v_mfma_f32_16x16x32_bf16 v[80:83], a[224:227], v[32:35], v[80:83]
v_mfma_f32_16x16x32_bf16 v[84:87], a[228:231], v[32:35], v[84:87]
s_waitcnt lgkmcnt(4)
v_mfma_f32_16x16x32_bf16 v[72:75], a[96:99], v[36:39], v[72:75]
v_mfma_f32_16x16x32_bf16 v[76:79], a[100:103], v[36:39], v[76:79]
ds_read_b128 v[56:59], v103 offset:24576
ds_read_b128 v[60:63], v107 offset:24576
s_waitcnt lgkmcnt(5)
v_mfma_f32_16x16x32_bf16 v[64:67], a[104:107], v[40:43], v[64:67]
v_mfma_f32_16x16x32_bf16 v[68:71], a[108:111], v[40:43], v[68:71]
v_mfma_f32_16x16x32_bf16 v[80:83], a[232:235], v[40:43], v[80:83]
v_mfma_f32_16x16x32_bf16 v[84:87], a[236:239], v[40:43], v[84:87]
s_waitcnt lgkmcnt(4)
v_mfma_f32_16x16x32_bf16 v[72:75], a[104:107], v[44:47], v[72:75]
v_mfma_f32_16x16x32_bf16 v[76:79], a[108:111], v[44:47], v[76:79]
s_cmp_lg_u32 s86, 0
s_cbranch_scc1 L_spin_136
L_go_137:
s_waitcnt vmcnt(7)
s_barrier
buffer_store_dword v25, v24, s[4:7], s83 offen sc1
s_add_u32 s28, s28, 32768
s_add_u32 s77, s77, 512
ds_read_b128 v[32:35], v4 offset:0
ds_read_b128 v[36:39], v8 offset:0
s_waitcnt lgkmcnt(5)
v_mfma_f32_16x16x32_bf16 v[64:67], a[112:115], v[48:51], v[64:67]
v_mfma_f32_16x16x32_bf16 v[68:71], a[116:119], v[48:51], v[68:71]
v_mfma_f32_16x16x32_bf16 v[80:83], a[240:243], v[48:51], v[80:83]
v_mfma_f32_16x16x32_bf16 v[84:87], a[244:247], v[48:51], v[84:87]
s_waitcnt lgkmcnt(4)
v_mfma_f32_16x16x32_bf16 v[72:75], a[112:115], v[52:55], v[72:75]
v_mfma_f32_16x16x32_bf16 v[76:79], a[116:119], v[52:55], v[76:79]
ds_read_b128 v[40:43], v5 offset:0
ds_read_b128 v[44:47], v9 offset:0
s_waitcnt lgkmcnt(5)
v_mfma_f32_16x16x32_bf16 v[64:67], a[120:123], v[56:59], v[64:67]
v_mfma_f32_16x16x32_bf16 v[68:71], a[124:127], v[56:59], v[68:71]
v_mfma_f32_16x16x32_bf16 v[80:83], a[248:251], v[56:59], v[80:83]
v_mfma_f32_16x16x32_bf16 v[84:87], a[252:255], v[56:59], v[84:87]
s_waitcnt lgkmcnt(4)
v_mfma_f32_16x16x32_bf16 v[72:75], a[120:123], v[60:63], v[72:75]
v_mfma_f32_16x16x32_bf16 v[76:79], a[124:127], v[60:63], v[76:79]
ds_read_b128 v[48:51], v6 offset:0
ds_read_b128 v[52:55], v10 offset:0
s_waitcnt lgkmcnt(5)
v_mfma_f32_16x16x32_bf16 v[112:115], a[0:3], v[32:35], 0
v_mfma_f32_16x16x32_bf16 v[116:119], a[4:7], v[32:35], 0
v_mfma_f32_16x16x32_bf16 v[128:131], a[128:131], v[32:35], 0
v_mfma_f32_16x16x32_bf16 v[132:135], a[132:135], v[32:35], 0
s_waitcnt lgkmcnt(4)
v_mfma_f32_16x16x32_bf16 v[120:123], a[0:3], v[36:39], 0
v_mfma_f32_16x16x32_bf16 v[124:127], a[4:7], v[36:39], 0
ds_read_b128 v[56:59], v7 offset:0
ds_read_b128 v[60:63], v11 offset:0
s_waitcnt lgkmcnt(5)
v_mfma_f32_16x16x32_bf16 v[112:115], a[8:11], v[40:43], v[112:115]
v_mfma_f32_16x16x32_bf16 v[116:119], a[12:15], v[40:43], v[116:119]
v_mfma_f32_16x16x32_bf16 v[128:131], a[136:139], v[40:43], v[128:131]
v_mfma_f32_16x16x32_bf16 v[132:135], a[140:143], v[40:43], v[132:135]
s_waitcnt lgkmcnt(4)
v_mfma_f32_16x16x32_bf16 v[120:123], a[8:11], v[44:47], v[120:123]
v_mfma_f32_16x16x32_bf16 v[124:127], a[12:15], v[44:47], v[124:127]
ds_read_b128 v[32:35], v4 offset:8192
ds_read_b128 v[36:39], v8 offset:8192
s_waitcnt lgkmcnt(5)
v_mfma_f32_16x16x32_bf16 v[112:115], a[16:19], v[48:51], v[112:115]
v_cvt_pk_bf16_f32 v96, v80, v84
v_cvt_pk_bf16_f32 v97, v81, v85
v_mfma_f32_16x16x32_bf16 v[116:119], a[20:23], v[48:51], v[116:119]
v_cvt_pk_bf16_f32 v98, v82, v86
v_cvt_pk_bf16_f32 v99, v83, v87
v_mfma_f32_16x16x32_bf16 v[128:131], a[144:147], v[48:51], v[128:131]
v_cvt_pk_bf16_f32 v88, v64, v68
v_cvt_pk_bf16_f32 v89, v65, v69
v_mfma_f32_16x16x32_bf16 v[132:135], a[148:151], v[48:51], v[132:135]
v_cvt_pk_bf16_f32 v90, v66, v70
v_cvt_pk_bf16_f32 v91, v67, v71
s_waitcnt lgkmcnt(4)
v_mfma_f32_16x16x32_bf16 v[120:123], a[16:19], v[52:55], v[120:123]
v_cvt_pk_bf16_f32 v92, v72, v76
v_cvt_pk_bf16_f32 v93, v73, v77
v_mfma_f32_16x16x32_bf16 v[124:127], a[20:23], v[52:55], v[124:127]
ds_read_b128 v[40:43], v5 offset:8192
ds_read_b128 v[44:47], v9 offset:8192
s_waitcnt lgkmcnt(5)
v_mfma_f32_16x16x32_bf16 v[112:115], a[24:27], v[56:59], v[112:115]
v_cvt_pk_bf16_f32 v94, v74, v78
v_cvt_pk_bf16_f32 v95, v75, v79
v_mfma_f32_16x16x32_bf16 v[116:119], a[28:31], v[56:59], v[116:119]
v_xor_b32 v100, 32768, v100
v_xor_b32 v101, 32768, v101
v_mfma_f32_16x16x32_bf16 v[128:131], a[152:155], v[56:59], v[128:131]
v_xor_b32 v102, 32768, v102
v_xor_b32 v103, 32768, v103
v_mfma_f32_16x16x32_bf16 v[132:135], a[156:159], v[56:59], v[132:135]
v_xor_b32 v104, 32768, v104
v_xor_b32 v105, 32768, v105
s_waitcnt lgkmcnt(4)
v_mfma_f32_16x16x32_bf16 v[120:123], a[24:27], v[60:63], v[120:123]
v_xor_b32 v106, 32768, v106
v_xor_b32 v107, 32768, v107
s_mov_b32 s88, s29
v_mfma_f32_16x16x32_bf16 v[124:127], a[28:31], v[60:63], v[124:127]
buffer_load_dword v26, v27, s[4:7], s77 offen sc1
ds_read_b128 v[48:51], v6 offset:8192
ds_read_b128 v[52:55], v10 offset:8192
s_waitcnt lgkmcnt(5)
v_mfma_f32_16x16x32_bf16 v[112:115], a[32:35], v[32:35], v[112:115]
s_mov_b32 s82, s31
s_add_u32 s29, s29, 262144
s_add_u32 s31, s31, 2048
v_mfma_f32_16x16x32_bf16 v[116:119], a[36:39], v[32:35], v[116:119]
v_mfma_f32_16x16x32_bf16 v[128:131], a[160:163], v[32:35], v[128:131]
v_mfma_f32_16x16x32_bf16 v[132:135], a[164:167], v[32:35], v[132:135]
s_waitcnt lgkmcnt(4)
v_mfma_f32_16x16x32_bf16 v[120:123], a[32:35], v[36:39], v[120:123]
v_mfma_f32_16x16x32_bf16 v[124:127], a[36:39], v[36:39], v[124:127]
ds_read_b128 v[56:59], v7 offset:8192
ds_read_b128 v[60:63], v11 offset:8192
s_waitcnt lgkmcnt(5)
v_mfma_f32_16x16x32_bf16 v[112:115], a[40:43], v[40:43], v[112:115]
v_mfma_f32_16x16x32_bf16 v[116:119], a[44:47], v[40:43], v[116:119]
v_mfma_f32_16x16x32_bf16 v[128:131], a[168:171], v[40:43], v[128:131]
v_mfma_f32_16x16x32_bf16 v[132:135], a[172:175], v[40:43], v[132:135]
s_waitcnt lgkmcnt(4)
v_mfma_f32_16x16x32_bf16 v[120:123], a[40:43], v[44:47], v[120:123]
v_mfma_f32_16x16x32_bf16 v[124:127], a[44:47], v[44:47], v[124:127]
s_waitcnt vmcnt(2)
s_barrier
buffer_store_dword v25, v24, s[4:7], s89 offen sc1
s_mov_b32 s89, s82
ds_read_b128 v[32:35], v4 offset:16384
ds_read_b128 v[36:39], v8 offset:16384
s_waitcnt lgkmcnt(5)
v_mfma_f32_16x16x32_bf16 v[112:115], a[48:51], v[48:51], v[112:115]
s_add_u32 m0, s79, 0
s_add_u32 s41, s39, 0
v_mfma_f32_16x16x32_bf16 v[116:119], a[52:55], v[48:51], v[116:119]
buffer_load_dwordx4 v30, s[4:7], s41 offen offset:0 sc1 lds
v_mfma_f32_16x16x32_bf16 v[128:131], a[176:179], v[48:51], v[128:131]
v_mfma_f32_16x16x32_bf16 v[132:135], a[180:183], v[48:51], v[132:135]
s_waitcnt lgkmcnt(4)
v_mfma_f32_16x16x32_bf16 v[120:123], a[48:51], v[52:55], v[120:123]
v_mfma_f32_16x16x32_bf16 v[124:127], a[52:55], v[52:55], v[124:127]
ds_read_b128 v[40:43], v5 offset:16384
ds_read_b128 v[44:47], v9 offset:16384
s_waitcnt lgkmcnt(5)
v_mfma_f32_16x16x32_bf16 v[112:115], a[56:59], v[56:59], v[112:115]
buffer_load_dwordx4 v31, s[4:7], s41 offen offset:1024 sc1 lds
s_add_u32 m0, s79, 8192
v_mfma_f32_16x16x32_bf16 v[116:119], a[60:63], v[56:59], v[116:119]
s_add_u32 s41, s39, 256
v_mfma_f32_16x16x32_bf16 v[128:131], a[184:187], v[56:59], v[128:131]
v_mfma_f32_16x16x32_bf16 v[132:135], a[188:191], v[56:59], v[132:135]
s_waitcnt lgkmcnt(4)
v_mfma_f32_16x16x32_bf16 v[120:123], a[56:59], v[60:63], v[120:123]
v_mfma_f32_16x16x32_bf16 v[124:127], a[60:63], v[60:63], v[124:127]
ds_read_b128 v[48:51], v6 offset:16384
ds_read_b128 v[52:55], v10 offset:16384
s_waitcnt lgkmcnt(5)
v_mfma_f32_16x16x32_bf16 v[112:115], a[64:67], v[32:35], v[112:115]
buffer_load_dwordx4 v30, s[4:7], s41 offen offset:0 sc1 lds
v_mfma_f32_16x16x32_bf16 v[116:119], a[68:71], v[32:35], v[116:119]
v_mfma_f32_16x16x32_bf16 v[128:131], a[192:195], v[32:35], v[128:131]
v_mfma_f32_16x16x32_bf16 v[132:135], a[196:199], v[32:35], v[132:135]
s_waitcnt lgkmcnt(4)
v_mfma_f32_16x16x32_bf16 v[120:123], a[64:67], v[36:39], v[120:123]
v_mfma_f32_16x16x32_bf16 v[124:127], a[68:71], v[36:39], v[124:127]
ds_read_b128 v[56:59], v7 offset:16384
ds_read_b128 v[60:63], v11 offset:16384
s_waitcnt lgkmcnt(5)
v_mfma_f32_16x16x32_bf16 v[112:115], a[72:75], v[40:43], v[112:115]
buffer_load_dwordx4 v31, s[4:7], s41 offen offset:1024 sc1 lds
s_add_u32 m0, s79, 16384
v_mfma_f32_16x16x32_bf16 v[116:119], a[76:79], v[40:43], v[116:119]
s_add_u32 s41, s39, 512
v_mfma_f32_16x16x32_bf16 v[128:131], a[200:203], v[40:43], v[128:131]
v_mfma_f32_16x16x32_bf16 v[132:135], a[204:207], v[40:43], v[132:135]
s_waitcnt lgkmcnt(4)
v_mfma_f32_16x16x32_bf16 v[120:123], a[72:75], v[44:47], v[120:123]
v_mfma_f32_16x16x32_bf16 v[124:127], a[76:79], v[44:47], v[124:127]
ds_read_b128 v[32:35], v4 offset:24576
ds_read_b128 v[36:39], v8 offset:24576
s_waitcnt lgkmcnt(5)
v_mfma_f32_16x16x32_bf16 v[112:115], a[80:83], v[48:51], v[112:115]
buffer_load_dwordx4 v30, s[4:7], s41 offen offset:0 sc1 lds
v_mfma_f32_16x16x32_bf16 v[116:119], a[84:87], v[48:51], v[116:119]
v_mfma_f32_16x16x32_bf16 v[128:131], a[208:211], v[48:51], v[128:131]
v_mfma_f32_16x16x32_bf16 v[132:135], a[212:215], v[48:51], v[132:135]
s_waitcnt lgkmcnt(4)
v_mfma_f32_16x16x32_bf16 v[120:123], a[80:83], v[52:55], v[120:123]
v_mfma_f32_16x16x32_bf16 v[124:127], a[84:87], v[52:55], v[124:127]
ds_read_b128 v[40:43], v5 offset:24576
ds_read_b128 v[44:47], v9 offset:24576
s_waitcnt lgkmcnt(5)
v_mfma_f32_16x16x32_bf16 v[112:115], a[88:91], v[56:59], v[112:115]
buffer_load_dwordx4 v31, s[4:7], s41 offen offset:1024 sc1 lds
s_add_u32 m0, s79, 24576
v_mfma_f32_16x16x32_bf16 v[116:119], a[92:95], v[56:59], v[116:119]
s_add_u32 s41, s39, 768
v_mfma_f32_16x16x32_bf16 v[128:131], a[216:219], v[56:59], v[128:131]
v_mfma_f32_16x16x32_bf16 v[132:135], a[220:223], v[56:59], v[132:135]
s_waitcnt lgkmcnt(4)
v_mfma_f32_16x16x32_bf16 v[120:123], a[88:91], v[60:63], v[120:123]
v_mfma_f32_16x16x32_bf16 v[124:127], a[92:95], v[60:63], v[124:127]
s_barrier
ds_read_b128 v[48:51], v6 offset:24576
ds_read_b128 v[52:55], v10 offset:24576
s_waitcnt lgkmcnt(5)
v_mfma_f32_16x16x32_bf16 v[112:115], a[96:99], v[32:35], v[112:115]
buffer_load_dwordx4 v30, s[4:7], s41 offen offset:0 sc1 lds
v_mfma_f32_16x16x32_bf16 v[116:119], a[100:103], v[32:35], v[116:119]
v_mfma_f32_16x16x32_bf16 v[128:131], a[224:227], v[32:35], v[128:131]
v_mfma_f32_16x16x32_bf16 v[132:135], a[228:231], v[32:35], v[132:135]
s_waitcnt lgkmcnt(4)
v_mfma_f32_16x16x32_bf16 v[120:123], a[96:99], v[36:39], v[120:123]
v_mfma_f32_16x16x32_bf16 v[124:127], a[100:103], v[36:39], v[124:127]
ds_read_b128 v[56:59], v7 offset:24576
ds_read_b128 v[60:63], v11 offset:24576
s_waitcnt lgkmcnt(5)
v_mfma_f32_16x16x32_bf16 v[112:115], a[104:107], v[40:43], v[112:115]
buffer_load_dwordx4 v31, s[4:7], s41 offen offset:1024 sc1 lds
s_add_u32 s39, s39, 32768
v_mfma_f32_16x16x32_bf16 v[116:119], a[108:111], v[40:43], v[116:119]
s_min_u32 s39, s39, s90
s_xor_b32 s79, s79, 32768
v_mfma_f32_16x16x32_bf16 v[128:131], a[232:235], v[40:43], v[128:131]
v_mfma_f32_16x16x32_bf16 v[132:135], a[236:239], v[40:43], v[132:135]
s_waitcnt lgkmcnt(4)
v_mfma_f32_16x16x32_bf16 v[120:123], a[104:107], v[44:47], v[120:123]
v_mfma_f32_16x16x32_bf16 v[124:127], a[108:111], v[44:47], v[124:127]
ds_read_b128 v[32:35], v100 offset:0
ds_read_b128 v[36:39], v104 offset:0
s_waitcnt lgkmcnt(5)
v_mfma_f32_16x16x32_bf16 v[112:115], a[112:115], v[48:51], v[112:115]
v_mfma_f32_16x16x32_bf16 v[116:119], a[116:119], v[48:51], v[116:119]
v_mfma_f32_16x16x32_bf16 v[128:131], a[240:243], v[48:51], v[128:131]
v_mfma_f32_16x16x32_bf16 v[132:135], a[244:247], v[48:51], v[132:135]
s_waitcnt lgkmcnt(4)
v_mfma_f32_16x16x32_bf16 v[120:123], a[112:115], v[52:55], v[120:123]
v_mfma_f32_16x16x32_bf16 v[124:127], a[116:119], v[52:55], v[124:127]
ds_read_b128 v[40:43], v101 offset:0
ds_read_b128 v[44:47], v105 offset:0
s_waitcnt lgkmcnt(5)
v_mfma_f32_16x16x32_bf16 v[112:115], a[120:123], v[56:59], v[112:115]
v_mfma_f32_16x16x32_bf16 v[116:119], a[124:127], v[56:59], v[116:119]
v_mfma_f32_16x16x32_bf16 v[128:131], a[248:251], v[56:59], v[128:131]
v_mfma_f32_16x16x32_bf16 v[132:135], a[252:255], v[56:59], v[132:135]
s_waitcnt lgkmcnt(4)
v_mfma_f32_16x16x32_bf16 v[120:123], a[120:123], v[60:63], v[120:123]
v_mfma_f32_16x16x32_bf16 v[124:127], a[124:127], v[60:63], v[124:127]
s_mov_b32 s84, s30
s_mov_b32 s83, s76
s_add_u32 s30, s30, 262144
s_add_u32 s76, s76, 2048
s_add_u32 s38, s38, 1
s_cmp_lt_u32 s38, 64
s_cbranch_scc1 L_qkv_loop_k_G
s_add_u32 s40, s88, s81
buffer_store_dwordx4 v[96:99], v28, s[4:7], s40 offen sc1
buffer_store_dwordx4 v[88:91], v28, s[4:7], s88 offen sc1
buffer_store_dwordx4 v[92:95], v29, s[4:7], s88 offen sc1
s_mov_b32 s82, s89
L_qkv_p3_k_G:
v_cvt_pk_bf16_f32 v144, v128, v132
v_cvt_pk_bf16_f32 v145, v129, v133
v_cvt_pk_bf16_f32 v146, v130, v134
v_cvt_pk_bf16_f32 v147, v131, v135
v_cvt_pk_bf16_f32 v136, v112, v116
v_cvt_pk_bf16_f32 v137, v113, v117
v_cvt_pk_bf16_f32 v138, v114, v118
v_cvt_pk_bf16_f32 v139, v115, v119
v_cvt_pk_bf16_f32 v140, v120, v124
v_cvt_pk_bf16_f32 v141, v121, v125
v_cvt_pk_bf16_f32 v142, v122, v126
v_cvt_pk_bf16_f32 v143, v123, v127
s_add_u32 s40, s84, s81
buffer_store_dwordx4 v[144:147], v28, s[4:7], s40 offen sc1
buffer_store_dwordx4 v[136:139], v28, s[4:7], s84 offen sc1
buffer_store_dwordx4 v[140:143], v29, s[4:7], s84 offen sc1
buffer_load_dword v26, v27, s[4:7], s77 offen sc1
s_waitcnt vmcnt(0) lgkmcnt(0)
buffer_store_dword v25, v24, s[4:7], s83 offen sc1
buffer_store_dword v25, v24, s[4:7], s82 offen sc1
s_cmp_eq_u32 s38, 78
s_cbranch_scc1 L_end_qkv_G
s_barrier
L_p3_138:
v_cmp_eq_u32 vcc, 0, v26
s_cbranch_vccz L_p3o_139
s_sub_u32 s36, s36, 1
s_cbranch_scc1 L_end_qkv_G
buffer_load_dword v26, v27, s[4:7], s77 offen sc1
s_waitcnt vmcnt(0)
s_branch L_p3_138
L_p3o_139:
s_add_u32 m0, s78, 0
s_add_u32 s41, s28, 0
buffer_load_dwordx4 v30, s[4:7], s41 offen offset:0 sc1 lds
buffer_load_dwordx4 v31, s[4:7], s41 offen offset:1024 sc1 lds
s_add_u32 m0, s78, 8192
s_add_u32 s41, s28, 256
buffer_load_dwordx4 v30, s[4:7], s41 offen offset:0 sc1 lds
buffer_load_dwordx4 v31, s[4:7], s41 offen offset:1024 sc1 lds
s_add_u32 m0, s78, 16384
s_add_u32 s41, s28, 512
buffer_load_dwordx4 v30, s[4:7], s41 offen offset:0 sc1 lds
buffer_load_dwordx4 v31, s[4:7], s41 offen offset:1024 sc1 lds
s_add_u32 m0, s78, 24576
s_add_u32 s41, s28, 768
buffer_load_dwordx4 v30, s[4:7], s41 offen offset:0 sc1 lds
buffer_load_dwordx4 v31, s[4:7], s41 offen offset:1024 sc1 lds
s_add_u32 s28, s28, 32768
s_add_u32 s77, s77, 512
s_waitcnt vmcnt(6)
s_barrier
ds_read_b128 v[32:35], v4 offset:0
ds_read_b128 v[36:39], v8 offset:0
ds_read_b128 v[40:43], v5 offset:0
ds_read_b128 v[44:47], v9 offset:0
ds_read_b128 v[48:51], v6 offset:0
ds_read_b128 v[52:55], v10 offset:0
s_waitcnt lgkmcnt(5)
v_mfma_f32_16x16x32_bf16 v[112:115], a[0:3], v[32:35], 0
v_mfma_f32_16x16x32_bf16 v[116:119], a[4:7], v[32:35], 0
v_mfma_f32_16x16x32_bf16 v[128:131], a[128:131], v[32:35], 0
v_mfma_f32_16x16x32_bf16 v[132:135], a[132:135], v[32:35], 0
s_waitcnt lgkmcnt(4)
v_mfma_f32_16x16x32_bf16 v[120:123], a[0:3], v[36:39], 0
v_mfma_f32_16x16x32_bf16 v[124:127], a[4:7], v[36:39], 0
ds_read_b128 v[56:59], v7 offset:0
ds_read_b128 v[60:63], v11 offset:0
s_waitcnt lgkmcnt(5)
v_mfma_f32_16x16x32_bf16 v[112:115], a[8:11], v[40:43], v[112:115]
v_mfma_f32_16x16x32_bf16 v[116:119], a[12:15], v[40:43], v[116:119]
v_mfma_f32_16x16x32_bf16 v[128:131], a[136:139], v[40:43], v[128:131]
v_mfma_f32_16x16x32_bf16 v[132:135], a[140:143], v[40:43], v[132:135]
s_waitcnt lgkmcnt(4)
v_mfma_f32_16x16x32_bf16 v[120:123], a[8:11], v[44:47], v[120:123]
v_mfma_f32_16x16x32_bf16 v[124:127], a[12:15], v[44:47], v[124:127]
s_waitcnt vmcnt(4)
s_barrier
ds_read_b128 v[32:35], v4 offset:8192
ds_read_b128 v[36:39], v8 offset:8192
s_waitcnt lgkmcnt(5)
v_mfma_f32_16x16x32_bf16 v[112:115], a[16:19], v[48:51], v[112:115]
v_mfma_f32_16x16x32_bf16 v[116:119], a[20:23], v[48:51], v[116:119]
v_mfma_f32_16x16x32_bf16 v[128:131], a[144:147], v[48:51], v[128:131]
v_mfma_f32_16x16x32_bf16 v[132:135], a[148:151], v[48:51], v[132:135]
s_waitcnt lgkmcnt(4)
v_mfma_f32_16x16x32_bf16 v[120:123], a[16:19], v[52:55], v[120:123]
v_mfma_f32_16x16x32_bf16 v[124:127], a[20:23], v[52:55], v[124:127]
ds_read_b128 v[40:43], v5 offset:8192
ds_read_b128 v[44:47], v9 offset:8192
s_waitcnt lgkmcnt(5)
v_mfma_f32_16x16x32_bf16 v[112:115], a[24:27], v[56:59], v[112:115]
v_mfma_f32_16x16x32_bf16 v[116:119], a[28:31], v[56:59], v[116:119]
v_mfma_f32_16x16x32_bf16 v[128:131], a[152:155], v[56:59], v[128:131]
v_mfma_f32_16x16x32_bf16 v[132:135], a[156:159], v[56:59], v[132:135]
s_waitcnt lgkmcnt(4)
v_mfma_f32_16x16x32_bf16 v[120:123], a[24:27], v[60:63], v[120:123]
v_mfma_f32_16x16x32_bf16 v[124:127], a[28:31], v[60:63], v[124:127]
ds_read_b128 v[48:51], v6 offset:8192
ds_read_b128 v[52:55], v10 offset:8192
s_waitcnt lgkmcnt(5)
v_mfma_f32_16x16x32_bf16 v[112:115], a[32:35], v[32:35], v[112:115]
v_mfma_f32_16x16x32_bf16 v[116:119], a[36:39], v[32:35], v[116:119]
v_mfma_f32_16x16x32_bf16 v[128:131], a[160:163], v[32:35], v[128:131]
v_mfma_f32_16x16x32_bf16 v[132:135], a[164:167], v[32:35], v[132:135]
s_waitcnt lgkmcnt(4)
v_mfma_f32_16x16x32_bf16 v[120:123], a[32:35], v[36:39], v[120:123]
v_mfma_f32_16x16x32_bf16 v[124:127], a[36:39], v[36:39], v[124:127]
ds_read_b128 v[56:59], v7 offset:8192
ds_read_b128 v[60:63], v11 offset:8192
s_waitcnt lgkmcnt(5)
v_mfma_f32_16x16x32_bf16 v[112:115], a[40:43], v[40:43], v[112:115]
v_mfma_f32_16x16x32_bf16 v[116:119], a[44:47], v[40:43], v[116:119]
v_mfma_f32_16x16x32_bf16 v[128:131], a[168:171], v[40:43], v[128:131]
v_mfma_f32_16x16x32_bf16 v[132:135], a[172:175], v[40:43], v[132:135]
s_waitcnt lgkmcnt(4)
v_mfma_f32_16x16x32_bf16 v[120:123], a[40:43], v[44:47], v[120:123]
v_mfma_f32_16x16x32_bf16 v[124:127], a[44:47], v[44:47], v[124:127]
s_waitcnt vmcnt(2)
s_barrier
ds_read_b128 v[32:35], v4 offset:16384
ds_read_b128 v[36:39], v8 offset:16384
s_waitcnt lgkmcnt(5)
v_mfma_f32_16x16x32_bf16 v[112:115], a[48:51], v[48:51], v[112:115]
v_mfma_f32_16x16x32_bf16 v[116:119], a[52:55], v[48:51], v[116:119]
v_mfma_f32_16x16x32_bf16 v[128:131], a[176:179], v[48:51], v[128:131]
v_mfma_f32_16x16x32_bf16 v[132:135], a[180:183], v[48:51], v[132:135]
s_waitcnt lgkmcnt(4)
v_mfma_f32_16x16x32_bf16 v[120:123], a[48:51], v[52:55], v[120:123]
v_mfma_f32_16x16x32_bf16 v[124:127], a[52:55], v[52:55], v[124:127]
ds_read_b128 v[40:43], v5 offset:16384
ds_read_b128 v[44:47], v9 offset:16384
s_waitcnt lgkmcnt(5)
v_mfma_f32_16x16x32_bf16 v[112:115], a[56:59], v[56:59], v[112:115]
v_mfma_f32_16x16x32_bf16 v[116:119], a[60:63], v[56:59], v[116:119]
v_mfma_f32_16x16x32_bf16 v[128:131], a[184:187], v[56:59], v[128:131]
v_mfma_f32_16x16x32_bf16 v[132:135], a[188:191], v[56:59], v[132:135]
s_waitcnt lgkmcnt(4)
v_mfma_f32_16x16x32_bf16 v[120:123], a[56:59], v[60:63], v[120:123]
v_mfma_f32_16x16x32_bf16 v[124:127], a[60:63], v[60:63], v[124:127]
ds_read_b128 v[48:51], v6 offset:16384
ds_read_b128 v[52:55], v10 offset:16384
s_waitcnt lgkmcnt(5)
v_mfma_f32_16x16x32_bf16 v[112:115], a[64:67], v[32:35], v[112:115]
v_mfma_f32_16x16x32_bf16 v[116:119], a[68:71], v[32:35], v[116:119]
v_mfma_f32_16x16x32_bf16 v[128:131], a[192:195], v[32:35], v[128:131]
v_mfma_f32_16x16x32_bf16 v[132:135], a[196:199], v[32:35], v[132:135]
s_waitcnt lgkmcnt(4)
v_mfma_f32_16x16x32_bf16 v[120:123], a[64:67], v[36:39], v[120:123]
v_mfma_f32_16x16x32_bf16 v[124:127], a[68:71], v[36:39], v[124:127]
ds_read_b128 v[56:59], v7 offset:16384
ds_read_b128 v[60:63], v11 offset:16384
s_waitcnt lgkmcnt(5)
v_mfma_f32_16x16x32_bf16 v[112:115], a[72:75], v[40:43], v[112:115]
v_mfma_f32_16x16x32_bf16 v[116:119], a[76:79], v[40:43], v[116:119]
v_mfma_f32_16x16x32_bf16 v[128:131], a[200:203], v[40:43], v[128:131]
v_mfma_f32_16x16x32_bf16 v[132:135], a[204:207], v[40:43], v[132:135]
s_waitcnt lgkmcnt(4)
v_mfma_f32_16x16x32_bf16 v[120:123], a[72:75], v[44:47], v[120:123]
v_mfma_f32_16x16x32_bf16 v[124:127], a[76:79], v[44:47], v[124:127]
s_waitcnt vmcnt(0)
s_barrier
ds_read_b128 v[32:35], v4 offset:24576
ds_read_b128 v[36:39], v8 offset:24576
s_waitcnt lgkmcnt(5)
v_mfma_f32_16x16x32_bf16 v[112:115], a[80:83], v[48:51], v[112:115]
v_mfma_f32_16x16x32_bf16 v[116:119], a[84:87], v[48:51], v[116:119]
v_mfma_f32_16x16x32_bf16 v[128:131], a[208:211], v[48:51], v[128:131]
v_mfma_f32_16x16x32_bf16 v[132:135], a[212:215], v[48:51], v[132:135]
s_waitcnt lgkmcnt(4)
v_mfma_f32_16x16x32_bf16 v[120:123], a[80:83], v[52:55], v[120:123]
v_mfma_f32_16x16x32_bf16 v[124:127], a[84:87], v[52:55], v[124:127]
ds_read_b128 v[40:43], v5 offset:24576
ds_read_b128 v[44:47], v9 offset:24576
s_waitcnt lgkmcnt(5)
v_mfma_f32_16x16x32_bf16 v[112:115], a[88:91], v[56:59], v[112:115]
v_mfma_f32_16x16x32_bf16 v[116:119], a[92:95], v[56:59], v[116:119]
v_mfma_f32_16x16x32_bf16 v[128:131], a[216:219], v[56:59], v[128:131]
v_mfma_f32_16x16x32_bf16 v[132:135], a[220:223], v[56:59], v[132:135]
s_waitcnt lgkmcnt(4)
v_mfma_f32_16x16x32_bf16 v[120:123], a[88:91], v[60:63], v[120:123]
v_mfma_f32_16x16x32_bf16 v[124:127], a[92:95], v[60:63], v[124:127]
ds_read_b128 v[48:51], v6 offset:24576
ds_read_b128 v[52:55], v10 offset:24576
s_waitcnt lgkmcnt(5)
v_mfma_f32_16x16x32_bf16 v[112:115], a[96:99], v[32:35], v[112:115]
v_mfma_f32_16x16x32_bf16 v[116:119], a[100:103], v[32:35], v[116:119]
v_mfma_f32_16x16x32_bf16 v[128:131], a[224:227], v[32:35], v[128:131]
v_mfma_f32_16x16x32_bf16 v[132:135], a[228:231], v[32:35], v[132:135]
s_waitcnt lgkmcnt(4)
v_mfma_f32_16x16x32_bf16 v[120:123], a[96:99], v[36:39], v[120:123]
v_mfma_f32_16x16x32_bf16 v[124:127], a[100:103], v[36:39], v[124:127]
ds_read_b128 v[56:59], v7 offset:24576
ds_read_b128 v[60:63], v11 offset:24576
s_waitcnt lgkmcnt(5)
v_mfma_f32_16x16x32_bf16 v[112:115], a[104:107], v[40:43], v[112:115]
v_mfma_f32_16x16x32_bf16 v[116:119], a[108:111], v[40:43], v[116:119]
v_mfma_f32_16x16x32_bf16 v[128:131], a[232:235], v[40:43], v[128:131]
v_mfma_f32_16x16x32_bf16 v[132:135], a[236:239], v[40:43], v[132:135]
s_waitcnt lgkmcnt(4)
v_mfma_f32_16x16x32_bf16 v[120:123], a[104:107], v[44:47], v[120:123]
v_mfma_f32_16x16x32_bf16 v[124:127], a[108:111], v[44:47], v[124:127]
s_waitcnt lgkmcnt(3)
v_mfma_f32_16x16x32_bf16 v[112:115], a[112:115], v[48:51], v[112:115]
v_mfma_f32_16x16x32_bf16 v[116:119], a[116:119], v[48:51], v[116:119]
v_mfma_f32_16x16x32_bf16 v[128:131], a[240:243], v[48:51], v[128:131]
v_mfma_f32_16x16x32_bf16 v[132:135], a[244:247], v[48:51], v[132:135]
s_waitcnt lgkmcnt(2)
v_mfma_f32_16x16x32_bf16 v[120:123], a[112:115], v[52:55], v[120:123]
v_mfma_f32_16x16x32_bf16 v[124:127], a[116:119], v[52:55], v[124:127]
s_waitcnt lgkmcnt(1)
v_mfma_f32_16x16x32_bf16 v[112:115], a[120:123], v[56:59], v[112:115]
v_mfma_f32_16x16x32_bf16 v[116:119], a[124:127], v[56:59], v[116:119]
v_mfma_f32_16x16x32_bf16 v[128:131], a[248:251], v[56:59], v[128:131]
v_mfma_f32_16x16x32_bf16 v[132:135], a[252:255], v[56:59], v[132:135]
s_waitcnt lgkmcnt(0)
v_mfma_f32_16x16x32_bf16 v[120:123], a[120:123], v[60:63], v[120:123]
v_mfma_f32_16x16x32_bf16 v[124:127], a[124:127], v[60:63], v[124:127]
s_mov_b32 s84, s30
s_mov_b32 s83, s76
s_add_u32 s30, s30, 262144
s_add_u32 s76, s76, 2048
s_add_u32 s38, s38, 1
s_branch L_qkv_p3_k_G
L_spin_136:
buffer_load_dword v26, v27, s[4:7], s77 offen sc1
s_waitcnt vmcnt(0)
buffer_store_dword v25, v24, s[4:7], s83 offen sc1
buffer_store_dword v25, v24, s[4:7], s89 offen sc1
L_spin2_140:
v_cmp_eq_u32 vcc, 0, v26
s_cbranch_vccz L_spin2_140o
s_sub_u32 s36, s36, 1
s_cbranch_scc1 L_end_qkv_G
buffer_load_dword v26, v27, s[4:7], s77 offen sc1
s_waitcnt vmcnt(0)
s_branch L_spin2_140
L_spin2_140o:
s_add_u32 m0, s78, 0
s_add_u32 s41, s28, 0
buffer_load_dwordx4 v30, s[4:7], s41 offen offset:0 sc1 lds
buffer_load_dwordx4 v31, s[4:7], s41 offen offset:1024 sc1 lds
s_add_u32 m0, s78, 8192
s_add_u32 s41, s28, 256
buffer_load_dwordx4 v30, s[4:7], s41 offen offset:0 sc1 lds
buffer_load_dwordx4 v31, s[4:7], s41 offen offset:1024 sc1 lds
s_add_u32 m0, s78, 16384
s_add_u32 s41, s28, 512
buffer_load_dwordx4 v30, s[4:7], s41 offen offset:0 sc1 lds
buffer_load_dwordx4 v31, s[4:7], s41 offen offset:1024 sc1 lds
s_add_u32 m0, s78, 24576
s_add_u32 s41, s28, 768
buffer_load_dwordx4 v30, s[4:7], s41 offen offset:0 sc1 lds
buffer_load_dwordx4 v31, s[4:7], s41 offen offset:1024 sc1 lds
s_waitcnt vmcnt(4)
s_branch L_go_137
L_qkv_v_G:
s_add_u32 m0, s79, 0
s_add_u32 s41, s39, 0
buffer_load_dwordx4 v30, s[4:7], s41 offen offset:0 sc1 lds
buffer_load_dwordx4 v31, s[4:7], s41 offen offset:1024 sc1 lds
s_add_u32 m0, s79, 8192
s_add_u32 s41, s39, 256
buffer_load_dwordx4 v30, s[4:7], s41 offen offset:0 sc1 lds
buffer_load_dwordx4 v31, s[4:7], s41 offen offset:1024 sc1 lds
s_add_u32 m0, s79, 16384
s_add_u32 s41, s39, 512
buffer_load_dwordx4 v30, s[4:7], s41 offen offset:0 sc1 lds
buffer_load_dwordx4 v31, s[4:7], s41 offen offset:1024 sc1 lds
s_add_u32 m0, s79, 24576
s_add_u32 s41, s39, 768
buffer_load_dwordx4 v30, s[4:7], s41 offen offset:0 sc1 lds
buffer_load_dwordx4 v31, s[4:7], s41 offen offset:1024 sc1 lds
s_add_u32 s39, s39, 32768
s_min_u32 s39, s39, s90
s_xor_b32 s79, s79, 32768
L_qkv_p1_v_G:
s_waitcnt vmcnt(0)
buffer_store_dword v25, v24, s[4:7], s82 offen sc1
s_barrier
ds_read_b128 v[32:35], v100 offset:0
ds_read_b128 v[36:39], v104 offset:0
ds_read_b128 v[40:43], v101 offset:0
ds_read_b128 v[44:47], v105 offset:0
ds_read_b128 v[48:51], v102 offset:0
ds_read_b128 v[52:55], v106 offset:0
s_waitcnt lgkmcnt(5)
v_mfma_f32_16x16x32_bf16 v[64:67], v[32:35], a[0:3], 0
s_add_u32 m0, s79, 0
s_add_u32 s41, s39, 0
v_mfma_f32_16x16x32_bf16 v[68:71], v[32:35], a[4:7], 0
buffer_load_dwordx4 v30, s[4:7], s41 offen offset:0 sc1 lds
v_mfma_f32_16x16x32_bf16 v[80:83], a[128:131], v[32:35], 0
v_mfma_f32_16x16x32_bf16 v[84:87], a[132:135], v[32:35], 0
s_waitcnt lgkmcnt(4)
v_mfma_f32_16x16x32_bf16 v[72:75], v[36:39], a[0:3], 0
v_mfma_f32_16x16x32_bf16 v[76:79], v[36:39], a[4:7], 0
ds_read_b128 v[56:59], v103 offset:0
ds_read_b128 v[60:63], v107 offset:0
s_waitcnt lgkmcnt(5)
v_mfma_f32_16x16x32_bf16 v[64:67], v[40:43], a[8:11], v[64:67]
buffer_load_dwordx4 v31, s[4:7], s41 offen offset:1024 sc1 lds
s_add_u32 m0, s79, 8192
v_mfma_f32_16x16x32_bf16 v[68:71], v[40:43], a[12:15], v[68:71]
s_add_u32 s41, s39, 256
v_mfma_f32_16x16x32_bf16 v[80:83], a[136:139], v[40:43], v[80:83]
v_mfma_f32_16x16x32_bf16 v[84:87], a[140:143], v[40:43], v[84:87]
s_waitcnt lgkmcnt(4)
v_mfma_f32_16x16x32_bf16 v[72:75], v[44:47], a[8:11], v[72:75]
v_mfma_f32_16x16x32_bf16 v[76:79], v[44:47], a[12:15], v[76:79]
ds_read_b128 v[32:35], v100 offset:8192
ds_read_b128 v[36:39], v104 offset:8192
s_waitcnt lgkmcnt(5)
v_mfma_f32_16x16x32_bf16 v[64:67], v[48:51], a[16:19], v[64:67]
buffer_load_dwordx4 v30, s[4:7], s41 offen offset:0 sc1 lds
v_mfma_f32_16x16x32_bf16 v[68:71], v[48:51], a[20:23], v[68:71]
v_mfma_f32_16x16x32_bf16 v[80:83], a[144:147], v[48:51], v[80:83]
v_mfma_f32_16x16x32_bf16 v[84:87], a[148:151], v[48:51], v[84:87]
s_waitcnt lgkmcnt(4)
v_mfma_f32_16x16x32_bf16 v[72:75], v[52:55], a[16:19], v[72:75]
v_mfma_f32_16x16x32_bf16 v[76:79], v[52:55], a[20:23], v[76:79]
ds_read_b128 v[40:43], v101 offset:8192
ds_read_b128 v[44:47], v105 offset:8192
s_waitcnt lgkmcnt(5)
v_mfma_f32_16x16x32_bf16 v[64:67], v[56:59], a[24:27], v[64:67]
buffer_load_dwordx4 v31, s[4:7], s41 offen offset:1024 sc1 lds
s_add_u32 m0, s79, 16384
v_mfma_f32_16x16x32_bf16 v[68:71], v[56:59], a[28:31], v[68:71]
s_add_u32 s41, s39, 512
v_mfma_f32_16x16x32_bf16 v[80:83], a[152:155], v[56:59], v[80:83]
v_mfma_f32_16x16x32_bf16 v[84:87], a[156:159], v[56:59], v[84:87]
s_waitcnt lgkmcnt(4)
v_mfma_f32_16x16x32_bf16 v[72:75], v[60:63], a[24:27], v[72:75]
v_mfma_f32_16x16x32_bf16 v[76:79], v[60:63], a[28:31], v[76:79]
ds_read_b128 v[48:51], v102 offset:8192
ds_read_b128 v[52:55], v106 offset:8192
s_waitcnt lgkmcnt(5)
v_mfma_f32_16x16x32_bf16 v[64:67], v[32:35], a[32:35], v[64:67]
buffer_load_dwordx4 v30, s[4:7], s41 offen offset:0 sc1 lds
v_mfma_f32_16x16x32_bf16 v[68:71], v[32:35], a[36:39], v[68:71]
v_mfma_f32_16x16x32_bf16 v[80:83], a[160:163], v[32:35], v[80:83]
v_mfma_f32_16x16x32_bf16 v[84:87], a[164:167], v[32:35], v[84:87]
s_waitcnt lgkmcnt(4)
v_mfma_f32_16x16x32_bf16 v[72:75], v[36:39], a[32:35], v[72:75]
v_mfma_f32_16x16x32_bf16 v[76:79], v[36:39], a[36:39], v[76:79]
ds_read_b128 v[56:59], v103 offset:8192
ds_read_b128 v[60:63], v107 offset:8192
s_waitcnt lgkmcnt(5)
v_mfma_f32_16x16x32_bf16 v[64:67], v[40:43], a[40:43], v[64:67]
buffer_load_dwordx4 v31, s[4:7], s41 offen offset:1024 sc1 lds
s_add_u32 m0, s79, 24576
v_mfma_f32_16x16x32_bf16 v[68:71], v[40:43], a[44:47], v[68:71]
s_add_u32 s41, s39, 768
v_mfma_f32_16x16x32_bf16 v[80:83], a[168:171], v[40:43], v[80:83]
v_mfma_f32_16x16x32_bf16 v[84:87], a[172:175], v[40:43], v[84:87]
s_waitcnt lgkmcnt(4)
v_mfma_f32_16x16x32_bf16 v[72:75], v[44:47], a[40:43], v[72:75]
v_mfma_f32_16x16x32_bf16 v[76:79], v[44:47], a[44:47], v[76:79]
ds_read_b128 v[32:35], v100 offset:16384
ds_read_b128 v[36:39], v104 offset:16384
s_waitcnt lgkmcnt(5)
v_mfma_f32_16x16x32_bf16 v[64:67], v[48:51], a[48:51], v[64:67]
buffer_load_dwordx4 v30, s[4:7], s41 offen offset:0 sc1 lds
v_mfma_f32_16x16x32_bf16 v[68:71], v[48:51], a[52:55], v[68:71]
v_mfma_f32_16x16x32_bf16 v[80:83], a[176:179], v[48:51], v[80:83]
v_mfma_f32_16x16x32_bf16 v[84:87], a[180:183], v[48:51], v[84:87]
s_waitcnt lgkmcnt(4)
v_mfma_f32_16x16x32_bf16 v[72:75], v[52:55], a[48:51], v[72:75]
v_mfma_f32_16x16x32_bf16 v[76:79], v[52:55], a[52:55], v[76:79]
ds_read_b128 v[40:43], v101 offset:16384
ds_read_b128 v[44:47], v105 offset:16384
s_waitcnt lgkmcnt(5)
v_mfma_f32_16x16x32_bf16 v[64:67], v[56:59], a[56:59], v[64:67]
buffer_load_dwordx4 v31, s[4:7], s41 offen offset:1024 sc1 lds
s_add_u32 s39, s39, 32768
v_mfma_f32_16x16x32_bf16 v[68:71], v[56:59], a[60:63], v[68:71]
s_min_u32 s39, s39, s90
s_xor_b32 s79, s79, 32768
v_mfma_f32_16x16x32_bf16 v[80:83], a[184:187], v[56:59], v[80:83]
v_mfma_f32_16x16x32_bf16 v[84:87], a[188:191], v[56:59], v[84:87]
s_waitcnt lgkmcnt(4)
v_mfma_f32_16x16x32_bf16 v[72:75], v[60:63], a[56:59], v[72:75]
v_mfma_f32_16x16x32_bf16 v[76:79], v[60:63], a[60:63], v[76:79]
ds_read_b128 v[48:51], v102 offset:16384
ds_read_b128 v[52:55], v106 offset:16384
s_waitcnt lgkmcnt(5)
v_mfma_f32_16x16x32_bf16 v[64:67], v[32:35], a[64:67], v[64:67]
v_mfma_f32_16x16x32_bf16 v[68:71], v[32:35], a[68:71], v[68:71]
v_mfma_f32_16x16x32_bf16 v[80:83], a[192:195], v[32:35], v[80:83]
v_mfma_f32_16x16x32_bf16 v[84:87], a[196:199], v[32:35], v[84:87]
s_waitcnt lgkmcnt(4)
v_mfma_f32_16x16x32_bf16 v[72:75], v[36:39], a[64:67], v[72:75]
v_mfma_f32_16x16x32_bf16 v[76:79], v[36:39], a[68:71], v[76:79]
ds_read_b128 v[56:59], v103 offset:16384
ds_read_b128 v[60:63], v107 offset:16384
s_waitcnt lgkmcnt(5)
v_mfma_f32_16x16x32_bf16 v[64:67], v[40:43], a[72:75], v[64:67]
v_mfma_f32_16x16x32_bf16 v[68:71], v[40:43], a[76:79], v[68:71]
v_mfma_f32_16x16x32_bf16 v[80:83], a[200:203], v[40:43], v[80:83]
v_mfma_f32_16x16x32_bf16 v[84:87], a[204:207], v[40:43], v[84:87]
s_waitcnt lgkmcnt(4)
v_mfma_f32_16x16x32_bf16 v[72:75], v[44:47], a[72:75], v[72:75]
v_mfma_f32_16x16x32_bf16 v[76:79], v[44:47], a[76:79], v[76:79]
ds_read_b128 v[32:35], v100 offset:24576
ds_read_b128 v[36:39], v104 offset:24576
s_waitcnt lgkmcnt(5)
v_mfma_f32_16x16x32_bf16 v[64:67], v[48:51], a[80:83], v[64:67]
v_mfma_f32_16x16x32_bf16 v[68:71], v[48:51], a[84:87], v[68:71]
v_mfma_f32_16x16x32_bf16 v[80:83], a[208:211], v[48:51], v[80:83]
v_mfma_f32_16x16x32_bf16 v[84:87], a[212:215], v[48:51], v[84:87]
s_waitcnt lgkmcnt(4)
v_mfma_f32_16x16x32_bf16 v[72:75], v[52:55], a[80:83], v[72:75]
v_mfma_f32_16x16x32_bf16 v[76:79], v[52:55], a[84:87], v[76:79]
ds_read_b128 v[40:43], v101 offset:24576
ds_read_b128 v[44:47], v105 offset:24576
s_waitcnt lgkmcnt(5)
v_mfma_f32_16x16x32_bf16 v[64:67], v[56:59], a[88:91], v[64:67]
v_mfma_f32_16x16x32_bf16 v[68:71], v[56:59], a[92:95], v[68:71]
v_mfma_f32_16x16x32_bf16 v[80:83], a[216:219], v[56:59], v[80:83]
v_mfma_f32_16x16x32_bf16 v[84:87], a[220:223], v[56:59], v[84:87]
s_waitcnt lgkmcnt(4)
v_mfma_f32_16x16x32_bf16 v[72:75], v[60:63], a[88:91], v[72:75]
v_mfma_f32_16x16x32_bf16 v[76:79], v[60:63], a[92:95], v[76:79]
ds_read_b128 v[48:51], v102 offset:24576
ds_read_b128 v[52:55], v106 offset:24576
s_waitcnt lgkmcnt(5)
v_mfma_f32_16x16x32_bf16 v[64:67], v[32:35], a[96:99], v[64:67]
v_mfma_f32_16x16x32_bf16 v[68:71], v[32:35], a[100:103], v[68:71]
v_mfma_f32_16x16x32_bf16 v[80:83], a[224:227], v[32:35], v[80:83]
v_mfma_f32_16x16x32_bf16 v[84:87], a[228:231], v[32:35], v[84:87]
s_waitcnt lgkmcnt(4)
v_mfma_f32_16x16x32_bf16 v[72:75], v[36:39], a[96:99], v[72:75]
v_mfma_f32_16x16x32_bf16 v[76:79], v[36:39], a[100:103], v[76:79]
ds_read_b128 v[56:59], v103 offset:24576
ds_read_b128 v[60:63], v107 offset:24576
s_waitcnt lgkmcnt(5)
v_mfma_f32_16x16x32_bf16 v[64:67], v[40:43], a[104:107], v[64:67]
v_mfma_f32_16x16x32_bf16 v[68:71], v[40:43], a[108:111], v[68:71]
v_mfma_f32_16x16x32_bf16 v[80:83], a[232:235], v[40:43], v[80:83]
v_mfma_f32_16x16x32_bf16 v[84:87], a[236:239], v[40:43], v[84:87]
s_waitcnt lgkmcnt(4)
v_mfma_f32_16x16x32_bf16 v[72:75], v[44:47], a[104:107], v[72:75]
v_mfma_f32_16x16x32_bf16 v[76:79], v[44:47], a[108:111], v[76:79]
s_waitcnt lgkmcnt(3)
v_mfma_f32_16x16x32_bf16 v[64:67], v[48:51], a[112:115], v[64:67]
v_mfma_f32_16x16x32_bf16 v[68:71], v[48:51], a[116:119], v[68:71]
v_mfma_f32_16x16x32_bf16 v[80:83], a[240:243], v[48:51], v[80:83]
v_mfma_f32_16x16x32_bf16 v[84:87], a[244:247], v[48:51], v[84:87]
s_waitcnt lgkmcnt(2)
v_mfma_f32_16x16x32_bf16 v[72:75], v[52:55], a[112:115], v[72:75]
v_mfma_f32_16x16x32_bf16 v[76:79], v[52:55], a[116:119], v[76:79]
s_waitcnt lgkmcnt(1)
v_mfma_f32_16x16x32_bf16 v[64:67], v[56:59], a[120:123], v[64:67]
v_mfma_f32_16x16x32_bf16 v[68:71], v[56:59], a[124:127], v[68:71]
v_mfma_f32_16x16x32_bf16 v[80:83], a[248:251], v[56:59], v[80:83]
v_mfma_f32_16x16x32_bf16 v[84:87], a[252:255], v[56:59], v[84:87]
s_waitcnt lgkmcnt(0)
v_mfma_f32_16x16x32_bf16 v[72:75], v[60:63], a[120:123], v[72:75]
v_mfma_f32_16x16x32_bf16 v[76:79], v[60:63], a[124:127], v[76:79]
s_nop 4
v_cvt_pk_bf16_f32 v96, v80, v84
v_cvt_pk_bf16_f32 v97, v81, v85
v_cvt_pk_bf16_f32 v98, v82, v86
v_cvt_pk_bf16_f32 v99, v83, v87
v_cvt_pk_bf16_f32 v88, v64, v72
v_cvt_pk_bf16_f32 v89, v65, v73
v_cvt_pk_bf16_f32 v90, v66, v74
v_cvt_pk_bf16_f32 v91, v67, v75
v_cvt_pk_bf16_f32 v92, v68, v76
v_cvt_pk_bf16_f32 v93, v69, v77
v_cvt_pk_bf16_f32 v94, v70, v78
v_cvt_pk_bf16_f32 v95, v71, v79
v_alignbit_b32 v88, v88, v88, s85
v_alignbit_b32 v89, v89, v89, s85
v_alignbit_b32 v90, v90, v90, s85
v_alignbit_b32 v91, v91, v91, s85
v_alignbit_b32 v92, v92, v92, s85
v_alignbit_b32 v93, v93, v93, s85
v_alignbit_b32 v94, v94, v94, s85
v_alignbit_b32 v95, v95, v95, s85
s_add_u32 s40, s29, s81
buffer_store_dwordx4 v[96:99], v28, s[4:7], s40 offen sc1
buffer_store_dwordx4 v[88:91], v2, s[4:7], s29 offen offset:0 sc1
buffer_store_dwordx4 v[92:95], v2, s[4:7], s29 offen offset:1024 sc1
v_xor_b32 v100, 32768, v100
v_xor_b32 v101, 32768, v101
v_xor_b32 v102, 32768, v102
v_xor_b32 v103, 32768, v103
v_xor_b32 v104, 32768, v104
v_xor_b32 v105, 32768, v105
v_xor_b32 v106, 32768, v106
v_xor_b32 v107, 32768, v107
s_mov_b32 s82, s31
s_add_u32 s29, s29, 262144
s_add_u32 s31, s31, 2048
s_add_u32 s38, s38, 1
s_cmp_lt_u32 s38, 14
s_cbranch_scc1 L_qkv_p1_v_G
buffer_load_dword v26, v27, s[4:7], s77 offen sc1
s_waitcnt vmcnt(0)
buffer_store_dword v25, v24, s[4:7], s82 offen sc1
s_barrier
s_add_u32 m0, s79, 0
s_add_u32 s41, s39, 0
buffer_load_dwordx4 v30, s[4:7], s41 offen offset:0 sc1 lds
buffer_load_dwordx4 v31, s[4:7], s41 offen offset:1024 sc1 lds
s_add_u32 m0, s79, 8192
s_add_u32 s41, s39, 256
buffer_load_dwordx4 v30, s[4:7], s41 offen offset:0 sc1 lds
buffer_load_dwordx4 v31, s[4:7], s41 offen offset:1024 sc1 lds
s_add_u32 m0, s79, 16384
s_add_u32 s41, s39, 512
buffer_load_dwordx4 v30, s[4:7], s41 offen offset:0 sc1 lds
buffer_load_dwordx4 v31, s[4:7], s41 offen offset:1024 sc1 lds
s_add_u32 m0, s79, 24576
s_add_u32 s41, s39, 768
buffer_load_dwordx4 v30, s[4:7], s41 offen offset:0 sc1 lds
buffer_load_dwordx4 v31, s[4:7], s41 offen offset:1024 sc1 lds
s_add_u32 s39, s39, 32768
s_min_u32 s39, s39, s90
s_xor_b32 s79, s79, 32768
s_mov_b32 s88, s84
s_mov_b32 s89, s83
ds_read_b128 v[32:35], v100 offset:0
ds_read_b128 v[36:39], v104 offset:0
ds_read_b128 v[40:43], v101 offset:0
ds_read_b128 v[44:47], v105 offset:0
L_qkv_loop_v_G:
s_waitcnt vmcnt(8)
v_cmp_eq_u32 s[86:87], 0, v26
ds_read_b128 v[48:51], v102 offset:0
ds_read_b128 v[52:55], v106 offset:0
s_waitcnt lgkmcnt(5)
v_mfma_f32_16x16x32_bf16 v[64:67], v[32:35], a[0:3], 0
s_add_u32 m0, s78, 0
s_add_u32 s41, s28, 0
v_cvt_pk_bf16_f32 v144, v128, v132
v_mfma_f32_16x16x32_bf16 v[68:71], v[32:35], a[4:7], 0
buffer_load_dwordx4 v30, s[4:7], s41 offen offset:0 sc1 lds
v_cvt_pk_bf16_f32 v145, v129, v133
v_mfma_f32_16x16x32_bf16 v[80:83], a[128:131], v[32:35], 0
v_cvt_pk_bf16_f32 v146, v130, v134
v_cvt_pk_bf16_f32 v147, v131, v135
v_mfma_f32_16x16x32_bf16 v[84:87], a[132:135], v[32:35], 0
v_cvt_pk_bf16_f32 v136, v112, v120
v_cvt_pk_bf16_f32 v137, v113, v121
s_waitcnt lgkmcnt(4)
v_mfma_f32_16x16x32_bf16 v[72:75], v[36:39], a[0:3], 0
v_cvt_pk_bf16_f32 v138, v114, v122
v_cvt_pk_bf16_f32 v139, v115, v123
v_mfma_f32_16x16x32_bf16 v[76:79], v[36:39], a[4:7], 0
ds_read_b128 v[56:59], v103 offset:0
ds_read_b128 v[60:63], v107 offset:0
s_waitcnt lgkmcnt(5)
v_mfma_f32_16x16x32_bf16 v[64:67], v[40:43], a[8:11], v[64:67]
buffer_load_dwordx4 v31, s[4:7], s41 offen offset:1024 sc1 lds
s_add_u32 m0, s78, 8192
v_mfma_f32_16x16x32_bf16 v[68:71], v[40:43], a[12:15], v[68:71]
s_add_u32 s41, s28, 256
v_cvt_pk_bf16_f32 v140, v116, v124
v_cvt_pk_bf16_f32 v141, v117, v125
v_mfma_f32_16x16x32_bf16 v[80:83], a[136:139], v[40:43], v[80:83]
v_cvt_pk_bf16_f32 v142, v118, v126
v_cvt_pk_bf16_f32 v143, v119, v127
v_mfma_f32_16x16x32_bf16 v[84:87], a[140:143], v[40:43], v[84:87]
v_alignbit_b32 v136, v136, v136, s85
v_alignbit_b32 v137, v137, v137, s85
s_waitcnt lgkmcnt(4)
v_mfma_f32_16x16x32_bf16 v[72:75], v[44:47], a[8:11], v[72:75]
buffer_load_dwordx4 v30, s[4:7], s41 offen offset:0 sc1 lds
v_alignbit_b32 v138, v138, v138, s85
v_mfma_f32_16x16x32_bf16 v[76:79], v[44:47], a[12:15], v[76:79]
ds_read_b128 v[32:35], v100 offset:8192
ds_read_b128 v[36:39], v104 offset:8192
s_waitcnt lgkmcnt(5)
v_mfma_f32_16x16x32_bf16 v[64:67], v[48:51], a[16:19], v[64:67]
v_alignbit_b32 v139, v139, v139, s85
v_alignbit_b32 v140, v140, v140, s85
v_mfma_f32_16x16x32_bf16 v[68:71], v[48:51], a[20:23], v[68:71]
v_alignbit_b32 v141, v141, v141, s85
v_alignbit_b32 v142, v142, v142, s85
v_mfma_f32_16x16x32_bf16 v[80:83], a[144:147], v[48:51], v[80:83]
buffer_load_dwordx4 v31, s[4:7], s41 offen offset:1024 sc1 lds
v_alignbit_b32 v143, v143, v143, s85
v_mfma_f32_16x16x32_bf16 v[84:87], a[148:151], v[48:51], v[84:87]
s_waitcnt lgkmcnt(4)
v_mfma_f32_16x16x32_bf16 v[72:75], v[52:55], a[16:19], v[72:75]
v_mfma_f32_16x16x32_bf16 v[76:79], v[52:55], a[20:23], v[76:79]
s_barrier
ds_read_b128 v[40:43], v101 offset:8192
ds_read_b128 v[44:47], v105 offset:8192
s_waitcnt lgkmcnt(5)
v_mfma_f32_16x16x32_bf16 v[64:67], v[56:59], a[24:27], v[64:67]
s_add_u32 s40, s84, s81
v_mfma_f32_16x16x32_bf16 v[68:71], v[56:59], a[28:31], v[68:71]
buffer_store_dwordx4 v[144:147], v28, s[4:7], s40 offen sc1
v_mfma_f32_16x16x32_bf16 v[80:83], a[152:155], v[56:59], v[80:83]
v_mfma_f32_16x16x32_bf16 v[84:87], a[156:159], v[56:59], v[84:87]
s_waitcnt lgkmcnt(4)
v_mfma_f32_16x16x32_bf16 v[72:75], v[60:63], a[24:27], v[72:75]
v_mfma_f32_16x16x32_bf16 v[76:79], v[60:63], a[28:31], v[76:79]
ds_read_b128 v[48:51], v102 offset:8192
ds_read_b128 v[52:55], v106 offset:8192
s_waitcnt lgkmcnt(5)
v_mfma_f32_16x16x32_bf16 v[64:67], v[32:35], a[32:35], v[64:67]
buffer_store_dwordx4 v[136:139], v2, s[4:7], s84 offen offset:0 sc1
v_mfma_f32_16x16x32_bf16 v[68:71], v[32:35], a[36:39], v[68:71]
v_mfma_f32_16x16x32_bf16 v[80:83], a[160:163], v[32:35], v[80:83]
v_mfma_f32_16x16x32_bf16 v[84:87], a[164:167], v[32:35], v[84:87]
s_waitcnt lgkmcnt(4)
v_mfma_f32_16x16x32_bf16 v[72:75], v[36:39], a[32:35], v[72:75]
v_mfma_f32_16x16x32_bf16 v[76:79], v[36:39], a[36:39], v[76:79]
ds_read_b128 v[56:59], v103 offset:8192
ds_read_b128 v[60:63], v107 offset:8192
s_waitcnt lgkmcnt(5)
v_mfma_f32_16x16x32_bf16 v[64:67], v[40:43], a[40:43], v[64:67]
buffer_store_dwordx4 v[140:143], v2, s[4:7], s84 offen offset:1024 sc1
v_mfma_f32_16x16x32_bf16 v[68:71], v[40:43], a[44:47], v[68:71]
s_add_u32 m0, s78, 16384
s_add_u32 s41, s28, 512
v_mfma_f32_16x16x32_bf16 v[80:83], a[168:171], v[40:43], v[80:83]
v_mfma_f32_16x16x32_bf16 v[84:87], a[172:175], v[40:43], v[84:87]
s_waitcnt lgkmcnt(4)
v_mfma_f32_16x16x32_bf16 v[72:75], v[44:47], a[40:43], v[72:75]
v_mfma_f32_16x16x32_bf16 v[76:79], v[44:47], a[44:47], v[76:79]
ds_read_b128 v[32:35], v100 offset:16384
ds_read_b128 v[36:39], v104 offset:16384
s_waitcnt lgkmcnt(5)
v_mfma_f32_16x16x32_bf16 v[64:67], v[48:51], a[48:51], v[64:67]
buffer_load_dwordx4 v30, s[4:7], s41 offen offset:0 sc1 lds
v_mfma_f32_16x16x32_bf16 v[68:71], v[48:51], a[52:55], v[68:71]
v_mfma_f32_16x16x32_bf16 v[80:83], a[176:179], v[48:51], v[80:83]
v_mfma_f32_16x16x32_bf16 v[84:87], a[180:183], v[48:51], v[84:87]
s_waitcnt lgkmcnt(4)
v_mfma_f32_16x16x32_bf16 v[72:75], v[52:55], a[48:51], v[72:75]
v_mfma_f32_16x16x32_bf16 v[76:79], v[52:55], a[52:55], v[76:79]
ds_read_b128 v[40:43], v101 offset:16384
ds_read_b128 v[44:47], v105 offset:16384
s_waitcnt lgkmcnt(5)
v_mfma_f32_16x16x32_bf16 v[64:67], v[56:59], a[56:59], v[64:67]
buffer_load_dwordx4 v31, s[4:7], s41 offen offset:1024 sc1 lds
s_add_u32 m0, s78, 24576
v_mfma_f32_16x16x32_bf16 v[68:71], v[56:59], a[60:63], v[68:71]
s_add_u32 s41, s28, 768
v_mfma_f32_16x16x32_bf16 v[80:83], a[184:187], v[56:59], v[80:83]
v_mfma_f32_16x16x32_bf16 v[84:87], a[188:191], v[56:59], v[84:87]
s_waitcnt lgkmcnt(4)
v_mfma_f32_16x16x32_bf16 v[72:75], v[60:63], a[56:59], v[72:75]
v_mfma_f32_16x16x32_bf16 v[76:79], v[60:63], a[60:63], v[76:79]
ds_read_b128 v[48:51], v102 offset:16384
ds_read_b128 v[52:55], v106 offset:16384
s_waitcnt lgkmcnt(5)
v_mfma_f32_16x16x32_bf16 v[64:67], v[32:35], a[64:67], v[64:67]
buffer_load_dwordx4 v30, s[4:7], s41 offen offset:0 sc1 lds
v_mfma_f32_16x16x32_bf16 v[68:71], v[32:35], a[68:71], v[68:71]
v_mfma_f32_16x16x32_bf16 v[80:83], a[192:195], v[32:35], v[80:83]
v_mfma_f32_16x16x32_bf16 v[84:87], a[196:199], v[32:35], v[84:87]
s_waitcnt lgkmcnt(4)
v_mfma_f32_16x16x32_bf16 v[72:75], v[36:39], a[64:67], v[72:75]
v_mfma_f32_16x16x32_bf16 v[76:79], v[36:39], a[68:71], v[76:79]
ds_read_b128 v[56:59], v103 offset:16384
ds_read_b128 v[60:63], v107 offset:16384
s_waitcnt lgkmcnt(5)
v_mfma_f32_16x16x32_bf16 v[64:67], v[40:43], a[72:75], v[64:67]
buffer_load_dwordx4 v31, s[4:7], s41 offen offset:1024 sc1 lds
s_add_u32 s40, s88, s81
v_mfma_f32_16x16x32_bf16 v[68:71], v[40:43], a[76:79], v[68:71]
v_mfma_f32_16x16x32_bf16 v[80:83], a[200:203], v[40:43], v[80:83]
v_mfma_f32_16x16x32_bf16 v[84:87], a[204:207], v[40:43], v[84:87]
s_waitcnt lgkmcnt(4)
v_mfma_f32_16x16x32_bf16 v[72:75], v[44:47], a[72:75], v[72:75]
v_mfma_f32_16x16x32_bf16 v[76:79], v[44:47], a[76:79], v[76:79]
ds_read_b128 v[32:35], v100 offset:24576
ds_read_b128 v[36:39], v104 offset:24576
s_waitcnt lgkmcnt(5)
v_mfma_f32_16x16x32_bf16 v[64:67], v[48:51], a[80:83], v[64:67]
buffer_store_dwordx4 v[96:99], v28, s[4:7], s40 offen sc1
v_mfma_f32_16x16x32_bf16 v[68:71], v[48:51], a[84:87], v[68:71]
v_mfma_f32_16x16x32_bf16 v[80:83], a[208:211], v[48:51], v[80:83]
v_mfma_f32_16x16x32_bf16 v[84:87], a[212:215], v[48:51], v[84:87]
s_waitcnt lgkmcnt(4)
v_mfma_f32_16x16x32_bf16 v[72:75], v[52:55], a[80:83], v[72:75]
v_mfma_f32_16x16x32_bf16 v[76:79], v[52:55], a[84:87], v[76:79]
ds_read_b128 v[40:43], v101 offset:24576
ds_read_b128 v[44:47], v105 offset:24576
s_waitcnt lgkmcnt(5)
v_mfma_f32_16x16x32_bf16 v[64:67], v[56:59], a[88:91], v[64:67]
buffer_store_dwordx4 v[88:91], v2, s[4:7], s88 offen offset:0 sc1
v_mfma_f32_16x16x32_bf16 v[68:71], v[56:59], a[92:95], v[68:71]
v_mfma_f32_16x16x32_bf16 v[80:83], a[216:219], v[56:59], v[80:83]
v_mfma_f32_16x16x32_bf16 v[84:87], a[220:223], v[56:59], v[84:87]
s_waitcnt lgkmcnt(4)
v_mfma_f32_16x16x32_bf16 v[72:75], v[60:63], a[88:91], v[72:75]
v_mfma_f32_16x16x32_bf16 v[76:79], v[60:63], a[92:95], v[76:79]
ds_read_b128 v[48:51], v102 offset:24576
ds_read_b128 v[52:55], v106 offset:24576
s_waitcnt lgkmcnt(5)
v_mfma_f32_16x16x32_bf16 v[64:67], v[32:35], a[96:99], v[64:67]
buffer_store_dwordx4 v[92:95], v2, s[4:7], s88 offen offset:1024 sc1
v_mfma_f32_16x16x32_bf16 v[68:71], v[32:35], a[100:103], v[68:71]
v_mfma_f32_16x16x32_bf16 v[80:83], a[224:227], v[32:35], v[80:83]
v_mfma_f32_16x16x32_bf16 v[84:87], a[228:231], v[32:35], v[84:87]
s_waitcnt lgkmcnt(4)
v_mfma_f32_16x16x32_bf16 v[72:75], v[36:39], a[96:99], v[72:75]
v_mfma_f32_16x16x32_bf16 v[76:79], v[36:39], a[100:103], v[76:79]
ds_read_b128 v[56:59], v103 offset:24576
ds_read_b128 v[60:63], v107 offset:24576
s_waitcnt lgkmcnt(5)
v_mfma_f32_16x16x32_bf16 v[64:67], v[40:43], a[104:107], v[64:67]
v_mfma_f32_16x16x32_bf16 v[68:71], v[40:43], a[108:111], v[68:71]
v_mfma_f32_16x16x32_bf16 v[80:83], a[232:235], v[40:43], v[80:83]
v_mfma_f32_16x16x32_bf16 v[84:87], a[236:239], v[40:43], v[84:87]
s_waitcnt lgkmcnt(4)
v_mfma_f32_16x16x32_bf16 v[72:75], v[44:47], a[104:107], v[72:75]
v_mfma_f32_16x16x32_bf16 v[76:79], v[44:47], a[108:111], v[76:79]
s_cmp_lg_u32 s86, 0
s_cbranch_scc1 L_spin_141
L_go_142:
s_waitcnt vmcnt(7)
s_barrier
buffer_store_dword v25, v24, s[4:7], s83 offen sc1
s_add_u32 s28, s28, 32768
s_add_u32 s77, s77, 512
ds_read_b128 v[32:35], v4 offset:0
ds_read_b128 v[36:39], v8 offset:0
s_waitcnt lgkmcnt(5)
v_mfma_f32_16x16x32_bf16 v[64:67], v[48:51], a[112:115], v[64:67]
v_mfma_f32_16x16x32_bf16 v[68:71], v[48:51], a[116:119], v[68:71]
v_mfma_f32_16x16x32_bf16 v[80:83], a[240:243], v[48:51], v[80:83]
v_mfma_f32_16x16x32_bf16 v[84:87], a[244:247], v[48:51], v[84:87]
s_waitcnt lgkmcnt(4)
v_mfma_f32_16x16x32_bf16 v[72:75], v[52:55], a[112:115], v[72:75]
v_mfma_f32_16x16x32_bf16 v[76:79], v[52:55], a[116:119], v[76:79]
ds_read_b128 v[40:43], v5 offset:0
ds_read_b128 v[44:47], v9 offset:0
s_waitcnt lgkmcnt(5)
v_mfma_f32_16x16x32_bf16 v[64:67], v[56:59], a[120:123], v[64:67]
v_mfma_f32_16x16x32_bf16 v[68:71], v[56:59], a[124:127], v[68:71]
v_mfma_f32_16x16x32_bf16 v[80:83], a[248:251], v[56:59], v[80:83]
v_mfma_f32_16x16x32_bf16 v[84:87], a[252:255], v[56:59], v[84:87]
s_waitcnt lgkmcnt(4)
v_mfma_f32_16x16x32_bf16 v[72:75], v[60:63], a[120:123], v[72:75]
v_mfma_f32_16x16x32_bf16 v[76:79], v[60:63], a[124:127], v[76:79]
ds_read_b128 v[48:51], v6 offset:0
ds_read_b128 v[52:55], v10 offset:0
s_waitcnt lgkmcnt(5)
v_mfma_f32_16x16x32_bf16 v[112:115], v[32:35], a[0:3], 0
v_mfma_f32_16x16x32_bf16 v[116:119], v[32:35], a[4:7], 0
v_mfma_f32_16x16x32_bf16 v[128:131], a[128:131], v[32:35], 0
v_mfma_f32_16x16x32_bf16 v[132:135], a[132:135], v[32:35], 0
s_waitcnt lgkmcnt(4)
v_mfma_f32_16x16x32_bf16 v[120:123], v[36:39], a[0:3], 0
v_mfma_f32_16x16x32_bf16 v[124:127], v[36:39], a[4:7], 0
ds_read_b128 v[56:59], v7 offset:0
ds_read_b128 v[60:63], v11 offset:0
s_waitcnt lgkmcnt(5)
v_mfma_f32_16x16x32_bf16 v[112:115], v[40:43], a[8:11], v[112:115]
v_mfma_f32_16x16x32_bf16 v[116:119], v[40:43], a[12:15], v[116:119]
v_mfma_f32_16x16x32_bf16 v[128:131], a[136:139], v[40:43], v[128:131]
v_mfma_f32_16x16x32_bf16 v[132:135], a[140:143], v[40:43], v[132:135]
s_waitcnt lgkmcnt(4)
v_mfma_f32_16x16x32_bf16 v[120:123], v[44:47], a[8:11], v[120:123]
v_mfma_f32_16x16x32_bf16 v[124:127], v[44:47], a[12:15], v[124:127]
ds_read_b128 v[32:35], v4 offset:8192
ds_read_b128 v[36:39], v8 offset:8192
s_waitcnt lgkmcnt(5)
v_mfma_f32_16x16x32_bf16 v[112:115], v[48:51], a[16:19], v[112:115]
v_cvt_pk_bf16_f32 v96, v80, v84
v_cvt_pk_bf16_f32 v97, v81, v85
v_mfma_f32_16x16x32_bf16 v[116:119], v[48:51], a[20:23], v[116:119]
v_cvt_pk_bf16_f32 v98, v82, v86
v_cvt_pk_bf16_f32 v99, v83, v87
v_mfma_f32_16x16x32_bf16 v[128:131], a[144:147], v[48:51], v[128:131]
v_cvt_pk_bf16_f32 v88, v64, v72
v_cvt_pk_bf16_f32 v89, v65, v73
v_mfma_f32_16x16x32_bf16 v[132:135], a[148:151], v[48:51], v[132:135]
v_cvt_pk_bf16_f32 v90, v66, v74
v_cvt_pk_bf16_f32 v91, v67, v75
s_waitcnt lgkmcnt(4)
v_mfma_f32_16x16x32_bf16 v[120:123], v[52:55], a[16:19], v[120:123]
v_cvt_pk_bf16_f32 v92, v68, v76
v_cvt_pk_bf16_f32 v93, v69, v77
v_mfma_f32_16x16x32_bf16 v[124:127], v[52:55], a[20:23], v[124:127]
ds_read_b128 v[40:43], v5 offset:8192
ds_read_b128 v[44:47], v9 offset:8192
s_waitcnt lgkmcnt(5)
v_mfma_f32_16x16x32_bf16 v[112:115], v[56:59], a[24:27], v[112:115]
v_cvt_pk_bf16_f32 v94, v70, v78
v_cvt_pk_bf16_f32 v95, v71, v79
v_mfma_f32_16x16x32_bf16 v[116:119], v[56:59], a[28:31], v[116:119]
v_alignbit_b32 v88, v88, v88, s85
v_alignbit_b32 v89, v89, v89, s85
v_mfma_f32_16x16x32_bf16 v[128:131], a[152:155], v[56:59], v[128:131]
v_alignbit_b32 v90, v90, v90, s85
v_alignbit_b32 v91, v91, v91, s85
v_mfma_f32_16x16x32_bf16 v[132:135], a[156:159], v[56:59], v[132:135]
v_alignbit_b32 v92, v92, v92, s85
v_alignbit_b32 v93, v93, v93, s85
s_waitcnt lgkmcnt(4)
v_mfma_f32_16x16x32_bf16 v[120:123], v[60:63], a[24:27], v[120:123]
v_alignbit_b32 v94, v94, v94, s85
v_alignbit_b32 v95, v95, v95, s85
v_mfma_f32_16x16x32_bf16 v[124:127], v[60:63], a[28:31], v[124:127]
buffer_load_dword v26, v27, s[4:7], s77 offen sc1
ds_read_b128 v[48:51], v6 offset:8192
ds_read_b128 v[52:55], v10 offset:8192
s_waitcnt lgkmcnt(5)
v_mfma_f32_16x16x32_bf16 v[112:115], v[32:35], a[32:35], v[112:115]
v_xor_b32 v100, 32768, v100
v_xor_b32 v101, 32768, v101
v_mfma_f32_16x16x32_bf16 v[116:119], v[32:35], a[36:39], v[116:119]
v_xor_b32 v102, 32768, v102
v_xor_b32 v103, 32768, v103
v_mfma_f32_16x16x32_bf16 v[128:131], a[160:163], v[32:35], v[128:131]
v_xor_b32 v104, 32768, v104
v_xor_b32 v105, 32768, v105
v_mfma_f32_16x16x32_bf16 v[132:135], a[164:167], v[32:35], v[132:135]
v_xor_b32 v106, 32768, v106
v_xor_b32 v107, 32768, v107
s_waitcnt lgkmcnt(4)
v_mfma_f32_16x16x32_bf16 v[120:123], v[36:39], a[32:35], v[120:123]
s_mov_b32 s88, s29
s_mov_b32 s82, s31
s_add_u32 s29, s29, 262144
v_mfma_f32_16x16x32_bf16 v[124:127], v[36:39], a[36:39], v[124:127]
ds_read_b128 v[56:59], v7 offset:8192
ds_read_b128 v[60:63], v11 offset:8192
s_waitcnt lgkmcnt(5)
v_mfma_f32_16x16x32_bf16 v[112:115], v[40:43], a[40:43], v[112:115]
s_add_u32 s31, s31, 2048
v_mfma_f32_16x16x32_bf16 v[116:119], v[40:43], a[44:47], v[116:119]
v_mfma_f32_16x16x32_bf16 v[128:131], a[168:171], v[40:43], v[128:131]
v_mfma_f32_16x16x32_bf16 v[132:135], a[172:175], v[40:43], v[132:135]
s_waitcnt lgkmcnt(4)
v_mfma_f32_16x16x32_bf16 v[120:123], v[44:47], a[40:43], v[120:123]
v_mfma_f32_16x16x32_bf16 v[124:127], v[44:47], a[44:47], v[124:127]
s_waitcnt vmcnt(2)
s_barrier
buffer_store_dword v25, v24, s[4:7], s89 offen sc1
s_mov_b32 s89, s82
ds_read_b128 v[32:35], v4 offset:16384
ds_read_b128 v[36:39], v8 offset:16384
s_waitcnt lgkmcnt(5)
v_mfma_f32_16x16x32_bf16 v[112:115], v[48:51], a[48:51], v[112:115]
s_add_u32 m0, s79, 0
s_add_u32 s41, s39, 0
v_mfma_f32_16x16x32_bf16 v[116:119], v[48:51], a[52:55], v[116:119]
buffer_load_dwordx4 v30, s[4:7], s41 offen offset:0 sc1 lds
v_mfma_f32_16x16x32_bf16 v[128:131], a[176:179], v[48:51], v[128:131]
v_mfma_f32_16x16x32_bf16 v[132:135], a[180:183], v[48:51], v[132:135]
s_waitcnt lgkmcnt(4)
v_mfma_f32_16x16x32_bf16 v[120:123], v[52:55], a[48:51], v[120:123]
v_mfma_f32_16x16x32_bf16 v[124:127], v[52:55], a[52:55], v[124:127]
ds_read_b128 v[40:43], v5 offset:16384
ds_read_b128 v[44:47], v9 offset:16384
s_waitcnt lgkmcnt(5)
v_mfma_f32_16x16x32_bf16 v[112:115], v[56:59], a[56:59], v[112:115]
buffer_load_dwordx4 v31, s[4:7], s41 offen offset:1024 sc1 lds
s_add_u32 m0, s79, 8192
v_mfma_f32_16x16x32_bf16 v[116:119], v[56:59], a[60:63], v[116:119]
s_add_u32 s41, s39, 256
v_mfma_f32_16x16x32_bf16 v[128:131], a[184:187], v[56:59], v[128:131]
v_mfma_f32_16x16x32_bf16 v[132:135], a[188:191], v[56:59], v[132:135]
s_waitcnt lgkmcnt(4)
v_mfma_f32_16x16x32_bf16 v[120:123], v[60:63], a[56:59], v[120:123]
v_mfma_f32_16x16x32_bf16 v[124:127], v[60:63], a[60:63], v[124:127]
ds_read_b128 v[48:51], v6 offset:16384
ds_read_b128 v[52:55], v10 offset:16384
s_waitcnt lgkmcnt(5)
v_mfma_f32_16x16x32_bf16 v[112:115], v[32:35], a[64:67], v[112:115]
buffer_load_dwordx4 v30, s[4:7], s41 offen offset:0 sc1 lds
v_mfma_f32_16x16x32_bf16 v[116:119], v[32:35], a[68:71], v[116:119]
v_mfma_f32_16x16x32_bf16 v[128:131], a[192:195], v[32:35], v[128:131]
v_mfma_f32_16x16x32_bf16 v[132:135], a[196:199], v[32:35], v[132:135]
s_waitcnt lgkmcnt(4)
v_mfma_f32_16x16x32_bf16 v[120:123], v[36:39], a[64:67], v[120:123]
v_mfma_f32_16x16x32_bf16 v[124:127], v[36:39], a[68:71], v[124:127]
ds_read_b128 v[56:59], v7 offset:16384
ds_read_b128 v[60:63], v11 offset:16384
s_waitcnt lgkmcnt(5)
v_mfma_f32_16x16x32_bf16 v[112:115], v[40:43], a[72:75], v[112:115]
buffer_load_dwordx4 v31, s[4:7], s41 offen offset:1024 sc1 lds
s_add_u32 m0, s79, 16384
v_mfma_f32_16x16x32_bf16 v[116:119], v[40:43], a[76:79], v[116:119]
s_add_u32 s41, s39, 512
v_mfma_f32_16x16x32_bf16 v[128:131], a[200:203], v[40:43], v[128:131]
v_mfma_f32_16x16x32_bf16 v[132:135], a[204:207], v[40:43], v[132:135]
s_waitcnt lgkmcnt(4)
v_mfma_f32_16x16x32_bf16 v[120:123], v[44:47], a[72:75], v[120:123]
v_mfma_f32_16x16x32_bf16 v[124:127], v[44:47], a[76:79], v[124:127]
ds_read_b128 v[32:35], v4 offset:24576
ds_read_b128 v[36:39], v8 offset:24576
s_waitcnt lgkmcnt(5)
v_mfma_f32_16x16x32_bf16 v[112:115], v[48:51], a[80:83], v[112:115]
buffer_load_dwordx4 v30, s[4:7], s41 offen offset:0 sc1 lds
v_mfma_f32_16x16x32_bf16 v[116:119], v[48:51], a[84:87], v[116:119]
v_mfma_f32_16x16x32_bf16 v[128:131], a[208:211], v[48:51], v[128:131]
v_mfma_f32_16x16x32_bf16 v[132:135], a[212:215], v[48:51], v[132:135]
s_waitcnt lgkmcnt(4)
v_mfma_f32_16x16x32_bf16 v[120:123], v[52:55], a[80:83], v[120:123]
v_mfma_f32_16x16x32_bf16 v[124:127], v[52:55], a[84:87], v[124:127]
ds_read_b128 v[40:43], v5 offset:24576
ds_read_b128 v[44:47], v9 offset:24576
s_waitcnt lgkmcnt(5)
v_mfma_f32_16x16x32_bf16 v[112:115], v[56:59], a[88:91], v[112:115]
buffer_load_dwordx4 v31, s[4:7], s41 offen offset:1024 sc1 lds
s_add_u32 m0, s79, 24576
v_mfma_f32_16x16x32_bf16 v[116:119], v[56:59], a[92:95], v[116:119]
s_add_u32 s41, s39, 768
v_mfma_f32_16x16x32_bf16 v[128:131], a[216:219], v[56:59], v[128:131]
v_mfma_f32_16x16x32_bf16 v[132:135], a[220:223], v[56:59], v[132:135]
s_waitcnt lgkmcnt(4)
v_mfma_f32_16x16x32_bf16 v[120:123], v[60:63], a[88:91], v[120:123]
v_mfma_f32_16x16x32_bf16 v[124:127], v[60:63], a[92:95], v[124:127]
s_barrier
ds_read_b128 v[48:51], v6 offset:24576
ds_read_b128 v[52:55], v10 offset:24576
s_waitcnt lgkmcnt(5)
v_mfma_f32_16x16x32_bf16 v[112:115], v[32:35], a[96:99], v[112:115]
buffer_load_dwordx4 v30, s[4:7], s41 offen offset:0 sc1 lds
v_mfma_f32_16x16x32_bf16 v[116:119], v[32:35], a[100:103], v[116:119]
v_mfma_f32_16x16x32_bf16 v[128:131], a[224:227], v[32:35], v[128:131]
v_mfma_f32_16x16x32_bf16 v[132:135], a[228:231], v[32:35], v[132:135]
s_waitcnt lgkmcnt(4)
v_mfma_f32_16x16x32_bf16 v[120:123], v[36:39], a[96:99], v[120:123]
v_mfma_f32_16x16x32_bf16 v[124:127], v[36:39], a[100:103], v[124:127]
ds_read_b128 v[56:59], v7 offset:24576
ds_read_b128 v[60:63], v11 offset:24576
s_waitcnt lgkmcnt(5)
v_mfma_f32_16x16x32_bf16 v[112:115], v[40:43], a[104:107], v[112:115]
buffer_load_dwordx4 v31, s[4:7], s41 offen offset:1024 sc1 lds
s_add_u32 s39, s39, 32768
v_mfma_f32_16x16x32_bf16 v[116:119], v[40:43], a[108:111], v[116:119]
s_min_u32 s39, s39, s90
s_xor_b32 s79, s79, 32768
v_mfma_f32_16x16x32_bf16 v[128:131], a[232:235], v[40:43], v[128:131]
v_mfma_f32_16x16x32_bf16 v[132:135], a[236:239], v[40:43], v[132:135]
s_waitcnt lgkmcnt(4)
v_mfma_f32_16x16x32_bf16 v[120:123], v[44:47], a[104:107], v[120:123]
v_mfma_f32_16x16x32_bf16 v[124:127], v[44:47], a[108:111], v[124:127]
ds_read_b128 v[32:35], v100 offset:0
ds_read_b128 v[36:39], v104 offset:0
s_waitcnt lgkmcnt(5)
v_mfma_f32_16x16x32_bf16 v[112:115], v[48:51], a[112:115], v[112:115]
v_mfma_f32_16x16x32_bf16 v[116:119], v[48:51], a[116:119], v[116:119]
v_mfma_f32_16x16x32_bf16 v[128:131], a[240:243], v[48:51], v[128:131]
v_mfma_f32_16x16x32_bf16 v[132:135], a[244:247], v[48:51], v[132:135]
s_waitcnt lgkmcnt(4)
v_mfma_f32_16x16x32_bf16 v[120:123], v[52:55], a[112:115], v[120:123]
v_mfma_f32_16x16x32_bf16 v[124:127], v[52:55], a[116:119], v[124:127]
ds_read_b128 v[40:43], v101 offset:0
ds_read_b128 v[44:47], v105 offset:0
s_waitcnt lgkmcnt(5)
v_mfma_f32_16x16x32_bf16 v[112:115], v[56:59], a[120:123], v[112:115]
v_mfma_f32_16x16x32_bf16 v[116:119], v[56:59], a[124:127], v[116:119]
v_mfma_f32_16x16x32_bf16 v[128:131], a[248:251], v[56:59], v[128:131]
v_mfma_f32_16x16x32_bf16 v[132:135], a[252:255], v[56:59], v[132:135]
s_waitcnt lgkmcnt(4)
v_mfma_f32_16x16x32_bf16 v[120:123], v[60:63], a[120:123], v[120:123]
v_mfma_f32_16x16x32_bf16 v[124:127], v[60:63], a[124:127], v[124:127]
s_mov_b32 s84, s30
s_mov_b32 s83, s76
s_add_u32 s30, s30, 262144
s_add_u32 s76, s76, 2048
s_add_u32 s38, s38, 1
s_cmp_lt_u32 s38, 64
s_cbranch_scc1 L_qkv_loop_v_G
s_add_u32 s40, s88, s81
buffer_store_dwordx4 v[96:99], v28, s[4:7], s40 offen sc1
buffer_store_dwordx4 v[88:91], v2, s[4:7], s88 offen offset:0 sc1
buffer_store_dwordx4 v[92:95], v2, s[4:7], s88 offen offset:1024 sc1
s_mov_b32 s82, s89
L_qkv_p3_v_G:
v_cvt_pk_bf16_f32 v144, v128, v132
v_cvt_pk_bf16_f32 v145, v129, v133
v_cvt_pk_bf16_f32 v146, v130, v134
v_cvt_pk_bf16_f32 v147, v131, v135
v_cvt_pk_bf16_f32 v136, v112, v120
v_cvt_pk_bf16_f32 v137, v113, v121
v_cvt_pk_bf16_f32 v138, v114, v122
v_cvt_pk_bf16_f32 v139, v115, v123
v_cvt_pk_bf16_f32 v140, v116, v124
v_cvt_pk_bf16_f32 v141, v117, v125
v_cvt_pk_bf16_f32 v142, v118, v126
v_cvt_pk_bf16_f32 v143, v119, v127
v_alignbit_b32 v136, v136, v136, s85
v_alignbit_b32 v137, v137, v137, s85
v_alignbit_b32 v138, v138, v138, s85
v_alignbit_b32 v139, v139, v139, s85
v_alignbit_b32 v140, v140, v140, s85
v_alignbit_b32 v141, v141, v141, s85
v_alignbit_b32 v142, v142, v142, s85
v_alignbit_b32 v143, v143, v143, s85
s_add_u32 s40, s84, s81
buffer_store_dwordx4 v[144:147], v28, s[4:7], s40 offen sc1
buffer_store_dwordx4 v[136:139], v2, s[4:7], s84 offen offset:0 sc1
buffer_store_dwordx4 v[140:143], v2, s[4:7], s84 offen offset:1024 sc1
buffer_load_dword v26, v27, s[4:7], s77 offen sc1
s_waitcnt vmcnt(0) lgkmcnt(0)
buffer_store_dword v25, v24, s[4:7], s83 offen sc1
buffer_store_dword v25, v24, s[4:7], s82 offen sc1
s_cmp_eq_u32 s38, 78
s_cbranch_scc1 L_end_qkv_G
s_barrier
L_p3_143:
v_cmp_eq_u32 vcc, 0, v26
s_cbranch_vccz L_p3o_144
s_sub_u32 s36, s36, 1
s_cbranch_scc1 L_end_qkv_G
buffer_load_dword v26, v27, s[4:7], s77 offen sc1
s_waitcnt vmcnt(0)
s_branch L_p3_143
L_p3o_144:
s_add_u32 m0, s78, 0
s_add_u32 s41, s28, 0
buffer_load_dwordx4 v30, s[4:7], s41 offen offset:0 sc1 lds
buffer_load_dwordx4 v31, s[4:7], s41 offen offset:1024 sc1 lds
s_add_u32 m0, s78, 8192
s_add_u32 s41, s28, 256
buffer_load_dwordx4 v30, s[4:7], s41 offen offset:0 sc1 lds
buffer_load_dwordx4 v31, s[4:7], s41 offen offset:1024 sc1 lds
s_add_u32 m0, s78, 16384
s_add_u32 s41, s28, 512
buffer_load_dwordx4 v30, s[4:7], s41 offen offset:0 sc1 lds
buffer_load_dwordx4 v31, s[4:7], s41 offen offset:1024 sc1 lds
s_add_u32 m0, s78, 24576
s_add_u32 s41, s28, 768
buffer_load_dwordx4 v30, s[4:7], s41 offen offset:0 sc1 lds
buffer_load_dwordx4 v31, s[4:7], s41 offen offset:1024 sc1 lds
s_add_u32 s28, s28, 32768
s_add_u32 s77, s77, 512
s_waitcnt vmcnt(6)
s_barrier
ds_read_b128 v[32:35], v4 offset:0
ds_read_b128 v[36:39], v8 offset:0
ds_read_b128 v[40:43], v5 offset:0
ds_read_b128 v[44:47], v9 offset:0
ds_read_b128 v[48:51], v6 offset:0
ds_read_b128 v[52:55], v10 offset:0
s_waitcnt lgkmcnt(5)
v_mfma_f32_16x16x32_bf16 v[112:115], v[32:35], a[0:3], 0
v_mfma_f32_16x16x32_bf16 v[116:119], v[32:35], a[4:7], 0
v_mfma_f32_16x16x32_bf16 v[128:131], a[128:131], v[32:35], 0
v_mfma_f32_16x16x32_bf16 v[132:135], a[132:135], v[32:35], 0
s_waitcnt lgkmcnt(4)
v_mfma_f32_16x16x32_bf16 v[120:123], v[36:39], a[0:3], 0
v_mfma_f32_16x16x32_bf16 v[124:127], v[36:39], a[4:7], 0
ds_read_b128 v[56:59], v7 offset:0
ds_read_b128 v[60:63], v11 offset:0
s_waitcnt lgkmcnt(5)
v_mfma_f32_16x16x32_bf16 v[112:115], v[40:43], a[8:11], v[112:115]
v_mfma_f32_16x16x32_bf16 v[116:119], v[40:43], a[12:15], v[116:119]
v_mfma_f32_16x16x32_bf16 v[128:131], a[136:139], v[40:43], v[128:131]
v_mfma_f32_16x16x32_bf16 v[132:135], a[140:143], v[40:43], v[132:135]
s_waitcnt lgkmcnt(4)
v_mfma_f32_16x16x32_bf16 v[120:123], v[44:47], a[8:11], v[120:123]
v_mfma_f32_16x16x32_bf16 v[124:127], v[44:47], a[12:15], v[124:127]
s_waitcnt vmcnt(4)
s_barrier
ds_read_b128 v[32:35], v4 offset:8192
ds_read_b128 v[36:39], v8 offset:8192
s_waitcnt lgkmcnt(5)
v_mfma_f32_16x16x32_bf16 v[112:115], v[48:51], a[16:19], v[112:115]
v_mfma_f32_16x16x32_bf16 v[116:119], v[48:51], a[20:23], v[116:119]
v_mfma_f32_16x16x32_bf16 v[128:131], a[144:147], v[48:51], v[128:131]
v_mfma_f32_16x16x32_bf16 v[132:135], a[148:151], v[48:51], v[132:135]
s_waitcnt lgkmcnt(4)
v_mfma_f32_16x16x32_bf16 v[120:123], v[52:55], a[16:19], v[120:123]
v_mfma_f32_16x16x32_bf16 v[124:127], v[52:55], a[20:23], v[124:127]
ds_read_b128 v[40:43], v5 offset:8192
ds_read_b128 v[44:47], v9 offset:8192
s_waitcnt lgkmcnt(5)
v_mfma_f32_16x16x32_bf16 v[112:115], v[56:59], a[24:27], v[112:115]
v_mfma_f32_16x16x32_bf16 v[116:119], v[56:59], a[28:31], v[116:119]
v_mfma_f32_16x16x32_bf16 v[128:131], a[152:155], v[56:59], v[128:131]
v_mfma_f32_16x16x32_bf16 v[132:135], a[156:159], v[56:59], v[132:135]
s_waitcnt lgkmcnt(4)
v_mfma_f32_16x16x32_bf16 v[120:123], v[60:63], a[24:27], v[120:123]
v_mfma_f32_16x16x32_bf16 v[124:127], v[60:63], a[28:31], v[124:127]
ds_read_b128 v[48:51], v6 offset:8192
ds_read_b128 v[52:55], v10 offset:8192
s_waitcnt lgkmcnt(5)
v_mfma_f32_16x16x32_bf16 v[112:115], v[32:35], a[32:35], v[112:115]
v_mfma_f32_16x16x32_bf16 v[116:119], v[32:35], a[36:39], v[116:119]
v_mfma_f32_16x16x32_bf16 v[128:131], a[160:163], v[32:35], v[128:131]
v_mfma_f32_16x16x32_bf16 v[132:135], a[164:167], v[32:35], v[132:135]
s_waitcnt lgkmcnt(4)
v_mfma_f32_16x16x32_bf16 v[120:123], v[36:39], a[32:35], v[120:123]
v_mfma_f32_16x16x32_bf16 v[124:127], v[36:39], a[36:39], v[124:127]
ds_read_b128 v[56:59], v7 offset:8192
ds_read_b128 v[60:63], v11 offset:8192
s_waitcnt lgkmcnt(5)
v_mfma_f32_16x16x32_bf16 v[112:115], v[40:43], a[40:43], v[112:115]
v_mfma_f32_16x16x32_bf16 v[116:119], v[40:43], a[44:47], v[116:119]
v_mfma_f32_16x16x32_bf16 v[128:131], a[168:171], v[40:43], v[128:131]
v_mfma_f32_16x16x32_bf16 v[132:135], a[172:175], v[40:43], v[132:135]
s_waitcnt lgkmcnt(4)
v_mfma_f32_16x16x32_bf16 v[120:123], v[44:47], a[40:43], v[120:123]
v_mfma_f32_16x16x32_bf16 v[124:127], v[44:47], a[44:47], v[124:127]
s_waitcnt vmcnt(2)
s_barrier
ds_read_b128 v[32:35], v4 offset:16384
ds_read_b128 v[36:39], v8 offset:16384
s_waitcnt lgkmcnt(5)
v_mfma_f32_16x16x32_bf16 v[112:115], v[48:51], a[48:51], v[112:115]
v_mfma_f32_16x16x32_bf16 v[116:119], v[48:51], a[52:55], v[116:119]
v_mfma_f32_16x16x32_bf16 v[128:131], a[176:179], v[48:51], v[128:131]
v_mfma_f32_16x16x32_bf16 v[132:135], a[180:183], v[48:51], v[132:135]
s_waitcnt lgkmcnt(4)
v_mfma_f32_16x16x32_bf16 v[120:123], v[52:55], a[48:51], v[120:123]
v_mfma_f32_16x16x32_bf16 v[124:127], v[52:55], a[52:55], v[124:127]
ds_read_b128 v[40:43], v5 offset:16384
ds_read_b128 v[44:47], v9 offset:16384
s_waitcnt lgkmcnt(5)
v_mfma_f32_16x16x32_bf16 v[112:115], v[56:59], a[56:59], v[112:115]
v_mfma_f32_16x16x32_bf16 v[116:119], v[56:59], a[60:63], v[116:119]
v_mfma_f32_16x16x32_bf16 v[128:131], a[184:187], v[56:59], v[128:131]
v_mfma_f32_16x16x32_bf16 v[132:135], a[188:191], v[56:59], v[132:135]
s_waitcnt lgkmcnt(4)
v_mfma_f32_16x16x32_bf16 v[120:123], v[60:63], a[56:59], v[120:123]
v_mfma_f32_16x16x32_bf16 v[124:127], v[60:63], a[60:63], v[124:127]
ds_read_b128 v[48:51], v6 offset:16384
ds_read_b128 v[52:55], v10 offset:16384
s_waitcnt lgkmcnt(5)
v_mfma_f32_16x16x32_bf16 v[112:115], v[32:35], a[64:67], v[112:115]
v_mfma_f32_16x16x32_bf16 v[116:119], v[32:35], a[68:71], v[116:119]
v_mfma_f32_16x16x32_bf16 v[128:131], a[192:195], v[32:35], v[128:131]
v_mfma_f32_16x16x32_bf16 v[132:135], a[196:199], v[32:35], v[132:135]
s_waitcnt lgkmcnt(4)
v_mfma_f32_16x16x32_bf16 v[120:123], v[36:39], a[64:67], v[120:123]
v_mfma_f32_16x16x32_bf16 v[124:127], v[36:39], a[68:71], v[124:127]
ds_read_b128 v[56:59], v7 offset:16384
ds_read_b128 v[60:63], v11 offset:16384
s_waitcnt lgkmcnt(5)
v_mfma_f32_16x16x32_bf16 v[112:115], v[40:43], a[72:75], v[112:115]
v_mfma_f32_16x16x32_bf16 v[116:119], v[40:43], a[76:79], v[116:119]
v_mfma_f32_16x16x32_bf16 v[128:131], a[200:203], v[40:43], v[128:131]
v_mfma_f32_16x16x32_bf16 v[132:135], a[204:207], v[40:43], v[132:135]
s_waitcnt lgkmcnt(4)
v_mfma_f32_16x16x32_bf16 v[120:123], v[44:47], a[72:75], v[120:123]
v_mfma_f32_16x16x32_bf16 v[124:127], v[44:47], a[76:79], v[124:127]
s_waitcnt vmcnt(0)
s_barrier
ds_read_b128 v[32:35], v4 offset:24576
ds_read_b128 v[36:39], v8 offset:24576
s_waitcnt lgkmcnt(5)
v_mfma_f32_16x16x32_bf16 v[112:115], v[48:51], a[80:83], v[112:115]
v_mfma_f32_16x16x32_bf16 v[116:119], v[48:51], a[84:87], v[116:119]
v_mfma_f32_16x16x32_bf16 v[128:131], a[208:211], v[48:51], v[128:131]
v_mfma_f32_16x16x32_bf16 v[132:135], a[212:215], v[48:51], v[132:135]
s_waitcnt lgkmcnt(4)
v_mfma_f32_16x16x32_bf16 v[120:123], v[52:55], a[80:83], v[120:123]
v_mfma_f32_16x16x32_bf16 v[124:127], v[52:55], a[84:87], v[124:127]
ds_read_b128 v[40:43], v5 offset:24576
ds_read_b128 v[44:47], v9 offset:24576
s_waitcnt lgkmcnt(5)
v_mfma_f32_16x16x32_bf16 v[112:115], v[56:59], a[88:91], v[112:115]
v_mfma_f32_16x16x32_bf16 v[116:119], v[56:59], a[92:95], v[116:119]
v_mfma_f32_16x16x32_bf16 v[128:131], a[216:219], v[56:59], v[128:131]
v_mfma_f32_16x16x32_bf16 v[132:135], a[220:223], v[56:59], v[132:135]
s_waitcnt lgkmcnt(4)
v_mfma_f32_16x16x32_bf16 v[120:123], v[60:63], a[88:91], v[120:123]
v_mfma_f32_16x16x32_bf16 v[124:127], v[60:63], a[92:95], v[124:127]
ds_read_b128 v[48:51], v6 offset:24576
ds_read_b128 v[52:55], v10 offset:24576
s_waitcnt lgkmcnt(5)
v_mfma_f32_16x16x32_bf16 v[112:115], v[32:35], a[96:99], v[112:115]
v_mfma_f32_16x16x32_bf16 v[116:119], v[32:35], a[100:103], v[116:119]
v_mfma_f32_16x16x32_bf16 v[128:131], a[224:227], v[32:35], v[128:131]
v_mfma_f32_16x16x32_bf16 v[132:135], a[228:231], v[32:35], v[132:135]
s_waitcnt lgkmcnt(4)
v_mfma_f32_16x16x32_bf16 v[120:123], v[36:39], a[96:99], v[120:123]
v_mfma_f32_16x16x32_bf16 v[124:127], v[36:39], a[100:103], v[124:127]
ds_read_b128 v[56:59], v7 offset:24576
ds_read_b128 v[60:63], v11 offset:24576
s_waitcnt lgkmcnt(5)
v_mfma_f32_16x16x32_bf16 v[112:115], v[40:43], a[104:107], v[112:115]
v_mfma_f32_16x16x32_bf16 v[116:119], v[40:43], a[108:111], v[116:119]
v_mfma_f32_16x16x32_bf16 v[128:131], a[232:235], v[40:43], v[128:131]
v_mfma_f32_16x16x32_bf16 v[132:135], a[236:239], v[40:43], v[132:135]
s_waitcnt lgkmcnt(4)
v_mfma_f32_16x16x32_bf16 v[120:123], v[44:47], a[104:107], v[120:123]
v_mfma_f32_16x16x32_bf16 v[124:127], v[44:47], a[108:111], v[124:127]
s_waitcnt lgkmcnt(3)
v_mfma_f32_16x16x32_bf16 v[112:115], v[48:51], a[112:115], v[112:115]
v_mfma_f32_16x16x32_bf16 v[116:119], v[48:51], a[116:119], v[116:119]
v_mfma_f32_16x16x32_bf16 v[128:131], a[240:243], v[48:51], v[128:131]
v_mfma_f32_16x16x32_bf16 v[132:135], a[244:247], v[48:51], v[132:135]
s_waitcnt lgkmcnt(2)
v_mfma_f32_16x16x32_bf16 v[120:123], v[52:55], a[112:115], v[120:123]
v_mfma_f32_16x16x32_bf16 v[124:127], v[52:55], a[116:119], v[124:127]
s_waitcnt lgkmcnt(1)
v_mfma_f32_16x16x32_bf16 v[112:115], v[56:59], a[120:123], v[112:115]
v_mfma_f32_16x16x32_bf16 v[116:119], v[56:59], a[124:127], v[116:119]
v_mfma_f32_16x16x32_bf16 v[128:131], a[248:251], v[56:59], v[128:131]
v_mfma_f32_16x16x32_bf16 v[132:135], a[252:255], v[56:59], v[132:135]
s_waitcnt lgkmcnt(0)
v_mfma_f32_16x16x32_bf16 v[120:123], v[60:63], a[120:123], v[120:123]
v_mfma_f32_16x16x32_bf16 v[124:127], v[60:63], a[124:127], v[124:127]
s_mov_b32 s84, s30
s_mov_b32 s83, s76
s_add_u32 s30, s30, 262144
s_add_u32 s76, s76, 2048
s_add_u32 s38, s38, 1
s_branch L_qkv_p3_v_G
L_spin_141:
buffer_load_dword v26, v27, s[4:7], s77 offen sc1
s_waitcnt vmcnt(0)
buffer_store_dword v25, v24, s[4:7], s83 offen sc1
buffer_store_dword v25, v24, s[4:7], s89 offen sc1
L_spin2_145:
v_cmp_eq_u32 vcc, 0, v26
s_cbranch_vccz L_spin2_145o
s_sub_u32 s36, s36, 1
s_cbranch_scc1 L_end_qkv_G
buffer_load_dword v26, v27, s[4:7], s77 offen sc1
s_waitcnt vmcnt(0)
s_branch L_spin2_145
L_spin2_145o:
s_add_u32 m0, s78, 0
s_add_u32 s41, s28, 0
buffer_load_dwordx4 v30, s[4:7], s41 offen offset:0 sc1 lds
buffer_load_dwordx4 v31, s[4:7], s41 offen offset:1024 sc1 lds
s_add_u32 m0, s78, 8192
s_add_u32 s41, s28, 256
buffer_load_dwordx4 v30, s[4:7], s41 offen offset:0 sc1 lds
buffer_load_dwordx4 v31, s[4:7], s41 offen offset:1024 sc1 lds
s_add_u32 m0, s78, 16384
s_add_u32 s41, s28, 512
buffer_load_dwordx4 v30, s[4:7], s41 offen offset:0 sc1 lds
buffer_load_dwordx4 v31, s[4:7], s41 offen offset:1024 sc1 lds
s_add_u32 m0, s78, 24576
s_add_u32 s41, s28, 768
buffer_load_dwordx4 v30, s[4:7], s41 offen offset:0 sc1 lds
buffer_load_dwordx4 v31, s[4:7], s41 offen offset:1024 sc1 lds
s_waitcnt vmcnt(4)
s_branch L_go_142
L_end_qkv_G:
s_endpgm
.p2align 6
R_att_G:
s_sub_u32 s38, s35, 4
s_lshr_b32 s38, s38, 1
v_and_b32 v3, 15, v1
v_lshrrev_b32 v4, 4, v1
s_and_b32 s98, s34, 15
s_lshr_b32 s99, s34, 4
s_sub_u32 s40, s35, 4
s_lshl_b32 s40, s40, 1
s_add_u32 s40, s40, s99
s_lshl_b32 s40, s40, 20
s_add_u32 s39, s40, 2097152
s_lshl_b32 s40, s98, 15
s_lshl_b32 s41, s32, 8
s_add_u32 s40, s40, s41
v_lshlrev_b32 v232, 4, v3
v_lshl_add_u32 v233, v4, 10, v232
v_add_u32 v5, s40, v233
s_and_b32 s3, s32, 1
s_lshl_b32 s42, s3, 14
v_add_u32 v5, s42, v5
v_xor_b32 v252, 16384, v5
s_lshl_b32 s40, s98, 10
s_add_u32 s40, s40, s41
v_lshl_add_u32 v233, v4, 17, v232
v_add3_u32 v8, v233, s40, 0
v_add_u32 v8, s42, v8
v_xor_b32 v253, 16384, v8
v_and_b32 v233, 1, v4
v_lshlrev_b32 v233, 3, v233
v_lshrrev_b32 v234, 1, v4
v_lshl_add_u32 v233, v234, 10, v233
s_lshl_b32 s40, s34, 11
s_add_u32 s40, s40, s41
v_add3_u32 v6, v232, v233, s40
v_and_b32 v254, 0xfffffc00, v6
v_xor_b32 v232, s98, v3
v_lshlrev_b32 v232, 4, v232
v_add3_u32 v7, v232, v233, s40
v_mov_b32 v9, 1
v_lshlrev_b32 v234, 6, v234
v_add_u32 v11, 163712, v234
s_lshl_b32 s40, s32, 2
v_and_b32 v234, 1, v4
v_lshlrev_b32 v234, 4, v234
v_add3_u32 v10, v234, v11, s40
s_mov_b32 s37, s99
s_mov_b32 s76, 0
s_mov_b32 s101, 0
s_lshl_b32 s42, s3, 3
v_xor_b32 v234, s42, v3
v_mov_b32 v12, 0
v_cmp_eq_u32 vcc, 0, v234
v_mov_b32 v233, 0x3f80
s_nop 0
v_cndmask_b32 v12, v12, v233, vcc
v_cmp_eq_u32 vcc, 1, v234
v_mov_b32 v233, 0x3f800000
s_nop 0
v_cndmask_b32 v12, v12, v233, vcc
v_mov_b32 v16, 0
v_cmp_eq_u32 vcc, 8, v234
v_mov_b32 v233, 0x3f80
s_nop 0
v_cndmask_b32 v16, v16, v233, vcc
v_cmp_eq_u32 vcc, 9, v234
v_mov_b32 v233, 0x3f800000
s_nop 0
v_cndmask_b32 v16, v16, v233, vcc
v_mov_b32 v13, 0
v_cmp_eq_u32 vcc, 2, v234
v_mov_b32 v233, 0x3f80
s_nop 0
v_cndmask_b32 v13, v13, v233, vcc
v_cmp_eq_u32 vcc, 3, v234
v_mov_b32 v233, 0x3f800000
s_nop 0
v_cndmask_b32 v13, v13, v233, vcc
v_mov_b32 v17, 0
v_cmp_eq_u32 vcc, 10, v234
v_mov_b32 v233, 0x3f80
s_nop 0
v_cndmask_b32 v17, v17, v233, vcc
v_cmp_eq_u32 vcc, 11, v234
v_mov_b32 v233, 0x3f800000
s_nop 0
v_cndmask_b32 v17, v17, v233, vcc
v_mov_b32 v14, 0
v_cmp_eq_u32 vcc, 4, v234
v_mov_b32 v233, 0x3f80
s_nop 0
v_cndmask_b32 v14, v14, v233, vcc
v_cmp_eq_u32 vcc, 5, v234
v_mov_b32 v233, 0x3f800000
s_nop 0
v_cndmask_b32 v14, v14, v233, vcc
v_mov_b32 v18, 0
v_cmp_eq_u32 vcc, 12, v234
v_mov_b32 v233, 0x3f80
s_nop 0
v_cndmask_b32 v18, v18, v233, vcc
v_cmp_eq_u32 vcc, 13, v234
v_mov_b32 v233, 0x3f800000
s_nop 0
v_cndmask_b32 v18, v18, v233, vcc
v_mov_b32 v15, 0
v_cmp_eq_u32 vcc, 6, v234
v_mov_b32 v233, 0x3f80
s_nop 0
v_cndmask_b32 v15, v15, v233, vcc
v_cmp_eq_u32 vcc, 7, v234
v_mov_b32 v233, 0x3f800000
s_nop 0
v_cndmask_b32 v15, v15, v233, vcc
v_mov_b32 v19, 0
v_cmp_eq_u32 vcc, 14, v234
v_mov_b32 v233, 0x3f80
s_nop 0
v_cndmask_b32 v19, v19, v233, vcc
v_cmp_eq_u32 vcc, 15, v234
v_mov_b32 v233, 0x3f800000
s_nop 0
v_cndmask_b32 v19, v19, v233, vcc
s_cmp_eq_u32 s38, 0
s_cselect_b32 s16, s48, s74
s_cselect_b32 s17, s49, s75
s_cselect_b32 s18, 2097152, s6
s_mov_b32 s19, 0x20000
s_cselect_b32 s28, 0, 20971520
s_lshl_b32 s40, s38, 22
s_add_u32 s29, s40, 18874368
s_add_u32 s30, s40, 12582912
s_lshl_b32 s40, s38, 16
s_lshl_b32 s41, s34, 5
s_add_u32 s40, s40, s41
s_lshl_b32 s43, s32, 2
s_add_u32 s40, s40, s43
s_add_u32 s31, s40, 16384
s_lshl_b32 s40, s38, 6
s_add_u32 s40, s40, s99
s_lshl_b32 s40, s40, 5
s_lshl_b32 s41, s98, 1
s_add_u32 s40, s40, s41
s_lshl_b32 s41, s40, 13
s_lshl_b32 s42, s32, 11
s_add_u32 s41, s41, s42
s_add_u32 s77, s41, 41943040
s_lshl_b32 s41, s40, 6
s_add_u32 s79, s41, 131072
s_lshr_b32 s42, s32, 1
s_lshl_b32 s41, s42, 6
s_add_u32 s26, s79, s41
s_and_b32 s41, s32, 1
s_lshl_b32 s41, s41, 2
s_add_u32 s26, s26, s41
s_add_u32 s26, s26, 48
s_lshl_b32 s41, s98, 1
s_add_u32 s41, s41, s42
s_lshl_b32 s41, s41, 12
s_lshl_b32 s42, s38, 20
s_add_u32 s41, s41, s42
s_add_u32 s24, s41, 25165824
v_lshlrev_b32 v38, 2, v1
s_mov_b32 s80, 0
s_mov_b32 s81, 0x3e0293ee
v_mov_b32 v25, 0xff800000
v_mov_b32 v39, 1133903872
s_and_b32 s40, s32, 1
s_lshr_b32 s42, s32, 1
s_mul_i32 s41, s42, 24576
v_add_u32 v27, s41, v2
s_lshl_b32 s41, s40, 10
v_add_u32 v20, s41, v27
v_lshrrev_b32 v232, 2, v3
v_and_b32 v233, 1, v3
v_lshl_add_u32 v232, v232, 1, v233
v_lshlrev_b32 v232, 4, v232
v_lshl_add_u32 v21, v4, 7, v232
v_lshlrev_b32 v22, 3, v1
s_lshl_b32 s41, s32, 12
s_add_u32 s41, s41, 98304
v_add_u32 v26, s41, v2
v_lshl_add_u32 v232, v3, 1, s40
v_lshlrev_b32 v233, 3, v4
v_sub_u32 v232, v232, v233
v_cmp_le_i32 s[82:83], 0, v232
v_cmp_le_i32 s[84:85], 2, v232
v_cmp_le_i32 s[86:87], 4, v232
v_cmp_le_i32 s[88:89], 6, v232
v_cmp_le_i32 s[90:91], 1, v232
v_cmp_le_i32 s[92:93], 3, v232
v_cmp_le_i32 s[94:95], 5, v232
v_cmp_le_i32 s[96:97], 7, v232
v_mov_b32 v28, 0x3f803f80
v_mov_b32 v29, 0x3f803f80
v_mov_b32 v30, 0x3f803f80
v_mov_b32 v31, 0x3f803f80
v_mov_b32 v32, 0
v_mov_b32 v33, 0
v_mov_b32 v34, 0
v_mov_b32 v35, 0
v_mov_b32 v36, 0
v_mov_b32 v37, 0
v_mov_b32 v140, 0
v_mov_b32 v141, 0
v_mov_b32 v142, 0
v_mov_b32 v143, 0
v_mov_b32 v144, 0
v_mov_b32 v145, 0
v_mov_b32 v146, 0
v_mov_b32 v147, 0
v_mov_b32 v148, 0
v_mov_b32 v149, 0
v_mov_b32 v150, 0
v_mov_b32 v151, 0
v_mov_b32 v152, 0
v_mov_b32 v153, 0
v_mov_b32 v154, 0
v_mov_b32 v155, 0
s_waitcnt vmcnt(0)
s_barrier
s_cmp_lg_u32 s32, 0
s_cbranch_scc1 L_da_146
v_mov_b32 v236, 1
s_lshl_b32 s40, s33, 5
v_mov_b32 v237, s40
s_mov_b64 exec, 1
buffer_atomic_add v236, v237, s[8:11], 0 offen offset:12
s_mov_b64 exec, -1
L_da_146:
s_sub_u32 s40, s35, 4
s_lshl_b32 s40, s40, 5
s_add_u32 s40, s40, s34
s_lshl_b32 s40, s40, 2
s_add_u32 s40, s40, s32
s_mul_i32 s40, s40, 7168
s_mov_b32 s12, s54
s_mov_b32 s13, s55
s_mov_b32 s14, 4194304
s_mov_b32 s15, 0x20000
s_add_u32 s41, s40, 0
buffer_load_dwordx4 v[240:243], v2, s[12:15], s41 offen offset:0
buffer_load_dwordx4 v[240:243], v2, s[12:15], s41 offen offset:1024
buffer_load_dwordx4 v[240:243], v2, s[12:15], s41 offen offset:2048
buffer_load_dwordx4 v[240:243], v2, s[12:15], s41 offen offset:3072
s_add_u32 s41, s40, 4096
buffer_load_dwordx4 v[240:243], v2, s[12:15], s41 offen offset:0
buffer_load_dwordx4 v[240:243], v2, s[12:15], s41 offen offset:1024
buffer_load_dwordx4 v[240:243], v2, s[12:15], s41 offen offset:2048
s_mov_b32 s12, s56
s_mov_b32 s13, s57
s_mov_b32 s14, 4194304
s_mov_b32 s15, 0x20000
s_add_u32 s41, s40, 0
buffer_load_dwordx4 v[240:243], v2, s[12:15], s41 offen offset:0
buffer_load_dwordx4 v[240:243], v2, s[12:15], s41 offen offset:1024
buffer_load_dwordx4 v[240:243], v2, s[12:15], s41 offen offset:2048
buffer_load_dwordx4 v[240:243], v2, s[12:15], s41 offen offset:3072
s_add_u32 s41, s40, 4096
buffer_load_dwordx4 v[240:243], v2, s[12:15], s41 offen offset:0
buffer_load_dwordx4 v[240:243], v2, s[12:15], s41 offen offset:1024
buffer_load_dwordx4 v[240:243], v2, s[12:15], s41 offen offset:2048
s_mov_b32 s12, s52
s_mov_b32 s13, s53
s_mov_b32 s14, 4194304
s_mov_b32 s15, 0x20000
s_add_u32 s41, s40, 0
buffer_load_dwordx4 v[240:243], v2, s[12:15], s41 offen offset:0
buffer_load_dwordx4 v[240:243], v2, s[12:15], s41 offen offset:1024
buffer_load_dwordx4 v[240:243], v2, s[12:15], s41 offen offset:2048
buffer_load_dwordx4 v[240:243], v2, s[12:15], s41 offen offset:3072
s_add_u32 s41, s40, 4096
buffer_load_dwordx4 v[240:243], v2, s[12:15], s41 offen offset:0
buffer_load_dwordx4 v[240:243], v2, s[12:15], s41 offen offset:1024
buffer_load_dwordx4 v[240:243], v2, s[12:15], s41 offen offset:2048
s_mov_b32 s12, s58
s_mov_b32 s13, s59
s_mov_b32 s14, 4194304
s_mov_b32 s15, 0x20000
s_add_u32 s41, s40, 0
buffer_load_dwordx4 v[240:243], v2, s[12:15], s41 offen offset:0
buffer_load_dwordx4 v[240:243], v2, s[12:15], s41 offen offset:1024
buffer_load_dwordx4 v[240:243], v2, s[12:15], s41 offen offset:2048
buffer_load_dwordx4 v[240:243], v2, s[12:15], s41 offen offset:3072
s_add_u32 s41, s40, 4096
buffer_load_dwordx4 v[240:243], v2, s[12:15], s41 offen offset:0
buffer_load_dwordx4 v[240:243], v2, s[12:15], s41 offen offset:1024
buffer_load_dwordx4 v[240:243], v2, s[12:15], s41 offen offset:2048
v_lshlrev_b32 v238, 5, v1
buffer_load_dword v237, v238, s[8:11], 0 offen offset:12 sc1
s_waitcnt vmcnt(0)
L_cen_147:
s_mov_b32 s40, 0
v_readlane_b32 s41, v237, 0
s_nop 0
s_add_u32 s40, s40, s41
v_readlane_b32 s41, v237, 1
s_nop 0
s_add_u32 s40, s40, s41
v_readlane_b32 s41, v237, 2
s_nop 0
s_add_u32 s40, s40, s41
v_readlane_b32 s41, v237, 3
s_nop 0
s_add_u32 s40, s40, s41
v_readlane_b32 s41, v237, 4
s_nop 0
s_add_u32 s40, s40, s41
v_readlane_b32 s41, v237, 5
s_nop 0
s_add_u32 s40, s40, s41
v_readlane_b32 s41, v237, 6
s_nop 0
s_add_u32 s40, s40, s41
v_readlane_b32 s41, v237, 7
s_nop 0
s_add_u32 s40, s40, s41
s_cmp_eq_u32 s40, 256
s_cbranch_scc1 L_cenok_148
s_sub_u32 s36, s36, 1
s_cbranch_scc1 L_end_att_G
s_sleep 4
buffer_load_dword v237, v238, s[8:11], 0 offen offset:12 sc1
s_waitcnt vmcnt(0)
s_branch L_cen_147
L_cenok_148:
v_mov_b32 v232, -1
v_mov_b32 v233, -1
v_mov_b32 v234, -1
v_mov_b32 v235, -1
s_and_b32 s41, s32, 1
s_lshl_b32 s41, s41, 11
s_lshl_b32 s42, s99, 17
s_add_u32 s42, s42, s41
s_add_u32 s42, s42, s24
buffer_store_dwordx4 v[232:235], v2, s[4:7], s42 offen offset:0 sc1
buffer_store_dwordx4 v[232:235], v2, s[4:7], s42 offen offset:1024 sc1
s_add_u32 s42, s42, 262144
buffer_store_dwordx4 v[232:235], v2, s[4:7], s42 offen offset:0 sc1
buffer_store_dwordx4 v[232:235], v2, s[4:7], s42 offen offset:1024 sc1
s_add_u32 s42, s42, 262144
buffer_store_dwordx4 v[232:235], v2, s[4:7], s42 offen offset:0 sc1
buffer_store_dwordx4 v[232:235], v2, s[4:7], s42 offen offset:1024 sc1
s_add_u32 s42, s42, 262144
buffer_store_dwordx4 v[232:235], v2, s[4:7], s42 offen offset:0 sc1
buffer_store_dwordx4 v[232:235], v2, s[4:7], s42 offen offset:1024 sc1
s_add_u32 s42, s42, 262144
s_nop 0
v_mov_b32 v232, -1
v_mov_b32 v233, -1
v_mov_b32 v234, -1
v_mov_b32 v235, -1
s_add_u32 s40, s39, 0
buffer_store_dwordx4 v[232:235], v5, s[4:7], s40 offen sc1
s_add_u32 s40, s39, 4096
buffer_store_dwordx4 v[232:235], v5, s[4:7], s40 offen sc1
s_add_u32 s40, s39, 8192
buffer_store_dwordx4 v[232:235], v5, s[4:7], s40 offen sc1
s_add_u32 s40, s39, 12288
buffer_store_dwordx4 v[232:235], v5, s[4:7], s40 offen sc1
s_add_u32 s40, s39, 0
buffer_store_dwordx4 v[232:235], v252, s[4:7], s40 offen sc1
s_add_u32 s40, s39, 4096
buffer_store_dwordx4 v[232:235], v252, s[4:7], s40 offen sc1
s_add_u32 s40, s39, 8192
buffer_store_dwordx4 v[232:235], v252, s[4:7], s40 offen sc1
s_add_u32 s40, s39, 12288
buffer_store_dwordx4 v[232:235], v252, s[4:7], s40 offen sc1
s_add_u32 s40, s39, 524288
buffer_store_dwordx4 v[232:235], v5, s[4:7], s40 offen sc1
s_add_u32 s40, s39, 528384
buffer_store_dwordx4 v[232:235], v5, s[4:7], s40 offen sc1
s_add_u32 s40, s39, 532480
buffer_store_dwordx4 v[232:235], v5, s[4:7], s40 offen sc1
s_add_u32 s40, s39, 536576
buffer_store_dwordx4 v[232:235], v5, s[4:7], s40 offen sc1
s_add_u32 s40, s39, 524288
buffer_store_dwordx4 v[232:235], v252, s[4:7], s40 offen sc1
s_add_u32 s40, s39, 528384
buffer_store_dwordx4 v[232:235], v252, s[4:7], s40 offen sc1
s_add_u32 s40, s39, 532480
buffer_store_dwordx4 v[232:235], v252, s[4:7], s40 offen sc1
s_add_u32 s40, s39, 536576
buffer_store_dwordx4 v[232:235], v252, s[4:7], s40 offen sc1
s_cmp_eq_u32 s38, 0
s_cbranch_scc1 L_go_149
s_mul_i32 s40, s35, 0
s_add_u32 s40, s40, 0
v_mov_b32 v237, s40
L_rw_150:
buffer_load_dword v236, v237, s[8:11], 0 offen offset:8 sc1
s_waitcnt vmcnt(0)
v_cmp_ne_u32 vcc, 32, v236
s_cbranch_vccz L_rwo_151
s_sub_u32 s36, s36, 1
s_cbranch_scc1 L_end_att_G
s_sleep 2
s_branch L_rw_150
L_rwo_151:
L_go_149:
s_mov_b32 s20, s58
s_mov_b32 s21, s59
s_mov_b32 s22, 4194304
s_mov_b32 s23, 0x20000
s_lshl_b32 s40, s98, 18
s_lshl_b32 s41, s32, 8
s_add_u32 s40, s40, s41
v_lshlrev_b32 v240, 4, v3
v_lshl_add_u32 v240, v4, 13, v240
v_add_u32 v240, s40, v240
v_add_u32 v241, 4096, v240
s_lshr_b32 s44, s32, 1
s_lshl_b32 s44, s44, 17
s_xor_b32 s45, s44, 0
buffer_load_dwordx4 v[44:47], v240, s[20:23], s45 offen
buffer_load_dwordx4 v[48:51], v240, s[20:23], s45 offen offset:1024
buffer_load_dwordx4 v[52:55], v240, s[20:23], s45 offen offset:2048
buffer_load_dwordx4 v[56:59], v240, s[20:23], s45 offen offset:3072
buffer_load_dwordx4 v[60:63], v241, s[20:23], s45 offen
buffer_load_dwordx4 v[64:67], v241, s[20:23], s45 offen offset:1024
buffer_load_dwordx4 v[68:71], v241, s[20:23], s45 offen offset:2048
buffer_load_dwordx4 v[72:75], v241, s[20:23], s45 offen offset:3072
s_xor_b32 s45, s44, 32768
buffer_load_dwordx4 v[76:79], v240, s[20:23], s45 offen
buffer_load_dwordx4 v[80:83], v240, s[20:23], s45 offen offset:1024
buffer_load_dwordx4 v[84:87], v240, s[20:23], s45 offen offset:2048
buffer_load_dwordx4 v[88:91], v240, s[20:23], s45 offen offset:3072
buffer_load_dwordx4 v[92:95], v241, s[20:23], s45 offen
buffer_load_dwordx4 v[96:99], v241, s[20:23], s45 offen offset:1024
buffer_load_dwordx4 v[100:103], v241, s[20:23], s45 offen offset:2048
buffer_load_dwordx4 v[104:107], v241, s[20:23], s45 offen offset:3072
s_xor_b32 s45, s44, 65536
buffer_load_dwordx4 v[108:111], v240, s[20:23], s45 offen
buffer_load_dwordx4 v[112:115], v240, s[20:23], s45 offen offset:1024
buffer_load_dwordx4 v[116:119], v240, s[20:23], s45 offen offset:2048
buffer_load_dwordx4 v[120:123], v240, s[20:23], s45 offen offset:3072
buffer_load_dwordx4 v[124:127], v241, s[20:23], s45 offen
buffer_load_dwordx4 v[128:131], v241, s[20:23], s45 offen offset:1024
buffer_load_dwordx4 v[132:135], v241, s[20:23], s45 offen offset:2048
buffer_load_dwordx4 v[136:139], v241, s[20:23], s45 offen offset:3072
s_xor_b32 s45, s44, 98304
buffer_load_dwordx4 v[140:143], v240, s[20:23], s45 offen
buffer_load_dwordx4 v[144:147], v240, s[20:23], s45 offen offset:1024
buffer_load_dwordx4 v[148:151], v240, s[20:23], s45 offen offset:2048
buffer_load_dwordx4 v[152:155], v240, s[20:23], s45 offen offset:3072
buffer_load_dwordx4 v[156:159], v241, s[20:23], s45 offen
buffer_load_dwordx4 v[160:163], v241, s[20:23], s45 offen offset:1024
buffer_load_dwordx4 v[164:167], v241, s[20:23], s45 offen offset:2048
buffer_load_dwordx4 v[168:171], v241, s[20:23], s45 offen offset:3072
s_waitcnt vmcnt(24)
s_barrier
s_cmp_lg_u32 s32, 0
s_cbranch_scc1 L_ra_152
v_mov_b32 v236, 1
s_lshl_b32 s40, s35, 5
v_mov_b32 v237, s40
s_mov_b64 exec, 1
buffer_atomic_add v236, v237, s[8:11], 0 offen offset:8
s_mov_b64 exec, -1
L_ra_152:
buffer_store_dword v9, v33, s[4:7], s26 offen sc1
s_add_u32 s26, s26, 4096
buffer_store_dword v9, v33, s[4:7], s26 offen sc1
s_add_u32 s26, s26, 4096
buffer_store_dword v9, v33, s[4:7], s26 offen sc1
s_add_u32 s26, s26, 4096
buffer_store_dword v9, v33, s[4:7], s26 offen sc1
s_add_u32 s26, s26, 4096
v_perm_b32 v172, v48, v44, s46
v_accvgpr_write_b32 a0, v172
v_perm_b32 v173, v56, v52, s46
v_accvgpr_write_b32 a1, v173
v_perm_b32 v174, v64, v60, s46
v_accvgpr_write_b32 a2, v174
v_perm_b32 v175, v72, v68, s46
v_accvgpr_write_b32 a3, v175
v_perm_b32 v176, v48, v44, s47
v_accvgpr_write_b32 a4, v176
v_perm_b32 v177, v56, v52, s47
v_accvgpr_write_b32 a5, v177
v_perm_b32 v178, v64, v60, s47
v_accvgpr_write_b32 a6, v178
v_perm_b32 v179, v72, v68, s47
v_accvgpr_write_b32 a7, v179
v_perm_b32 v172, v49, v45, s46
v_accvgpr_write_b32 a8, v172
v_perm_b32 v173, v57, v53, s46
v_accvgpr_write_b32 a9, v173
v_perm_b32 v174, v65, v61, s46
v_accvgpr_write_b32 a10, v174
v_perm_b32 v175, v73, v69, s46
v_accvgpr_write_b32 a11, v175
v_perm_b32 v176, v49, v45, s47
v_accvgpr_write_b32 a12, v176
v_perm_b32 v177, v57, v53, s47
v_accvgpr_write_b32 a13, v177
v_perm_b32 v178, v65, v61, s47
v_accvgpr_write_b32 a14, v178
v_perm_b32 v179, v73, v69, s47
v_accvgpr_write_b32 a15, v179
v_perm_b32 v172, v50, v46, s46
v_accvgpr_write_b32 a16, v172
v_perm_b32 v173, v58, v54, s46
v_accvgpr_write_b32 a17, v173
v_perm_b32 v174, v66, v62, s46
v_accvgpr_write_b32 a18, v174
v_perm_b32 v175, v74, v70, s46
v_accvgpr_write_b32 a19, v175
v_perm_b32 v176, v50, v46, s47
v_accvgpr_write_b32 a20, v176
v_perm_b32 v177, v58, v54, s47
v_accvgpr_write_b32 a21, v177
v_perm_b32 v178, v66, v62, s47
v_accvgpr_write_b32 a22, v178
v_perm_b32 v179, v74, v70, s47
v_accvgpr_write_b32 a23, v179
v_perm_b32 v172, v51, v47, s46
v_accvgpr_write_b32 a24, v172
v_perm_b32 v173, v59, v55, s46
v_accvgpr_write_b32 a25, v173
v_perm_b32 v174, v67, v63, s46
v_accvgpr_write_b32 a26, v174
v_perm_b32 v175, v75, v71, s46
v_accvgpr_write_b32 a27, v175
v_perm_b32 v176, v51, v47, s47
v_accvgpr_write_b32 a28, v176
v_perm_b32 v177, v59, v55, s47
v_accvgpr_write_b32 a29, v177
v_perm_b32 v178, v67, v63, s47
v_accvgpr_write_b32 a30, v178
v_perm_b32 v179, v75, v71, s47
v_accvgpr_write_b32 a31, v179
s_xor_b32 s45, s44, 131072
buffer_load_dwordx4 v[44:47], v240, s[20:23], s45 offen
buffer_load_dwordx4 v[48:51], v240, s[20:23], s45 offen offset:1024
buffer_load_dwordx4 v[52:55], v240, s[20:23], s45 offen offset:2048
buffer_load_dwordx4 v[56:59], v240, s[20:23], s45 offen offset:3072
buffer_load_dwordx4 v[60:63], v241, s[20:23], s45 offen
buffer_load_dwordx4 v[64:67], v241, s[20:23], s45 offen offset:1024
buffer_load_dwordx4 v[68:71], v241, s[20:23], s45 offen offset:2048
buffer_load_dwordx4 v[72:75], v241, s[20:23], s45 offen offset:3072
s_waitcnt vmcnt(24)
v_perm_b32 v172, v80, v76, s46
v_accvgpr_write_b32 a32, v172
v_perm_b32 v173, v88, v84, s46
v_accvgpr_write_b32 a33, v173
v_perm_b32 v174, v96, v92, s46
v_accvgpr_write_b32 a34, v174
v_perm_b32 v175, v104, v100, s46
v_accvgpr_write_b32 a35, v175
v_perm_b32 v176, v80, v76, s47
v_accvgpr_write_b32 a36, v176
v_perm_b32 v177, v88, v84, s47
v_accvgpr_write_b32 a37, v177
v_perm_b32 v178, v96, v92, s47
v_accvgpr_write_b32 a38, v178
v_perm_b32 v179, v104, v100, s47
v_accvgpr_write_b32 a39, v179
v_perm_b32 v172, v81, v77, s46
v_accvgpr_write_b32 a40, v172
v_perm_b32 v173, v89, v85, s46
v_accvgpr_write_b32 a41, v173
v_perm_b32 v174, v97, v93, s46
v_accvgpr_write_b32 a42, v174
v_perm_b32 v175, v105, v101, s46
v_accvgpr_write_b32 a43, v175
v_perm_b32 v176, v81, v77, s47
v_accvgpr_write_b32 a44, v176
v_perm_b32 v177, v89, v85, s47
v_accvgpr_write_b32 a45, v177
v_perm_b32 v178, v97, v93, s47
v_accvgpr_write_b32 a46, v178
v_perm_b32 v179, v105, v101, s47
v_accvgpr_write_b32 a47, v179
v_perm_b32 v172, v82, v78, s46
v_accvgpr_write_b32 a48, v172
v_perm_b32 v173, v90, v86, s46
v_accvgpr_write_b32 a49, v173
v_perm_b32 v174, v98, v94, s46
v_accvgpr_write_b32 a50, v174
v_perm_b32 v175, v106, v102, s46
v_accvgpr_write_b32 a51, v175
v_perm_b32 v176, v82, v78, s47
v_accvgpr_write_b32 a52, v176
v_perm_b32 v177, v90, v86, s47
v_accvgpr_write_b32 a53, v177
v_perm_b32 v178, v98, v94, s47
v_accvgpr_write_b32 a54, v178
v_perm_b32 v179, v106, v102, s47
v_accvgpr_write_b32 a55, v179
v_perm_b32 v172, v83, v79, s46
v_accvgpr_write_b32 a56, v172
v_perm_b32 v173, v91, v87, s46
v_accvgpr_write_b32 a57, v173
v_perm_b32 v174, v99, v95, s46
v_accvgpr_write_b32 a58, v174
v_perm_b32 v175, v107, v103, s46
v_accvgpr_write_b32 a59, v175
v_perm_b32 v176, v83, v79, s47
v_accvgpr_write_b32 a60, v176
v_perm_b32 v177, v91, v87, s47
v_accvgpr_write_b32 a61, v177
v_perm_b32 v178, v99, v95, s47
v_accvgpr_write_b32 a62, v178
v_perm_b32 v179, v107, v103, s47
v_accvgpr_write_b32 a63, v179
s_xor_b32 s45, s44, 163840
buffer_load_dwordx4 v[76:79], v240, s[20:23], s45 offen
buffer_load_dwordx4 v[80:83], v240, s[20:23], s45 offen offset:1024
buffer_load_dwordx4 v[84:87], v240, s[20:23], s45 offen offset:2048
buffer_load_dwordx4 v[88:91], v240, s[20:23], s45 offen offset:3072
buffer_load_dwordx4 v[92:95], v241, s[20:23], s45 offen
buffer_load_dwordx4 v[96:99], v241, s[20:23], s45 offen offset:1024
buffer_load_dwordx4 v[100:103], v241, s[20:23], s45 offen offset:2048
buffer_load_dwordx4 v[104:107], v241, s[20:23], s45 offen offset:3072
s_waitcnt vmcnt(24)
v_perm_b32 v172, v112, v108, s46
v_accvgpr_write_b32 a64, v172
v_perm_b32 v173, v120, v116, s46
v_accvgpr_write_b32 a65, v173
v_perm_b32 v174, v128, v124, s46
v_accvgpr_write_b32 a66, v174
v_perm_b32 v175, v136, v132, s46
v_accvgpr_write_b32 a67, v175
v_perm_b32 v176, v112, v108, s47
v_accvgpr_write_b32 a68, v176
v_perm_b32 v177, v120, v116, s47
v_accvgpr_write_b32 a69, v177
v_perm_b32 v178, v128, v124, s47
v_accvgpr_write_b32 a70, v178
v_perm_b32 v179, v136, v132, s47
v_accvgpr_write_b32 a71, v179
v_perm_b32 v172, v113, v109, s46
v_accvgpr_write_b32 a72, v172
v_perm_b32 v173, v121, v117, s46
v_accvgpr_write_b32 a73, v173
v_perm_b32 v174, v129, v125, s46
v_accvgpr_write_b32 a74, v174
v_perm_b32 v175, v137, v133, s46
v_accvgpr_write_b32 a75, v175
v_perm_b32 v176, v113, v109, s47
v_accvgpr_write_b32 a76, v176
v_perm_b32 v177, v121, v117, s47
v_accvgpr_write_b32 a77, v177
v_perm_b32 v178, v129, v125, s47
v_accvgpr_write_b32 a78, v178
v_perm_b32 v179, v137, v133, s47
v_accvgpr_write_b32 a79, v179
v_perm_b32 v172, v114, v110, s46
v_accvgpr_write_b32 a80, v172
v_perm_b32 v173, v122, v118, s46
v_accvgpr_write_b32 a81, v173
v_perm_b32 v174, v130, v126, s46
v_accvgpr_write_b32 a82, v174
v_perm_b32 v175, v138, v134, s46
v_accvgpr_write_b32 a83, v175
v_perm_b32 v176, v114, v110, s47
v_accvgpr_write_b32 a84, v176
v_perm_b32 v177, v122, v118, s47
v_accvgpr_write_b32 a85, v177
v_perm_b32 v178, v130, v126, s47
v_accvgpr_write_b32 a86, v178
v_perm_b32 v179, v138, v134, s47
v_accvgpr_write_b32 a87, v179
v_perm_b32 v172, v115, v111, s46
v_accvgpr_write_b32 a88, v172
v_perm_b32 v173, v123, v119, s46
v_accvgpr_write_b32 a89, v173
v_perm_b32 v174, v131, v127, s46
v_accvgpr_write_b32 a90, v174
v_perm_b32 v175, v139, v135, s46
v_accvgpr_write_b32 a91, v175
v_perm_b32 v176, v115, v111, s47
v_accvgpr_write_b32 a92, v176
v_perm_b32 v177, v123, v119, s47
v_accvgpr_write_b32 a93, v177
v_perm_b32 v178, v131, v127, s47
v_accvgpr_write_b32 a94, v178
v_perm_b32 v179, v139, v135, s47
v_accvgpr_write_b32 a95, v179
s_xor_b32 s45, s44, 196608
buffer_load_dwordx4 v[108:111], v240, s[20:23], s45 offen
buffer_load_dwordx4 v[112:115], v240, s[20:23], s45 offen offset:1024
buffer_load_dwordx4 v[116:119], v240, s[20:23], s45 offen offset:2048
buffer_load_dwordx4 v[120:123], v240, s[20:23], s45 offen offset:3072
buffer_load_dwordx4 v[124:127], v241, s[20:23], s45 offen
buffer_load_dwordx4 v[128:131], v241, s[20:23], s45 offen offset:1024
buffer_load_dwordx4 v[132:135], v241, s[20:23], s45 offen offset:2048
buffer_load_dwordx4 v[136:139], v241, s[20:23], s45 offen offset:3072
s_waitcnt vmcnt(24)
v_perm_b32 v172, v144, v140, s46
v_accvgpr_write_b32 a96, v172
v_perm_b32 v173, v152, v148, s46
v_accvgpr_write_b32 a97, v173
v_perm_b32 v174, v160, v156, s46
v_accvgpr_write_b32 a98, v174
v_perm_b32 v175, v168, v164, s46
v_accvgpr_write_b32 a99, v175
v_perm_b32 v176, v144, v140, s47
v_accvgpr_write_b32 a100, v176
v_perm_b32 v177, v152, v148, s47
v_accvgpr_write_b32 a101, v177
v_perm_b32 v178, v160, v156, s47
v_accvgpr_write_b32 a102, v178
v_perm_b32 v179, v168, v164, s47
v_accvgpr_write_b32 a103, v179
v_perm_b32 v172, v145, v141, s46
v_accvgpr_write_b32 a104, v172
v_perm_b32 v173, v153, v149, s46
v_accvgpr_write_b32 a105, v173
v_perm_b32 v174, v161, v157, s46
v_accvgpr_write_b32 a106, v174
v_perm_b32 v175, v169, v165, s46
v_accvgpr_write_b32 a107, v175
v_perm_b32 v176, v145, v141, s47
v_accvgpr_write_b32 a108, v176
v_perm_b32 v177, v153, v149, s47
v_accvgpr_write_b32 a109, v177
v_perm_b32 v178, v161, v157, s47
v_accvgpr_write_b32 a110, v178
v_perm_b32 v179, v169, v165, s47
v_accvgpr_write_b32 a111, v179
v_perm_b32 v172, v146, v142, s46
v_accvgpr_write_b32 a112, v172
v_perm_b32 v173, v154, v150, s46
v_accvgpr_write_b32 a113, v173
v_perm_b32 v174, v162, v158, s46
v_accvgpr_write_b32 a114, v174
v_perm_b32 v175, v170, v166, s46
v_accvgpr_write_b32 a115, v175
v_perm_b32 v176, v146, v142, s47
v_accvgpr_write_b32 a116, v176
v_perm_b32 v177, v154, v150, s47
v_accvgpr_write_b32 a117, v177
v_perm_b32 v178, v162, v158, s47
v_accvgpr_write_b32 a118, v178
v_perm_b32 v179, v170, v166, s47
v_accvgpr_write_b32 a119, v179
v_perm_b32 v172, v147, v143, s46
v_accvgpr_write_b32 a120, v172
v_perm_b32 v173, v155, v151, s46
v_accvgpr_write_b32 a121, v173
v_perm_b32 v174, v163, v159, s46
v_accvgpr_write_b32 a122, v174
v_perm_b32 v175, v171, v167, s46
v_accvgpr_write_b32 a123, v175
v_perm_b32 v176, v147, v143, s47
v_accvgpr_write_b32 a124, v176
v_perm_b32 v177, v155, v151, s47
v_accvgpr_write_b32 a125, v177
v_perm_b32 v178, v163, v159, s47
v_accvgpr_write_b32 a126, v178
v_perm_b32 v179, v171, v167, s47
v_accvgpr_write_b32 a127, v179
s_xor_b32 s45, s44, 229376
buffer_load_dwordx4 v[140:143], v240, s[20:23], s45 offen
buffer_load_dwordx4 v[144:147], v240, s[20:23], s45 offen offset:1024
buffer_load_dwordx4 v[148:151], v240, s[20:23], s45 offen offset:2048
buffer_load_dwordx4 v[152:155], v240, s[20:23], s45 offen offset:3072
buffer_load_dwordx4 v[156:159], v241, s[20:23], s45 offen
buffer_load_dwordx4 v[160:163], v241, s[20:23], s45 offen offset:1024
buffer_load_dwordx4 v[164:167], v241, s[20:23], s45 offen offset:2048
buffer_load_dwordx4 v[168:171], v241, s[20:23], s45 offen offset:3072
s_waitcnt vmcnt(24)
v_perm_b32 v172, v48, v44, s46
v_accvgpr_write_b32 a128, v172
v_perm_b32 v173, v56, v52, s46
v_accvgpr_write_b32 a129, v173
v_perm_b32 v174, v64, v60, s46
v_accvgpr_write_b32 a130, v174
v_perm_b32 v175, v72, v68, s46
v_accvgpr_write_b32 a131, v175
v_perm_b32 v176, v48, v44, s47
v_accvgpr_write_b32 a132, v176
v_perm_b32 v177, v56, v52, s47
v_accvgpr_write_b32 a133, v177
v_perm_b32 v178, v64, v60, s47
v_accvgpr_write_b32 a134, v178
v_perm_b32 v179, v72, v68, s47
v_accvgpr_write_b32 a135, v179
v_perm_b32 v172, v49, v45, s46
v_accvgpr_write_b32 a136, v172
v_perm_b32 v173, v57, v53, s46
v_accvgpr_write_b32 a137, v173
v_perm_b32 v174, v65, v61, s46
v_accvgpr_write_b32 a138, v174
v_perm_b32 v175, v73, v69, s46
v_accvgpr_write_b32 a139, v175
v_perm_b32 v176, v49, v45, s47
v_accvgpr_write_b32 a140, v176
v_perm_b32 v177, v57, v53, s47
v_accvgpr_write_b32 a141, v177
v_perm_b32 v178, v65, v61, s47
v_accvgpr_write_b32 a142, v178
v_perm_b32 v179, v73, v69, s47
v_accvgpr_write_b32 a143, v179
v_perm_b32 v172, v50, v46, s46
v_accvgpr_write_b32 a144, v172
v_perm_b32 v173, v58, v54, s46
v_accvgpr_write_b32 a145, v173
v_perm_b32 v174, v66, v62, s46
v_accvgpr_write_b32 a146, v174
v_perm_b32 v175, v74, v70, s46
v_accvgpr_write_b32 a147, v175
v_perm_b32 v176, v50, v46, s47
v_accvgpr_write_b32 a148, v176
v_perm_b32 v177, v58, v54, s47
v_accvgpr_write_b32 a149, v177
v_perm_b32 v178, v66, v62, s47
v_accvgpr_write_b32 a150, v178
v_perm_b32 v179, v74, v70, s47
v_accvgpr_write_b32 a151, v179
v_perm_b32 v172, v51, v47, s46
v_accvgpr_write_b32 a152, v172
v_perm_b32 v173, v59, v55, s46
v_accvgpr_write_b32 a153, v173
v_perm_b32 v174, v67, v63, s46
v_accvgpr_write_b32 a154, v174
v_perm_b32 v175, v75, v71, s46
v_accvgpr_write_b32 a155, v175
v_perm_b32 v176, v51, v47, s47
v_accvgpr_write_b32 a156, v176
v_perm_b32 v177, v59, v55, s47
v_accvgpr_write_b32 a157, v177
v_perm_b32 v178, v67, v63, s47
v_accvgpr_write_b32 a158, v178
v_perm_b32 v179, v75, v71, s47
v_accvgpr_write_b32 a159, v179
s_waitcnt vmcnt(16)
v_perm_b32 v172, v80, v76, s46
v_accvgpr_write_b32 a160, v172
v_perm_b32 v173, v88, v84, s46
v_accvgpr_write_b32 a161, v173
v_perm_b32 v174, v96, v92, s46
v_accvgpr_write_b32 a162, v174
v_perm_b32 v175, v104, v100, s46
v_accvgpr_write_b32 a163, v175
v_perm_b32 v176, v80, v76, s47
v_accvgpr_write_b32 a164, v176
v_perm_b32 v177, v88, v84, s47
v_accvgpr_write_b32 a165, v177
v_perm_b32 v178, v96, v92, s47
v_accvgpr_write_b32 a166, v178
v_perm_b32 v179, v104, v100, s47
v_accvgpr_write_b32 a167, v179
v_perm_b32 v172, v81, v77, s46
v_accvgpr_write_b32 a168, v172
v_perm_b32 v173, v89, v85, s46
v_accvgpr_write_b32 a169, v173
v_perm_b32 v174, v97, v93, s46
v_accvgpr_write_b32 a170, v174
v_perm_b32 v175, v105, v101, s46
v_accvgpr_write_b32 a171, v175
v_perm_b32 v176, v81, v77, s47
v_accvgpr_write_b32 a172, v176
v_perm_b32 v177, v89, v85, s47
v_accvgpr_write_b32 a173, v177
v_perm_b32 v178, v97, v93, s47
v_accvgpr_write_b32 a174, v178
v_perm_b32 v179, v105, v101, s47
v_accvgpr_write_b32 a175, v179
v_perm_b32 v172, v82, v78, s46
v_accvgpr_write_b32 a176, v172
v_perm_b32 v173, v90, v86, s46
v_accvgpr_write_b32 a177, v173
v_perm_b32 v174, v98, v94, s46
v_accvgpr_write_b32 a178, v174
v_perm_b32 v175, v106, v102, s46
v_accvgpr_write_b32 a179, v175
v_perm_b32 v176, v82, v78, s47
v_accvgpr_write_b32 a180, v176
v_perm_b32 v177, v90, v86, s47
v_accvgpr_write_b32 a181, v177
v_perm_b32 v178, v98, v94, s47
v_accvgpr_write_b32 a182, v178
v_perm_b32 v179, v106, v102, s47
v_accvgpr_write_b32 a183, v179
v_perm_b32 v172, v83, v79, s46
v_accvgpr_write_b32 a184, v172
v_perm_b32 v173, v91, v87, s46
v_accvgpr_write_b32 a185, v173
v_perm_b32 v174, v99, v95, s46
v_accvgpr_write_b32 a186, v174
v_perm_b32 v175, v107, v103, s46
v_accvgpr_write_b32 a187, v175
v_perm_b32 v176, v83, v79, s47
v_accvgpr_write_b32 a188, v176
v_perm_b32 v177, v91, v87, s47
v_accvgpr_write_b32 a189, v177
v_perm_b32 v178, v99, v95, s47
v_accvgpr_write_b32 a190, v178
v_perm_b32 v179, v107, v103, s47
v_accvgpr_write_b32 a191, v179
s_waitcnt vmcnt(8)
v_perm_b32 v172, v112, v108, s46
v_accvgpr_write_b32 a192, v172
v_perm_b32 v173, v120, v116, s46
v_accvgpr_write_b32 a193, v173
v_perm_b32 v174, v128, v124, s46
v_accvgpr_write_b32 a194, v174
v_perm_b32 v175, v136, v132, s46
v_accvgpr_write_b32 a195, v175
v_perm_b32 v176, v112, v108, s47
v_accvgpr_write_b32 a196, v176
v_perm_b32 v177, v120, v116, s47
v_accvgpr_write_b32 a197, v177
v_perm_b32 v178, v128, v124, s47
v_accvgpr_write_b32 a198, v178
v_perm_b32 v179, v136, v132, s47
v_accvgpr_write_b32 a199, v179
v_perm_b32 v172, v113, v109, s46
v_accvgpr_write_b32 a200, v172
v_perm_b32 v173, v121, v117, s46
v_accvgpr_write_b32 a201, v173
v_perm_b32 v174, v129, v125, s46
v_accvgpr_write_b32 a202, v174
v_perm_b32 v175, v137, v133, s46
v_accvgpr_write_b32 a203, v175
v_perm_b32 v176, v113, v109, s47
v_accvgpr_write_b32 a204, v176
v_perm_b32 v177, v121, v117, s47
v_accvgpr_write_b32 a205, v177
v_perm_b32 v178, v129, v125, s47
v_accvgpr_write_b32 a206, v178
v_perm_b32 v179, v137, v133, s47
v_accvgpr_write_b32 a207, v179
v_perm_b32 v172, v114, v110, s46
v_accvgpr_write_b32 a208, v172
v_perm_b32 v173, v122, v118, s46
v_accvgpr_write_b32 a209, v173
v_perm_b32 v174, v130, v126, s46
v_accvgpr_write_b32 a210, v174
v_perm_b32 v175, v138, v134, s46
v_accvgpr_write_b32 a211, v175
v_perm_b32 v176, v114, v110, s47
v_accvgpr_write_b32 a212, v176
v_perm_b32 v177, v122, v118, s47
v_accvgpr_write_b32 a213, v177
v_perm_b32 v178, v130, v126, s47
v_accvgpr_write_b32 a214, v178
v_perm_b32 v179, v138, v134, s47
v_accvgpr_write_b32 a215, v179
v_perm_b32 v172, v115, v111, s46
v_accvgpr_write_b32 a216, v172
v_perm_b32 v173, v123, v119, s46
v_accvgpr_write_b32 a217, v173
v_perm_b32 v174, v131, v127, s46
v_accvgpr_write_b32 a218, v174
v_perm_b32 v175, v139, v135, s46
v_accvgpr_write_b32 a219, v175
v_perm_b32 v176, v115, v111, s47
v_accvgpr_write_b32 a220, v176
v_perm_b32 v177, v123, v119, s47
v_accvgpr_write_b32 a221, v177
v_perm_b32 v178, v131, v127, s47
v_accvgpr_write_b32 a222, v178
v_perm_b32 v179, v139, v135, s47
v_accvgpr_write_b32 a223, v179
s_waitcnt vmcnt(0)
v_perm_b32 v172, v144, v140, s46
v_accvgpr_write_b32 a224, v172
v_perm_b32 v173, v152, v148, s46
v_accvgpr_write_b32 a225, v173
v_perm_b32 v174, v160, v156, s46
v_accvgpr_write_b32 a226, v174
v_perm_b32 v175, v168, v164, s46
v_accvgpr_write_b32 a227, v175
v_perm_b32 v176, v144, v140, s47
v_accvgpr_write_b32 a228, v176
v_perm_b32 v177, v152, v148, s47
v_accvgpr_write_b32 a229, v177
v_perm_b32 v178, v160, v156, s47
v_accvgpr_write_b32 a230, v178
v_perm_b32 v179, v168, v164, s47
v_accvgpr_write_b32 a231, v179
v_perm_b32 v172, v145, v141, s46
v_accvgpr_write_b32 a232, v172
v_perm_b32 v173, v153, v149, s46
v_accvgpr_write_b32 a233, v173
v_perm_b32 v174, v161, v157, s46
v_accvgpr_write_b32 a234, v174
v_perm_b32 v175, v169, v165, s46
v_accvgpr_write_b32 a235, v175
v_perm_b32 v176, v145, v141, s47
v_accvgpr_write_b32 a236, v176
v_perm_b32 v177, v153, v149, s47
v_accvgpr_write_b32 a237, v177
v_perm_b32 v178, v161, v157, s47
v_accvgpr_write_b32 a238, v178
v_perm_b32 v179, v169, v165, s47
v_accvgpr_write_b32 a239, v179
v_perm_b32 v172, v146, v142, s46
v_accvgpr_write_b32 a240, v172
v_perm_b32 v173, v154, v150, s46
v_accvgpr_write_b32 a241, v173
v_perm_b32 v174, v162, v158, s46
v_accvgpr_write_b32 a242, v174
v_perm_b32 v175, v170, v166, s46
v_accvgpr_write_b32 a243, v175
v_perm_b32 v176, v146, v142, s47
v_accvgpr_write_b32 a244, v176
v_perm_b32 v177, v154, v150, s47
v_accvgpr_write_b32 a245, v177
v_perm_b32 v178, v162, v158, s47
v_accvgpr_write_b32 a246, v178
v_perm_b32 v179, v170, v166, s47
v_accvgpr_write_b32 a247, v179
v_perm_b32 v172, v147, v143, s46
v_accvgpr_write_b32 a248, v172
v_perm_b32 v173, v155, v151, s46
v_accvgpr_write_b32 a249, v173
v_perm_b32 v174, v163, v159, s46
v_accvgpr_write_b32 a250, v174
v_perm_b32 v175, v171, v167, s46
v_accvgpr_write_b32 a251, v175
v_perm_b32 v176, v147, v143, s47
v_accvgpr_write_b32 a252, v176
v_perm_b32 v177, v155, v151, s47
v_accvgpr_write_b32 a253, v177
v_perm_b32 v178, v163, v159, s47
v_accvgpr_write_b32 a254, v178
v_perm_b32 v179, v171, v167, s47
v_accvgpr_write_b32 a255, v179
s_mul_i32 s40, s35, 32
s_add_u32 s40, s40, 0
v_mov_b32 v237, s40
L_rw_153:
buffer_load_dword v236, v237, s[8:11], 0 offen offset:8 sc1
s_waitcnt vmcnt(0)
v_cmp_ne_u32 vcc, 32, v236
s_cbranch_vccz L_rwo_154
s_sub_u32 s36, s36, 1
s_cbranch_scc1 L_end_att_G
s_sleep 2
s_branch L_rw_153
L_rwo_154:
v_mov_b32 v140, 0
v_mov_b32 v141, 0
v_mov_b32 v142, 0
v_mov_b32 v143, 0
v_mov_b32 v144, 0
v_mov_b32 v145, 0
v_mov_b32 v146, 0
v_mov_b32 v147, 0
v_mov_b32 v148, 0
v_mov_b32 v149, 0
v_mov_b32 v150, 0
v_mov_b32 v151, 0
v_mov_b32 v152, 0
v_mov_b32 v153, 0
v_mov_b32 v154, 0
v_mov_b32 v155, 0
v_and_b32 v38, 124, v38
buffer_load_dword v24, v38, s[4:7], s79 offen sc1
s_waitcnt vmcnt(0)
v_cmp_eq_u32 vcc, 0, v24
s_nop 0
s_and_b32 s40, vcc_lo, 0x0ff00ff0
s_cbranch_scc1 L_sp_155
L_spo_156:
s_lshl_b32 s42, s32, 11
s_add_u32 s42, s42, s80
s_add_u32 m0, s42, 0
s_add_u32 s41, s77, 0
buffer_load_dwordx4 v2, s[4:7], s41 offen offset:0 sc1 lds
buffer_load_dwordx4 v2, s[4:7], s41 offen offset:1024 sc1 lds
s_add_u32 m0, s42, 8192
s_add_u32 s41, s77, 33554432
buffer_load_dwordx4 v2, s[4:7], s41 offen offset:0 sc1 lds
buffer_load_dwordx4 v2, s[4:7], s41 offen offset:1024 sc1 lds
s_add_u32 m0, s42, 16384
s_add_u32 s41, s77, 67108864
buffer_load_dwordx4 v2, s[4:7], s41 offen offset:0 sc1 lds
buffer_load_dwordx4 v2, s[4:7], s41 offen offset:1024 sc1 lds
s_add_u32 m0, s42, 24576
s_add_u32 s41, s77, 8192
buffer_load_dwordx4 v2, s[4:7], s41 offen offset:0 sc1 lds
buffer_load_dwordx4 v2, s[4:7], s41 offen offset:1024 sc1 lds
s_add_u32 m0, s42, 32768
s_add_u32 s41, s77, 33562624
buffer_load_dwordx4 v2, s[4:7], s41 offen offset:0 sc1 lds
buffer_load_dwordx4 v2, s[4:7], s41 offen offset:1024 sc1 lds
s_add_u32 m0, s42, 40960
s_add_u32 s41, s77, 67117056
buffer_load_dwordx4 v2, s[4:7], s41 offen offset:0 sc1 lds
buffer_load_dwordx4 v2, s[4:7], s41 offen offset:1024 sc1 lds
s_add_u32 s77, s77, 524288
s_add_u32 s79, s79, 4096
s_add_u32 s41, s37, 0
s_bfe_u32 s25, s41, 0x10003
s_and_b32 s41, s41, 7
s_lshl_b32 s41, s41, 17
s_add_u32 s78, s41, s24
buffer_load_dword v24, v38, s[4:7], s79 offen sc1
buffer_load_dwordx4 v[92:95], v21, s[4:7], s78 offen offset:0 sc1
buffer_load_dwordx4 v[96:99], v21, s[4:7], s78 offen offset:512 sc1
buffer_load_dwordx4 v[100:103], v21, s[4:7], s78 offen offset:1024 sc1
buffer_load_dwordx4 v[104:107], v21, s[4:7], s78 offen offset:1536 sc1
s_mov_b32 s27, 0
s_waitcnt vmcnt(5)
s_barrier
L_att_loop_G:
v_add_u32 v246, s80, v27
v_add_u32 v247, s80, v20
s_xor_b32 s80, s80, 49152
ds_read_b128 v[44:47], v247 offset:0
ds_read_b128 v[60:63], v246 offset:8192
ds_read_b128 v[64:67], v246 offset:9216
ds_read_b128 v[48:51], v247 offset:2048
ds_read_b128 v[68:71], v246 offset:10240
ds_read_b128 v[72:75], v246 offset:11264
ds_read_b128 v[52:55], v247 offset:4096
ds_read_b128 v[76:79], v246 offset:12288
ds_read_b128 v[80:83], v246 offset:13312
ds_read_b128 v[56:59], v247 offset:6144
ds_read_b128 v[84:87], v246 offset:14336
ds_read_b128 v[88:91], v246 offset:15360
s_waitcnt lgkmcnt(9)
v_mfma_f32_16x16x32_bf16 v[156:159], v[60:63], v[44:47], 0
v_mfma_f32_16x16x32_bf16 v[160:163], v[64:67], v[44:47], 0
s_waitcnt lgkmcnt(6)
v_mfma_f32_16x16x32_bf16 v[156:159], v[68:71], v[48:51], v[156:159]
v_mfma_f32_16x16x32_bf16 v[160:163], v[72:75], v[48:51], v[160:163]
s_waitcnt lgkmcnt(3)
v_mfma_f32_16x16x32_bf16 v[156:159], v[76:79], v[52:55], v[156:159]
v_mfma_f32_16x16x32_bf16 v[160:163], v[80:83], v[52:55], v[160:163]
s_waitcnt lgkmcnt(0)
v_mfma_f32_16x16x32_bf16 v[156:159], v[84:87], v[56:59], v[156:159]
v_mfma_f32_16x16x32_bf16 v[160:163], v[88:91], v[56:59], v[160:163]
ds_read_b128 v[108:111], v246 offset:16384
ds_read_b128 v[112:115], v246 offset:17408
ds_read_b128 v[116:119], v246 offset:18432
ds_read_b128 v[120:123], v246 offset:19456
ds_read_b128 v[124:127], v246 offset:20480
ds_read_b128 v[128:131], v246 offset:21504
ds_read_b128 v[132:135], v246 offset:22528
ds_read_b128 v[136:139], v246 offset:23552
v_cndmask_b32 v156, v25, v156, s[82:83]
v_cndmask_b32 v157, v25, v157, s[84:85]
v_cndmask_b32 v158, v25, v158, s[86:87]
v_cndmask_b32 v159, v25, v159, s[88:89]
v_cndmask_b32 v160, v25, v160, s[90:91]
v_cndmask_b32 v161, v25, v161, s[92:93]
v_cndmask_b32 v162, v25, v162, s[94:95]
v_cndmask_b32 v163, v25, v163, s[96:97]
v_max3_f32 v248, v156, v157, v158
v_max3_f32 v249, v159, v160, v161
v_max3_f32 v248, v248, v162, v163
s_cmp_eq_u32 s27, 1
s_cbranch_scc1 L_kv_160
s_cmp_lt_u32 s37, 2
s_cbranch_scc1 L_km_157
s_waitcnt vmcnt(2)
L_kmo_158:
v_mfma_f32_16x16x32_bf16 v[164:167], v[92:95], v[44:47], 0
v_bitop3_b32 v168, v92, v93, s25 bitop3:0x7e
v_bitop3_b32 v169, v94, v95, s25 bitop3:0x7e
v_bitop3_b32 v170, v96, v97, s25 bitop3:0x7e
v_mfma_f32_16x16x32_bf16 v[164:167], v[96:99], v[48:51], v[164:167]
v_bitop3_b32 v171, v98, v99, s25 bitop3:0x7e
v_bitop3_b32 v172, v100, v101, s25 bitop3:0x7e
v_bitop3_b32 v173, v102, v103, s25 bitop3:0x7e
v_mfma_f32_16x16x32_bf16 v[164:167], v[100:103], v[52:55], v[164:167]
v_bitop3_b32 v174, v104, v105, s25 bitop3:0x7e
v_bitop3_b32 v175, v106, v107, s25 bitop3:0x7e
v_or3_b32 v168, v168, v169, v170
v_mfma_f32_16x16x32_bf16 v[164:167], v[104:107], v[56:59], v[164:167]
v_or3_b32 v168, v168, v171, v172
v_or3_b32 v168, v168, v173, v174
v_or3_b32 v168, v168, v175, v175
v_and_b32 v168, 1, v168
v_cmp_ne_u32 vcc, 0, v168
s_cbranch_vccnz L_km2_159
L_kj_161:
s_nop 6
v_max3_f32 v249, v249, v164, v165
v_max_f32 v248, v248, v249
v_cmp_gt_f32 vcc, abs(v248), v39
s_cbranch_vccnz L_smx_163
L_smb_164:
v_mul_f32 v156, s81, v156
v_mul_f32 v157, s81, v157
v_mul_f32 v158, s81, v158
v_mul_f32 v159, s81, v159
v_mul_f32 v160, s81, v160
v_mul_f32 v161, s81, v161
v_mul_f32 v162, s81, v162
v_mul_f32 v163, s81, v163
v_mul_f32 v164, s81, v164
v_mul_f32 v165, s81, v165
s_cmp_eq_u32 s27, 1
s_cbranch_scc1 L_vx_162
buffer_load_dwordx2 v[140:141], v22, s[4:7], s78 offen offset:2048 sc1
buffer_load_dwordx2 v[144:145], v22, s[4:7], s78 offen offset:2560 sc1
buffer_load_dwordx2 v[148:149], v22, s[4:7], s78 offen offset:3072 sc1
buffer_load_dwordx2 v[152:153], v22, s[4:7], s78 offen offset:3584 sc1
L_vx_162:
v_exp_f32 v156, v156
v_exp_f32 v157, v157
v_exp_f32 v158, v158
v_exp_f32 v159, v159
v_exp_f32 v160, v160
v_exp_f32 v161, v161
v_exp_f32 v162, v162
v_exp_f32 v163, v163
v_exp_f32 v164, v164
v_exp_f32 v165, v165
v_cvt_pk_bf16_f32 v40, v156, v160
v_cvt_pk_bf16_f32 v41, v157, v161
v_cvt_pk_bf16_f32 v42, v158, v162
v_cvt_pk_bf16_f32 v43, v159, v163
v_cvt_pk_bf16_f32 v35, v164, v165
s_nop 0
v_mfma_f32_16x16x32_bf16 v[200:203], v[28:31], v[40:43], 0
v_mfma_f32_16x16x32_bf16 v[200:203], v[28:31], v[34:37], v[200:203]
s_waitcnt lgkmcnt(6)
v_mfma_f32_16x16x32_bf16 v[168:171], v[108:111], v[40:43], 0
v_mfma_f32_16x16x32_bf16 v[172:175], v[112:115], v[40:43], 0
s_waitcnt lgkmcnt(4)
v_mfma_f32_16x16x32_bf16 v[176:179], v[116:119], v[40:43], 0
v_mfma_f32_16x16x32_bf16 v[180:183], v[120:123], v[40:43], 0
s_waitcnt lgkmcnt(2)
v_mfma_f32_16x16x32_bf16 v[184:187], v[124:127], v[40:43], 0
v_mfma_f32_16x16x32_bf16 v[188:191], v[128:131], v[40:43], 0
s_waitcnt lgkmcnt(0)
v_mfma_f32_16x16x32_bf16 v[192:195], v[132:135], v[40:43], 0
v_rcp_f32 v200, v200
v_mfma_f32_16x16x32_bf16 v[196:199], v[136:139], v[40:43], 0
v_mul_f32 v164, v164, v200
v_mul_f32 v165, v165, v200
v_cvt_pk_bf16_f32 v32, v164, v165
v_cvt_pk_bf16_f32 v35, v164, v165
v_mul_f32 v168, v168, v200
v_mul_f32 v169, v169, v200
v_mul_f32 v170, v170, v200
v_mul_f32 v171, v171, v200
v_mul_f32 v172, v172, v200
v_mul_f32 v173, v173, v200
v_mul_f32 v174, v174, v200
v_mul_f32 v175, v175, v200
v_mul_f32 v176, v176, v200
v_mul_f32 v177, v177, v200
v_mul_f32 v178, v178, v200
v_mul_f32 v179, v179, v200
v_mul_f32 v180, v180, v200
v_mul_f32 v181, v181, v200
v_mul_f32 v182, v182, v200
v_mul_f32 v183, v183, v200
v_mul_f32 v184, v184, v200
v_mul_f32 v185, v185, v200
v_mul_f32 v186, v186, v200
v_mul_f32 v187, v187, v200
v_mul_f32 v188, v188, v200
v_mul_f32 v189, v189, v200
v_mul_f32 v190, v190, v200
v_mul_f32 v191, v191, v200
v_mul_f32 v192, v192, v200
v_mul_f32 v193, v193, v200
v_mul_f32 v194, v194, v200
v_mul_f32 v195, v195, v200
v_mul_f32 v196, v196, v200
v_mul_f32 v197, v197, v200
v_mul_f32 v198, v198, v200
v_mul_f32 v199, v199, v200
s_waitcnt vmcnt(2)
s_cmp_eq_u32 s27, 1
s_cbranch_scc1 L_vy_167
L_vmo_166:
s_waitcnt vmcnt(0)
L_vy_167:
v_bitop3_b32 v60, v140, v141, s25 bitop3:0x7e
v_bitop3_b32 v61, v144, v145, s25 bitop3:0x7e
v_bitop3_b32 v62, v148, v149, s25 bitop3:0x7e
v_bitop3_b32 v63, v152, v153, s25 bitop3:0x7e
v_or3_b32 v60, v60, v61, v62
v_or3_b32 v60, v60, v63, v63
v_and_b32 v60, 1, v60
v_cmp_ne_u32 vcc, 0, v60
s_cbranch_vccnz L_vm_165
v_mfma_f32_16x16x32_bf16 v[168:171], v[140:143], v[32:35], v[168:171]
v_mfma_f32_16x16x32_bf16 v[172:175], v[140:143], v[34:37], v[172:175]
v_mfma_f32_16x16x32_bf16 v[176:179], v[144:147], v[32:35], v[176:179]
v_mfma_f32_16x16x32_bf16 v[180:183], v[144:147], v[34:37], v[180:183]
v_mfma_f32_16x16x32_bf16 v[184:187], v[148:151], v[32:35], v[184:187]
v_mfma_f32_16x16x32_bf16 v[188:191], v[148:151], v[34:37], v[188:191]
v_mfma_f32_16x16x32_bf16 v[192:195], v[152:155], v[32:35], v[192:195]
s_nop 2
v_cvt_pk_bf16_f32 v204, v168, v172
v_cvt_pk_bf16_f32 v205, v169, v173
v_mfma_f32_16x16x32_bf16 v[196:199], v[152:155], v[34:37], v[196:199]
v_cvt_pk_bf16_f32 v206, v170, v174
v_cvt_pk_bf16_f32 v207, v171, v175
ds_write_b128 v26, v[204:207] offset:0
s_nop 0
v_mfma_f32_16x16x32_bf16 v[44:47], v[204:207], a[0:3], 0
v_cvt_pk_bf16_f32 v208, v176, v180
v_cvt_pk_bf16_f32 v209, v177, v181
v_mfma_f32_16x16x32_bf16 v[48:51], v[204:207], a[4:7], 0
v_cvt_pk_bf16_f32 v210, v178, v182
v_cvt_pk_bf16_f32 v211, v179, v183
v_mfma_f32_16x16x32_bf16 v[52:55], v[204:207], a[8:11], 0
ds_write_b128 v26, v[208:211] offset:1024
v_mfma_f32_16x16x32_bf16 v[56:59], v[204:207], a[12:15], 0
v_cvt_pk_bf16_f32 v212, v184, v188
v_cvt_pk_bf16_f32 v213, v185, v189
v_mfma_f32_16x16x32_bf16 v[60:63], v[204:207], a[16:19], 0
v_cvt_pk_bf16_f32 v214, v186, v190
v_cvt_pk_bf16_f32 v215, v187, v191
v_mfma_f32_16x16x32_bf16 v[64:67], v[204:207], a[20:23], 0
ds_write_b128 v26, v[212:215] offset:2048
v_mfma_f32_16x16x32_bf16 v[68:71], v[204:207], a[24:27], 0
v_cvt_pk_bf16_f32 v216, v192, v196
v_cvt_pk_bf16_f32 v217, v193, v197
v_mfma_f32_16x16x32_bf16 v[72:75], v[204:207], a[28:31], 0
v_cvt_pk_bf16_f32 v218, v194, v198
v_mfma_f32_16x16x32_bf16 v[44:47], v[208:211], a[32:35], v[44:47]
v_cvt_pk_bf16_f32 v219, v195, v199
v_mfma_f32_16x16x32_bf16 v[48:51], v[208:211], a[36:39], v[48:51]
ds_write_b128 v26, v[216:219] offset:3072
v_mfma_f32_16x16x32_bf16 v[52:55], v[208:211], a[40:43], v[52:55]
v_xor_b32 v245, 8192, v26
v_xor_b32 v244, 4096, v26
v_mfma_f32_16x16x32_bf16 v[56:59], v[208:211], a[44:47], v[56:59]
v_xor_b32 v232, 12288, v26
v_mfma_f32_16x16x32_bf16 v[60:63], v[208:211], a[48:51], v[60:63]
v_mfma_f32_16x16x32_bf16 v[64:67], v[208:211], a[52:55], v[64:67]
v_mfma_f32_16x16x32_bf16 v[68:71], v[208:211], a[56:59], v[68:71]
v_mfma_f32_16x16x32_bf16 v[72:75], v[208:211], a[60:63], v[72:75]
s_waitcnt lgkmcnt(0)
s_barrier
ds_read_b128 v[112:115], v245 offset:0
v_cmp_eq_u32 vcc, 0, v24
s_nop 0
s_and_b32 s40, vcc_lo, 0x0ff00ff0
s_cbranch_scc1 L_sp_168
L_spo_169:
s_cmp_ge_u32 s37, 56
s_cbranch_scc1 L_rel_170
buffer_store_dword v9, v33, s[4:7], s26 offen sc1
s_add_u32 s26, s26, 4096
L_rel_170:
v_mfma_f32_16x16x32_bf16 v[44:47], v[212:215], a[64:67], v[44:47]
s_cmp_ge_u32 s37, 62
s_cselect_b32 s42, 524288, 0
s_sub_u32 s77, s77, s42
v_mfma_f32_16x16x32_bf16 v[48:51], v[212:215], a[68:71], v[48:51]
s_add_u32 s79, s79, 4096
buffer_load_dwordx2 v[228:229], v6, s[16:19], s28 offen sc1
v_mfma_f32_16x16x32_bf16 v[52:55], v[212:215], a[72:75], v[52:55]
buffer_load_ushort v230, v254, s[16:19], s28 offen sc1
s_lshl_b32 s42, s32, 11
v_mfma_f32_16x16x32_bf16 v[56:59], v[212:215], a[76:79], v[56:59]
s_add_u32 s42, s42, s80
s_add_u32 m0, s42, 0
s_add_u32 s41, s77, 0
v_mfma_f32_16x16x32_bf16 v[60:63], v[212:215], a[80:83], v[60:63]
buffer_load_dwordx4 v2, s[4:7], s41 offen offset:0 sc1 lds
v_mfma_f32_16x16x32_bf16 v[64:67], v[212:215], a[84:87], v[64:67]
v_mfma_f32_16x16x32_bf16 v[68:71], v[212:215], a[88:91], v[68:71]
v_mfma_f32_16x16x32_bf16 v[72:75], v[212:215], a[92:95], v[72:75]
ds_read_b128 v[116:119], v245 offset:1024
v_mfma_f32_16x16x32_bf16 v[44:47], v[216:219], a[96:99], v[44:47]
buffer_load_dwordx4 v2, s[4:7], s41 offen offset:1024 sc1 lds
s_add_u32 m0, s42, 8192
v_mfma_f32_16x16x32_bf16 v[48:51], v[216:219], a[100:103], v[48:51]
s_add_u32 s41, s77, 33554432
v_mfma_f32_16x16x32_bf16 v[52:55], v[216:219], a[104:107], v[52:55]
v_mfma_f32_16x16x32_bf16 v[56:59], v[216:219], a[108:111], v[56:59]
v_mfma_f32_16x16x32_bf16 v[60:63], v[216:219], a[112:115], v[60:63]
buffer_load_dwordx4 v2, s[4:7], s41 offen offset:0 sc1 lds
v_mfma_f32_16x16x32_bf16 v[64:67], v[216:219], a[116:119], v[64:67]
v_mfma_f32_16x16x32_bf16 v[68:71], v[216:219], a[120:123], v[68:71]
v_mfma_f32_16x16x32_bf16 v[72:75], v[216:219], a[124:127], v[72:75]
ds_read_b128 v[108:111], v245 offset:2048
s_waitcnt vmcnt(5)
s_cmp_eq_u32 s76, 0
s_cbranch_scc1 L_np_171
s_mov_b64 exec, 3
buffer_store_dword v9, v2, s[4:7], s76 offen sc1
s_mov_b64 exec, -1
s_mov_b32 s76, 0
L_np_171:
s_waitcnt lgkmcnt(2)
v_mfma_f32_16x16x32_bf16 v[44:47], v[112:115], a[128:131], v[44:47]
buffer_load_dwordx4 v2, s[4:7], s41 offen offset:1024 sc1 lds
s_add_u32 m0, s42, 16384
v_mfma_f32_16x16x32_bf16 v[48:51], v[112:115], a[132:135], v[48:51]
s_add_u32 s41, s77, 67108864
v_mfma_f32_16x16x32_bf16 v[52:55], v[112:115], a[136:139], v[52:55]
v_mfma_f32_16x16x32_bf16 v[56:59], v[112:115], a[140:143], v[56:59]
v_mfma_f32_16x16x32_bf16 v[60:63], v[112:115], a[144:147], v[60:63]
buffer_load_dwordx4 v2, s[4:7], s41 offen offset:0 sc1 lds
v_mfma_f32_16x16x32_bf16 v[64:67], v[112:115], a[148:151], v[64:67]
v_mfma_f32_16x16x32_bf16 v[68:71], v[112:115], a[152:155], v[68:71]
v_mfma_f32_16x16x32_bf16 v[72:75], v[112:115], a[156:159], v[72:75]
ds_read_b128 v[112:115], v245 offset:3072
s_waitcnt lgkmcnt(2)
v_mfma_f32_16x16x32_bf16 v[44:47], v[116:119], a[160:163], v[44:47]
buffer_load_dwordx4 v2, s[4:7], s41 offen offset:1024 sc1 lds
s_add_u32 m0, s42, 24576
v_mfma_f32_16x16x32_bf16 v[48:51], v[116:119], a[164:167], v[48:51]
s_add_u32 s41, s77, 8192
v_mfma_f32_16x16x32_bf16 v[52:55], v[116:119], a[168:171], v[52:55]
v_mfma_f32_16x16x32_bf16 v[56:59], v[116:119], a[172:175], v[56:59]
v_mfma_f32_16x16x32_bf16 v[60:63], v[116:119], a[176:179], v[60:63]
buffer_load_dwordx4 v2, s[4:7], s41 offen offset:0 sc1 lds
v_mfma_f32_16x16x32_bf16 v[64:67], v[116:119], a[180:183], v[64:67]
v_mfma_f32_16x16x32_bf16 v[68:71], v[116:119], a[184:187], v[68:71]
v_mfma_f32_16x16x32_bf16 v[72:75], v[116:119], a[188:191], v[72:75]
ds_read_b128 v[116:119], v244 offset:0
s_waitcnt lgkmcnt(2)
v_mfma_f32_16x16x32_bf16 v[44:47], v[108:111], a[192:195], v[44:47]
buffer_load_dwordx4 v2, s[4:7], s41 offen offset:1024 sc1 lds
s_add_u32 m0, s42, 32768
v_mfma_f32_16x16x32_bf16 v[48:51], v[108:111], a[196:199], v[48:51]
s_add_u32 s41, s77, 33562624
v_mfma_f32_16x16x32_bf16 v[52:55], v[108:111], a[200:203], v[52:55]
v_mfma_f32_16x16x32_bf16 v[56:59], v[108:111], a[204:207], v[56:59]
v_mfma_f32_16x16x32_bf16 v[60:63], v[108:111], a[208:211], v[60:63]
buffer_load_dwordx4 v2, s[4:7], s41 offen offset:0 sc1 lds
v_mfma_f32_16x16x32_bf16 v[64:67], v[108:111], a[212:215], v[64:67]
v_mfma_f32_16x16x32_bf16 v[68:71], v[108:111], a[216:219], v[68:71]
v_mfma_f32_16x16x32_bf16 v[72:75], v[108:111], a[220:223], v[72:75]
ds_read_b128 v[108:111], v244 offset:1024
s_waitcnt lgkmcnt(2)
v_mfma_f32_16x16x32_bf16 v[44:47], v[112:115], a[224:227], v[44:47]
buffer_load_dwordx4 v2, s[4:7], s41 offen offset:1024 sc1 lds
s_add_u32 m0, s42, 40960
v_mfma_f32_16x16x32_bf16 v[48:51], v[112:115], a[228:231], v[48:51]
s_add_u32 s41, s77, 67117056
v_mfma_f32_16x16x32_bf16 v[52:55], v[112:115], a[232:235], v[52:55]
v_mfma_f32_16x16x32_bf16 v[56:59], v[112:115], a[236:239], v[56:59]
v_mfma_f32_16x16x32_bf16 v[60:63], v[112:115], a[240:243], v[60:63]
buffer_load_dwordx4 v2, s[4:7], s41 offen offset:0 sc1 lds
v_mfma_f32_16x16x32_bf16 v[64:67], v[112:115], a[244:247], v[64:67]
v_mfma_f32_16x16x32_bf16 v[68:71], v[112:115], a[248:251], v[68:71]
v_mfma_f32_16x16x32_bf16 v[72:75], v[112:115], a[252:255], v[72:75]
ds_read_b128 v[112:115], v244 offset:2048
s_waitcnt lgkmcnt(2)
v_mfma_f32_16x16x32_bf16 v[76:79], v[116:119], a[0:3], 0
buffer_load_dwordx4 v2, s[4:7], s41 offen offset:1024 sc1 lds
s_add_u32 s77, s77, 524288
v_mfma_f32_16x16x32_bf16 v[80:83], v[116:119], a[4:7], 0
v_cvt_pk_bf16_f32 v220, v44, v48
v_cvt_pk_bf16_f32 v221, v52, v56
v_mfma_f32_16x16x32_bf16 v[84:87], v[116:119], a[8:11], 0
v_cvt_pk_bf16_f32 v222, v60, v64
v_cvt_pk_bf16_f32 v223, v68, v72
v_mfma_f32_16x16x32_bf16 v[88:91], v[116:119], a[12:15], 0
v_bfi_b32 v220, 1, s101, v220
v_bfi_b32 v221, 1, s101, v221
v_mfma_f32_16x16x32_bf16 v[92:95], v[116:119], a[16:19], 0
v_bfi_b32 v222, 1, s101, v222
v_bfi_b32 v223, 1, s101, v223
s_add_u32 s40, s39, 0
v_mfma_f32_16x16x32_bf16 v[96:99], v[116:119], a[20:23], 0
buffer_store_dwordx4 v[220:223], v8, s[4:7], s40 offen sc1
v_mfma_f32_16x16x32_bf16 v[100:103], v[116:119], a[24:27], 0
v_mfma_f32_16x16x32_bf16 v[104:107], v[116:119], a[28:31], 0
ds_read_b128 v[116:119], v244 offset:3072
s_waitcnt lgkmcnt(2)
v_mfma_f32_16x16x32_bf16 v[76:79], v[108:111], a[32:35], v[76:79]
v_cvt_pk_bf16_f32 v216, v45, v49
v_cvt_pk_bf16_f32 v217, v53, v57
v_mfma_f32_16x16x32_bf16 v[80:83], v[108:111], a[36:39], v[80:83]
v_cvt_pk_bf16_f32 v218, v61, v65
v_cvt_pk_bf16_f32 v219, v69, v73
v_mfma_f32_16x16x32_bf16 v[84:87], v[108:111], a[40:43], v[84:87]
v_bfi_b32 v216, 1, s101, v216
v_bfi_b32 v217, 1, s101, v217
v_mfma_f32_16x16x32_bf16 v[88:91], v[108:111], a[44:47], v[88:91]
v_bfi_b32 v218, 1, s101, v218
v_bfi_b32 v219, 1, s101, v219
s_add_u32 s40, s39, 32768
v_mfma_f32_16x16x32_bf16 v[92:95], v[108:111], a[48:51], v[92:95]
buffer_store_dwordx4 v[216:219], v8, s[4:7], s40 offen sc1
v_mfma_f32_16x16x32_bf16 v[96:99], v[108:111], a[52:55], v[96:99]
v_mfma_f32_16x16x32_bf16 v[100:103], v[108:111], a[56:59], v[100:103]
v_mfma_f32_16x16x32_bf16 v[104:107], v[108:111], a[60:63], v[104:107]
ds_read_b128 v[108:111], v232 offset:0
s_waitcnt lgkmcnt(2)
v_mfma_f32_16x16x32_bf16 v[76:79], v[112:115], a[64:67], v[76:79]
v_cvt_pk_bf16_f32 v220, v46, v50
v_cvt_pk_bf16_f32 v221, v54, v58
v_mfma_f32_16x16x32_bf16 v[80:83], v[112:115], a[68:71], v[80:83]
v_cvt_pk_bf16_f32 v222, v62, v66
v_cvt_pk_bf16_f32 v223, v70, v74
v_mfma_f32_16x16x32_bf16 v[84:87], v[112:115], a[72:75], v[84:87]
v_bfi_b32 v220, 1, s101, v220
v_bfi_b32 v221, 1, s101, v221
v_mfma_f32_16x16x32_bf16 v[88:91], v[112:115], a[76:79], v[88:91]
v_bfi_b32 v222, 1, s101, v222
v_bfi_b32 v223, 1, s101, v223
s_add_u32 s40, s39, 65536
v_mfma_f32_16x16x32_bf16 v[92:95], v[112:115], a[80:83], v[92:95]
buffer_store_dwordx4 v[220:223], v8, s[4:7], s40 offen sc1
v_mfma_f32_16x16x32_bf16 v[96:99], v[112:115], a[84:87], v[96:99]
v_mfma_f32_16x16x32_bf16 v[100:103], v[112:115], a[88:91], v[100:103]
v_mfma_f32_16x16x32_bf16 v[104:107], v[112:115], a[92:95], v[104:107]
ds_read_b128 v[112:115], v232 offset:1024
s_waitcnt lgkmcnt(2)
v_mfma_f32_16x16x32_bf16 v[76:79], v[116:119], a[96:99], v[76:79]
v_cvt_pk_bf16_f32 v216, v47, v51
v_cvt_pk_bf16_f32 v217, v55, v59
v_mfma_f32_16x16x32_bf16 v[80:83], v[116:119], a[100:103], v[80:83]
v_cvt_pk_bf16_f32 v218, v63, v67
v_cvt_pk_bf16_f32 v219, v71, v75
v_mfma_f32_16x16x32_bf16 v[84:87], v[116:119], a[104:107], v[84:87]
v_bfi_b32 v216, 1, s101, v216
v_bfi_b32 v217, 1, s101, v217
v_mfma_f32_16x16x32_bf16 v[88:91], v[116:119], a[108:111], v[88:91]
v_bfi_b32 v218, 1, s101, v218
v_bfi_b32 v219, 1, s101, v219
s_add_u32 s40, s39, 98304
v_mfma_f32_16x16x32_bf16 v[92:95], v[116:119], a[112:115], v[92:95]
buffer_store_dwordx4 v[216:219], v8, s[4:7], s40 offen sc1
v_mfma_f32_16x16x32_bf16 v[96:99], v[116:119], a[116:119], v[96:99]
v_mfma_f32_16x16x32_bf16 v[100:103], v[116:119], a[120:123], v[100:103]
v_mfma_f32_16x16x32_bf16 v[104:107], v[116:119], a[124:127], v[104:107]
ds_read_b128 v[116:119], v232 offset:2048
s_waitcnt lgkmcnt(2)
v_mfma_f32_16x16x32_bf16 v[76:79], v[108:111], a[128:131], v[76:79]
v_mfma_f32_16x16x32_bf16 v[80:83], v[108:111], a[132:135], v[80:83]
v_mfma_f32_16x16x32_bf16 v[84:87], v[108:111], a[136:139], v[84:87]
v_mfma_f32_16x16x32_bf16 v[88:91], v[108:111], a[140:143], v[88:91]
v_mfma_f32_16x16x32_bf16 v[92:95], v[108:111], a[144:147], v[92:95]
v_mfma_f32_16x16x32_bf16 v[96:99], v[108:111], a[148:151], v[96:99]
v_mfma_f32_16x16x32_bf16 v[100:103], v[108:111], a[152:155], v[100:103]
v_mfma_f32_16x16x32_bf16 v[104:107], v[108:111], a[156:159], v[104:107]
ds_read_b128 v[108:111], v232 offset:3072
s_waitcnt lgkmcnt(2)
v_mfma_f32_16x16x32_bf16 v[76:79], v[112:115], a[160:163], v[76:79]
v_mfma_f32_16x16x32_bf16 v[80:83], v[112:115], a[164:167], v[80:83]
v_mfma_f32_16x16x32_bf16 v[84:87], v[112:115], a[168:171], v[84:87]
v_mfma_f32_16x16x32_bf16 v[88:91], v[112:115], a[172:175], v[88:91]
v_mfma_f32_16x16x32_bf16 v[92:95], v[112:115], a[176:179], v[92:95]
v_mfma_f32_16x16x32_bf16 v[96:99], v[112:115], a[180:183], v[96:99]
v_mfma_f32_16x16x32_bf16 v[100:103], v[112:115], a[184:187], v[100:103]
v_mfma_f32_16x16x32_bf16 v[104:107], v[112:115], a[188:191], v[104:107]
s_waitcnt lgkmcnt(1)
v_mfma_f32_16x16x32_bf16 v[76:79], v[116:119], a[192:195], v[76:79]
v_mfma_f32_16x16x32_bf16 v[80:83], v[116:119], a[196:199], v[80:83]
v_mfma_f32_16x16x32_bf16 v[84:87], v[116:119], a[200:203], v[84:87]
v_mfma_f32_16x16x32_bf16 v[88:91], v[116:119], a[204:207], v[88:91]
v_mfma_f32_16x16x32_bf16 v[92:95], v[116:119], a[208:211], v[92:95]
v_mfma_f32_16x16x32_bf16 v[96:99], v[116:119], a[212:215], v[96:99]
v_mfma_f32_16x16x32_bf16 v[100:103], v[116:119], a[216:219], v[100:103]
v_mfma_f32_16x16x32_bf16 v[104:107], v[116:119], a[220:223], v[104:107]
s_waitcnt lgkmcnt(0)
v_mfma_f32_16x16x32_bf16 v[76:79], v[108:111], a[224:227], v[76:79]
v_mfma_f32_16x16x32_bf16 v[80:83], v[108:111], a[228:231], v[80:83]
v_mfma_f32_16x16x32_bf16 v[84:87], v[108:111], a[232:235], v[84:87]
v_mfma_f32_16x16x32_bf16 v[88:91], v[108:111], a[236:239], v[88:91]
v_mfma_f32_16x16x32_bf16 v[92:95], v[108:111], a[240:243], v[92:95]
v_mfma_f32_16x16x32_bf16 v[96:99], v[108:111], a[244:247], v[96:99]
v_mfma_f32_16x16x32_bf16 v[100:103], v[108:111], a[248:251], v[100:103]
v_mfma_f32_16x16x32_bf16 v[104:107], v[108:111], a[252:255], v[104:107]
s_nop 1
v_cvt_pk_bf16_f32 v216, v76, v80
s_nop 0
v_cvt_pk_bf16_f32 v217, v84, v88
s_nop 0
v_cvt_pk_bf16_f32 v218, v92, v96
s_nop 0
v_cvt_pk_bf16_f32 v219, v100, v104
v_bfi_b32 v216, 1, s101, v216
v_bfi_b32 v217, 1, s101, v217
v_bfi_b32 v218, 1, s101, v218
v_bfi_b32 v219, 1, s101, v219
s_add_u32 s40, s39, 0
buffer_store_dwordx4 v[216:219], v253, s[4:7], s40 offen sc1
v_cvt_pk_bf16_f32 v220, v77, v81
v_cvt_pk_bf16_f32 v221, v85, v89
v_cvt_pk_bf16_f32 v222, v93, v97
v_cvt_pk_bf16_f32 v223, v101, v105
v_bfi_b32 v220, 1, s101, v220
v_bfi_b32 v221, 1, s101, v221
v_bfi_b32 v222, 1, s101, v222
v_bfi_b32 v223, 1, s101, v223
s_add_u32 s40, s39, 32768
buffer_store_dwordx4 v[220:223], v253, s[4:7], s40 offen sc1
v_cvt_pk_bf16_f32 v216, v78, v82
v_cvt_pk_bf16_f32 v217, v86, v90
v_cvt_pk_bf16_f32 v218, v94, v98
v_cvt_pk_bf16_f32 v219, v102, v106
v_bfi_b32 v216, 1, s101, v216
v_bfi_b32 v217, 1, s101, v217
v_bfi_b32 v218, 1, s101, v218
v_bfi_b32 v219, 1, s101, v219
s_add_u32 s40, s39, 65536
buffer_store_dwordx4 v[216:219], v253, s[4:7], s40 offen sc1
v_cvt_pk_bf16_f32 v220, v79, v83
v_cvt_pk_bf16_f32 v221, v87, v91
v_cvt_pk_bf16_f32 v222, v95, v99
v_cvt_pk_bf16_f32 v223, v103, v107
v_bfi_b32 v220, 1, s101, v220
v_bfi_b32 v221, 1, s101, v221
v_bfi_b32 v222, 1, s101, v222
v_bfi_b32 v223, 1, s101, v223
s_add_u32 s40, s39, 98304
buffer_store_dwordx4 v[220:223], v253, s[4:7], s40 offen sc1
s_add_u32 s43, s39, 0
buffer_load_dwordx4 v[192:195], v5, s[4:7], s43 offen sc1
s_add_u32 s43, s39, 4096
buffer_load_dwordx4 v[196:199], v5, s[4:7], s43 offen sc1
s_add_u32 s43, s39, 8192
buffer_load_dwordx4 v[200:203], v5, s[4:7], s43 offen sc1
s_add_u32 s43, s39, 12288
buffer_load_dwordx4 v[204:207], v5, s[4:7], s43 offen sc1
s_waitcnt vmcnt(0)
s_add_u32 s43, s39, 0
buffer_load_dwordx4 v[208:211], v252, s[4:7], s43 offen sc1
s_add_u32 s43, s39, 4096
buffer_load_dwordx4 v[212:215], v252, s[4:7], s43 offen sc1
s_add_u32 s43, s39, 8192
buffer_load_dwordx4 v[216:219], v252, s[4:7], s43 offen sc1
s_add_u32 s43, s39, 12288
buffer_load_dwordx4 v[220:223], v252, s[4:7], s43 offen sc1
L_rea2_175:
v_mov_b32 v232, 0
v_mov_b32 v233, -1
v_mfma_f32_16x16x32_bf16 v[240:243], v[12:15], v[192:195], 0
v_or3_b32 v232, v232, v192, v193
v_bitop3_b32 v233, v233, v192, v193 bitop3:0x80
v_or3_b32 v232, v232, v194, v195
v_bitop3_b32 v233, v233, v194, v195 bitop3:0x80
v_mfma_f32_16x16x32_bf16 v[240:243], v[12:15], v[196:199], v[240:243]
v_or3_b32 v232, v232, v196, v197
v_bitop3_b32 v233, v233, v196, v197 bitop3:0x80
v_or3_b32 v232, v232, v198, v199
v_bitop3_b32 v233, v233, v198, v199 bitop3:0x80
v_mfma_f32_16x16x32_bf16 v[240:243], v[12:15], v[200:203], v[240:243]
v_or3_b32 v232, v232, v200, v201
v_bitop3_b32 v233, v233, v200, v201 bitop3:0x80
v_or3_b32 v232, v232, v202, v203
v_bitop3_b32 v233, v233, v202, v203 bitop3:0x80
v_mfma_f32_16x16x32_bf16 v[240:243], v[12:15], v[204:207], v[240:243]
v_or3_b32 v232, v232, v204, v205
v_bitop3_b32 v233, v233, v204, v205 bitop3:0x80
v_or3_b32 v232, v232, v206, v207
v_bitop3_b32 v233, v233, v206, v207 bitop3:0x80
v_xor_b32 v232, s101, v232
v_bitop3_b32 v232, v232, v233, s101 bitop3:0xf6
v_and_b32 v232, 1, v232
v_cmp_ne_u32 vcc, 0, v232
s_cbranch_vccnz L_rea_174
v_lshlrev_b32 v236, 16, v228
v_and_b32 v237, 0xffff0000, v228
v_lshlrev_b32 v238, 16, v229
v_and_b32 v239, 0xffff0000, v229
L_red2_173:
v_mov_b32 v232, 0
v_mov_b32 v233, -1
s_waitcnt vmcnt(3)
v_mfma_f32_16x16x32_bf16 v[224:227], v[16:19], v[208:211], v[240:243]
v_or3_b32 v232, v232, v208, v209
v_bitop3_b32 v233, v233, v208, v209 bitop3:0x80
v_or3_b32 v232, v232, v210, v211
v_bitop3_b32 v233, v233, v210, v211 bitop3:0x80
s_waitcnt vmcnt(2)
v_mfma_f32_16x16x32_bf16 v[224:227], v[16:19], v[212:215], v[224:227]
v_or3_b32 v232, v232, v212, v213
v_bitop3_b32 v233, v233, v212, v213 bitop3:0x80
v_or3_b32 v232, v232, v214, v215
v_bitop3_b32 v233, v233, v214, v215 bitop3:0x80
s_waitcnt vmcnt(1)
v_mfma_f32_16x16x32_bf16 v[224:227], v[16:19], v[216:219], v[224:227]
v_or3_b32 v232, v232, v216, v217
v_bitop3_b32 v233, v233, v216, v217 bitop3:0x80
v_or3_b32 v232, v232, v218, v219
v_bitop3_b32 v233, v233, v218, v219 bitop3:0x80
s_waitcnt vmcnt(0)
v_mfma_f32_16x16x32_bf16 v[224:227], v[16:19], v[220:223], v[224:227]
v_or3_b32 v232, v232, v220, v221
v_bitop3_b32 v233, v233, v220, v221 bitop3:0x80
v_or3_b32 v232, v232, v222, v223
v_bitop3_b32 v233, v233, v222, v223 bitop3:0x80
v_xor_b32 v232, s101, v232
v_bitop3_b32 v232, v232, v233, s101 bitop3:0xf6
v_and_b32 v232, 1, v232
v_cmp_ne_u32 vcc, 0, v232
s_cbranch_vccnz L_red_172
v_add_f32 v236, v236, v224
v_add_f32 v237, v237, v225
v_add_f32 v238, v238, v226
v_add_f32 v239, v239, v227
v_cvt_pk_bf16_f32 v224, v236, v237
v_cvt_pk_bf16_f32 v225, v238, v239
s_add_u32 s41, s37, 2
s_bfe_u32 s25, s41, 0x10003
s_and_b32 s41, s41, 7
s_lshl_b32 s41, s41, 17
s_add_u32 s78, s41, s24
buffer_load_dword v24, v38, s[4:7], s79 offen sc1
v_lshlrev_b32 v234, 16, v230
v_lshlrev_b32 v236, 16, v224
v_and_b32 v237, 0xffff0000, v224
v_lshlrev_b32 v238, 16, v225
v_and_b32 v239, 0xffff0000, v225
v_sub_f32 v236, v236, v234
v_sub_f32 v237, v237, v234
v_sub_f32 v238, v238, v234
v_sub_f32 v239, v239, v234
v_add_f32 v232, v236, v237
buffer_load_dwordx4 v[92:95], v21, s[4:7], s78 offen offset:0 sc1
v_mul_f32 v233, v236, v236
v_add_f32 v232, v232, v238
v_fmac_f32 v233, v237, v237
v_add_f32 v232, v232, v239
v_fmac_f32 v233, v238, v238
v_fmac_f32 v233, v239, v239
v_add_f32_dpp v232, v232, v232 row_ror:8 row_mask:0xf bank_mask:0xf
s_nop 0
v_add_f32_dpp v233, v233, v233 row_ror:8 row_mask:0xf bank_mask:0xf
v_add_f32_dpp v232, v232, v232 row_ror:4 row_mask:0xf bank_mask:0xf
s_nop 0
v_add_f32_dpp v233, v233, v233 row_ror:4 row_mask:0xf bank_mask:0xf
v_add_f32_dpp v232, v232, v232 row_ror:2 row_mask:0xf bank_mask:0xf
s_nop 0
v_add_f32_dpp v233, v233, v233 row_ror:2 row_mask:0xf bank_mask:0xf
v_add_f32_dpp v232, v232, v232 row_ror:1 row_mask:0xf bank_mask:0xf
s_nop 0
v_add_f32_dpp v233, v233, v233 row_ror:1 row_mask:0xf bank_mask:0xf
s_nop 1
v_permlane16_swap_b32 v232, v233
v_add_f32 v232, v232, v233
ds_write_b32 v10, v232
s_waitcnt lgkmcnt(0)
s_barrier
ds_read_b128 v[192:195], v11
ds_read_b128 v[196:199], v11 offset:16
v_mov_b32 v235, 0x3727c5ac
s_waitcnt lgkmcnt(1)
v_add_f32 v192, v192, v193
buffer_load_dwordx4 v[96:99], v21, s[4:7], s78 offen offset:512 sc1
v_add_f32 v194, v194, v195
v_add_f32 v192, v192, v194
s_waitcnt lgkmcnt(0)
v_add_f32 v196, v196, v197
v_add_f32 v198, v198, v199
v_mul_f32 v192, 0x3b000000, v192
v_add_f32 v196, v196, v198
v_mul_f32 v196, 0x3b000000, v196
v_fma_f32 v196, -v192, v192, v196
v_max_f32 v196, 0, v196
v_add_f32 v235, v235, v196
buffer_load_dwordx4 v[100:103], v21, s[4:7], s78 offen offset:1024 sc1
v_rsq_f32 v235, v235
v_sub_f32 v236, v236, v192
v_sub_f32 v237, v237, v192
v_sub_f32 v238, v238, v192
v_sub_f32 v239, v239, v192
v_mul_f32 v236, v236, v235
v_mul_f32 v237, v237, v235
v_mul_f32 v238, v238, v235
v_mul_f32 v239, v239, v235
v_cvt_pk_bf16_f32 v192, v236, v237
buffer_load_dwordx4 v[104:107], v21, s[4:7], s78 offen offset:1536 sc1
v_cvt_pk_bf16_f32 v193, v238, v239
buffer_store_dwordx2 v[192:193], v7, s[4:7], s30 offen sc1
buffer_store_dwordx2 v[224:225], v6, s[4:7], s29 offen sc1
s_mov_b32 s76, s31
s_xor_b32 s39, s39, 524288
s_add_u32 s28, s28, 65536
s_add_u32 s29, s29, 65536
s_add_u32 s30, s30, 65536
s_add_u32 s31, s31, 1024
s_add_u32 s37, s37, 2
s_bfe_u32 s101, s37, 0x10002
s_cmp_lt_u32 s37, 64
s_cbranch_scc1 L_att_loop_G
s_waitcnt vmcnt(0)
s_cmp_eq_u32 s76, 0
s_cbranch_scc1 L_np_176
s_mov_b64 exec, 3
buffer_store_dword v9, v2, s[4:7], s76 offen sc1
s_mov_b64 exec, -1
s_mov_b32 s76, 0
L_np_176:
s_endpgm
L_sp_155:
s_cmp_ge_u32 s37, 62
s_cbranch_scc1 L_spo_156
s_sub_u32 s36, s36, 1
s_cbranch_scc1 L_end_att_G
buffer_load_dword v24, v38, s[4:7], s79 offen sc1
s_waitcnt vmcnt(0)
v_cmp_eq_u32 vcc, 0, v24
s_nop 0
s_and_b32 s40, vcc_lo, 0x0ff00ff0
s_cbranch_scc1 L_sp_155
s_branch L_spo_156
L_km2_159:
s_sub_u32 s36, s36, 1
s_cbranch_scc1 L_end_att_G
buffer_load_dwordx4 v[92:95], v21, s[4:7], s78 offen offset:0 sc1
buffer_load_dwordx4 v[96:99], v21, s[4:7], s78 offen offset:512 sc1
buffer_load_dwordx4 v[100:103], v21, s[4:7], s78 offen offset:1024 sc1
buffer_load_dwordx4 v[104:107], v21, s[4:7], s78 offen offset:1536 sc1
L_km_157:
s_waitcnt vmcnt(0)
s_cmp_eq_u32 s76, 0
s_cbranch_scc1 L_np_177
s_mov_b64 exec, 3
buffer_store_dword v9, v2, s[4:7], s76 offen sc1
s_mov_b64 exec, -1
s_mov_b32 s76, 0
L_np_177:
s_branch L_kmo_158
L_kv_160:
v_mfma_f32_16x16x32_bf16 v[164:167], v[92:95], v[44:47], 0
v_mfma_f32_16x16x32_bf16 v[164:167], v[96:99], v[48:51], v[164:167]
v_mfma_f32_16x16x32_bf16 v[164:167], v[100:103], v[52:55], v[164:167]
v_mfma_f32_16x16x32_bf16 v[164:167], v[104:107], v[56:59], v[164:167]
s_branch L_kj_161
L_smx_163:
v_mov_b32 v249, v248
s_nop 1
v_permlane16_swap_b32 v248, v249
v_max_f32 v248, v248, v249
v_mov_b32 v249, v248
s_nop 1
v_permlane32_swap_b32 v248, v249
v_max_f32 v248, v248, v249
v_sub_f32 v156, v156, v248
v_sub_f32 v157, v157, v248
v_sub_f32 v158, v158, v248
v_sub_f32 v159, v159, v248
v_sub_f32 v160, v160, v248
v_sub_f32 v161, v161, v248
v_sub_f32 v162, v162, v248
v_sub_f32 v163, v163, v248
v_sub_f32 v164, v164, v248
v_sub_f32 v165, v165, v248
s_branch L_smb_164
L_vm_165:
s_sub_u32 s36, s36, 1
s_cbranch_scc1 L_end_att_G
buffer_load_dwordx2 v[140:141], v22, s[4:7], s78 offen offset:2048 sc1
buffer_load_dwordx2 v[144:145], v22, s[4:7], s78 offen offset:2560 sc1
buffer_load_dwordx2 v[148:149], v22, s[4:7], s78 offen offset:3072 sc1
buffer_load_dwordx2 v[152:153], v22, s[4:7], s78 offen offset:3584 sc1
s_branch L_vmo_166
L_sp_168:
s_cmp_ge_u32 s37, 62
s_cbranch_scc1 L_spo_169
s_sub_u32 s36, s36, 1
s_cbranch_scc1 L_end_att_G
buffer_load_dword v24, v38, s[4:7], s79 offen sc1
s_waitcnt vmcnt(0)
v_cmp_eq_u32 vcc, 0, v24
s_nop 0
s_and_b32 s40, vcc_lo, 0x0ff00ff0
s_cbranch_scc1 L_sp_168
s_branch L_spo_169
L_rea_174:
s_sub_u32 s36, s36, 1
s_cbranch_scc1 L_end_att_G
s_add_u32 s43, s39, 0
buffer_load_dwordx4 v[192:195], v5, s[4:7], s43 offen sc1
s_add_u32 s43, s39, 4096
buffer_load_dwordx4 v[196:199], v5, s[4:7], s43 offen sc1
s_add_u32 s43, s39, 8192
buffer_load_dwordx4 v[200:203], v5, s[4:7], s43 offen sc1
s_add_u32 s43, s39, 12288
buffer_load_dwordx4 v[204:207], v5, s[4:7], s43 offen sc1
s_waitcnt vmcnt(0)
s_branch L_rea2_175
L_red_172:
s_sub_u32 s36, s36, 1
s_cbranch_scc1 L_end_att_G
s_add_u32 s43, s39, 0
buffer_load_dwordx4 v[208:211], v252, s[4:7], s43 offen sc1
s_add_u32 s43, s39, 4096
buffer_load_dwordx4 v[212:215], v252, s[4:7], s43 offen sc1
s_add_u32 s43, s39, 8192
buffer_load_dwordx4 v[216:219], v252, s[4:7], s43 offen sc1
s_add_u32 s43, s39, 12288
buffer_load_dwordx4 v[220:223], v252, s[4:7], s43 offen sc1
s_waitcnt vmcnt(0)
s_branch L_red2_173
L_end_att_G:
s_endpgm
.p2align 6
R_ffn_G:
s_sub_u32 s38, s35, 5
s_lshr_b32 s38, s38, 1
v_and_b32 v3, 15, v1
v_lshrrev_b32 v4, 4, v1
s_and_b32 s98, s34, 15
s_lshr_b32 s99, s34, 4
s_sub_u32 s40, s35, 4
s_lshl_b32 s40, s40, 1
s_add_u32 s40, s40, s99
s_lshl_b32 s40, s40, 20
s_add_u32 s39, s40, 2097152
s_lshl_b32 s40, s98, 15
s_lshl_b32 s41, s32, 8
s_add_u32 s40, s40, s41
v_lshlrev_b32 v68, 4, v3
v_lshl_add_u32 v69, v4, 10, v68
v_add_u32 v5, s40, v69
s_and_b32 s3, s32, 0
s_lshl_b32 s42, s3, 14
v_add_u32 v5, s42, v5
v_xor_b32 v0, 16384, v5
s_lshl_b32 s40, s98, 10
s_add_u32 s40, s40, s41
v_lshl_add_u32 v69, v4, 17, v68
v_add3_u32 v8, v69, s40, 0
v_add_u32 v8, s42, v8
v_xor_b32 v27, 16384, v8
v_and_b32 v69, 1, v4
v_lshlrev_b32 v69, 3, v69
v_lshrrev_b32 v70, 1, v4
v_lshl_add_u32 v69, v70, 10, v69
s_lshl_b32 s40, s34, 11
s_add_u32 s40, s40, s41
v_add3_u32 v6, v68, v69, s40
v_and_b32 v31, 0xfffffc00, v6
v_xor_b32 v68, s98, v3
v_lshlrev_b32 v68, 4, v68
v_add3_u32 v7, v68, v69, s40
v_mov_b32 v9, 1
v_lshlrev_b32 v70, 6, v70
v_add_u32 v11, 163712, v70
s_lshl_b32 s40, s32, 2
v_and_b32 v70, 1, v4
v_lshlrev_b32 v70, 4, v70
v_add3_u32 v10, v70, v11, s40
s_mov_b32 s37, s99
s_mov_b32 s76, 0
s_mov_b32 s101, 0
s_lshl_b32 s42, s3, 3
v_xor_b32 v70, s42, v3
v_mov_b32 v12, 0
v_cmp_eq_u32 vcc, 0, v70
v_mov_b32 v69, 0x3f80
s_nop 0
v_cndmask_b32 v12, v12, v69, vcc
v_cmp_eq_u32 vcc, 1, v70
v_mov_b32 v69, 0x3f800000
s_nop 0
v_cndmask_b32 v12, v12, v69, vcc
v_mov_b32 v16, 0
v_cmp_eq_u32 vcc, 8, v70
v_mov_b32 v69, 0x3f80
s_nop 0
v_cndmask_b32 v16, v16, v69, vcc
v_cmp_eq_u32 vcc, 9, v70
v_mov_b32 v69, 0x3f800000
s_nop 0
v_cndmask_b32 v16, v16, v69, vcc
v_mov_b32 v13, 0
v_cmp_eq_u32 vcc, 2, v70
v_mov_b32 v69, 0x3f80
s_nop 0
v_cndmask_b32 v13, v13, v69, vcc
v_cmp_eq_u32 vcc, 3, v70
v_mov_b32 v69, 0x3f800000
s_nop 0
v_cndmask_b32 v13, v13, v69, vcc
v_mov_b32 v17, 0
v_cmp_eq_u32 vcc, 10, v70
v_mov_b32 v69, 0x3f80
s_nop 0
v_cndmask_b32 v17, v17, v69, vcc
v_cmp_eq_u32 vcc, 11, v70
v_mov_b32 v69, 0x3f800000
s_nop 0
v_cndmask_b32 v17, v17, v69, vcc
v_mov_b32 v14, 0
v_cmp_eq_u32 vcc, 4, v70
v_mov_b32 v69, 0x3f80
s_nop 0
v_cndmask_b32 v14, v14, v69, vcc
v_cmp_eq_u32 vcc, 5, v70
v_mov_b32 v69, 0x3f800000
s_nop 0
v_cndmask_b32 v14, v14, v69, vcc
v_mov_b32 v18, 0
v_cmp_eq_u32 vcc, 12, v70
v_mov_b32 v69, 0x3f80
s_nop 0
v_cndmask_b32 v18, v18, v69, vcc
v_cmp_eq_u32 vcc, 13, v70
v_mov_b32 v69, 0x3f800000
s_nop 0
v_cndmask_b32 v18, v18, v69, vcc
v_mov_b32 v15, 0
v_cmp_eq_u32 vcc, 6, v70
v_mov_b32 v69, 0x3f80
s_nop 0
v_cndmask_b32 v15, v15, v69, vcc
v_cmp_eq_u32 vcc, 7, v70
v_mov_b32 v69, 0x3f800000
s_nop 0
v_cndmask_b32 v15, v15, v69, vcc
v_mov_b32 v19, 0
v_cmp_eq_u32 vcc, 14, v70
v_mov_b32 v69, 0x3f80
s_nop 0
v_cndmask_b32 v19, v19, v69, vcc
v_cmp_eq_u32 vcc, 15, v70
v_mov_b32 v69, 0x3f800000
s_nop 0
v_cndmask_b32 v19, v19, v69, vcc
s_waitcnt vmcnt(0)
s_barrier
s_cmp_lg_u32 s32, 0
s_cbranch_scc1 L_da_178
v_mov_b32 v72, 1
s_lshl_b32 s40, s33, 5
v_mov_b32 v73, s40
s_mov_b64 exec, 1
buffer_atomic_add v72, v73, s[8:11], 0 offen offset:12
s_mov_b64 exec, -1
L_da_178:
s_sub_u32 s40, s35, 4
s_lshl_b32 s40, s40, 5
s_add_u32 s40, s40, s34
s_lshl_b32 s40, s40, 2
s_add_u32 s40, s40, s32
s_mul_i32 s40, s40, 7168
s_mov_b32 s12, s54
s_mov_b32 s13, s55
s_mov_b32 s14, 4194304
s_mov_b32 s15, 0x20000
s_add_u32 s41, s40, 0
buffer_load_dwordx4 v[76:79], v2, s[12:15], s41 offen offset:0
buffer_load_dwordx4 v[76:79], v2, s[12:15], s41 offen offset:1024
buffer_load_dwordx4 v[76:79], v2, s[12:15], s41 offen offset:2048
buffer_load_dwordx4 v[76:79], v2, s[12:15], s41 offen offset:3072
s_add_u32 s41, s40, 4096
buffer_load_dwordx4 v[76:79], v2, s[12:15], s41 offen offset:0
buffer_load_dwordx4 v[76:79], v2, s[12:15], s41 offen offset:1024
buffer_load_dwordx4 v[76:79], v2, s[12:15], s41 offen offset:2048
s_mov_b32 s12, s56
s_mov_b32 s13, s57
s_mov_b32 s14, 4194304
s_mov_b32 s15, 0x20000
s_add_u32 s41, s40, 0
buffer_load_dwordx4 v[76:79], v2, s[12:15], s41 offen offset:0
buffer_load_dwordx4 v[76:79], v2, s[12:15], s41 offen offset:1024
buffer_load_dwordx4 v[76:79], v2, s[12:15], s41 offen offset:2048
buffer_load_dwordx4 v[76:79], v2, s[12:15], s41 offen offset:3072
s_add_u32 s41, s40, 4096
buffer_load_dwordx4 v[76:79], v2, s[12:15], s41 offen offset:0
buffer_load_dwordx4 v[76:79], v2, s[12:15], s41 offen offset:1024
buffer_load_dwordx4 v[76:79], v2, s[12:15], s41 offen offset:2048
s_mov_b32 s12, s52
s_mov_b32 s13, s53
s_mov_b32 s14, 4194304
s_mov_b32 s15, 0x20000
s_add_u32 s41, s40, 0
buffer_load_dwordx4 v[76:79], v2, s[12:15], s41 offen offset:0
buffer_load_dwordx4 v[76:79], v2, s[12:15], s41 offen offset:1024
buffer_load_dwordx4 v[76:79], v2, s[12:15], s41 offen offset:2048
buffer_load_dwordx4 v[76:79], v2, s[12:15], s41 offen offset:3072
s_add_u32 s41, s40, 4096
buffer_load_dwordx4 v[76:79], v2, s[12:15], s41 offen offset:0
buffer_load_dwordx4 v[76:79], v2, s[12:15], s41 offen offset:1024
buffer_load_dwordx4 v[76:79], v2, s[12:15], s41 offen offset:2048
s_mov_b32 s12, s58
s_mov_b32 s13, s59
s_mov_b32 s14, 4194304
s_mov_b32 s15, 0x20000
s_add_u32 s41, s40, 0
buffer_load_dwordx4 v[76:79], v2, s[12:15], s41 offen offset:0
buffer_load_dwordx4 v[76:79], v2, s[12:15], s41 offen offset:1024
buffer_load_dwordx4 v[76:79], v2, s[12:15], s41 offen offset:2048
buffer_load_dwordx4 v[76:79], v2, s[12:15], s41 offen offset:3072
s_add_u32 s41, s40, 4096
buffer_load_dwordx4 v[76:79], v2, s[12:15], s41 offen offset:0
buffer_load_dwordx4 v[76:79], v2, s[12:15], s41 offen offset:1024
buffer_load_dwordx4 v[76:79], v2, s[12:15], s41 offen offset:2048
v_lshlrev_b32 v74, 5, v1
buffer_load_dword v73, v74, s[8:11], 0 offen offset:12 sc1
s_waitcnt vmcnt(0)
L_cen_179:
s_mov_b32 s40, 0
v_readlane_b32 s41, v73, 0
s_nop 0
s_add_u32 s40, s40, s41
v_readlane_b32 s41, v73, 1
s_nop 0
s_add_u32 s40, s40, s41
v_readlane_b32 s41, v73, 2
s_nop 0
s_add_u32 s40, s40, s41
v_readlane_b32 s41, v73, 3
s_nop 0
s_add_u32 s40, s40, s41
v_readlane_b32 s41, v73, 4
s_nop 0
s_add_u32 s40, s40, s41
v_readlane_b32 s41, v73, 5
s_nop 0
s_add_u32 s40, s40, s41
v_readlane_b32 s41, v73, 6
s_nop 0
s_add_u32 s40, s40, s41
v_readlane_b32 s41, v73, 7
s_nop 0
s_add_u32 s40, s40, s41
s_cmp_eq_u32 s40, 256
s_cbranch_scc1 L_cenok_180
s_sub_u32 s36, s36, 1
s_cbranch_scc1 L_end_ffn_G
s_sleep 4
buffer_load_dword v73, v74, s[8:11], 0 offen offset:12 sc1
s_waitcnt vmcnt(0)
s_branch L_cen_179
L_cenok_180:
v_mov_b32 v68, -1
v_mov_b32 v69, -1
v_mov_b32 v70, -1
v_mov_b32 v71, -1
s_add_u32 s40, s39, 0
buffer_store_dwordx4 v[68:71], v5, s[4:7], s40 offen sc1
s_add_u32 s40, s39, 4096
buffer_store_dwordx4 v[68:71], v5, s[4:7], s40 offen sc1
s_add_u32 s40, s39, 8192
buffer_store_dwordx4 v[68:71], v5, s[4:7], s40 offen sc1
s_add_u32 s40, s39, 12288
buffer_store_dwordx4 v[68:71], v5, s[4:7], s40 offen sc1
s_add_u32 s40, s39, 0
buffer_store_dwordx4 v[68:71], v0, s[4:7], s40 offen sc1
s_add_u32 s40, s39, 4096
buffer_store_dwordx4 v[68:71], v0, s[4:7], s40 offen sc1
s_add_u32 s40, s39, 8192
buffer_store_dwordx4 v[68:71], v0, s[4:7], s40 offen sc1
s_add_u32 s40, s39, 12288
buffer_store_dwordx4 v[68:71], v0, s[4:7], s40 offen sc1
s_add_u32 s40, s39, 524288
buffer_store_dwordx4 v[68:71], v5, s[4:7], s40 offen sc1
s_add_u32 s40, s39, 528384
buffer_store_dwordx4 v[68:71], v5, s[4:7], s40 offen sc1
s_add_u32 s40, s39, 532480
buffer_store_dwordx4 v[68:71], v5, s[4:7], s40 offen sc1
s_add_u32 s40, s39, 536576
buffer_store_dwordx4 v[68:71], v5, s[4:7], s40 offen sc1
s_add_u32 s40, s39, 524288
buffer_store_dwordx4 v[68:71], v0, s[4:7], s40 offen sc1
s_add_u32 s40, s39, 528384
buffer_store_dwordx4 v[68:71], v0, s[4:7], s40 offen sc1
s_add_u32 s40, s39, 532480
buffer_store_dwordx4 v[68:71], v0, s[4:7], s40 offen sc1
s_add_u32 s40, s39, 536576
buffer_store_dwordx4 v[68:71], v0, s[4:7], s40 offen sc1
s_waitcnt vmcnt(0)
s_barrier
s_cmp_lg_u32 s32, 0
s_cbranch_scc1 L_ra_181
v_mov_b32 v72, 1
s_lshl_b32 s40, s35, 5
v_mov_b32 v73, s40
s_mov_b64 exec, 1
buffer_atomic_add v72, v73, s[8:11], 0 offen offset:8
s_mov_b64 exec, -1
L_ra_181:
s_cmp_eq_u32 s38, 0
s_cbranch_scc1 L_go_182
s_mul_i32 s40, s35, 0
s_add_u32 s40, s40, 0
v_mov_b32 v73, s40
L_rw_183:
buffer_load_dword v72, v73, s[8:11], 0 offen offset:8 sc1
s_waitcnt vmcnt(0)
v_cmp_ne_u32 vcc, 32, v72
s_cbranch_vccz L_rwo_184
s_sub_u32 s36, s36, 1
s_cbranch_scc1 L_end_ffn_G
s_sleep 2
s_branch L_rw_183
L_rwo_184:
L_go_182:
s_mov_b32 s12, s64
s_mov_b32 s13, s65
s_mov_b32 s14, 1835008
s_mov_b32 s15, 0x20000
s_mov_b32 s20, s66
s_mov_b32 s21, s67
s_mov_b32 s22, 1835008
s_mov_b32 s23, 0x20000
s_mov_b32 s24, s68
s_mov_b32 s25, s69
s_mov_b32 s26, 1835008
s_mov_b32 s27, 0x20000
s_cmp_ge_u32 s98, 14
s_cbranch_scc1 L_ffn_now_G
s_lshl_b32 s40, s98, 8
s_lshl_b32 s41, s32, 6
s_add_u32 s42, s40, s41
s_mul_i32 s77, s32, 40704
v_lshlrev_b32 v23, 3, v4
v_lshrrev_b32 v24, 2, v1
v_mul_u32_u24 v24, 3584, v24
v_and_b32 v20, 3, v1
v_lshl_add_u32 v20, v20, 4, v24
v_add_u32 v21, 56320, v20
v_and_b32 v24, 15, v1
v_lshlrev_b32 v24, 2, v24
v_lshl_add_u32 v22, v23, 6, v24
v_add_u32 v22, s77, v22
s_add_u32 s45, s42, 0
s_add_u32 m0, s77, 0
s_nop 0
buffer_load_dwordx4 v20, s[12:15], s45 offen offset:0 lds
buffer_load_dwordx4 v21, s[12:15], s45 offen offset:1024 lds
s_add_u32 s45, s42, 0
s_add_u32 m0, s77, 2048
s_nop 0
buffer_load_dwordx4 v20, s[20:23], s45 offen offset:0 lds
buffer_load_dwordx4 v21, s[20:23], s45 offen offset:1024 lds
s_add_u32 s45, s42, 114688
s_add_u32 m0, s77, 4096
s_nop 0
buffer_load_dwordx4 v20, s[12:15], s45 offen offset:0 lds
buffer_load_dwordx4 v21, s[12:15], s45 offen offset:1024 lds
s_add_u32 s45, s42, 114688
s_add_u32 m0, s77, 6144
s_nop 0
buffer_load_dwordx4 v20, s[20:23], s45 offen offset:0 lds
buffer_load_dwordx4 v21, s[20:23], s45 offen offset:1024 lds
s_add_u32 s45, s42, 229376
s_add_u32 m0, s77, 8192
s_nop 0
buffer_load_dwordx4 v20, s[12:15], s45 offen offset:0 lds
buffer_load_dwordx4 v21, s[12:15], s45 offen offset:1024 lds
s_add_u32 s45, s42, 229376
s_add_u32 m0, s77, 10240
s_nop 0
buffer_load_dwordx4 v20, s[20:23], s45 offen offset:0 lds
buffer_load_dwordx4 v21, s[20:23], s45 offen offset:1024 lds
s_add_u32 s45, s42, 344064
s_add_u32 m0, s77, 12288
s_nop 0
buffer_load_dwordx4 v20, s[12:15], s45 offen offset:0 lds
buffer_load_dwordx4 v21, s[12:15], s45 offen offset:1024 lds
s_add_u32 s45, s42, 344064
s_add_u32 m0, s77, 14336
s_nop 0
buffer_load_dwordx4 v20, s[20:23], s45 offen offset:0 lds
buffer_load_dwordx4 v21, s[20:23], s45 offen offset:1024 lds
s_add_u32 s45, s42, 458752
s_add_u32 m0, s77, 16384
s_nop 0
buffer_load_dwordx4 v20, s[12:15], s45 offen offset:0 lds
buffer_load_dwordx4 v21, s[12:15], s45 offen offset:1024 lds
s_add_u32 s45, s42, 458752
s_add_u32 m0, s77, 18432
s_nop 0
buffer_load_dwordx4 v20, s[20:23], s45 offen offset:0 lds
buffer_load_dwordx4 v21, s[20:23], s45 offen offset:1024 lds
s_add_u32 s45, s42, 573440
s_add_u32 m0, s77, 20480
s_nop 0
buffer_load_dwordx4 v20, s[12:15], s45 offen offset:0 lds
buffer_load_dwordx4 v21, s[12:15], s45 offen offset:1024 lds
s_add_u32 s45, s42, 573440
s_add_u32 m0, s77, 22528
s_nop 0
buffer_load_dwordx4 v20, s[20:23], s45 offen offset:0 lds
buffer_load_dwordx4 v21, s[20:23], s45 offen offset:1024 lds
s_add_u32 s45, s42, 688128
s_add_u32 m0, s77, 24576
s_nop 0
buffer_load_dwordx4 v20, s[12:15], s45 offen offset:0 lds
buffer_load_dwordx4 v21, s[12:15], s45 offen offset:1024 lds
s_add_u32 s45, s42, 688128
s_add_u32 m0, s77, 26624
s_nop 0
buffer_load_dwordx4 v20, s[20:23], s45 offen offset:0 lds
buffer_load_dwordx4 v21, s[20:23], s45 offen offset:1024 lds
s_add_u32 s45, s42, 802816
s_add_u32 m0, s77, 28672
s_nop 0
buffer_load_dwordx4 v20, s[12:15], s45 offen offset:0 lds
buffer_load_dwordx4 v21, s[12:15], s45 offen offset:1024 lds
s_add_u32 s45, s42, 802816
s_add_u32 m0, s77, 30720
s_nop 0
buffer_load_dwordx4 v20, s[20:23], s45 offen offset:0 lds
buffer_load_dwordx4 v21, s[20:23], s45 offen offset:1024 lds
s_add_u32 s45, s42, 917504
s_add_u32 m0, s77, 32768
s_nop 0
buffer_load_dwordx4 v20, s[12:15], s45 offen offset:0 lds
buffer_load_dwordx4 v21, s[12:15], s45 offen offset:1024 lds
s_add_u32 s45, s42, 917504
s_add_u32 m0, s77, 34816
s_nop 0
buffer_load_dwordx4 v20, s[20:23], s45 offen offset:0 lds
buffer_load_dwordx4 v21, s[20:23], s45 offen offset:1024 lds
s_add_u32 s45, s42, 1032192
s_add_u32 m0, s77, 36864
s_nop 0
buffer_load_dwordx4 v20, s[12:15], s45 offen offset:0 lds
buffer_load_dwordx4 v21, s[12:15], s45 offen offset:1024 lds
s_waitcnt vmcnt(36)
ds_read_b32 v40, v22 offset:0
ds_read_b32 v41, v22 offset:64
ds_read_b32 v42, v22 offset:128
ds_read_b32 v43, v22 offset:192
ds_read_b32 v44, v22 offset:256
ds_read_b32 v45, v22 offset:320
ds_read_b32 v46, v22 offset:384
ds_read_b32 v47, v22 offset:448
s_waitcnt lgkmcnt(6)
v_perm_b32 v32, v41, v40, s46
v_perm_b32 v36, v41, v40, s47
s_waitcnt lgkmcnt(4)
v_perm_b32 v33, v43, v42, s46
v_perm_b32 v37, v43, v42, s47
s_waitcnt lgkmcnt(2)
v_perm_b32 v34, v45, v44, s46
v_perm_b32 v38, v45, v44, s47
s_waitcnt lgkmcnt(0)
v_perm_b32 v35, v47, v46, s46
v_perm_b32 v39, v47, v46, s47
s_add_u32 s45, s42, 1032192
s_add_u32 m0, s77, 0
s_nop 0
buffer_load_dwordx4 v20, s[20:23], s45 offen offset:0 lds
buffer_load_dwordx4 v21, s[20:23], s45 offen offset:1024 lds
v_accvgpr_write_b32 a0, v32
v_accvgpr_write_b32 a1, v33
v_accvgpr_write_b32 a2, v34
v_accvgpr_write_b32 a3, v35
v_accvgpr_write_b32 a4, v36
v_accvgpr_write_b32 a5, v37
v_accvgpr_write_b32 a6, v38
v_accvgpr_write_b32 a7, v39
s_waitcnt vmcnt(36)
ds_read_b32 v40, v22 offset:2048
ds_read_b32 v41, v22 offset:2112
ds_read_b32 v42, v22 offset:2176
ds_read_b32 v43, v22 offset:2240
ds_read_b32 v44, v22 offset:2304
ds_read_b32 v45, v22 offset:2368
ds_read_b32 v46, v22 offset:2432
ds_read_b32 v47, v22 offset:2496
s_waitcnt lgkmcnt(6)
v_perm_b32 v32, v41, v40, s46
v_perm_b32 v36, v41, v40, s47
s_waitcnt lgkmcnt(4)
v_perm_b32 v33, v43, v42, s46
v_perm_b32 v37, v43, v42, s47
s_waitcnt lgkmcnt(2)
v_perm_b32 v34, v45, v44, s46
v_perm_b32 v38, v45, v44, s47
s_waitcnt lgkmcnt(0)
v_perm_b32 v35, v47, v46, s46
v_perm_b32 v39, v47, v46, s47
s_add_u32 s45, s42, 1146880
s_add_u32 m0, s77, 2048
s_nop 0
buffer_load_dwordx4 v20, s[12:15], s45 offen offset:0 lds
buffer_load_dwordx4 v21, s[12:15], s45 offen offset:1024 lds
v_accvgpr_write_b32 a128, v32
v_accvgpr_write_b32 a129, v33
v_accvgpr_write_b32 a130, v34
v_accvgpr_write_b32 a131, v35
v_accvgpr_write_b32 a132, v36
v_accvgpr_write_b32 a133, v37
v_accvgpr_write_b32 a134, v38
v_accvgpr_write_b32 a135, v39
s_waitcnt vmcnt(36)
ds_read_b32 v40, v22 offset:4096
ds_read_b32 v41, v22 offset:4160
ds_read_b32 v42, v22 offset:4224
ds_read_b32 v43, v22 offset:4288
ds_read_b32 v44, v22 offset:4352
ds_read_b32 v45, v22 offset:4416
ds_read_b32 v46, v22 offset:4480
ds_read_b32 v47, v22 offset:4544
s_waitcnt lgkmcnt(6)
v_perm_b32 v32, v41, v40, s46
v_perm_b32 v36, v41, v40, s47
s_waitcnt lgkmcnt(4)
v_perm_b32 v33, v43, v42, s46
v_perm_b32 v37, v43, v42, s47
s_waitcnt lgkmcnt(2)
v_perm_b32 v34, v45, v44, s46
v_perm_b32 v38, v45, v44, s47
s_waitcnt lgkmcnt(0)
v_perm_b32 v35, v47, v46, s46
v_perm_b32 v39, v47, v46, s47
s_add_u32 s45, s42, 1146880
s_add_u32 m0, s77, 4096
s_nop 0
buffer_load_dwordx4 v20, s[20:23], s45 offen offset:0 lds
buffer_load_dwordx4 v21, s[20:23], s45 offen offset:1024 lds
v_accvgpr_write_b32 a8, v32
v_accvgpr_write_b32 a9, v33
v_accvgpr_write_b32 a10, v34
v_accvgpr_write_b32 a11, v35
v_accvgpr_write_b32 a12, v36
v_accvgpr_write_b32 a13, v37
v_accvgpr_write_b32 a14, v38
v_accvgpr_write_b32 a15, v39
s_waitcnt vmcnt(36)
ds_read_b32 v40, v22 offset:6144
ds_read_b32 v41, v22 offset:6208
ds_read_b32 v42, v22 offset:6272
ds_read_b32 v43, v22 offset:6336
ds_read_b32 v44, v22 offset:6400
ds_read_b32 v45, v22 offset:6464
ds_read_b32 v46, v22 offset:6528
ds_read_b32 v47, v22 offset:6592
s_waitcnt lgkmcnt(6)
v_perm_b32 v32, v41, v40, s46
v_perm_b32 v36, v41, v40, s47
s_waitcnt lgkmcnt(4)
v_perm_b32 v33, v43, v42, s46
v_perm_b32 v37, v43, v42, s47
s_waitcnt lgkmcnt(2)
v_perm_b32 v34, v45, v44, s46
v_perm_b32 v38, v45, v44, s47
s_waitcnt lgkmcnt(0)
v_perm_b32 v35, v47, v46, s46
v_perm_b32 v39, v47, v46, s47
s_add_u32 s45, s42, 1261568
s_add_u32 m0, s77, 6144
s_nop 0
buffer_load_dwordx4 v20, s[12:15], s45 offen offset:0 lds
buffer_load_dwordx4 v21, s[12:15], s45 offen offset:1024 lds
v_accvgpr_write_b32 a136, v32
v_accvgpr_write_b32 a137, v33
v_accvgpr_write_b32 a138, v34
v_accvgpr_write_b32 a139, v35
v_accvgpr_write_b32 a140, v36
v_accvgpr_write_b32 a141, v37
v_accvgpr_write_b32 a142, v38
v_accvgpr_write_b32 a143, v39
s_waitcnt vmcnt(36)
ds_read_b32 v40, v22 offset:8192
ds_read_b32 v41, v22 offset:8256
ds_read_b32 v42, v22 offset:8320
ds_read_b32 v43, v22 offset:8384
ds_read_b32 v44, v22 offset:8448
ds_read_b32 v45, v22 offset:8512
ds_read_b32 v46, v22 offset:8576
ds_read_b32 v47, v22 offset:8640
s_waitcnt lgkmcnt(6)
v_perm_b32 v32, v41, v40, s46
v_perm_b32 v36, v41, v40, s47
s_waitcnt lgkmcnt(4)
v_perm_b32 v33, v43, v42, s46
v_perm_b32 v37, v43, v42, s47
s_waitcnt lgkmcnt(2)
v_perm_b32 v34, v45, v44, s46
v_perm_b32 v38, v45, v44, s47
s_waitcnt lgkmcnt(0)
v_perm_b32 v35, v47, v46, s46
v_perm_b32 v39, v47, v46, s47
s_add_u32 s45, s42, 1261568
s_add_u32 m0, s77, 8192
s_nop 0
buffer_load_dwordx4 v20, s[20:23], s45 offen offset:0 lds
buffer_load_dwordx4 v21, s[20:23], s45 offen offset:1024 lds
v_accvgpr_write_b32 a16, v32
v_accvgpr_write_b32 a17, v33
v_accvgpr_write_b32 a18, v34
v_accvgpr_write_b32 a19, v35
v_accvgpr_write_b32 a20, v36
v_accvgpr_write_b32 a21, v37
v_accvgpr_write_b32 a22, v38
v_accvgpr_write_b32 a23, v39
s_waitcnt vmcnt(36)
ds_read_b32 v40, v22 offset:10240
ds_read_b32 v41, v22 offset:10304
ds_read_b32 v42, v22 offset:10368
ds_read_b32 v43, v22 offset:10432
ds_read_b32 v44, v22 offset:10496
ds_read_b32 v45, v22 offset:10560
ds_read_b32 v46, v22 offset:10624
ds_read_b32 v47, v22 offset:10688
s_waitcnt lgkmcnt(6)
v_perm_b32 v32, v41, v40, s46
v_perm_b32 v36, v41, v40, s47
s_waitcnt lgkmcnt(4)
v_perm_b32 v33, v43, v42, s46
v_perm_b32 v37, v43, v42, s47
s_waitcnt lgkmcnt(2)
v_perm_b32 v34, v45, v44, s46
v_perm_b32 v38, v45, v44, s47
s_waitcnt lgkmcnt(0)
v_perm_b32 v35, v47, v46, s46
v_perm_b32 v39, v47, v46, s47
s_add_u32 s45, s42, 1376256
s_add_u32 m0, s77, 10240
s_nop 0
buffer_load_dwordx4 v20, s[12:15], s45 offen offset:0 lds
buffer_load_dwordx4 v21, s[12:15], s45 offen offset:1024 lds
v_accvgpr_write_b32 a144, v32
v_accvgpr_write_b32 a145, v33
v_accvgpr_write_b32 a146, v34
v_accvgpr_write_b32 a147, v35
v_accvgpr_write_b32 a148, v36
v_accvgpr_write_b32 a149, v37
v_accvgpr_write_b32 a150, v38
v_accvgpr_write_b32 a151, v39
s_waitcnt vmcnt(36)
ds_read_b32 v40, v22 offset:12288
ds_read_b32 v41, v22 offset:12352
ds_read_b32 v42, v22 offset:12416
ds_read_b32 v43, v22 offset:12480
ds_read_b32 v44, v22 offset:12544
ds_read_b32 v45, v22 offset:12608
ds_read_b32 v46, v22 offset:12672
ds_read_b32 v47, v22 offset:12736
s_waitcnt lgkmcnt(6)
v_perm_b32 v32, v41, v40, s46
v_perm_b32 v36, v41, v40, s47
s_waitcnt lgkmcnt(4)
v_perm_b32 v33, v43, v42, s46
v_perm_b32 v37, v43, v42, s47
s_waitcnt lgkmcnt(2)
v_perm_b32 v34, v45, v44, s46
v_perm_b32 v38, v45, v44, s47
s_waitcnt lgkmcnt(0)
v_perm_b32 v35, v47, v46, s46
v_perm_b32 v39, v47, v46, s47
s_add_u32 s45, s42, 1376256
s_add_u32 m0, s77, 12288
s_nop 0
buffer_load_dwordx4 v20, s[20:23], s45 offen offset:0 lds
buffer_load_dwordx4 v21, s[20:23], s45 offen offset:1024 lds
v_accvgpr_write_b32 a24, v32
v_accvgpr_write_b32 a25, v33
v_accvgpr_write_b32 a26, v34
v_accvgpr_write_b32 a27, v35
v_accvgpr_write_b32 a28, v36
v_accvgpr_write_b32 a29, v37
v_accvgpr_write_b32 a30, v38
v_accvgpr_write_b32 a31, v39
s_waitcnt vmcnt(36)
ds_read_b32 v40, v22 offset:14336
ds_read_b32 v41, v22 offset:14400
ds_read_b32 v42, v22 offset:14464
ds_read_b32 v43, v22 offset:14528
ds_read_b32 v44, v22 offset:14592
ds_read_b32 v45, v22 offset:14656
ds_read_b32 v46, v22 offset:14720
ds_read_b32 v47, v22 offset:14784
s_waitcnt lgkmcnt(6)
v_perm_b32 v32, v41, v40, s46
v_perm_b32 v36, v41, v40, s47
s_waitcnt lgkmcnt(4)
v_perm_b32 v33, v43, v42, s46
v_perm_b32 v37, v43, v42, s47
s_waitcnt lgkmcnt(2)
v_perm_b32 v34, v45, v44, s46
v_perm_b32 v38, v45, v44, s47
s_waitcnt lgkmcnt(0)
v_perm_b32 v35, v47, v46, s46
v_perm_b32 v39, v47, v46, s47
s_add_u32 s45, s42, 1490944
s_add_u32 m0, s77, 14336
s_nop 0
buffer_load_dwordx4 v20, s[12:15], s45 offen offset:0 lds
buffer_load_dwordx4 v21, s[12:15], s45 offen offset:1024 lds
v_accvgpr_write_b32 a152, v32
v_accvgpr_write_b32 a153, v33
v_accvgpr_write_b32 a154, v34
v_accvgpr_write_b32 a155, v35
v_accvgpr_write_b32 a156, v36
v_accvgpr_write_b32 a157, v37
v_accvgpr_write_b32 a158, v38
v_accvgpr_write_b32 a159, v39
s_waitcnt vmcnt(36)
ds_read_b32 v40, v22 offset:16384
ds_read_b32 v41, v22 offset:16448
ds_read_b32 v42, v22 offset:16512
ds_read_b32 v43, v22 offset:16576
ds_read_b32 v44, v22 offset:16640
ds_read_b32 v45, v22 offset:16704
ds_read_b32 v46, v22 offset:16768
ds_read_b32 v47, v22 offset:16832
s_waitcnt lgkmcnt(6)
v_perm_b32 v32, v41, v40, s46
v_perm_b32 v36, v41, v40, s47
s_waitcnt lgkmcnt(4)
v_perm_b32 v33, v43, v42, s46
v_perm_b32 v37, v43, v42, s47
s_waitcnt lgkmcnt(2)
v_perm_b32 v34, v45, v44, s46
v_perm_b32 v38, v45, v44, s47
s_waitcnt lgkmcnt(0)
v_perm_b32 v35, v47, v46, s46
v_perm_b32 v39, v47, v46, s47
s_add_u32 s45, s42, 1490944
s_add_u32 m0, s77, 16384
s_nop 0
buffer_load_dwordx4 v20, s[20:23], s45 offen offset:0 lds
buffer_load_dwordx4 v21, s[20:23], s45 offen offset:1024 lds
v_accvgpr_write_b32 a32, v32
v_accvgpr_write_b32 a33, v33
v_accvgpr_write_b32 a34, v34
v_accvgpr_write_b32 a35, v35
v_accvgpr_write_b32 a36, v36
v_accvgpr_write_b32 a37, v37
v_accvgpr_write_b32 a38, v38
v_accvgpr_write_b32 a39, v39
s_waitcnt vmcnt(36)
ds_read_b32 v40, v22 offset:18432
ds_read_b32 v41, v22 offset:18496
ds_read_b32 v42, v22 offset:18560
ds_read_b32 v43, v22 offset:18624
ds_read_b32 v44, v22 offset:18688
ds_read_b32 v45, v22 offset:18752
ds_read_b32 v46, v22 offset:18816
ds_read_b32 v47, v22 offset:18880
s_waitcnt lgkmcnt(6)
v_perm_b32 v32, v41, v40, s46
v_perm_b32 v36, v41, v40, s47
s_waitcnt lgkmcnt(4)
v_perm_b32 v33, v43, v42, s46
v_perm_b32 v37, v43, v42, s47
s_waitcnt lgkmcnt(2)
v_perm_b32 v34, v45, v44, s46
v_perm_b32 v38, v45, v44, s47
s_waitcnt lgkmcnt(0)
v_perm_b32 v35, v47, v46, s46
v_perm_b32 v39, v47, v46, s47
s_add_u32 s45, s42, 1605632
s_add_u32 m0, s77, 18432
s_nop 0
buffer_load_dwordx4 v20, s[12:15], s45 offen offset:0 lds
buffer_load_dwordx4 v21, s[12:15], s45 offen offset:1024 lds
v_accvgpr_write_b32 a160, v32
v_accvgpr_write_b32 a161, v33
v_accvgpr_write_b32 a162, v34
v_accvgpr_write_b32 a163, v35
v_accvgpr_write_b32 a164, v36
v_accvgpr_write_b32 a165, v37
v_accvgpr_write_b32 a166, v38
v_accvgpr_write_b32 a167, v39
s_waitcnt vmcnt(36)
ds_read_b32 v40, v22 offset:20480
ds_read_b32 v41, v22 offset:20544
ds_read_b32 v42, v22 offset:20608
ds_read_b32 v43, v22 offset:20672
ds_read_b32 v44, v22 offset:20736
ds_read_b32 v45, v22 offset:20800
ds_read_b32 v46, v22 offset:20864
ds_read_b32 v47, v22 offset:20928
s_waitcnt lgkmcnt(6)
v_perm_b32 v32, v41, v40, s46
v_perm_b32 v36, v41, v40, s47
s_waitcnt lgkmcnt(4)
v_perm_b32 v33, v43, v42, s46
v_perm_b32 v37, v43, v42, s47
s_waitcnt lgkmcnt(2)
v_perm_b32 v34, v45, v44, s46
v_perm_b32 v38, v45, v44, s47
s_waitcnt lgkmcnt(0)
v_perm_b32 v35, v47, v46, s46
v_perm_b32 v39, v47, v46, s47
s_add_u32 s45, s42, 1605632
s_add_u32 m0, s77, 20480
s_nop 0
buffer_load_dwordx4 v20, s[20:23], s45 offen offset:0 lds
buffer_load_dwordx4 v21, s[20:23], s45 offen offset:1024 lds
v_accvgpr_write_b32 a40, v32
v_accvgpr_write_b32 a41, v33
v_accvgpr_write_b32 a42, v34
v_accvgpr_write_b32 a43, v35
v_accvgpr_write_b32 a44, v36
v_accvgpr_write_b32 a45, v37
v_accvgpr_write_b32 a46, v38
v_accvgpr_write_b32 a47, v39
s_waitcnt vmcnt(36)
ds_read_b32 v40, v22 offset:22528
ds_read_b32 v41, v22 offset:22592
ds_read_b32 v42, v22 offset:22656
ds_read_b32 v43, v22 offset:22720
ds_read_b32 v44, v22 offset:22784
ds_read_b32 v45, v22 offset:22848
ds_read_b32 v46, v22 offset:22912
ds_read_b32 v47, v22 offset:22976
s_waitcnt lgkmcnt(6)
v_perm_b32 v32, v41, v40, s46
v_perm_b32 v36, v41, v40, s47
s_waitcnt lgkmcnt(4)
v_perm_b32 v33, v43, v42, s46
v_perm_b32 v37, v43, v42, s47
s_waitcnt lgkmcnt(2)
v_perm_b32 v34, v45, v44, s46
v_perm_b32 v38, v45, v44, s47
s_waitcnt lgkmcnt(0)
v_perm_b32 v35, v47, v46, s46
v_perm_b32 v39, v47, v46, s47
s_add_u32 s45, s42, 1720320
s_add_u32 m0, s77, 22528
s_nop 0
buffer_load_dwordx4 v20, s[12:15], s45 offen offset:0 lds
buffer_load_dwordx4 v21, s[12:15], s45 offen offset:1024 lds
v_accvgpr_write_b32 a168, v32
v_accvgpr_write_b32 a169, v33
v_accvgpr_write_b32 a170, v34
v_accvgpr_write_b32 a171, v35
v_accvgpr_write_b32 a172, v36
v_accvgpr_write_b32 a173, v37
v_accvgpr_write_b32 a174, v38
v_accvgpr_write_b32 a175, v39
s_waitcnt vmcnt(36)
ds_read_b32 v40, v22 offset:24576
ds_read_b32 v41, v22 offset:24640
ds_read_b32 v42, v22 offset:24704
ds_read_b32 v43, v22 offset:24768
ds_read_b32 v44, v22 offset:24832
ds_read_b32 v45, v22 offset:24896
ds_read_b32 v46, v22 offset:24960
ds_read_b32 v47, v22 offset:25024
s_waitcnt lgkmcnt(6)
v_perm_b32 v32, v41, v40, s46
v_perm_b32 v36, v41, v40, s47
s_waitcnt lgkmcnt(4)
v_perm_b32 v33, v43, v42, s46
v_perm_b32 v37, v43, v42, s47
s_waitcnt lgkmcnt(2)
v_perm_b32 v34, v45, v44, s46
v_perm_b32 v38, v45, v44, s47
s_waitcnt lgkmcnt(0)
v_perm_b32 v35, v47, v46, s46
v_perm_b32 v39, v47, v46, s47
s_add_u32 s45, s42, 1720320
s_add_u32 m0, s77, 24576
s_nop 0
buffer_load_dwordx4 v20, s[20:23], s45 offen offset:0 lds
buffer_load_dwordx4 v21, s[20:23], s45 offen offset:1024 lds
v_accvgpr_write_b32 a48, v32
v_accvgpr_write_b32 a49, v33
v_accvgpr_write_b32 a50, v34
v_accvgpr_write_b32 a51, v35
v_accvgpr_write_b32 a52, v36
v_accvgpr_write_b32 a53, v37
v_accvgpr_write_b32 a54, v38
v_accvgpr_write_b32 a55, v39
s_waitcnt vmcnt(36)
ds_read_b32 v40, v22 offset:26624
ds_read_b32 v41, v22 offset:26688
ds_read_b32 v42, v22 offset:26752
ds_read_b32 v43, v22 offset:26816
ds_read_b32 v44, v22 offset:26880
ds_read_b32 v45, v22 offset:26944
ds_read_b32 v46, v22 offset:27008
ds_read_b32 v47, v22 offset:27072
s_waitcnt lgkmcnt(6)
v_perm_b32 v32, v41, v40, s46
v_perm_b32 v36, v41, v40, s47
s_waitcnt lgkmcnt(4)
v_perm_b32 v33, v43, v42, s46
v_perm_b32 v37, v43, v42, s47
s_waitcnt lgkmcnt(2)
v_perm_b32 v34, v45, v44, s46
v_perm_b32 v38, v45, v44, s47
s_waitcnt lgkmcnt(0)
v_perm_b32 v35, v47, v46, s46
v_perm_b32 v39, v47, v46, s47
v_accvgpr_write_b32 a176, v32
v_accvgpr_write_b32 a177, v33
v_accvgpr_write_b32 a178, v34
v_accvgpr_write_b32 a179, v35
v_accvgpr_write_b32 a180, v36
v_accvgpr_write_b32 a181, v37
v_accvgpr_write_b32 a182, v38
v_accvgpr_write_b32 a183, v39
s_waitcnt vmcnt(34)
ds_read_b32 v40, v22 offset:28672
ds_read_b32 v41, v22 offset:28736
ds_read_b32 v42, v22 offset:28800
ds_read_b32 v43, v22 offset:28864
ds_read_b32 v44, v22 offset:28928
ds_read_b32 v45, v22 offset:28992
ds_read_b32 v46, v22 offset:29056
ds_read_b32 v47, v22 offset:29120
s_waitcnt lgkmcnt(6)
v_perm_b32 v32, v41, v40, s46
v_perm_b32 v36, v41, v40, s47
s_waitcnt lgkmcnt(4)
v_perm_b32 v33, v43, v42, s46
v_perm_b32 v37, v43, v42, s47
s_waitcnt lgkmcnt(2)
v_perm_b32 v34, v45, v44, s46
v_perm_b32 v38, v45, v44, s47
s_waitcnt lgkmcnt(0)
v_perm_b32 v35, v47, v46, s46
v_perm_b32 v39, v47, v46, s47
v_accvgpr_write_b32 a56, v32
v_accvgpr_write_b32 a57, v33
v_accvgpr_write_b32 a58, v34
v_accvgpr_write_b32 a59, v35
v_accvgpr_write_b32 a60, v36
v_accvgpr_write_b32 a61, v37
v_accvgpr_write_b32 a62, v38
v_accvgpr_write_b32 a63, v39
s_waitcnt vmcnt(32)
ds_read_b32 v40, v22 offset:30720
ds_read_b32 v41, v22 offset:30784
ds_read_b32 v42, v22 offset:30848
ds_read_b32 v43, v22 offset:30912
ds_read_b32 v44, v22 offset:30976
ds_read_b32 v45, v22 offset:31040
ds_read_b32 v46, v22 offset:31104
ds_read_b32 v47, v22 offset:31168
s_waitcnt lgkmcnt(6)
v_perm_b32 v32, v41, v40, s46
v_perm_b32 v36, v41, v40, s47
s_waitcnt lgkmcnt(4)
v_perm_b32 v33, v43, v42, s46
v_perm_b32 v37, v43, v42, s47
s_waitcnt lgkmcnt(2)
v_perm_b32 v34, v45, v44, s46
v_perm_b32 v38, v45, v44, s47
s_waitcnt lgkmcnt(0)
v_perm_b32 v35, v47, v46, s46
v_perm_b32 v39, v47, v46, s47
v_accvgpr_write_b32 a184, v32
v_accvgpr_write_b32 a185, v33
v_accvgpr_write_b32 a186, v34
v_accvgpr_write_b32 a187, v35
v_accvgpr_write_b32 a188, v36
v_accvgpr_write_b32 a189, v37
v_accvgpr_write_b32 a190, v38
v_accvgpr_write_b32 a191, v39
s_waitcnt vmcnt(30)
ds_read_b32 v40, v22 offset:32768
ds_read_b32 v41, v22 offset:32832
ds_read_b32 v42, v22 offset:32896
ds_read_b32 v43, v22 offset:32960
ds_read_b32 v44, v22 offset:33024
ds_read_b32 v45, v22 offset:33088
ds_read_b32 v46, v22 offset:33152
ds_read_b32 v47, v22 offset:33216
s_waitcnt lgkmcnt(6)
v_perm_b32 v32, v41, v40, s46
v_perm_b32 v36, v41, v40, s47
s_waitcnt lgkmcnt(4)
v_perm_b32 v33, v43, v42, s46
v_perm_b32 v37, v43, v42, s47
s_waitcnt lgkmcnt(2)
v_perm_b32 v34, v45, v44, s46
v_perm_b32 v38, v45, v44, s47
s_waitcnt lgkmcnt(0)
v_perm_b32 v35, v47, v46, s46
v_perm_b32 v39, v47, v46, s47
v_accvgpr_write_b32 a64, v32
v_accvgpr_write_b32 a65, v33
v_accvgpr_write_b32 a66, v34
v_accvgpr_write_b32 a67, v35
v_accvgpr_write_b32 a68, v36
v_accvgpr_write_b32 a69, v37
v_accvgpr_write_b32 a70, v38
v_accvgpr_write_b32 a71, v39
s_waitcnt vmcnt(28)
ds_read_b32 v40, v22 offset:34816
ds_read_b32 v41, v22 offset:34880
ds_read_b32 v42, v22 offset:34944
ds_read_b32 v43, v22 offset:35008
ds_read_b32 v44, v22 offset:35072
ds_read_b32 v45, v22 offset:35136
ds_read_b32 v46, v22 offset:35200
ds_read_b32 v47, v22 offset:35264
s_waitcnt lgkmcnt(6)
v_perm_b32 v32, v41, v40, s46
v_perm_b32 v36, v41, v40, s47
s_waitcnt lgkmcnt(4)
v_perm_b32 v33, v43, v42, s46
v_perm_b32 v37, v43, v42, s47
s_waitcnt lgkmcnt(2)
v_perm_b32 v34, v45, v44, s46
v_perm_b32 v38, v45, v44, s47
s_waitcnt lgkmcnt(0)
v_perm_b32 v35, v47, v46, s46
v_perm_b32 v39, v47, v46, s47
v_accvgpr_write_b32 a192, v32
v_accvgpr_write_b32 a193, v33
v_accvgpr_write_b32 a194, v34
v_accvgpr_write_b32 a195, v35
v_accvgpr_write_b32 a196, v36
v_accvgpr_write_b32 a197, v37
v_accvgpr_write_b32 a198, v38
v_accvgpr_write_b32 a199, v39
s_waitcnt vmcnt(26)
ds_read_b32 v40, v22 offset:36864
ds_read_b32 v41, v22 offset:36928
ds_read_b32 v42, v22 offset:36992
ds_read_b32 v43, v22 offset:37056
ds_read_b32 v44, v22 offset:37120
ds_read_b32 v45, v22 offset:37184
ds_read_b32 v46, v22 offset:37248
ds_read_b32 v47, v22 offset:37312
s_waitcnt lgkmcnt(6)
v_perm_b32 v32, v41, v40, s46
v_perm_b32 v36, v41, v40, s47
s_waitcnt lgkmcnt(4)
v_perm_b32 v33, v43, v42, s46
v_perm_b32 v37, v43, v42, s47
s_waitcnt lgkmcnt(2)
v_perm_b32 v34, v45, v44, s46
v_perm_b32 v38, v45, v44, s47
s_waitcnt lgkmcnt(0)
v_perm_b32 v35, v47, v46, s46
v_perm_b32 v39, v47, v46, s47
v_accvgpr_write_b32 a72, v32
v_accvgpr_write_b32 a73, v33
v_accvgpr_write_b32 a74, v34
v_accvgpr_write_b32 a75, v35
v_accvgpr_write_b32 a76, v36
v_accvgpr_write_b32 a77, v37
v_accvgpr_write_b32 a78, v38
v_accvgpr_write_b32 a79, v39
s_waitcnt vmcnt(24)
ds_read_b32 v40, v22 offset:0
ds_read_b32 v41, v22 offset:64
ds_read_b32 v42, v22 offset:128
ds_read_b32 v43, v22 offset:192
ds_read_b32 v44, v22 offset:256
ds_read_b32 v45, v22 offset:320
ds_read_b32 v46, v22 offset:384
ds_read_b32 v47, v22 offset:448
s_waitcnt lgkmcnt(6)
v_perm_b32 v32, v41, v40, s46
v_perm_b32 v36, v41, v40, s47
s_waitcnt lgkmcnt(4)
v_perm_b32 v33, v43, v42, s46
v_perm_b32 v37, v43, v42, s47
s_waitcnt lgkmcnt(2)
v_perm_b32 v34, v45, v44, s46
v_perm_b32 v38, v45, v44, s47
s_waitcnt lgkmcnt(0)
v_perm_b32 v35, v47, v46, s46
v_perm_b32 v39, v47, v46, s47
v_accvgpr_write_b32 a200, v32
v_accvgpr_write_b32 a201, v33
v_accvgpr_write_b32 a202, v34
v_accvgpr_write_b32 a203, v35
v_accvgpr_write_b32 a204, v36
v_accvgpr_write_b32 a205, v37
v_accvgpr_write_b32 a206, v38
v_accvgpr_write_b32 a207, v39
s_waitcnt vmcnt(22)
ds_read_b32 v40, v22 offset:2048
ds_read_b32 v41, v22 offset:2112
ds_read_b32 v42, v22 offset:2176
ds_read_b32 v43, v22 offset:2240
ds_read_b32 v44, v22 offset:2304
ds_read_b32 v45, v22 offset:2368
ds_read_b32 v46, v22 offset:2432
ds_read_b32 v47, v22 offset:2496
s_waitcnt lgkmcnt(6)
v_perm_b32 v32, v41, v40, s46
v_perm_b32 v36, v41, v40, s47
s_waitcnt lgkmcnt(4)
v_perm_b32 v33, v43, v42, s46
v_perm_b32 v37, v43, v42, s47
s_waitcnt lgkmcnt(2)
v_perm_b32 v34, v45, v44, s46
v_perm_b32 v38, v45, v44, s47
s_waitcnt lgkmcnt(0)
v_perm_b32 v35, v47, v46, s46
v_perm_b32 v39, v47, v46, s47
v_accvgpr_write_b32 a80, v32
v_accvgpr_write_b32 a81, v33
v_accvgpr_write_b32 a82, v34
v_accvgpr_write_b32 a83, v35
v_accvgpr_write_b32 a84, v36
v_accvgpr_write_b32 a85, v37
v_accvgpr_write_b32 a86, v38
v_accvgpr_write_b32 a87, v39
s_waitcnt vmcnt(20)
ds_read_b32 v40, v22 offset:4096
ds_read_b32 v41, v22 offset:4160
ds_read_b32 v42, v22 offset:4224
ds_read_b32 v43, v22 offset:4288
ds_read_b32 v44, v22 offset:4352
ds_read_b32 v45, v22 offset:4416
ds_read_b32 v46, v22 offset:4480
ds_read_b32 v47, v22 offset:4544
s_waitcnt lgkmcnt(6)
v_perm_b32 v32, v41, v40, s46
v_perm_b32 v36, v41, v40, s47
s_waitcnt lgkmcnt(4)
v_perm_b32 v33, v43, v42, s46
v_perm_b32 v37, v43, v42, s47
s_waitcnt lgkmcnt(2)
v_perm_b32 v34, v45, v44, s46
v_perm_b32 v38, v45, v44, s47
s_waitcnt lgkmcnt(0)
v_perm_b32 v35, v47, v46, s46
v_perm_b32 v39, v47, v46, s47
v_accvgpr_write_b32 a208, v32
v_accvgpr_write_b32 a209, v33
v_accvgpr_write_b32 a210, v34
v_accvgpr_write_b32 a211, v35
v_accvgpr_write_b32 a212, v36
v_accvgpr_write_b32 a213, v37
v_accvgpr_write_b32 a214, v38
v_accvgpr_write_b32 a215, v39
s_waitcnt vmcnt(18)
ds_read_b32 v40, v22 offset:6144
ds_read_b32 v41, v22 offset:6208
ds_read_b32 v42, v22 offset:6272
ds_read_b32 v43, v22 offset:6336
ds_read_b32 v44, v22 offset:6400
ds_read_b32 v45, v22 offset:6464
ds_read_b32 v46, v22 offset:6528
ds_read_b32 v47, v22 offset:6592
s_waitcnt lgkmcnt(6)
v_perm_b32 v32, v41, v40, s46
v_perm_b32 v36, v41, v40, s47
s_waitcnt lgkmcnt(4)
v_perm_b32 v33, v43, v42, s46
v_perm_b32 v37, v43, v42, s47
s_waitcnt lgkmcnt(2)
v_perm_b32 v34, v45, v44, s46
v_perm_b32 v38, v45, v44, s47
s_waitcnt lgkmcnt(0)
v_perm_b32 v35, v47, v46, s46
v_perm_b32 v39, v47, v46, s47
v_accvgpr_write_b32 a88, v32
v_accvgpr_write_b32 a89, v33
v_accvgpr_write_b32 a90, v34
v_accvgpr_write_b32 a91, v35
v_accvgpr_write_b32 a92, v36
v_accvgpr_write_b32 a93, v37
v_accvgpr_write_b32 a94, v38
v_accvgpr_write_b32 a95, v39
s_waitcnt vmcnt(16)
ds_read_b32 v40, v22 offset:8192
ds_read_b32 v41, v22 offset:8256
ds_read_b32 v42, v22 offset:8320
ds_read_b32 v43, v22 offset:8384
ds_read_b32 v44, v22 offset:8448
ds_read_b32 v45, v22 offset:8512
ds_read_b32 v46, v22 offset:8576
ds_read_b32 v47, v22 offset:8640
s_waitcnt lgkmcnt(6)
v_perm_b32 v32, v41, v40, s46
v_perm_b32 v36, v41, v40, s47
s_waitcnt lgkmcnt(4)
v_perm_b32 v33, v43, v42, s46
v_perm_b32 v37, v43, v42, s47
s_waitcnt lgkmcnt(2)
v_perm_b32 v34, v45, v44, s46
v_perm_b32 v38, v45, v44, s47
s_waitcnt lgkmcnt(0)
v_perm_b32 v35, v47, v46, s46
v_perm_b32 v39, v47, v46, s47
v_accvgpr_write_b32 a216, v32
v_accvgpr_write_b32 a217, v33
v_accvgpr_write_b32 a218, v34
v_accvgpr_write_b32 a219, v35
v_accvgpr_write_b32 a220, v36
v_accvgpr_write_b32 a221, v37
v_accvgpr_write_b32 a222, v38
v_accvgpr_write_b32 a223, v39
s_waitcnt vmcnt(14)
ds_read_b32 v40, v22 offset:10240
ds_read_b32 v41, v22 offset:10304
ds_read_b32 v42, v22 offset:10368
ds_read_b32 v43, v22 offset:10432
ds_read_b32 v44, v22 offset:10496
ds_read_b32 v45, v22 offset:10560
ds_read_b32 v46, v22 offset:10624
ds_read_b32 v47, v22 offset:10688
s_waitcnt lgkmcnt(6)
v_perm_b32 v32, v41, v40, s46
v_perm_b32 v36, v41, v40, s47
s_waitcnt lgkmcnt(4)
v_perm_b32 v33, v43, v42, s46
v_perm_b32 v37, v43, v42, s47
s_waitcnt lgkmcnt(2)
v_perm_b32 v34, v45, v44, s46
v_perm_b32 v38, v45, v44, s47
s_waitcnt lgkmcnt(0)
v_perm_b32 v35, v47, v46, s46
v_perm_b32 v39, v47, v46, s47
v_accvgpr_write_b32 a96, v32
v_accvgpr_write_b32 a97, v33
v_accvgpr_write_b32 a98, v34
v_accvgpr_write_b32 a99, v35
v_accvgpr_write_b32 a100, v36
v_accvgpr_write_b32 a101, v37
v_accvgpr_write_b32 a102, v38
v_accvgpr_write_b32 a103, v39
s_waitcnt vmcnt(12)
ds_read_b32 v40, v22 offset:12288
ds_read_b32 v41, v22 offset:12352
ds_read_b32 v42, v22 offset:12416
ds_read_b32 v43, v22 offset:12480
ds_read_b32 v44, v22 offset:12544
ds_read_b32 v45, v22 offset:12608
ds_read_b32 v46, v22 offset:12672
ds_read_b32 v47, v22 offset:12736
s_waitcnt lgkmcnt(6)
v_perm_b32 v32, v41, v40, s46
v_perm_b32 v36, v41, v40, s47
s_waitcnt lgkmcnt(4)
v_perm_b32 v33, v43, v42, s46
v_perm_b32 v37, v43, v42, s47
s_waitcnt lgkmcnt(2)
v_perm_b32 v34, v45, v44, s46
v_perm_b32 v38, v45, v44, s47
s_waitcnt lgkmcnt(0)
v_perm_b32 v35, v47, v46, s46
v_perm_b32 v39, v47, v46, s47
v_accvgpr_write_b32 a224, v32
v_accvgpr_write_b32 a225, v33
v_accvgpr_write_b32 a226, v34
v_accvgpr_write_b32 a227, v35
v_accvgpr_write_b32 a228, v36
v_accvgpr_write_b32 a229, v37
v_accvgpr_write_b32 a230, v38
v_accvgpr_write_b32 a231, v39
s_waitcnt vmcnt(10)
ds_read_b32 v40, v22 offset:14336
ds_read_b32 v41, v22 offset:14400
ds_read_b32 v42, v22 offset:14464
ds_read_b32 v43, v22 offset:14528
ds_read_b32 v44, v22 offset:14592
ds_read_b32 v45, v22 offset:14656
ds_read_b32 v46, v22 offset:14720
ds_read_b32 v47, v22 offset:14784
s_waitcnt lgkmcnt(6)
v_perm_b32 v32, v41, v40, s46
v_perm_b32 v36, v41, v40, s47
s_waitcnt lgkmcnt(4)
v_perm_b32 v33, v43, v42, s46
v_perm_b32 v37, v43, v42, s47
s_waitcnt lgkmcnt(2)
v_perm_b32 v34, v45, v44, s46
v_perm_b32 v38, v45, v44, s47
s_waitcnt lgkmcnt(0)
v_perm_b32 v35, v47, v46, s46
v_perm_b32 v39, v47, v46, s47
v_accvgpr_write_b32 a104, v32
v_accvgpr_write_b32 a105, v33
v_accvgpr_write_b32 a106, v34
v_accvgpr_write_b32 a107, v35
v_accvgpr_write_b32 a108, v36
v_accvgpr_write_b32 a109, v37
v_accvgpr_write_b32 a110, v38
v_accvgpr_write_b32 a111, v39
s_waitcnt vmcnt(8)
ds_read_b32 v40, v22 offset:16384
ds_read_b32 v41, v22 offset:16448
ds_read_b32 v42, v22 offset:16512
ds_read_b32 v43, v22 offset:16576
ds_read_b32 v44, v22 offset:16640
ds_read_b32 v45, v22 offset:16704
ds_read_b32 v46, v22 offset:16768
ds_read_b32 v47, v22 offset:16832
s_waitcnt lgkmcnt(6)
v_perm_b32 v32, v41, v40, s46
v_perm_b32 v36, v41, v40, s47
s_waitcnt lgkmcnt(4)
v_perm_b32 v33, v43, v42, s46
v_perm_b32 v37, v43, v42, s47
s_waitcnt lgkmcnt(2)
v_perm_b32 v34, v45, v44, s46
v_perm_b32 v38, v45, v44, s47
s_waitcnt lgkmcnt(0)
v_perm_b32 v35, v47, v46, s46
v_perm_b32 v39, v47, v46, s47
v_accvgpr_write_b32 a232, v32
v_accvgpr_write_b32 a233, v33
v_accvgpr_write_b32 a234, v34
v_accvgpr_write_b32 a235, v35
v_accvgpr_write_b32 a236, v36
v_accvgpr_write_b32 a237, v37
v_accvgpr_write_b32 a238, v38
v_accvgpr_write_b32 a239, v39
s_waitcnt vmcnt(6)
ds_read_b32 v40, v22 offset:18432
ds_read_b32 v41, v22 offset:18496
ds_read_b32 v42, v22 offset:18560
ds_read_b32 v43, v22 offset:18624
ds_read_b32 v44, v22 offset:18688
ds_read_b32 v45, v22 offset:18752
ds_read_b32 v46, v22 offset:18816
ds_read_b32 v47, v22 offset:18880
s_waitcnt lgkmcnt(6)
v_perm_b32 v32, v41, v40, s46
v_perm_b32 v36, v41, v40, s47
s_waitcnt lgkmcnt(4)
v_perm_b32 v33, v43, v42, s46
v_perm_b32 v37, v43, v42, s47
s_waitcnt lgkmcnt(2)
v_perm_b32 v34, v45, v44, s46
v_perm_b32 v38, v45, v44, s47
s_waitcnt lgkmcnt(0)
v_perm_b32 v35, v47, v46, s46
v_perm_b32 v39, v47, v46, s47
v_accvgpr_write_b32 a112, v32
v_accvgpr_write_b32 a113, v33
v_accvgpr_write_b32 a114, v34
v_accvgpr_write_b32 a115, v35
v_accvgpr_write_b32 a116, v36
v_accvgpr_write_b32 a117, v37
v_accvgpr_write_b32 a118, v38
v_accvgpr_write_b32 a119, v39
s_waitcnt vmcnt(4)
ds_read_b32 v40, v22 offset:20480
ds_read_b32 v41, v22 offset:20544
ds_read_b32 v42, v22 offset:20608
ds_read_b32 v43, v22 offset:20672
ds_read_b32 v44, v22 offset:20736
ds_read_b32 v45, v22 offset:20800
ds_read_b32 v46, v22 offset:20864
ds_read_b32 v47, v22 offset:20928
s_waitcnt lgkmcnt(6)
v_perm_b32 v32, v41, v40, s46
v_perm_b32 v36, v41, v40, s47
s_waitcnt lgkmcnt(4)
v_perm_b32 v33, v43, v42, s46
v_perm_b32 v37, v43, v42, s47
s_waitcnt lgkmcnt(2)
v_perm_b32 v34, v45, v44, s46
v_perm_b32 v38, v45, v44, s47
s_waitcnt lgkmcnt(0)
v_perm_b32 v35, v47, v46, s46
v_perm_b32 v39, v47, v46, s47
v_accvgpr_write_b32 a240, v32
v_accvgpr_write_b32 a241, v33
v_accvgpr_write_b32 a242, v34
v_accvgpr_write_b32 a243, v35
v_accvgpr_write_b32 a244, v36
v_accvgpr_write_b32 a245, v37
v_accvgpr_write_b32 a246, v38
v_accvgpr_write_b32 a247, v39
s_waitcnt vmcnt(2)
ds_read_b32 v40, v22 offset:22528
ds_read_b32 v41, v22 offset:22592
ds_read_b32 v42, v22 offset:22656
ds_read_b32 v43, v22 offset:22720
ds_read_b32 v44, v22 offset:22784
ds_read_b32 v45, v22 offset:22848
ds_read_b32 v46, v22 offset:22912
ds_read_b32 v47, v22 offset:22976
s_waitcnt lgkmcnt(6)
v_perm_b32 v32, v41, v40, s46
v_perm_b32 v36, v41, v40, s47
s_waitcnt lgkmcnt(4)
v_perm_b32 v33, v43, v42, s46
v_perm_b32 v37, v43, v42, s47
s_waitcnt lgkmcnt(2)
v_perm_b32 v34, v45, v44, s46
v_perm_b32 v38, v45, v44, s47
s_waitcnt lgkmcnt(0)
v_perm_b32 v35, v47, v46, s46
v_perm_b32 v39, v47, v46, s47
v_accvgpr_write_b32 a120, v32
v_accvgpr_write_b32 a121, v33
v_accvgpr_write_b32 a122, v34
v_accvgpr_write_b32 a123, v35
v_accvgpr_write_b32 a124, v36
v_accvgpr_write_b32 a125, v37
v_accvgpr_write_b32 a126, v38
v_accvgpr_write_b32 a127, v39
s_waitcnt vmcnt(0)
ds_read_b32 v40, v22 offset:24576
ds_read_b32 v41, v22 offset:24640
ds_read_b32 v42, v22 offset:24704
ds_read_b32 v43, v22 offset:24768
ds_read_b32 v44, v22 offset:24832
ds_read_b32 v45, v22 offset:24896
ds_read_b32 v46, v22 offset:24960
ds_read_b32 v47, v22 offset:25024
s_waitcnt lgkmcnt(6)
v_perm_b32 v32, v41, v40, s46
v_perm_b32 v36, v41, v40, s47
s_waitcnt lgkmcnt(4)
v_perm_b32 v33, v43, v42, s46
v_perm_b32 v37, v43, v42, s47
s_waitcnt lgkmcnt(2)
v_perm_b32 v34, v45, v44, s46
v_perm_b32 v38, v45, v44, s47
s_waitcnt lgkmcnt(0)
v_perm_b32 v35, v47, v46, s46
v_perm_b32 v39, v47, v46, s47
v_accvgpr_write_b32 a248, v32
v_accvgpr_write_b32 a249, v33
v_accvgpr_write_b32 a250, v34
v_accvgpr_write_b32 a251, v35
v_accvgpr_write_b32 a252, v36
v_accvgpr_write_b32 a253, v37
v_accvgpr_write_b32 a254, v38
v_accvgpr_write_b32 a255, v39
s_lshl_b32 s40, s98, 17
s_lshl_b32 s41, s32, 8
s_add_u32 s40, s40, s41
v_lshlrev_b32 v20, 4, v3
v_lshl_add_u32 v20, v4, 13, v20
v_add_u32 v20, s40, v20
v_add_u32 v21, 4096, v20
s_mov_b32 s45, 0
buffer_load_dwordx4 v[32:35], v20, s[24:27], s45 offen
buffer_load_dwordx4 v[36:39], v20, s[24:27], s45 offen offset:1024
buffer_load_dwordx4 v[40:43], v20, s[24:27], s45 offen offset:2048
buffer_load_dwordx4 v[44:47], v20, s[24:27], s45 offen offset:3072
buffer_load_dwordx4 v[48:51], v21, s[24:27], s45 offen
buffer_load_dwordx4 v[52:55], v21, s[24:27], s45 offen offset:1024
buffer_load_dwordx4 v[56:59], v21, s[24:27], s45 offen offset:2048
buffer_load_dwordx4 v[60:63], v21, s[24:27], s45 offen offset:3072
s_mov_b32 s45, 32768
buffer_load_dwordx4 v[64:67], v20, s[24:27], s45 offen
buffer_load_dwordx4 v[68:71], v20, s[24:27], s45 offen offset:1024
buffer_load_dwordx4 v[72:75], v20, s[24:27], s45 offen offset:2048
buffer_load_dwordx4 v[76:79], v20, s[24:27], s45 offen offset:3072
buffer_load_dwordx4 v[80:83], v21, s[24:27], s45 offen
buffer_load_dwordx4 v[84:87], v21, s[24:27], s45 offen offset:1024
buffer_load_dwordx4 v[88:91], v21, s[24:27], s45 offen offset:2048
buffer_load_dwordx4 v[92:95], v21, s[24:27], s45 offen offset:3072
s_mov_b32 s45, 65536
buffer_load_dwordx4 v[96:99], v20, s[24:27], s45 offen
buffer_load_dwordx4 v[100:103], v20, s[24:27], s45 offen offset:1024
buffer_load_dwordx4 v[104:107], v20, s[24:27], s45 offen offset:2048
buffer_load_dwordx4 v[108:111], v20, s[24:27], s45 offen offset:3072
buffer_load_dwordx4 v[112:115], v21, s[24:27], s45 offen
buffer_load_dwordx4 v[116:119], v21, s[24:27], s45 offen offset:1024
buffer_load_dwordx4 v[120:123], v21, s[24:27], s45 offen offset:2048
buffer_load_dwordx4 v[124:127], v21, s[24:27], s45 offen offset:3072
s_waitcnt vmcnt(16)
v_perm_b32 v128, v36, v32, s46
v_perm_b32 v129, v44, v40, s46
v_perm_b32 v130, v52, v48, s46
v_perm_b32 v131, v60, v56, s46
v_perm_b32 v132, v36, v32, s47
v_perm_b32 v133, v44, v40, s47
v_perm_b32 v134, v52, v48, s47
v_perm_b32 v135, v60, v56, s47
v_perm_b32 v136, v37, v33, s46
v_perm_b32 v137, v45, v41, s46
v_perm_b32 v138, v53, v49, s46
v_perm_b32 v139, v61, v57, s46
v_perm_b32 v140, v37, v33, s47
v_perm_b32 v141, v45, v41, s47
v_perm_b32 v142, v53, v49, s47
v_perm_b32 v143, v61, v57, s47
v_perm_b32 v144, v38, v34, s46
v_perm_b32 v145, v46, v42, s46
v_perm_b32 v146, v54, v50, s46
v_perm_b32 v147, v62, v58, s46
v_perm_b32 v148, v38, v34, s47
v_perm_b32 v149, v46, v42, s47
v_perm_b32 v150, v54, v50, s47
v_perm_b32 v151, v62, v58, s47
v_perm_b32 v152, v39, v35, s46
v_perm_b32 v153, v47, v43, s46
v_perm_b32 v154, v55, v51, s46
v_perm_b32 v155, v63, v59, s46
v_perm_b32 v156, v39, v35, s47
v_perm_b32 v157, v47, v43, s47
v_perm_b32 v158, v55, v51, s47
v_perm_b32 v159, v63, v59, s47
s_mov_b32 s45, 98304
buffer_load_dwordx4 v[32:35], v20, s[24:27], s45 offen
buffer_load_dwordx4 v[36:39], v20, s[24:27], s45 offen offset:1024
buffer_load_dwordx4 v[40:43], v20, s[24:27], s45 offen offset:2048
buffer_load_dwordx4 v[44:47], v20, s[24:27], s45 offen offset:3072
buffer_load_dwordx4 v[48:51], v21, s[24:27], s45 offen
buffer_load_dwordx4 v[52:55], v21, s[24:27], s45 offen offset:1024
buffer_load_dwordx4 v[56:59], v21, s[24:27], s45 offen offset:2048
buffer_load_dwordx4 v[60:63], v21, s[24:27], s45 offen offset:3072
s_waitcnt vmcnt(16)
v_perm_b32 v160, v68, v64, s46
v_perm_b32 v161, v76, v72, s46
v_perm_b32 v162, v84, v80, s46
v_perm_b32 v163, v92, v88, s46
v_perm_b32 v164, v68, v64, s47
v_perm_b32 v165, v76, v72, s47
v_perm_b32 v166, v84, v80, s47
v_perm_b32 v167, v92, v88, s47
v_perm_b32 v168, v69, v65, s46
v_perm_b32 v169, v77, v73, s46
v_perm_b32 v170, v85, v81, s46
v_perm_b32 v171, v93, v89, s46
v_perm_b32 v172, v69, v65, s47
v_perm_b32 v173, v77, v73, s47
v_perm_b32 v174, v85, v81, s47
v_perm_b32 v175, v93, v89, s47
v_perm_b32 v176, v70, v66, s46
v_perm_b32 v177, v78, v74, s46
v_perm_b32 v178, v86, v82, s46
v_perm_b32 v179, v94, v90, s46
v_perm_b32 v180, v70, v66, s47
v_perm_b32 v181, v78, v74, s47
v_perm_b32 v182, v86, v82, s47
v_perm_b32 v183, v94, v90, s47
v_perm_b32 v184, v71, v67, s46
v_perm_b32 v185, v79, v75, s46
v_perm_b32 v186, v87, v83, s46
v_perm_b32 v187, v95, v91, s46
v_perm_b32 v188, v71, v67, s47
v_perm_b32 v189, v79, v75, s47
v_perm_b32 v190, v87, v83, s47
v_perm_b32 v191, v95, v91, s47
s_waitcnt vmcnt(8)
v_perm_b32 v192, v100, v96, s46
v_perm_b32 v193, v108, v104, s46
v_perm_b32 v194, v116, v112, s46
v_perm_b32 v195, v124, v120, s46
v_perm_b32 v196, v100, v96, s47
v_perm_b32 v197, v108, v104, s47
v_perm_b32 v198, v116, v112, s47
v_perm_b32 v199, v124, v120, s47
v_perm_b32 v200, v101, v97, s46
v_perm_b32 v201, v109, v105, s46
v_perm_b32 v202, v117, v113, s46
v_perm_b32 v203, v125, v121, s46
v_perm_b32 v204, v101, v97, s47
v_perm_b32 v205, v109, v105, s47
v_perm_b32 v206, v117, v113, s47
v_perm_b32 v207, v125, v121, s47
v_perm_b32 v208, v102, v98, s46
v_perm_b32 v209, v110, v106, s46
v_perm_b32 v210, v118, v114, s46
v_perm_b32 v211, v126, v122, s46
v_perm_b32 v212, v102, v98, s47
v_perm_b32 v213, v110, v106, s47
v_perm_b32 v214, v118, v114, s47
v_perm_b32 v215, v126, v122, s47
v_perm_b32 v216, v103, v99, s46
v_perm_b32 v217, v111, v107, s46
v_perm_b32 v218, v119, v115, s46
v_perm_b32 v219, v127, v123, s46
v_perm_b32 v220, v103, v99, s47
v_perm_b32 v221, v111, v107, s47
v_perm_b32 v222, v119, v115, s47
v_perm_b32 v223, v127, v123, s47
s_waitcnt vmcnt(0)
v_perm_b32 v224, v36, v32, s46
v_perm_b32 v225, v44, v40, s46
v_perm_b32 v226, v52, v48, s46
v_perm_b32 v227, v60, v56, s46
v_perm_b32 v228, v36, v32, s47
v_perm_b32 v229, v44, v40, s47
v_perm_b32 v230, v52, v48, s47
v_perm_b32 v231, v60, v56, s47
v_perm_b32 v232, v37, v33, s46
v_perm_b32 v233, v45, v41, s46
v_perm_b32 v234, v53, v49, s46
v_perm_b32 v235, v61, v57, s46
v_perm_b32 v236, v37, v33, s47
v_perm_b32 v237, v45, v41, s47
v_perm_b32 v238, v53, v49, s47
v_perm_b32 v239, v61, v57, s47
v_perm_b32 v240, v38, v34, s46
v_perm_b32 v241, v46, v42, s46
v_perm_b32 v242, v54, v50, s46
v_perm_b32 v243, v62, v58, s46
v_perm_b32 v244, v38, v34, s47
v_perm_b32 v245, v46, v42, s47
v_perm_b32 v246, v54, v50, s47
v_perm_b32 v247, v62, v58, s47
v_perm_b32 v248, v39, v35, s46
v_perm_b32 v249, v47, v43, s46
v_perm_b32 v250, v55, v51, s46
v_perm_b32 v251, v63, v59, s46
v_perm_b32 v252, v39, v35, s47
v_perm_b32 v253, v47, v43, s47
v_perm_b32 v254, v55, v51, s47
v_perm_b32 v255, v63, v59, s47
L_ffn_now_G:
s_mul_i32 s40, s35, 32
s_add_u32 s40, s40, 0
v_mov_b32 v73, s40
L_rw_185:
buffer_load_dword v72, v73, s[8:11], 0 offen offset:8 sc1
s_waitcnt vmcnt(0)
v_cmp_ne_u32 vcc, 32, v72
s_cbranch_vccz L_rwo_186
s_sub_u32 s36, s36, 1
s_cbranch_scc1 L_end_ffn_G
s_sleep 2
s_branch L_rw_185
L_rwo_186:
s_barrier
s_mov_b32 s16, s70
s_mov_b32 s17, s71
s_mov_b32 s18, 2097152
s_mov_b32 s19, 0x20000
v_add_u32 v68, 0, v4
v_xor_b32 v68, v68, v3
v_lshlrev_b32 v68, 4, v68
v_lshl_add_u32 v20, v3, 11, v68
v_add_u32 v68, 4, v4
v_xor_b32 v68, v68, v3
v_lshlrev_b32 v68, 4, v68
v_lshl_add_u32 v21, v3, 11, v68
v_add_u32 v68, 8, v4
v_xor_b32 v68, v68, v3
v_lshlrev_b32 v68, 4, v68
v_lshl_add_u32 v22, v3, 11, v68
v_add_u32 v68, 12, v4
v_xor_b32 v68, v68, v3
v_lshlrev_b32 v68, 4, v68
v_lshl_add_u32 v23, v3, 11, v68
s_lshl_b32 s80, s32, 13
s_lshl_b32 s40, s38, 22
s_add_u32 s28, s40, 18874368
s_add_u32 s40, s40, s80
s_lshl_b32 s41, s99, 15
s_add_u32 s40, s40, s41
s_add_u32 s77, s40, 12582912
s_cmp_eq_u32 s38, 0
s_cselect_b32 s29, 20971520, 0
s_mov_b32 s30, 14680064
s_lshl_b32 s40, s34, 5
s_lshl_b32 s41, s32, 2
s_add_u32 s40, s40, s41
s_add_u32 s31, s40, 49152
s_lshl_b32 s41, s32, 7
s_lshl_b32 s42, s99, 9
s_add_u32 s41, s41, s42
s_cmp_ge_u32 s98, 14
s_cselect_b32 s41, s40, s41
s_cselect_b32 s43, 4, 2
s_lshl_b32 s42, s38, 16
s_add_u32 s42, s42, 16384
s_add_u32 s78, s42, s41
s_mov_b32 s79, 0xbfb8aa3b
s_cmp_ge_u32 s98, 14
s_cselect_b32 s41, 1, 31
v_and_b32 v24, s41, v1
v_lshlrev_b32 v24, s43, v24
s_mov_b32 s81, 0
s_lshl_b32 s40, s32, 10
s_add_u32 s40, s40, 32768
v_add_u32 v26, s40, v2
buffer_load_dword v25, v24, s[4:7], s78 offen sc1
L_ffn_loop_G:
s_cmp_ge_u32 s98, 14
s_cbranch_scc1 L_ffn_idle_G
s_cmp_eq_u32 s81, 0
s_cbranch_scc1 L_pf_187
s_waitcnt vmcnt(5)
L_pfo_188:
s_add_u32 s77, s77, 65536
s_add_u32 s78, s78, 1024
s_barrier
ds_read_b128 v[32:35], v20 offset:0
ds_read_b128 v[36:39], v21 offset:0
ds_read_b128 v[40:43], v22 offset:0
ds_read_b128 v[44:47], v23 offset:0
s_waitcnt lgkmcnt(3)
v_mfma_f32_16x16x32_bf16 v[48:51], a[0:3], v[32:35], 0
v_mfma_f32_16x16x32_bf16 v[52:55], a[4:7], v[32:35], 0
v_mfma_f32_16x16x32_bf16 v[56:59], a[128:131], v[32:35], 0
v_mfma_f32_16x16x32_bf16 v[60:63], a[132:135], v[32:35], 0
ds_read_b128 v[32:35], v20 offset:256
s_waitcnt lgkmcnt(3)
v_mfma_f32_16x16x32_bf16 v[48:51], a[8:11], v[36:39], v[48:51]
v_mfma_f32_16x16x32_bf16 v[52:55], a[12:15], v[36:39], v[52:55]
v_mfma_f32_16x16x32_bf16 v[56:59], a[136:139], v[36:39], v[56:59]
v_mfma_f32_16x16x32_bf16 v[60:63], a[140:143], v[36:39], v[60:63]
ds_read_b128 v[36:39], v21 offset:256
s_waitcnt lgkmcnt(3)
v_mfma_f32_16x16x32_bf16 v[48:51], a[16:19], v[40:43], v[48:51]
v_mfma_f32_16x16x32_bf16 v[52:55], a[20:23], v[40:43], v[52:55]
v_mfma_f32_16x16x32_bf16 v[56:59], a[144:147], v[40:43], v[56:59]
v_mfma_f32_16x16x32_bf16 v[60:63], a[148:151], v[40:43], v[60:63]
ds_read_b128 v[40:43], v22 offset:256
s_waitcnt lgkmcnt(3)
v_mfma_f32_16x16x32_bf16 v[48:51], a[24:27], v[44:47], v[48:51]
v_mfma_f32_16x16x32_bf16 v[52:55], a[28:31], v[44:47], v[52:55]
v_mfma_f32_16x16x32_bf16 v[56:59], a[152:155], v[44:47], v[56:59]
v_mfma_f32_16x16x32_bf16 v[60:63], a[156:159], v[44:47], v[60:63]
ds_read_b128 v[44:47], v23 offset:256
s_waitcnt lgkmcnt(3)
v_mfma_f32_16x16x32_bf16 v[48:51], a[32:35], v[32:35], v[48:51]
v_mfma_f32_16x16x32_bf16 v[52:55], a[36:39], v[32:35], v[52:55]
v_mfma_f32_16x16x32_bf16 v[56:59], a[160:163], v[32:35], v[56:59]
v_mfma_f32_16x16x32_bf16 v[60:63], a[164:167], v[32:35], v[60:63]
ds_read_b128 v[32:35], v20 offset:512
s_waitcnt lgkmcnt(3)
v_mfma_f32_16x16x32_bf16 v[48:51], a[40:43], v[36:39], v[48:51]
v_mfma_f32_16x16x32_bf16 v[52:55], a[44:47], v[36:39], v[52:55]
v_mfma_f32_16x16x32_bf16 v[56:59], a[168:171], v[36:39], v[56:59]
v_mfma_f32_16x16x32_bf16 v[60:63], a[172:175], v[36:39], v[60:63]
ds_read_b128 v[36:39], v21 offset:512
s_waitcnt lgkmcnt(3)
v_mfma_f32_16x16x32_bf16 v[48:51], a[48:51], v[40:43], v[48:51]
v_mfma_f32_16x16x32_bf16 v[52:55], a[52:55], v[40:43], v[52:55]
v_mfma_f32_16x16x32_bf16 v[56:59], a[176:179], v[40:43], v[56:59]
v_mfma_f32_16x16x32_bf16 v[60:63], a[180:183], v[40:43], v[60:63]
ds_read_b128 v[40:43], v22 offset:512
s_waitcnt lgkmcnt(3)
v_mfma_f32_16x16x32_bf16 v[48:51], a[56:59], v[44:47], v[48:51]
v_mfma_f32_16x16x32_bf16 v[52:55], a[60:63], v[44:47], v[52:55]
v_mfma_f32_16x16x32_bf16 v[56:59], a[184:187], v[44:47], v[56:59]
v_mfma_f32_16x16x32_bf16 v[60:63], a[188:191], v[44:47], v[60:63]
ds_read_b128 v[44:47], v23 offset:512
s_waitcnt lgkmcnt(3)
v_mfma_f32_16x16x32_bf16 v[48:51], a[64:67], v[32:35], v[48:51]
v_mfma_f32_16x16x32_bf16 v[52:55], a[68:71], v[32:35], v[52:55]
v_mfma_f32_16x16x32_bf16 v[56:59], a[192:195], v[32:35], v[56:59]
v_mfma_f32_16x16x32_bf16 v[60:63], a[196:199], v[32:35], v[60:63]
ds_read_b128 v[32:35], v20 offset:768
s_waitcnt lgkmcnt(3)
v_mfma_f32_16x16x32_bf16 v[48:51], a[72:75], v[36:39], v[48:51]
v_mfma_f32_16x16x32_bf16 v[52:55], a[76:79], v[36:39], v[52:55]
v_mfma_f32_16x16x32_bf16 v[56:59], a[200:203], v[36:39], v[56:59]
v_mfma_f32_16x16x32_bf16 v[60:63], a[204:207], v[36:39], v[60:63]
ds_read_b128 v[36:39], v21 offset:768
s_waitcnt lgkmcnt(3)
v_mfma_f32_16x16x32_bf16 v[48:51], a[80:83], v[40:43], v[48:51]
v_mfma_f32_16x16x32_bf16 v[52:55], a[84:87], v[40:43], v[52:55]
v_mfma_f32_16x16x32_bf16 v[56:59], a[208:211], v[40:43], v[56:59]
v_mfma_f32_16x16x32_bf16 v[60:63], a[212:215], v[40:43], v[60:63]
ds_read_b128 v[40:43], v22 offset:768
s_waitcnt lgkmcnt(3)
v_mfma_f32_16x16x32_bf16 v[48:51], a[88:91], v[44:47], v[48:51]
v_mfma_f32_16x16x32_bf16 v[52:55], a[92:95], v[44:47], v[52:55]
v_mfma_f32_16x16x32_bf16 v[56:59], a[216:219], v[44:47], v[56:59]
v_mfma_f32_16x16x32_bf16 v[60:63], a[220:223], v[44:47], v[60:63]
ds_read_b128 v[44:47], v23 offset:768
s_waitcnt lgkmcnt(3)
v_mfma_f32_16x16x32_bf16 v[48:51], a[96:99], v[32:35], v[48:51]
v_mfma_f32_16x16x32_bf16 v[52:55], a[100:103], v[32:35], v[52:55]
v_mfma_f32_16x16x32_bf16 v[56:59], a[224:227], v[32:35], v[56:59]
v_mfma_f32_16x16x32_bf16 v[60:63], a[228:231], v[32:35], v[60:63]
s_waitcnt vmcnt(0)
s_barrier
s_cmp_eq_u32 s76, 0
s_cbranch_scc1 L_np_189
s_mov_b64 exec, 3
buffer_store_dword v9, v2, s[4:7], s76 offen sc1
s_mov_b64 exec, -1
s_mov_b32 s76, 0
L_np_189:
buffer_load_dwordx2 v[28:29], v6, s[4:7], s28 offen sc1
buffer_load_ushort v30, v31, s[4:7], s28 offen sc1
ds_read_b128 v[32:35], v20 offset:1024
s_waitcnt lgkmcnt(3)
v_mfma_f32_16x16x32_bf16 v[48:51], a[104:107], v[36:39], v[48:51]
v_mfma_f32_16x16x32_bf16 v[52:55], a[108:111], v[36:39], v[52:55]
v_mfma_f32_16x16x32_bf16 v[56:59], a[232:235], v[36:39], v[56:59]
v_mfma_f32_16x16x32_bf16 v[60:63], a[236:239], v[36:39], v[60:63]
ds_read_b128 v[36:39], v21 offset:1024
s_waitcnt lgkmcnt(3)
v_mfma_f32_16x16x32_bf16 v[48:51], a[112:115], v[40:43], v[48:51]
v_mfma_f32_16x16x32_bf16 v[52:55], a[116:119], v[40:43], v[52:55]
v_mfma_f32_16x16x32_bf16 v[56:59], a[240:243], v[40:43], v[56:59]
v_mfma_f32_16x16x32_bf16 v[60:63], a[244:247], v[40:43], v[60:63]
ds_read_b128 v[40:43], v22 offset:1024
s_waitcnt lgkmcnt(3)
v_mfma_f32_16x16x32_bf16 v[48:51], a[120:123], v[44:47], v[48:51]
v_mfma_f32_16x16x32_bf16 v[52:55], a[124:127], v[44:47], v[52:55]
v_mfma_f32_16x16x32_bf16 v[56:59], a[248:251], v[44:47], v[56:59]
v_mfma_f32_16x16x32_bf16 v[60:63], a[252:255], v[44:47], v[60:63]
ds_read_b128 v[44:47], v23 offset:1024
s_waitcnt lgkmcnt(3)
v_mfma_f32_16x16x32_bf16 v[64:67], a[0:3], v[32:35], 0
v_mfma_f32_16x16x32_bf16 v[68:71], a[4:7], v[32:35], 0
v_mfma_f32_16x16x32_bf16 v[72:75], a[128:131], v[32:35], 0
v_mfma_f32_16x16x32_bf16 v[76:79], a[132:135], v[32:35], 0
ds_read_b128 v[32:35], v20 offset:1280
s_waitcnt lgkmcnt(3)
v_mfma_f32_16x16x32_bf16 v[64:67], a[8:11], v[36:39], v[64:67]
v_mfma_f32_16x16x32_bf16 v[68:71], a[12:15], v[36:39], v[68:71]
v_mfma_f32_16x16x32_bf16 v[72:75], a[136:139], v[36:39], v[72:75]
v_mfma_f32_16x16x32_bf16 v[76:79], a[140:143], v[36:39], v[76:79]
ds_read_b128 v[36:39], v21 offset:1280
s_waitcnt lgkmcnt(3)
v_mfma_f32_16x16x32_bf16 v[64:67], a[16:19], v[40:43], v[64:67]
v_mul_f32 v80, s79, v48
v_mfma_f32_16x16x32_bf16 v[68:71], a[20:23], v[40:43], v[68:71]
v_mul_f32 v81, s79, v49
v_mfma_f32_16x16x32_bf16 v[72:75], a[144:147], v[40:43], v[72:75]
v_mul_f32 v82, s79, v50
v_mfma_f32_16x16x32_bf16 v[76:79], a[148:151], v[40:43], v[76:79]
v_mul_f32 v83, s79, v51
ds_read_b128 v[40:43], v22 offset:1280
s_waitcnt lgkmcnt(3)
v_mfma_f32_16x16x32_bf16 v[64:67], a[24:27], v[44:47], v[64:67]
v_mul_f32 v84, s79, v52
v_mfma_f32_16x16x32_bf16 v[68:71], a[28:31], v[44:47], v[68:71]
v_mul_f32 v85, s79, v53
v_mfma_f32_16x16x32_bf16 v[72:75], a[152:155], v[44:47], v[72:75]
v_mul_f32 v86, s79, v54
v_mfma_f32_16x16x32_bf16 v[76:79], a[156:159], v[44:47], v[76:79]
v_mul_f32 v87, s79, v55
ds_read_b128 v[44:47], v23 offset:1280
s_waitcnt lgkmcnt(3)
v_mfma_f32_16x16x32_bf16 v[64:67], a[32:35], v[32:35], v[64:67]
v_exp_f32 v80, v80
v_mfma_f32_16x16x32_bf16 v[68:71], a[36:39], v[32:35], v[68:71]
v_mul_f32 v48, v48, v56
v_mfma_f32_16x16x32_bf16 v[72:75], a[160:163], v[32:35], v[72:75]
v_exp_f32 v81, v81
v_mfma_f32_16x16x32_bf16 v[76:79], a[164:167], v[32:35], v[76:79]
v_mul_f32 v49, v49, v57
ds_read_b128 v[32:35], v20 offset:1536
s_waitcnt lgkmcnt(3)
v_mfma_f32_16x16x32_bf16 v[64:67], a[40:43], v[36:39], v[64:67]
v_exp_f32 v82, v82
v_mfma_f32_16x16x32_bf16 v[68:71], a[44:47], v[36:39], v[68:71]
v_mul_f32 v50, v50, v58
v_mfma_f32_16x16x32_bf16 v[72:75], a[168:171], v[36:39], v[72:75]
v_exp_f32 v83, v83
v_mfma_f32_16x16x32_bf16 v[76:79], a[172:175], v[36:39], v[76:79]
v_mul_f32 v51, v51, v59
ds_read_b128 v[36:39], v21 offset:1536
s_waitcnt lgkmcnt(3)
v_mfma_f32_16x16x32_bf16 v[64:67], a[48:51], v[40:43], v[64:67]
v_exp_f32 v84, v84
v_mfma_f32_16x16x32_bf16 v[68:71], a[52:55], v[40:43], v[68:71]
v_mul_f32 v52, v52, v60
v_mfma_f32_16x16x32_bf16 v[72:75], a[176:179], v[40:43], v[72:75]
v_exp_f32 v85, v85
v_mfma_f32_16x16x32_bf16 v[76:79], a[180:183], v[40:43], v[76:79]
v_mul_f32 v53, v53, v61
ds_read_b128 v[40:43], v22 offset:1536
s_waitcnt lgkmcnt(3)
v_mfma_f32_16x16x32_bf16 v[64:67], a[56:59], v[44:47], v[64:67]
v_exp_f32 v86, v86
v_mfma_f32_16x16x32_bf16 v[68:71], a[60:63], v[44:47], v[68:71]
v_mul_f32 v54, v54, v62
v_mfma_f32_16x16x32_bf16 v[72:75], a[184:187], v[44:47], v[72:75]
v_exp_f32 v87, v87
v_mfma_f32_16x16x32_bf16 v[76:79], a[188:191], v[44:47], v[76:79]
v_mul_f32 v55, v55, v63
ds_read_b128 v[44:47], v23 offset:1536
s_waitcnt lgkmcnt(3)
v_mfma_f32_16x16x32_bf16 v[64:67], a[64:67], v[32:35], v[64:67]
v_add_f32 v80, 1.0, v80
v_mfma_f32_16x16x32_bf16 v[68:71], a[68:71], v[32:35], v[68:71]
v_add_f32 v81, 1.0, v81
v_mfma_f32_16x16x32_bf16 v[72:75], a[192:195], v[32:35], v[72:75]
v_add_f32 v82, 1.0, v82
v_mfma_f32_16x16x32_bf16 v[76:79], a[196:199], v[32:35], v[76:79]
v_add_f32 v83, 1.0, v83
ds_read_b128 v[32:35], v20 offset:1792
s_waitcnt lgkmcnt(3)
v_mfma_f32_16x16x32_bf16 v[64:67], a[72:75], v[36:39], v[64:67]
v_add_f32 v84, 1.0, v84
v_mfma_f32_16x16x32_bf16 v[68:71], a[76:79], v[36:39], v[68:71]
v_add_f32 v85, 1.0, v85
v_mfma_f32_16x16x32_bf16 v[72:75], a[200:203], v[36:39], v[72:75]
v_add_f32 v86, 1.0, v86
v_mfma_f32_16x16x32_bf16 v[76:79], a[204:207], v[36:39], v[76:79]
v_add_f32 v87, 1.0, v87
ds_read_b128 v[36:39], v21 offset:1792
s_waitcnt lgkmcnt(3)
v_mfma_f32_16x16x32_bf16 v[64:67], a[80:83], v[40:43], v[64:67]
v_rcp_f32 v80, v80
v_mfma_f32_16x16x32_bf16 v[68:71], a[84:87], v[40:43], v[68:71]
v_rcp_f32 v81, v81
v_mfma_f32_16x16x32_bf16 v[72:75], a[208:211], v[40:43], v[72:75]
v_rcp_f32 v82, v82
v_mfma_f32_16x16x32_bf16 v[76:79], a[212:215], v[40:43], v[76:79]
v_rcp_f32 v83, v83
ds_read_b128 v[40:43], v22 offset:1792
s_waitcnt lgkmcnt(3)
v_mfma_f32_16x16x32_bf16 v[64:67], a[88:91], v[44:47], v[64:67]
v_rcp_f32 v84, v84
v_mfma_f32_16x16x32_bf16 v[68:71], a[92:95], v[44:47], v[68:71]
v_rcp_f32 v85, v85
v_mfma_f32_16x16x32_bf16 v[72:75], a[216:219], v[44:47], v[72:75]
v_rcp_f32 v86, v86
v_mfma_f32_16x16x32_bf16 v[76:79], a[220:223], v[44:47], v[76:79]
v_rcp_f32 v87, v87
ds_read_b128 v[44:47], v23 offset:1792
s_waitcnt lgkmcnt(3)
v_mfma_f32_16x16x32_bf16 v[64:67], a[96:99], v[32:35], v[64:67]
v_mul_f32 v80, v80, v48
v_mfma_f32_16x16x32_bf16 v[68:71], a[100:103], v[32:35], v[68:71]
v_mul_f32 v81, v81, v49
v_mfma_f32_16x16x32_bf16 v[72:75], a[224:227], v[32:35], v[72:75]
v_mul_f32 v82, v82, v50
v_mfma_f32_16x16x32_bf16 v[76:79], a[228:231], v[32:35], v[76:79]
v_mul_f32 v83, v83, v51
s_waitcnt lgkmcnt(2)
v_mfma_f32_16x16x32_bf16 v[64:67], a[104:107], v[36:39], v[64:67]
v_mul_f32 v84, v84, v52
v_mfma_f32_16x16x32_bf16 v[68:71], a[108:111], v[36:39], v[68:71]
v_mul_f32 v85, v85, v53
v_mfma_f32_16x16x32_bf16 v[72:75], a[232:235], v[36:39], v[72:75]
v_mul_f32 v86, v86, v54
v_mfma_f32_16x16x32_bf16 v[76:79], a[236:239], v[36:39], v[76:79]
v_mul_f32 v87, v87, v55
s_waitcnt lgkmcnt(1)
v_mfma_f32_16x16x32_bf16 v[64:67], a[112:115], v[40:43], v[64:67]
v_cvt_pk_bf16_f32 v56, v80, v84
v_mfma_f32_16x16x32_bf16 v[68:71], a[116:119], v[40:43], v[68:71]
v_cvt_pk_bf16_f32 v57, v81, v85
v_mfma_f32_16x16x32_bf16 v[72:75], a[240:243], v[40:43], v[72:75]
v_cvt_pk_bf16_f32 v58, v82, v86
v_mfma_f32_16x16x32_bf16 v[76:79], a[244:247], v[40:43], v[76:79]
v_cvt_pk_bf16_f32 v59, v83, v87
s_waitcnt lgkmcnt(0)
v_mfma_f32_16x16x32_bf16 v[64:67], a[120:123], v[44:47], v[64:67]
ds_write_b128 v26, v[56:59] offset:0
v_mfma_f32_16x16x32_bf16 v[68:71], a[124:127], v[44:47], v[68:71]
v_mfma_f32_16x16x32_bf16 v[72:75], a[248:251], v[44:47], v[72:75]
v_mfma_f32_16x16x32_bf16 v[76:79], a[252:255], v[44:47], v[76:79]
s_waitcnt lgkmcnt(0)
s_barrier
ds_read_b128 v[32:35], v2 offset:32768
ds_read_b128 v[36:39], v2 offset:33792
ds_read_b128 v[40:43], v2 offset:34816
ds_read_b128 v[44:47], v2 offset:35840
v_mul_f32 v80, s79, v64
v_mul_f32 v81, s79, v65
v_mul_f32 v82, s79, v66
v_mul_f32 v83, s79, v67
v_mul_f32 v84, s79, v68
v_mul_f32 v85, s79, v69
v_mul_f32 v86, s79, v70
v_mul_f32 v87, s79, v71
v_exp_f32 v80, v80
v_mul_f32 v64, v64, v72
v_exp_f32 v81, v81
s_waitcnt lgkmcnt(3)
v_mfma_f32_16x16x32_bf16 v[88:91], v[32:35], v[128:131], 0
v_mul_f32 v65, v65, v73
v_exp_f32 v82, v82
v_mfma_f32_16x16x32_bf16 v[92:95], v[32:35], v[132:135], 0
v_mul_f32 v66, v66, v74
v_exp_f32 v83, v83
v_mfma_f32_16x16x32_bf16 v[96:99], v[32:35], v[136:139], 0
v_mul_f32 v67, v67, v75
v_exp_f32 v84, v84
v_mfma_f32_16x16x32_bf16 v[100:103], v[32:35], v[140:143], 0
v_mul_f32 v68, v68, v76
v_exp_f32 v85, v85
v_mfma_f32_16x16x32_bf16 v[104:107], v[32:35], v[144:147], 0
v_mul_f32 v69, v69, v77
v_exp_f32 v86, v86
v_mfma_f32_16x16x32_bf16 v[108:111], v[32:35], v[148:151], 0
v_mul_f32 v70, v70, v78
v_exp_f32 v87, v87
v_mfma_f32_16x16x32_bf16 v[112:115], v[32:35], v[152:155], 0
v_mul_f32 v71, v71, v79
v_add_f32 v80, 1.0, v80
v_mfma_f32_16x16x32_bf16 v[116:119], v[32:35], v[156:159], 0
v_add_f32 v81, 1.0, v81
v_add_f32 v82, 1.0, v82
s_waitcnt lgkmcnt(2)
v_mfma_f32_16x16x32_bf16 v[88:91], v[36:39], v[160:163], v[88:91]
v_add_f32 v83, 1.0, v83
v_add_f32 v84, 1.0, v84
v_mfma_f32_16x16x32_bf16 v[92:95], v[36:39], v[164:167], v[92:95]
v_add_f32 v85, 1.0, v85
v_add_f32 v86, 1.0, v86
v_mfma_f32_16x16x32_bf16 v[96:99], v[36:39], v[168:171], v[96:99]
v_add_f32 v87, 1.0, v87
v_rcp_f32 v80, v80
v_mfma_f32_16x16x32_bf16 v[100:103], v[36:39], v[172:175], v[100:103]
v_rcp_f32 v81, v81
v_mfma_f32_16x16x32_bf16 v[104:107], v[36:39], v[176:179], v[104:107]
v_rcp_f32 v82, v82
v_mfma_f32_16x16x32_bf16 v[108:111], v[36:39], v[180:183], v[108:111]
v_rcp_f32 v83, v83
v_mfma_f32_16x16x32_bf16 v[112:115], v[36:39], v[184:187], v[112:115]
v_rcp_f32 v84, v84
v_mfma_f32_16x16x32_bf16 v[116:119], v[36:39], v[188:191], v[116:119]
v_rcp_f32 v85, v85
s_waitcnt lgkmcnt(1)
v_mfma_f32_16x16x32_bf16 v[88:91], v[40:43], v[192:195], v[88:91]
v_rcp_f32 v86, v86
v_mfma_f32_16x16x32_bf16 v[92:95], v[40:43], v[196:199], v[92:95]
v_rcp_f32 v87, v87
v_mfma_f32_16x16x32_bf16 v[96:99], v[40:43], v[200:203], v[96:99]
v_mul_f32 v80, v80, v64
v_mul_f32 v81, v81, v65
v_mfma_f32_16x16x32_bf16 v[100:103], v[40:43], v[204:207], v[100:103]
v_mul_f32 v82, v82, v66
v_mul_f32 v83, v83, v67
v_mfma_f32_16x16x32_bf16 v[104:107], v[40:43], v[208:211], v[104:107]
v_mul_f32 v84, v84, v68
v_mul_f32 v85, v85, v69
v_mfma_f32_16x16x32_bf16 v[108:111], v[40:43], v[212:215], v[108:111]
v_mul_f32 v86, v86, v70
v_mul_f32 v87, v87, v71
v_mfma_f32_16x16x32_bf16 v[112:115], v[40:43], v[216:219], v[112:115]
v_cvt_pk_bf16_f32 v72, v80, v84
v_cvt_pk_bf16_f32 v73, v81, v85
v_mfma_f32_16x16x32_bf16 v[116:119], v[40:43], v[220:223], v[116:119]
v_cvt_pk_bf16_f32 v74, v82, v86
v_cvt_pk_bf16_f32 v75, v83, v87
s_waitcnt lgkmcnt(0)
v_mfma_f32_16x16x32_bf16 v[88:91], v[44:47], v[224:227], v[88:91]
ds_write_b128 v26, v[72:75] offset:4096
v_mfma_f32_16x16x32_bf16 v[92:95], v[44:47], v[228:231], v[92:95]
v_mfma_f32_16x16x32_bf16 v[96:99], v[44:47], v[232:235], v[96:99]
v_mfma_f32_16x16x32_bf16 v[100:103], v[44:47], v[236:239], v[100:103]
v_mfma_f32_16x16x32_bf16 v[104:107], v[44:47], v[240:243], v[104:107]
v_mfma_f32_16x16x32_bf16 v[108:111], v[44:47], v[244:247], v[108:111]
v_mfma_f32_16x16x32_bf16 v[112:115], v[44:47], v[248:251], v[112:115]
v_mfma_f32_16x16x32_bf16 v[116:119], v[44:47], v[252:255], v[116:119]
s_waitcnt lgkmcnt(0)
s_barrier
ds_read_b128 v[32:35], v2 offset:36864
ds_read_b128 v[36:39], v2 offset:37888
ds_read_b128 v[40:43], v2 offset:38912
ds_read_b128 v[44:47], v2 offset:39936
s_waitcnt lgkmcnt(3)
v_mfma_f32_16x16x32_bf16 v[48:51], v[32:35], v[128:131], 0
v_cvt_pk_bf16_f32 v120, v88, v92
v_cvt_pk_bf16_f32 v121, v96, v100
v_mfma_f32_16x16x32_bf16 v[52:55], v[32:35], v[132:135], 0
v_cvt_pk_bf16_f32 v122, v104, v108
v_cvt_pk_bf16_f32 v123, v112, v116
v_mfma_f32_16x16x32_bf16 v[56:59], v[32:35], v[136:139], 0
v_bfi_b32 v120, 1, s101, v120
v_bfi_b32 v121, 1, s101, v121
v_mfma_f32_16x16x32_bf16 v[60:63], v[32:35], v[140:143], 0
v_bfi_b32 v122, 1, s101, v122
v_bfi_b32 v123, 1, s101, v123
s_add_u32 s40, s39, 0
v_mfma_f32_16x16x32_bf16 v[64:67], v[32:35], v[144:147], 0
buffer_store_dwordx4 v[120:123], v8, s[4:7], s40 offen sc1
v_mfma_f32_16x16x32_bf16 v[68:71], v[32:35], v[148:151], 0
v_cvt_pk_bf16_f32 v124, v89, v93
v_cvt_pk_bf16_f32 v125, v97, v101
v_mfma_f32_16x16x32_bf16 v[72:75], v[32:35], v[152:155], 0
v_cvt_pk_bf16_f32 v126, v105, v109
v_cvt_pk_bf16_f32 v127, v113, v117
v_mfma_f32_16x16x32_bf16 v[76:79], v[32:35], v[156:159], 0
v_bfi_b32 v124, 1, s101, v124
v_bfi_b32 v125, 1, s101, v125
s_waitcnt lgkmcnt(2)
v_mfma_f32_16x16x32_bf16 v[48:51], v[36:39], v[160:163], v[48:51]
v_bfi_b32 v126, 1, s101, v126
v_bfi_b32 v127, 1, s101, v127
s_add_u32 s40, s39, 32768
v_mfma_f32_16x16x32_bf16 v[52:55], v[36:39], v[164:167], v[52:55]
buffer_store_dwordx4 v[124:127], v8, s[4:7], s40 offen sc1
v_mfma_f32_16x16x32_bf16 v[56:59], v[36:39], v[168:171], v[56:59]
v_cvt_pk_bf16_f32 v120, v90, v94
v_cvt_pk_bf16_f32 v121, v98, v102
v_mfma_f32_16x16x32_bf16 v[60:63], v[36:39], v[172:175], v[60:63]
v_cvt_pk_bf16_f32 v122, v106, v110
v_cvt_pk_bf16_f32 v123, v114, v118
v_mfma_f32_16x16x32_bf16 v[64:67], v[36:39], v[176:179], v[64:67]
v_bfi_b32 v120, 1, s101, v120
v_bfi_b32 v121, 1, s101, v121
v_mfma_f32_16x16x32_bf16 v[68:71], v[36:39], v[180:183], v[68:71]
v_bfi_b32 v122, 1, s101, v122
v_bfi_b32 v123, 1, s101, v123
s_add_u32 s40, s39, 65536
v_mfma_f32_16x16x32_bf16 v[72:75], v[36:39], v[184:187], v[72:75]
buffer_store_dwordx4 v[120:123], v8, s[4:7], s40 offen sc1
v_mfma_f32_16x16x32_bf16 v[76:79], v[36:39], v[188:191], v[76:79]
v_cvt_pk_bf16_f32 v124, v91, v95
v_cvt_pk_bf16_f32 v125, v99, v103
s_waitcnt lgkmcnt(1)
v_mfma_f32_16x16x32_bf16 v[48:51], v[40:43], v[192:195], v[48:51]
v_cvt_pk_bf16_f32 v126, v107, v111
v_cvt_pk_bf16_f32 v127, v115, v119
v_mfma_f32_16x16x32_bf16 v[52:55], v[40:43], v[196:199], v[52:55]
v_bfi_b32 v124, 1, s101, v124
v_bfi_b32 v125, 1, s101, v125
v_mfma_f32_16x16x32_bf16 v[56:59], v[40:43], v[200:203], v[56:59]
v_bfi_b32 v126, 1, s101, v126
v_bfi_b32 v127, 1, s101, v127
s_add_u32 s40, s39, 98304
v_mfma_f32_16x16x32_bf16 v[60:63], v[40:43], v[204:207], v[60:63]
buffer_store_dwordx4 v[124:127], v8, s[4:7], s40 offen sc1
v_mfma_f32_16x16x32_bf16 v[64:67], v[40:43], v[208:211], v[64:67]
v_mfma_f32_16x16x32_bf16 v[68:71], v[40:43], v[212:215], v[68:71]
v_mfma_f32_16x16x32_bf16 v[72:75], v[40:43], v[216:219], v[72:75]
v_mfma_f32_16x16x32_bf16 v[76:79], v[40:43], v[220:223], v[76:79]
s_waitcnt lgkmcnt(0)
v_mfma_f32_16x16x32_bf16 v[48:51], v[44:47], v[224:227], v[48:51]
v_mfma_f32_16x16x32_bf16 v[52:55], v[44:47], v[228:231], v[52:55]
v_mfma_f32_16x16x32_bf16 v[56:59], v[44:47], v[232:235], v[56:59]
v_mfma_f32_16x16x32_bf16 v[60:63], v[44:47], v[236:239], v[60:63]
v_mfma_f32_16x16x32_bf16 v[64:67], v[44:47], v[240:243], v[64:67]
v_mfma_f32_16x16x32_bf16 v[68:71], v[44:47], v[244:247], v[68:71]
v_mfma_f32_16x16x32_bf16 v[72:75], v[44:47], v[248:251], v[72:75]
v_mfma_f32_16x16x32_bf16 v[76:79], v[44:47], v[252:255], v[76:79]
s_nop 1
v_cvt_pk_bf16_f32 v120, v48, v52
s_nop 0
v_cvt_pk_bf16_f32 v121, v56, v60
s_nop 0
v_cvt_pk_bf16_f32 v122, v64, v68
s_nop 0
v_cvt_pk_bf16_f32 v123, v72, v76
v_bfi_b32 v120, 1, s101, v120
v_bfi_b32 v121, 1, s101, v121
v_bfi_b32 v122, 1, s101, v122
v_bfi_b32 v123, 1, s101, v123
s_add_u32 s40, s39, 0
buffer_store_dwordx4 v[120:123], v27, s[4:7], s40 offen sc1
v_cvt_pk_bf16_f32 v124, v49, v53
v_cvt_pk_bf16_f32 v125, v57, v61
v_cvt_pk_bf16_f32 v126, v65, v69
v_cvt_pk_bf16_f32 v127, v73, v77
v_bfi_b32 v124, 1, s101, v124
v_bfi_b32 v125, 1, s101, v125
v_bfi_b32 v126, 1, s101, v126
v_bfi_b32 v127, 1, s101, v127
s_add_u32 s40, s39, 32768
buffer_store_dwordx4 v[124:127], v27, s[4:7], s40 offen sc1
v_cvt_pk_bf16_f32 v120, v50, v54
v_cvt_pk_bf16_f32 v121, v58, v62
v_cvt_pk_bf16_f32 v122, v66, v70
v_cvt_pk_bf16_f32 v123, v74, v78
v_bfi_b32 v120, 1, s101, v120
v_bfi_b32 v121, 1, s101, v121
v_bfi_b32 v122, 1, s101, v122
v_bfi_b32 v123, 1, s101, v123
s_add_u32 s40, s39, 65536
buffer_store_dwordx4 v[120:123], v27, s[4:7], s40 offen sc1
v_cvt_pk_bf16_f32 v124, v51, v55
v_cvt_pk_bf16_f32 v125, v59, v63
v_cvt_pk_bf16_f32 v126, v67, v71
v_cvt_pk_bf16_f32 v127, v75, v79
v_bfi_b32 v124, 1, s101, v124
v_bfi_b32 v125, 1, s101, v125
v_bfi_b32 v126, 1, s101, v126
v_bfi_b32 v127, 1, s101, v127
s_add_u32 s40, s39, 98304
buffer_store_dwordx4 v[124:127], v27, s[4:7], s40 offen sc1
s_add_u32 s43, s39, 0
buffer_load_dwordx4 v[88:91], v5, s[4:7], s43 offen sc1
s_add_u32 s43, s39, 4096
buffer_load_dwordx4 v[92:95], v5, s[4:7], s43 offen sc1
s_add_u32 s43, s39, 8192
buffer_load_dwordx4 v[96:99], v5, s[4:7], s43 offen sc1
s_add_u32 s43, s39, 12288
buffer_load_dwordx4 v[100:103], v5, s[4:7], s43 offen sc1
s_branch L_ffn_red_G
L_ffn_idle_G:
s_waitcnt vmcnt(0)
s_cmp_eq_u32 s76, 0
s_cbranch_scc1 L_np_192
s_mov_b64 exec, 3
buffer_store_dword v9, v2, s[4:7], s76 offen sc1
s_mov_b64 exec, -1
s_mov_b32 s76, 0
L_np_192:
L_sp_190:
v_cmp_eq_u32 vcc, 0, v25
s_cbranch_vccz L_spo_191
s_sub_u32 s36, s36, 1
s_cbranch_scc1 L_end_ffn_G
buffer_load_dword v25, v24, s[4:7], s78 offen sc1
s_waitcnt vmcnt(0)
s_branch L_sp_190
L_spo_191:
s_add_u32 s78, s78, 1024
s_barrier
buffer_load_dwordx2 v[28:29], v6, s[4:7], s28 offen sc1
buffer_load_ushort v30, v31, s[4:7], s28 offen sc1
v_mov_b32 v120, s101
v_mov_b32 v121, s101
v_mov_b32 v122, s101
v_mov_b32 v123, s101
s_add_u32 s40, s39, 0
buffer_store_dwordx4 v[120:123], v8, s[4:7], s40 offen sc1
s_add_u32 s40, s39, 16384
buffer_store_dwordx4 v[120:123], v8, s[4:7], s40 offen sc1
s_add_u32 s40, s39, 32768
buffer_store_dwordx4 v[120:123], v8, s[4:7], s40 offen sc1
s_add_u32 s40, s39, 49152
buffer_store_dwordx4 v[120:123], v8, s[4:7], s40 offen sc1
s_add_u32 s40, s39, 65536
buffer_store_dwordx4 v[120:123], v8, s[4:7], s40 offen sc1
s_add_u32 s40, s39, 81920
buffer_store_dwordx4 v[120:123], v8, s[4:7], s40 offen sc1
s_add_u32 s40, s39, 98304
buffer_store_dwordx4 v[120:123], v8, s[4:7], s40 offen sc1
s_add_u32 s40, s39, 114688
buffer_store_dwordx4 v[120:123], v8, s[4:7], s40 offen sc1
s_add_u32 s43, s39, 0
buffer_load_dwordx4 v[88:91], v5, s[4:7], s43 offen sc1
s_add_u32 s43, s39, 4096
buffer_load_dwordx4 v[92:95], v5, s[4:7], s43 offen sc1
s_add_u32 s43, s39, 8192
buffer_load_dwordx4 v[96:99], v5, s[4:7], s43 offen sc1
s_add_u32 s43, s39, 12288
buffer_load_dwordx4 v[100:103], v5, s[4:7], s43 offen sc1
L_ffn_red_G:
s_waitcnt vmcnt(0)
s_add_u32 s43, s39, 0
buffer_load_dwordx4 v[104:107], v0, s[4:7], s43 offen sc1
s_add_u32 s43, s39, 4096
buffer_load_dwordx4 v[108:111], v0, s[4:7], s43 offen sc1
s_add_u32 s43, s39, 8192
buffer_load_dwordx4 v[112:115], v0, s[4:7], s43 offen sc1
s_add_u32 s43, s39, 12288
buffer_load_dwordx4 v[116:119], v0, s[4:7], s43 offen sc1
buffer_load_dword v25, v24, s[4:7], s78 offen sc1
L_rea2_204:
v_mov_b32 v68, 0
v_mov_b32 v69, -1
v_mfma_f32_16x16x32_bf16 v[76:79], v[12:15], v[88:91], 0
v_or3_b32 v68, v68, v88, v89
v_bitop3_b32 v69, v69, v88, v89 bitop3:0x80
v_or3_b32 v68, v68, v90, v91
v_bitop3_b32 v69, v69, v90, v91 bitop3:0x80
v_mfma_f32_16x16x32_bf16 v[76:79], v[12:15], v[92:95], v[76:79]
v_or3_b32 v68, v68, v92, v93
v_bitop3_b32 v69, v69, v92, v93 bitop3:0x80
v_or3_b32 v68, v68, v94, v95
v_bitop3_b32 v69, v69, v94, v95 bitop3:0x80
v_mfma_f32_16x16x32_bf16 v[76:79], v[12:15], v[96:99], v[76:79]
v_or3_b32 v68, v68, v96, v97
v_bitop3_b32 v69, v69, v96, v97 bitop3:0x80
v_or3_b32 v68, v68, v98, v99
v_bitop3_b32 v69, v69, v98, v99 bitop3:0x80
v_mfma_f32_16x16x32_bf16 v[76:79], v[12:15], v[100:103], v[76:79]
v_or3_b32 v68, v68, v100, v101
v_bitop3_b32 v69, v69, v100, v101 bitop3:0x80
v_or3_b32 v68, v68, v102, v103
v_bitop3_b32 v69, v69, v102, v103 bitop3:0x80
v_xor_b32 v68, s101, v68
v_bitop3_b32 v68, v68, v69, s101 bitop3:0xf6
v_and_b32 v68, 1, v68
v_cmp_ne_u32 vcc, 0, v68
s_cbranch_vccnz L_rea_203
v_lshlrev_b32 v72, 16, v28
v_and_b32 v73, 0xffff0000, v28
v_lshlrev_b32 v74, 16, v29
v_and_b32 v75, 0xffff0000, v29
L_red2_202:
v_mov_b32 v68, 0
v_mov_b32 v69, -1
s_waitcnt vmcnt(4)
v_mfma_f32_16x16x32_bf16 v[64:67], v[16:19], v[104:107], v[76:79]
v_or3_b32 v68, v68, v104, v105
v_bitop3_b32 v69, v69, v104, v105 bitop3:0x80
v_or3_b32 v68, v68, v106, v107
v_bitop3_b32 v69, v69, v106, v107 bitop3:0x80
s_waitcnt vmcnt(3)
v_mfma_f32_16x16x32_bf16 v[64:67], v[16:19], v[108:111], v[64:67]
v_or3_b32 v68, v68, v108, v109
v_bitop3_b32 v69, v69, v108, v109 bitop3:0x80
v_or3_b32 v68, v68, v110, v111
v_bitop3_b32 v69, v69, v110, v111 bitop3:0x80
s_waitcnt vmcnt(2)
v_mfma_f32_16x16x32_bf16 v[64:67], v[16:19], v[112:115], v[64:67]
v_or3_b32 v68, v68, v112, v113
v_bitop3_b32 v69, v69, v112, v113 bitop3:0x80
v_or3_b32 v68, v68, v114, v115
v_bitop3_b32 v69, v69, v114, v115 bitop3:0x80
s_waitcnt vmcnt(1)
v_mfma_f32_16x16x32_bf16 v[64:67], v[16:19], v[116:119], v[64:67]
v_or3_b32 v68, v68, v116, v117
v_bitop3_b32 v69, v69, v116, v117 bitop3:0x80
v_or3_b32 v68, v68, v118, v119
v_bitop3_b32 v69, v69, v118, v119 bitop3:0x80
v_xor_b32 v68, s101, v68
v_bitop3_b32 v68, v68, v69, s101 bitop3:0xf6
v_and_b32 v68, 1, v68
v_cmp_ne_u32 vcc, 0, v68
s_cbranch_vccnz L_red_201
v_add_f32 v72, v72, v64
v_add_f32 v73, v73, v65
v_add_f32 v74, v74, v66
v_add_f32 v75, v75, v67
v_cvt_pk_bf16_f32 v64, v72, v73
v_cvt_pk_bf16_f32 v65, v74, v75
s_waitcnt vmcnt(0)
v_cmp_eq_u32 vcc, 0, v25
s_cmp_ge_u32 s98, 14
s_cselect_b64 vcc, -1, vcc
s_cmp_eq_u64 vcc, 0
s_cselect_b32 s81, 1, 0
s_cselect_b64 vcc, -1, 0
s_cbranch_scc1 L_nx_205
buffer_load_dword v25, v24, s[4:7], s78 offen sc1
L_nx_205:
s_cmp_eq_u32 s38, 1
s_cbranch_scc1 L_ffn_fin_G
v_lshlrev_b32 v70, 16, v30
v_lshlrev_b32 v72, 16, v64
v_and_b32 v73, 0xffff0000, v64
v_lshlrev_b32 v74, 16, v65
v_and_b32 v75, 0xffff0000, v65
s_cbranch_vccz L_gd_193
s_add_u32 m0, s80, 0
s_add_u32 s44, s77, 0
buffer_load_dwordx4 v2, s[4:7], s44 offen offset:0 sc1 lds
L_gd_193:
v_sub_f32 v72, v72, v70
v_sub_f32 v73, v73, v70
v_sub_f32 v74, v74, v70
v_sub_f32 v75, v75, v70
v_add_f32 v68, v72, v73
s_cbranch_vccz L_gd_194
s_add_u32 m0, s80, 0
s_add_u32 s44, s77, 0
buffer_load_dwordx4 v2, s[4:7], s44 offen offset:2048 sc1 lds
L_gd_194:
v_mul_f32 v69, v72, v72
v_add_f32 v68, v68, v74
v_fmac_f32 v69, v73, v73
v_add_f32 v68, v68, v75
v_fmac_f32 v69, v74, v74
s_cbranch_vccz L_gd_195
s_add_u32 m0, s80, 4096
s_add_u32 s44, s77, 4096
buffer_load_dwordx4 v2, s[4:7], s44 offen offset:0 sc1 lds
L_gd_195:
v_fmac_f32 v69, v75, v75
v_add_f32_dpp v68, v68, v68 row_ror:8 row_mask:0xf bank_mask:0xf
s_nop 0
v_add_f32_dpp v69, v69, v69 row_ror:8 row_mask:0xf bank_mask:0xf
v_add_f32_dpp v68, v68, v68 row_ror:4 row_mask:0xf bank_mask:0xf
s_nop 0
v_add_f32_dpp v69, v69, v69 row_ror:4 row_mask:0xf bank_mask:0xf
v_add_f32_dpp v68, v68, v68 row_ror:2 row_mask:0xf bank_mask:0xf
s_nop 0
v_add_f32_dpp v69, v69, v69 row_ror:2 row_mask:0xf bank_mask:0xf
v_add_f32_dpp v68, v68, v68 row_ror:1 row_mask:0xf bank_mask:0xf
s_nop 0
v_add_f32_dpp v69, v69, v69 row_ror:1 row_mask:0xf bank_mask:0xf
s_nop 1
v_permlane16_swap_b32 v68, v69
v_add_f32 v68, v68, v69
ds_write_b32 v10, v68
s_waitcnt lgkmcnt(0)
s_barrier
ds_read_b128 v[88:91], v11
ds_read_b128 v[92:95], v11 offset:16
v_mov_b32 v71, 0x3727c5ac
s_waitcnt lgkmcnt(1)
v_add_f32 v88, v88, v89
s_cbranch_vccz L_gd_196
s_add_u32 m0, s80, 4096
s_add_u32 s44, s77, 4096
buffer_load_dwordx4 v2, s[4:7], s44 offen offset:2048 sc1 lds
L_gd_196:
v_add_f32 v90, v90, v91
v_add_f32 v88, v88, v90
s_waitcnt lgkmcnt(0)
v_add_f32 v92, v92, v93
v_add_f32 v94, v94, v95
v_mul_f32 v88, 0x3b000000, v88
s_cbranch_vccz L_gd_197
s_add_u32 m0, s80, 0
s_add_u32 s44, s77, 0
buffer_load_dwordx4 v2, s[4:7], s44 offen offset:1024 sc1 lds
L_gd_197:
v_add_f32 v92, v92, v94
v_mul_f32 v92, 0x3b000000, v92
v_fma_f32 v92, -v88, v88, v92
v_max_f32 v92, 0, v92
v_add_f32 v71, v71, v92
s_cbranch_vccz L_gd_198
s_add_u32 m0, s80, 0
s_add_u32 s44, s77, 0
buffer_load_dwordx4 v2, s[4:7], s44 offen offset:3072 sc1 lds
L_gd_198:
v_rsq_f32 v71, v71
v_sub_f32 v72, v72, v88
v_sub_f32 v73, v73, v88
v_sub_f32 v74, v74, v88
v_sub_f32 v75, v75, v88
s_cbranch_vccz L_gd_199
s_add_u32 m0, s80, 4096
s_add_u32 s44, s77, 4096
buffer_load_dwordx4 v2, s[4:7], s44 offen offset:1024 sc1 lds
L_gd_199:
v_mul_f32 v72, v72, v71
v_mul_f32 v73, v73, v71
v_mul_f32 v74, v74, v71
v_mul_f32 v75, v75, v71
v_cvt_pk_bf16_f32 v88, v72, v73
s_cbranch_vccz L_gd_200
s_add_u32 m0, s80, 4096
s_add_u32 s44, s77, 4096
buffer_load_dwordx4 v2, s[4:7], s44 offen offset:3072 sc1 lds
L_gd_200:
v_cvt_pk_bf16_f32 v89, v74, v75
buffer_store_dwordx2 v[88:89], v7, s[4:7], s30 offen sc1
buffer_store_dwordx2 v[64:65], v6, s[4:7], s29 offen sc1
s_mov_b32 s76, s31
s_branch L_ffn_adv_G
L_ffn_fin_G:
s_cbranch_vccz L_gd_206
s_add_u32 m0, s80, 0
s_add_u32 s44, s77, 0
buffer_load_dwordx4 v2, s[4:7], s44 offen offset:0 sc1 lds
s_add_u32 m0, s80, 0
s_add_u32 s44, s77, 0
buffer_load_dwordx4 v2, s[4:7], s44 offen offset:2048 sc1 lds
s_add_u32 m0, s80, 4096
s_add_u32 s44, s77, 4096
buffer_load_dwordx4 v2, s[4:7], s44 offen offset:0 sc1 lds
s_add_u32 m0, s80, 4096
s_add_u32 s44, s77, 4096
buffer_load_dwordx4 v2, s[4:7], s44 offen offset:2048 sc1 lds
s_add_u32 m0, s80, 0
s_add_u32 s44, s77, 0
buffer_load_dwordx4 v2, s[4:7], s44 offen offset:1024 sc1 lds
s_add_u32 m0, s80, 0
s_add_u32 s44, s77, 0
buffer_load_dwordx4 v2, s[4:7], s44 offen offset:3072 sc1 lds
s_add_u32 m0, s80, 4096
s_add_u32 s44, s77, 4096
buffer_load_dwordx4 v2, s[4:7], s44 offen offset:1024 sc1 lds
s_add_u32 m0, s80, 4096
s_add_u32 s44, s77, 4096
buffer_load_dwordx4 v2, s[4:7], s44 offen offset:3072 sc1 lds
L_gd_206:
buffer_store_dwordx2 v[64:65], v6, s[16:19], s29 offen
L_ffn_adv_G:
s_xor_b32 s39, s39, 524288
s_add_u32 s28, s28, 65536
s_add_u32 s29, s29, 65536
s_add_u32 s30, s30, 65536
s_add_u32 s31, s31, 1024
s_add_u32 s37, s37, 2
s_bfe_u32 s101, s37, 0x10002
s_cmp_lt_u32 s37, 64
s_cbranch_scc1 L_ffn_loop_G
s_waitcnt vmcnt(0)
s_cmp_eq_u32 s76, 0
s_cbranch_scc1 L_np_207
s_mov_b64 exec, 3
buffer_store_dword v9, v2, s[4:7], s76 offen sc1
s_mov_b64 exec, -1
s_mov_b32 s76, 0
L_np_207:
s_endpgm
L_pf_187:
s_waitcnt vmcnt(2)
s_cmp_eq_u32 s38, 0
s_cbranch_scc1 L_pz_208w
s_waitcnt vmcnt(1)
L_pz_208w:
v_cmp_eq_u32 vcc, 0, v25
s_cmp_lt_u32 s37, 2
s_cselect_b64 vcc, -1, vcc
s_cbranch_vccz L_pz_208
s_waitcnt vmcnt(0)
s_cmp_eq_u32 s76, 0
s_cbranch_scc1 L_np_211
s_mov_b64 exec, 3
buffer_store_dword v9, v2, s[4:7], s76 offen sc1
s_mov_b64 exec, -1
s_mov_b32 s76, 0
L_np_211:
L_sp_209:
v_cmp_eq_u32 vcc, 0, v25
s_cbranch_vccz L_spo_210
s_sub_u32 s36, s36, 1
s_cbranch_scc1 L_end_ffn_G
buffer_load_dword v25, v24, s[4:7], s78 offen sc1
s_waitcnt vmcnt(0)
s_branch L_sp_209
L_spo_210:
L_pz_208:
s_add_u32 m0, s80, 0
s_add_u32 s44, s77, 0
buffer_load_dwordx4 v2, s[4:7], s44 offen offset:0 sc1 lds
s_add_u32 m0, s80, 0
s_add_u32 s44, s77, 0
buffer_load_dwordx4 v2, s[4:7], s44 offen offset:2048 sc1 lds
s_add_u32 m0, s80, 4096
s_add_u32 s44, s77, 4096
buffer_load_dwordx4 v2, s[4:7], s44 offen offset:0 sc1 lds
s_add_u32 m0, s80, 4096
s_add_u32 s44, s77, 4096
buffer_load_dwordx4 v2, s[4:7], s44 offen offset:2048 sc1 lds
s_add_u32 m0, s80, 0
s_add_u32 s44, s77, 0
buffer_load_dwordx4 v2, s[4:7], s44 offen offset:1024 sc1 lds
s_add_u32 m0, s80, 0
s_add_u32 s44, s77, 0
buffer_load_dwordx4 v2, s[4:7], s44 offen offset:3072 sc1 lds
s_add_u32 m0, s80, 4096
s_add_u32 s44, s77, 4096
buffer_load_dwordx4 v2, s[4:7], s44 offen offset:1024 sc1 lds
s_add_u32 m0, s80, 4096
s_add_u32 s44, s77, 4096
buffer_load_dwordx4 v2, s[4:7], s44 offen offset:3072 sc1 lds
s_waitcnt vmcnt(4)
s_branch L_pfo_188
L_rea_203:
s_sub_u32 s36, s36, 1
s_cbranch_scc1 L_end_ffn_G
s_add_u32 s43, s39, 0
buffer_load_dwordx4 v[88:91], v5, s[4:7], s43 offen sc1
s_add_u32 s43, s39, 4096
buffer_load_dwordx4 v[92:95], v5, s[4:7], s43 offen sc1
s_add_u32 s43, s39, 8192
buffer_load_dwordx4 v[96:99], v5, s[4:7], s43 offen sc1
s_add_u32 s43, s39, 12288
buffer_load_dwordx4 v[100:103], v5, s[4:7], s43 offen sc1
s_waitcnt vmcnt(0)
s_branch L_rea2_204
L_red_201:
s_sub_u32 s36, s36, 1
s_cbranch_scc1 L_end_ffn_G
s_add_u32 s43, s39, 0
buffer_load_dwordx4 v[104:107], v0, s[4:7], s43 offen sc1
s_add_u32 s43, s39, 4096
buffer_load_dwordx4 v[108:111], v0, s[4:7], s43 offen sc1
s_add_u32 s43, s39, 8192
buffer_load_dwordx4 v[112:115], v0, s[4:7], s43 offen sc1
s_add_u32 s43, s39, 12288
buffer_load_dwordx4 v[116:119], v0, s[4:7], s43 offen sc1
s_waitcnt vmcnt(0)
s_branch L_red2_202
L_end_ffn_G:
s_endpgm
.section .rodata,"a"
.p2align 6
.amdhsa_kernel interleave_layers__memory_aug_recurrent_mem_tr__glu_gated_swiglu__prompt_kernel
.amdhsa_next_free_vgpr 512
.amdhsa_next_free_sgpr 102
.amdhsa_accum_offset 256
.amdhsa_group_segment_fixed_size 0
.amdhsa_kernarg_size 112
.amdhsa_user_sgpr_count 2
.amdhsa_user_sgpr_kernarg_segment_ptr 1
.amdhsa_system_sgpr_workgroup_id_x 1
.end_amdhsa_kernel
```
